```python
import torch

def _softmax(x, axis=-1):
    return torch.softmax(x, dim=axis)

def _gelu(x):
    return torch.nn.functional.gelu(x, approximate='tanh')

def _silu(x):
    return torch.nn.functional.silu(x)

def _sigmoid(x):
    return torch.sigmoid(x)

def _layernorm(x, axis=-1, eps=1e-05):
    m = x.mean(dim=axis, keepdim=True)
    v = x.var(dim=axis, keepdim=True, unbiased=False)
    return (x - m) / torch.sqrt(v + eps)

def _scatter_add(tgt, idx, src, axis=0):
    return tgt.clone().index_add_(axis, idx, src)

def _segment_sum(src, seg, n):
    out = torch.zeros((n,) + src.shape[1:], dtype=src.dtype)
    return out.index_add_(0, seg, src)

def _pad(x, pw):
    flat = tuple((v for pair in reversed(pw) for v in pair))
    return torch.nn.functional.pad(x, flat)
kernel_name = 'gated_mix__compressed_kv_cla__mixer_gmlp__prompt'

def setup_inputs():

    _w = lambda a: (lambda t: t.to(torch.bfloat16) if t.is_floating_point() else t)(torch.as_tensor(a))

    def _A_setup():
        B, H, Sq, Sk, D, M = (1, 16, 2048, 2048, 256, 448)
        Dc = 4 * D
        return {'x': _w((lambda *s: torch.randn(*s, dtype=torch.bfloat16) * 0.05)(B, Sq, M)), 'c_kv': _w((lambda *s: torch.randn(*s, dtype=torch.bfloat16) * 0.8)(B, Sk, Dc)), 'w_q': _w((lambda *s: torch.randn(*s, dtype=torch.bfloat16) * 6.4)(M, H, D) * M ** (-0.5)), 'w_uk': _w((lambda *s: torch.randn(*s, dtype=torch.bfloat16) * 6.4)(Dc, H, D) * Dc ** (-0.5)), 'w_uv': _w((lambda *s: torch.randn(*s, dtype=torch.bfloat16) * 0.8)(Dc, H, D) * Dc ** (-0.5)), 'w_o': _w((lambda *s: torch.randn(*s, dtype=torch.bfloat16) * 0.8)(H, D, M) * (H * D) ** (-0.5))}
    _A_in = _A_setup()

    def _B_setup():
        B, S, D, F = (1, 2048, 448, 1792)
        Fh = F // 2
        return {'x': _w((lambda *s: torch.randn(*s, dtype=torch.bfloat16) * 0.05)(B, S, D)), 'w_in': _w((lambda *s: torch.randn(*s, dtype=torch.bfloat16) * 0.4)(D, 2 * Fh)), 'w_sp': _w(0.01 * (lambda *s: torch.randn(*s, dtype=torch.bfloat16) * 0.4)(S, S)), 'b_sp': _w(1.0 + 0.01 * (lambda *s: torch.randn(*s, dtype=torch.bfloat16) * 0.05)(S)), 'w_out': _w((lambda *s: torch.randn(*s, dtype=torch.bfloat16) * 0.05)(Fh, D))}
    _B_in = _B_setup()
    return {'A_x': _A_in['x'], 'A_c_kv': _A_in['c_kv'], 'A_w_q': _A_in['w_q'], 'A_w_uk': _A_in['w_uk'], 'A_w_uv': _A_in['w_uv'], 'A_w_o': _A_in['w_o'], 'B_x': _B_in['x'], 'B_w_in': _B_in['w_in'], 'B_w_sp': _B_in['w_sp'], 'B_b_sp': _B_in['b_sp'], 'B_w_out': _B_in['w_out'], 'gate_w': _w((lambda *s: torch.randn(*s, dtype=torch.bfloat16) * 0.05)(448) * 16.0)}

def reference(A_x, A_c_kv, A_w_q, A_w_uk, A_w_uv, A_w_o, B_x, B_w_in, B_w_sp, B_b_sp, B_w_out, gate_w):

    def _A_ref(x, c_kv, w_q, w_uk, w_uv, w_o):
        B, Sq, M = (x.shape[0], x.shape[1], x.shape[2])
        Sk = c_kv.shape[1]
        H, D = (w_q.shape[1], w_q.shape[2])
        q = torch.einsum('bqm,mhd->bhqd', x, w_q)
        k = torch.einsum('bkc,chd->bhkd', c_kv, w_uk)
        v = torch.einsum('bkc,chd->bhkd', c_kv, w_uv)
        scores = torch.einsum('bhqd,bhkd->bhqk', q, k) * D ** (-0.5)
        off = Sk - Sq
        qi = torch.arange(Sq)[:, None]
        kj = torch.arange(Sk)[None, :]
        cmask = kj <= qi + off
        scores = torch.where(cmask[None, None], scores, -1000000000.0)
        p = _softmax(scores, axis=-1)
        ctx = torch.einsum('bhqk,bhkd->bhqd', p, v)
        return torch.einsum('bhqd,hdm->bqm', ctx, w_o)

    def _B_ref(x, w_in, w_sp, b_sp, w_out):
        B, S, D = x.shape
        F = w_in.shape[-1]
        Fh = F // 2
        z = _gelu(torch.einsum('bsd,df->bsf', x, w_in))
        z1 = z[..., :Fh].clone()
        z2 = _layernorm(z[..., Fh:], axis=-1)
        g = torch.einsum('ts,bsf->btf', w_sp, z2) + b_sp[None, :, None]
        return torch.einsum('bsf,fd->bsd', z1 * g, w_out)
    x = A_x
    g = _sigmoid((x * gate_w).sum(-1, keepdims=True))
    a = _A_ref(x, A_c_kv, A_w_q, A_w_uk, A_w_uv, A_w_o)
    b = _B_ref(x, B_w_in, B_w_sp, B_b_sp, B_w_out)
    return g * a + (1 - g) * b
```

```asm
; @launch grid=(256,1,1) block=(256,1,1) lds=163840
.amdgcn_target "amdgcn-amd-amdhsa--gfx950"

.macro mA d,a,b
v_mfma_f32_16x16x32_bf16 a[\d:\d+3], v[\a:\a+3], v[\b:\b+3], a[\d:\d+3]
.endm
.macro mV d,a,b
v_mfma_f32_16x16x32_bf16 v[\d:\d+3], v[\a:\a+3], v[\b:\b+3], v[\d:\d+3]
.endm
.macro mAz d,a,b
v_mfma_f32_16x16x32_bf16 a[\d:\d+3], v[\a:\a+3], v[\b:\b+3], 0
.endm
.macro mVz d,a,b
v_mfma_f32_16x16x32_bf16 v[\d:\d+3], v[\a:\a+3], v[\b:\b+3], 0
.endm
.macro rB d,a,o
ds_read_b128 v[\d:\d+3], v\a offset:\o
.endm
.macro rT d,a,o
ds_read_b64_tr_b16 v[\d:\d+1], v\a offset:\o
.endm
.macro aR d,a
v_accvgpr_read_b32 v\d, a\a
.endm
.macro aW d,a
v_accvgpr_write_b32 a\d, v\a
.endm
.macro cP d,a,b
v_cvt_pk_bf16_f32 v\d, v\a, v\b
.endm
.macro dS v,s,f,o
buffer_load_dwordx4 v\v, s[\s:\s+3], s\f offen offset:\o sc1 lds
.endm
.macro dL v,s,f,o
buffer_load_dwordx4 v\v, s[\s:\s+3], s\f offen offset:\o lds
.endm

.text
.globl gated_mix__compressed_kv_cla__mixer_gmlp__prompt_kernel
.p2align 8
.type gated_mix__compressed_kv_cla__mixer_gmlp__prompt_kernel,@function
gated_mix__compressed_kv_cla__mixer_gmlp__prompt_kernel:
s_cmp_lt_u32 s2, 256
s_cbranch_scc1 gated_mix__compressed_kv_cla__mixer_gmlp__prompt_kernel_go
s_endpgm
gated_mix__compressed_kv_cla__mixer_gmlp__prompt_kernel_go:
s_load_dwordx16 s[20:35], s[0:1], 0
s_load_dwordx8 s[36:43], s[0:1], 64
s_load_dwordx4 s[44:47], s[0:1], 96
s_load_dwordx2 s[48:49], s[0:1], 112
v_lshrrev_b32 v2, 6, v0
v_and_b32 v1, 63, v0
v_readfirstlane_b32 s3, v2
s_nop 2
s_getpc_b64 s[96:97]
s_add_u32 s96, s96, gated_mix__compressed_kv_cla__mixer_gmlp__prompt_kernel@rel32@lo+4
s_addc_u32 s97, s97, gated_mix__compressed_kv_cla__mixer_gmlp__prompt_kernel@rel32@hi+12
s_mov_b32 s98, gated_mix__compressed_kv_cla__mixer_gmlp__prompt_kernel_stop-gated_mix__compressed_kv_cla__mixer_gmlp__prompt_kernel
s_mov_b32 s99, 0x20000
s_lshr_b32 s100, s2, 3
s_lshl_b32 s100, s100, 2
s_add_u32 s100, s100, s3
s_lshl_b32 s100, s100, 13
v_lshlrev_b32 v255, 7, v1
buffer_load_dword v255, v255, s[96:99], s100 offen
s_waitcnt lgkmcnt(0)
s_getpc_b64 s[76:77]
s_add_u32 s76, s76, mega_jt@rel32@lo+4
s_addc_u32 s77, s77, mega_jt@rel32@hi+12
s_lshl_b32 s100, s2, 6
s_add_u32 s76, s76, s100
s_addc_u32 s77, s77, 0
s_load_dwordx2 s[94:95], s[76:77], 56
s_load_dword s51, s[76:77], 52
s_mov_b32 s12, s48
s_mov_b32 s13, s49
s_mov_b32 s14, 268435456
s_mov_b32 s15, 0x20000
s_mov_b32 s4, s20
s_mov_b32 s5, s21
s_mov_b32 s6, 1835008
s_mov_b32 s7, 0x20000
s_mov_b32 s8, s34
s_mov_b32 s9, s35
s_mov_b32 s10, 1605632
s_mov_b32 s11, 0x20000
s_mov_b32 s16, s22
s_mov_b32 s17, s23
s_mov_b32 s18, 4194304
s_mov_b32 s19, 0x20000
s_mov_b32 s60, s46
s_mov_b32 s61, s47
s_mov_b32 s62, 256
s_mov_b32 s63, 0x20000
s_and_b32 s64, s2, 7
s_lshr_b32 s65, s2, 3
s_and_b32 s66, s65, 7
s_lshr_b32 s68, s65, 3
s_and_b32 s67, s68, 1
s_lshl_b32 s69, s66, 1
s_add_u32 s69, s69, s67
s_lshl_b32 s100, s64, 1
s_add_u32 s67, s67, s100
s_cmp_ge_u32 s68, 2
s_cbranch_scc1 L1_V
s_mov_b32 s74, s30
s_mov_b32 s75, s31
s_mov_b32 s78, s40
s_mov_b32 s79, s41
s_mov_b32 s52, s26
s_mov_b32 s53, s27
s_mov_b32 s54, 8388608
s_mov_b32 s55, 0x20000
s_mov_b32 s56, s24
s_mov_b32 s57, s25
s_mov_b32 s58, 3670016
s_mov_b32 s59, 0x20000
s_mov_b32 s40, s42
s_mov_b32 s41, s43
s_mov_b32 s42, 896
s_mov_b32 s43, 0x20000
s_mov_b32 s44, s36
s_mov_b32 s45, s37
s_mov_b32 s46, 8388608
s_mov_b32 s47, 0x20000
s_lshr_b32 s71, s3, 1
s_and_b32 s72, s3, 1
s_lshl_b32 s27, s66, 19
s_lshl_b32 s29, s67, 9
s_lshl_b32 s73, s72, 7
s_lshl_b32 s35, s71, 3
s_mul_i32 s26, s3, 131072
s_add_u32 s27, s27, s26
s_mul_i32 s26, s3, 8192
v_lshrrev_b32 v240, 3, v1
v_mul_u32_u24 v240, 2048, v240
v_bfe_u32 v242, v1, 4, 2
v_and_b32 v241, 7, v1
v_xor_b32 v241, v241, v242
v_lshl_add_u32 v240, v241, 4, v240
v_add_u32 v21, 0, v240
v_xor_b32 v22, 64, v240
v_add_u32 v22, 15360, v22
v_add_u32 v23, 30720, v240
v_add_u32 v24, 30720, v22
v_add_u32 v25, 65536, v240
v_add_u32 v26, 65536, v22
v_add_u32 v27, 96256, v240
v_add_u32 v28, 96256, v22
s_mov_b32 s25, 65536
s_mul_i32 s28, s3, 65536
s_add_u32 s29, s29, s28
s_mul_i32 s28, s3, 4096
v_lshrrev_b32 v240, 5, v1
v_and_b32 v241, 31, v1
v_lshlrev_b32 v242, 1, v240
v_xor_b32 v241, v241, v242
s_and_b32 s101, s3, 1
s_lshl_b32 s101, s101, 3
v_xor_b32 v241, s101, v241
v_lshlrev_b32 v241, 4, v241
v_mul_u32_u24 v240, 8192, v240
v_add_u32 v31, v241, v240
v_xor_b32 v32, 64, v241
v_add_u32 v32, v32, v240
v_add_u32 v32, 15360, v32
v_add_u32 v33, v241, v240
v_add_u32 v33, 30720, v33
v_xor_b32 v34, 64, v241
v_add_u32 v34, v34, v240
v_add_u32 v34, 46080, v34
s_add_u32 s100, s26, s25
s_add_u32 m0, s100, 0
s_nop 0
dL 21,16,27,0
dL 22,16,27,1024
dL 23,16,27,2048
dL 24,16,27,3072
s_add_u32 s100, s26, s25
s_add_u32 m0, s100, 4096
s_nop 0
dL 25,16,27,0
dL 26,16,27,1024
dL 27,16,27,2048
dL 28,16,27,3072
s_add_u32 s27, s27, 128
s_add_u32 s25, s25, 32768
s_cmp_lt_u32 s25, 98304
s_cselect_b32 s25, s25, 0
s_add_u32 m0, s28, 147456
s_nop 0
dL 31,52,29,0
dL 32,52,29,1024
dL 33,52,29,2048
dL 34,52,29,3072
s_add_u32 s29, s29, 262144
s_add_u32 m0, s28, 98304
s_nop 0
dL 31,52,29,0
dL 32,52,29,1024
dL 33,52,29,2048
dL 34,52,29,3072
s_add_u32 s29, s29, 262144
v_lshlrev_b32 v0, 4, v1
v_lshl_add_u32 v244, s3, 10, v0
v_cmp_gt_u32 vcc, 256, v244
v_mov_b32 v245, 2147483648
s_lshl_b32 s101, s2, 8
v_cndmask_b32 v244, v245, v244, vcc
v_mov_b32 v245, 0
s_add_u32 s101, s101, 80216064
buffer_store_dword v245, v244, s[12:15], s101 offen sc1
s_add_u32 m0, s28, 114688
s_nop 0
dL 31,52,29,0
dL 32,52,29,1024
dL 33,52,29,2048
dL 34,52,29,3072
s_add_u32 s29, s29, 262144
s_add_u32 s100, s26, s25
s_add_u32 m0, s100, 0
s_nop 0
dL 21,16,27,0
dL 22,16,27,1024
dL 23,16,27,2048
dL 24,16,27,3072
s_add_u32 s100, s26, s25
s_add_u32 m0, s100, 4096
s_nop 0
dL 25,16,27,0
dL 26,16,27,1024
dL 27,16,27,2048
dL 28,16,27,3072
s_add_u32 s27, s27, 128
s_add_u32 s25, s25, 32768
s_cmp_lt_u32 s25, 98304
s_cselect_b32 s25, s25, 0
v_and_b32 v240, 15, v1
v_lshrrev_b32 v241, 1, v240
v_lshrrev_b32 v242, 4, v1
v_xor_b32 v241, v241, v242
v_add_u32 v240, s73, v240
v_lshlrev_b32 v240, 7, v240
v_lshl_add_u32 v29, v241, 4, v240
v_mov_b32 v20, v29
s_mov_b32 s24, 65536
v_add_u32 v29, s24, v20
v_xor_b32 v30, 64, v29
v_lshrrev_b32 v240, 4, v1
v_bfe_u32 v241, v1, 2, 2
v_lshl_add_u32 v242, v240, 3, v241
v_and_b32 v240, 1, v240
v_lshl_add_u32 v240, v240, 2, v241
v_lshrrev_b32 v240, 0, v240
v_lshlrev_b32 v240, 5, v240
v_mul_u32_u24 v242, 512, v242
v_and_b32 v241, 3, v1
v_lshl_add_u32 v242, v241, 3, v242
v_add_u32 v242, 98304, v242
s_lshl_b32 s101, s35, 5
v_xad_u32 v35, s101, v240, v242
s_add_u32 s101, s101, 32
v_xad_u32 v36, s101, v240, v242
s_add_u32 s101, s101, 32
v_xad_u32 v37, s101, v240, v242
s_add_u32 s101, s101, 32
v_xad_u32 v38, s101, v240, v242
s_add_u32 s101, s101, 32
v_xad_u32 v39, s101, v240, v242
s_add_u32 s101, s101, 32
v_xad_u32 v40, s101, v240, v242
s_add_u32 s101, s101, 32
v_xad_u32 v41, s101, v240, v242
s_add_u32 s101, s101, 32
v_xad_u32 v42, s101, v240, v242
s_add_u32 s101, s101, 32
v_lshl_add_u32 v60, s3, 6, v1
v_cmp_eq_u32 vcc, 0, v60
v_mov_b32 v60, 2147483648
s_nop 0
v_cndmask_b32 v60, v60, 0, vcc
s_getreg_b32 s93, hwreg(HW_REG_XCC_ID, 0, 4)
s_mul_i32 s92, s93, s93
s_lshl_b32 s92, s92, 8
s_add_u32 s93, s93, s92
s_lshl_b32 s93, s93, 8
s_add_u32 s93, s93, 1
v_mov_b32 v61, s93
s_lshl_b32 s93, s93, 5
s_lshr_b32 s77, s65, 2
s_lshl_b32 s76, s64, 2
s_waitcnt vmcnt(13)
s_barrier
rT 64,35,49152
rT 66,35,51200
rT 68,36,49152
rT 70,36,51200
rT 72,37,49152
rT 74,37,51200
rT 76,38,49152
rT 78,38,51200
rT 80,39,49152
rT 82,39,51200
rT 84,40,49152
rT 86,40,51200
rT 88,41,49152
rT 90,41,51200
rT 92,42,49152
rT 94,42,51200
rB 96,29,0
rB 100,29,2048
rB 104,29,4096
rB 108,29,6144
rB 112,29,8192
rB 116,29,10240
rB 120,29,12288
rB 124,29,14336
s_waitcnt lgkmcnt(0)
s_barrier
mAz 0,64,96
rT 128,35,0
s_add_u32 m0, s28, 131072
mAz 32,68,96
rT 130,35,2048
mAz 36,68,100
mAz 4,64,100
rT 132,36,0
mAz 8,64,104
mAz 40,68,104
rT 134,36,2048
mAz 44,68,108
rT 136,37,0
mAz 12,64,108
mAz 16,64,112
rT 138,37,2048
mAz 48,68,112
mAz 52,68,116
rT 140,38,0
mAz 20,64,116
dL 31,52,29,0
mAz 24,64,120
rT 142,38,2048
mAz 56,68,120
rT 144,39,0
mAz 60,68,124
mAz 28,64,124
rT 146,39,2048
mAz 92,72,124
rT 148,40,0
mAz 124,76,124
mAz 120,76,120
rT 150,40,2048
mAz 88,72,120
mAz 84,72,116
rT 152,41,0
mAz 116,76,116
dL 32,52,29,1024
mAz 112,76,112
rT 154,41,2048
mAz 80,72,112
rT 156,42,0
mAz 76,72,108
mAz 108,76,108
rT 158,42,2048
mAz 104,76,104
rB 160,30,0
mAz 72,72,104
mAz 68,72,100
rB 164,30,2048
mAz 100,76,100
mAz 96,76,96
rB 168,30,4096
mAz 64,72,96
dL 33,52,29,2048
mAz 128,80,96
rB 172,30,6144
mAz 160,84,96
rB 176,30,8192
mAz 164,84,100
mAz 132,80,100
rB 180,30,10240
mAz 136,80,104
rB 184,30,12288
mAz 168,84,104
mAz 172,84,108
rB 188,30,14336
mAz 140,80,108
mAz 144,80,112
s_add_u32 s24, s24, 32768
s_cmp_lt_u32 s24, 98304
s_cselect_b32 s24, s24, 0
mAz 176,84,112
dL 34,52,29,3072
mAz 180,84,116
v_add_u32 v29, s24, v20
mAz 148,80,116
v_xor_b32 v30, 64, v29
mAz 152,80,120
mAz 184,84,120
mAz 188,84,124
mAz 156,80,124
mAz 220,88,124
mAz 252,92,124
mAz 248,92,120
s_add_u32 s29, s29, 262144
mAz 216,88,120
s_waitcnt lgkmcnt(0)
s_waitcnt vmcnt(4)
s_barrier
mAz 212,88,116
mAz 244,92,116
mAz 240,92,112
mAz 208,88,112
mAz 204,88,108
mAz 236,92,108
mAz 232,92,104
mAz 200,88,104
mAz 196,88,100
mAz 228,92,100
mAz 224,92,96
mAz 192,88,96
mA 0,128,160
rT 64,35,16384
mA 32,132,160
s_add_u32 s100, s26, s25
s_add_u32 m0, s100, 0
s_lshl_b32 s70, s2, 3
mA 36,132,164
rT 66,35,18432
s_lshl_b32 s101, s3, 1
mA 4,128,164
rT 68,36,16384
mA 8,128,168
mA 40,132,168
dL 21,16,27,0
mA 44,132,172
s_add_u32 s70, s70, s101
rT 70,36,18432
mA 12,128,172
rT 72,37,16384
mA 16,128,176
s_add_u32 s70, s70, 0
mA 48,132,176
rT 74,37,18432
mA 52,132,180
dL 22,16,27,1024
mA 20,128,180
s_mul_i32 s101, s70, 896
rT 76,38,16384
mA 24,128,184
mA 56,132,184
rT 78,38,18432
v_lshlrev_b32 v236, 4, v1
mA 60,132,188
mA 28,128,188
rT 80,39,16384
mA 92,136,188
dL 23,16,27,2048
mA 124,140,188
v_mov_b32 v238, 2147483648
mA 120,140,184
rT 82,39,18432
rT 84,40,16384
mA 88,136,184
v_cmp_gt_u32 vcc, 56, v1
mA 84,136,180
dL 24,16,27,3072
mA 116,140,180
rT 86,40,18432
v_cndmask_b32 v236, v238, v236, vcc
mA 112,140,176
rT 88,41,16384
mA 80,136,176
mA 76,136,172
buffer_load_dwordx4 v[232:235], v236, s[40:43], 0 offen
mA 108,140,172
rT 90,41,18432
mA 104,140,168
s_add_u32 s100, s26, s25
s_add_u32 m0, s100, 4096
rT 92,42,16384
mA 72,136,168
buffer_load_dwordx4 v[224:227], v236, s[4:7], s101 offen
mA 68,136,164
rT 94,42,18432
mA 100,140,164
buffer_load_dwordx4 v[228:231], v236, s[4:7], s101 offen offset:896
mA 96,140,160
rB 96,29,0
mA 64,136,160
dL 25,16,27,0
mA 128,144,160
rB 100,29,2048
s_lshl_b32 s70, s70, 2
mA 160,148,160
rB 104,29,4096
mA 164,148,164
mA 132,144,164
s_add_u32 s70, s70, 79953920
dL 26,16,27,1024
mA 136,144,168
rB 108,29,6144
mA 168,148,168
rB 112,29,8192
mA 172,148,172
mA 140,144,172
rB 116,29,10240
mA 144,144,176
dL 27,16,27,2048
mA 176,148,176
rB 120,29,12288
mA 180,148,180
mA 148,144,180
rB 124,29,14336
mA 152,144,184
mA 184,148,184
dL 28,16,27,3072
mA 188,148,188
mA 156,144,188
mA 220,152,188
mA 252,156,188
mA 248,156,184
s_add_u32 s27, s27, 128
mA 216,152,184
s_waitcnt lgkmcnt(0)
s_waitcnt vmcnt(11)
s_barrier
mA 212,152,180
mA 244,156,180
mA 240,156,176
mA 208,152,176
s_add_u32 s25, s25, 32768
s_cmp_lt_u32 s25, 98304
s_cselect_b32 s25, s25, 0
mA 204,152,172
mA 236,156,172
mA 232,156,168
mA 200,152,168
mA 196,152,164
mA 228,156,164
mA 224,156,160
mA 192,152,160
mA 0,64,96
rT 128,35,32768
s_add_u32 m0, s28, 147456
mA 32,68,96
s_mul_i32 s31, s95, 114688
s_lshl_b32 s33, s94, 9
s_lshl_b32 s73, s72, 6
mA 36,68,100
rT 130,35,34816
s_mul_i32 s30, s3, 28672
mA 4,64,100
dL 31,52,29,0
mA 8,64,104
s_add_u32 s31, s31, s30
rT 132,36,32768
s_mul_i32 s30, s3, 4096
mA 40,68,104
v_lshrrev_b32 v248, 3, v1
mA 44,68,108
rT 134,36,34816
mA 12,64,108
dL 32,52,29,1024
mA 16,64,112
v_mul_u32_u24 v248, 896, v248
v_bfe_u32 v250, v1, 4, 2
mA 48,68,112
rT 136,37,32768
v_and_b32 v249, 7, v1
mA 52,68,116
dL 33,52,29,2048
mA 20,64,116
v_xor_b32 v249, v249, v250
mA 24,64,120
rT 138,37,34816
v_lshl_add_u32 v248, v249, 4, v248
mA 56,68,120
v_add_u32 v2, 0, v248
mA 60,68,124
rT 140,38,32768
mA 28,64,124
dL 34,52,29,3072
mA 92,72,124
v_xor_b32 v3, 64, v248
v_add_u32 v3, 6144, v3
mA 124,76,124
rT 142,38,34816
v_add_u32 v4, 12288, v248
mA 120,76,120
v_add_u32 v5, 12288, v3
s_add_u32 s29, s29, 262144
mA 88,72,120
rT 144,39,32768
v_and_b32 v248, 15, v1
mA 84,72,116
v_lshrrev_b32 v249, 1, v248
mA 116,76,116
rT 146,39,34816
v_lshrrev_b32 v250, 4, v1
mA 112,76,112
s_add_u32 s100, s26, s25
s_add_u32 m0, s100, 0
v_xor_b32 v249, v249, v250
mA 80,72,112
rT 148,40,32768
v_add_u32 v248, s73, v248
mA 76,72,108
v_lshlrev_b32 v248, 7, v248
mA 108,76,108
rT 150,40,34816
mA 104,76,104
dL 21,16,27,0
mA 72,72,104
v_lshl_add_u32 v6, v249, 4, v248
v_xor_b32 v7, 64, v6
mA 68,72,100
rT 152,41,32768
s_lshl_b32 s73, s71, 3
mA 100,76,100
dL 22,16,27,1024
mA 96,76,96
s_mul_i32 s32, s3, 65536
rT 154,41,34816
s_add_u32 s33, s33, s32
mA 64,72,96
s_mul_i32 s32, s3, 4096
rT 156,42,32768
mA 128,80,96
dL 23,16,27,2048
mA 160,84,96
v_lshrrev_b32 v248, 5, v1
v_and_b32 v249, 31, v1
mA 164,84,100
rT 158,42,34816
v_lshlrev_b32 v250, 1, v248
mA 132,80,100
v_xor_b32 v249, v249, v250
mA 136,80,104
dL 24,16,27,3072
mA 168,84,104
rB 160,30,0
s_and_b32 s101, s3, 1
mA 172,84,108
s_lshl_b32 s101, s101, 3
rB 164,30,2048
v_xor_b32 v249, s101, v249
mA 140,80,108
s_add_u32 m0, s28, 98304
v_lshlrev_b32 v249, 4, v249
mA 144,80,112
rB 168,30,4096
v_mul_u32_u24 v248, 8192, v248
mA 176,84,112
v_add_u32 v8, v249, v248
mA 180,84,116
dL 31,52,29,0
mA 148,80,116
rB 172,30,6144
v_xor_b32 v9, 64, v249
mA 152,80,120
v_add_u32 v9, v9, v248
mA 184,84,120
rB 176,30,8192
v_add_u32 v9, 15360, v9
mA 188,84,124
dL 32,52,29,1024
mA 156,80,124
v_add_u32 v10, v249, v248
mA 220,88,124
rB 180,30,10240
v_add_u32 v10, 30720, v10
mA 252,92,124
v_xor_b32 v11, 64, v249
mA 248,92,120
rB 184,30,12288
v_add_u32 v11, v11, v248
mA 216,88,120
dL 33,52,29,2048
mA 212,88,116
v_add_u32 v11, 46080, v11
mA 244,92,116
rB 188,30,14336
v_lshrrev_b32 v248, 4, v1
mA 240,92,112
v_bfe_u32 v249, v1, 2, 2
mA 208,88,112
dL 34,52,29,3072
mA 204,88,108
s_add_u32 s24, s24, 32768
s_cmp_lt_u32 s24, 98304
s_cselect_b32 s24, s24, 0
mA 236,92,108
v_lshl_add_u32 v250, v248, 3, v249
v_and_b32 v248, 1, v248
mA 232,92,104
v_add_u32 v29, s24, v20
v_lshl_add_u32 v248, v248, 2, v249
mA 200,88,104
s_add_u32 s29, s29, 262144
v_lshrrev_b32 v248, 0, v248
v_lshlrev_b32 v248, 5, v248
mA 196,88,100
v_xor_b32 v30, 64, v29
v_mul_u32_u24 v250, 512, v250
mA 228,92,100
s_add_u32 m0, s28, 114688
v_and_b32 v249, 3, v1
v_lshl_add_u32 v250, v249, 3, v250
mA 224,92,96
v_add_u32 v250, 65536, v250
mA 192,88,96
dL 31,52,29,0
s_lshl_b32 s101, s73, 5
v_xad_u32 v12, s101, v248, v250
s_add_u32 s101, s101, 32
v_xad_u32 v13, s101, v248, v250
s_add_u32 s101, s101, 32
v_xad_u32 v14, s101, v248, v250
s_add_u32 s101, s101, 32
dL 32,52,29,1024
v_xad_u32 v15, s101, v248, v250
s_add_u32 s101, s101, 32
s_waitcnt lgkmcnt(0)
s_waitcnt vmcnt(10)
s_barrier
v_xad_u32 v16, s101, v248, v250
s_add_u32 s101, s101, 32
v_xad_u32 v17, s101, v248, v250
s_add_u32 s101, s101, 32
dL 33,52,29,2048
v_xad_u32 v18, s101, v248, v250
s_add_u32 s101, s101, 32
v_xad_u32 v19, s101, v248, v250
s_add_u32 s101, s101, 32
dL 34,52,29,3072
s_cmp_eq_u32 s77, 0
s_cselect_b32 s92, s76, 0x40000000
buffer_atomic_add v61, v60, s[60:63], s92 offen offset:128
s_add_u32 s29, s29, 262144
s_lshl_b32 s35, s2, 14
s_sub_u32 s101, s3, 0
s_lshl_b32 s101, s101, 13
s_add_u32 s35, s35, s101
s_cmp_lt_u32 s101, 16384
s_cselect_b32 s35, s35, 0x80000000
v_lshlrev_b32 v255, 7, v1
buffer_load_dword v255, v255, s[56:59], s35 offen
mA 0,128,160
rT 64,35,49152
mA 32,132,160
s_add_u32 s100, s26, s25
s_add_u32 m0, s100, 4096
s_mul_i32 s21, s69, 114688
mA 36,132,164
s_mul_i32 s23, s64, 224
s_add_u32 s23, s23, 0
rT 66,35,51200
mA 4,128,164
s_lshl_b32 s73, s3, 5
s_mul_i32 s20, s3, 28672
mA 8,128,168
dL 25,16,27,0
mA 40,132,168
rT 68,36,49152
s_add_u32 s21, s21, s20
mA 44,132,172
s_mul_i32 s20, s3, 4096
v_lshrrev_b32 v248, 3, v1
mA 12,128,172
rT 70,36,51200
v_mul_u32_u24 v248, 896, v248
mA 16,128,176
dL 26,16,27,1024
mA 48,132,176
v_bfe_u32 v250, v1, 4, 2
mA 52,132,180
rT 72,37,49152
v_and_b32 v249, 7, v1
mA 20,128,180
v_xor_b32 v249, v249, v250
mA 24,128,184
rT 74,37,51200
v_lshl_add_u32 v248, v249, 4, v248
mA 56,132,184
dL 27,16,27,2048
mA 60,132,188
v_add_u32 v43, 0, v248
v_xor_b32 v44, 64, v248
mA 28,128,188
rT 76,38,49152
v_add_u32 v44, 6144, v44
mA 92,136,188
v_add_u32 v45, 12288, v248
mA 124,140,188
rT 78,38,51200
v_add_u32 v46, 12288, v44
mA 120,140,184
dL 28,16,27,3072
mA 88,136,184
v_and_b32 v248, 15, v1
v_lshrrev_b32 v249, 1, v248
mA 84,136,180
rT 80,39,49152
v_lshrrev_b32 v250, 4, v1
mA 116,140,180
v_xor_b32 v249, v249, v250
s_add_u32 s27, s27, 128
mA 112,140,176
rT 82,39,51200
v_add_u32 v248, s73, v248
mA 80,136,176
v_lshlrev_b32 v248, 7, v248
mA 76,136,172
rT 84,40,49152
v_lshl_add_u32 v47, v249, 4, v248
mA 108,140,172
v_add_u32 v47, 98304, v47
mA 104,140,168
s_add_u32 s25, s25, 32768
s_cmp_lt_u32 s25, 98304
s_cselect_b32 s25, s25, 0
mA 72,136,168
v_xor_b32 v48, 64, v47
mA 68,136,164
rT 86,40,51200
s_mov_b32 s73, 0
mA 100,140,164
s_mul_i32 s22, s3, 28672
rT 88,41,49152
s_add_u32 s23, s23, s22
mA 96,140,160
s_mul_i32 s22, s3, 2048
s_add_u32 s100, s26, s25
s_add_u32 m0, s100, 0
mA 64,136,160
v_lshrrev_b32 v248, 4, v1
mA 128,144,160
rT 90,41,51200
v_and_b32 v249, 15, v1
mA 160,148,160
v_lshlrev_b32 v250, 1, v248
mA 164,148,164
rT 92,42,49152
v_xor_b32 v249, v249, v250
mA 132,144,164
dL 21,16,27,0
mA 136,144,168
s_and_b32 s101, s3, 1
rT 94,42,51200
s_lshl_b32 s101, s101, 3
mA 168,148,168
v_xor_b32 v249, s101, v249
v_lshlrev_b32 v249, 4, v249
mA 172,148,172
rB 96,29,0
mA 140,144,172
dL 22,16,27,1024
mA 144,144,176
v_mul_u32_u24 v248, 3584, v248
v_add_u32 v49, v249, v248
mA 176,148,176
rB 100,29,2048
v_xor_b32 v250, 0, v249
mA 180,148,180
v_cmp_gt_u32 vcc, 224, v250
mA 148,144,180
dL 23,16,27,2048
mA 152,144,184
v_mov_b32 v250, 0x80000000
mA 184,148,184
rB 104,29,4096
v_cndmask_b32 v49, v250, v49, vcc
mA 188,148,188
v_add_u32 v50, v249, v248
mA 156,144,188
rB 108,29,6144
v_add_u32 v50, 13312, v50
mA 220,152,188
v_xor_b32 v250, 0, v249
mA 252,156,188
dL 24,16,27,3072
mA 248,156,184
rB 112,29,8192
v_cmp_gt_u32 vcc, 224, v250
mA 216,152,184
v_mov_b32 v250, 0x80000000
v_cndmask_b32 v50, v250, v50, vcc
mA 212,152,180
rB 116,29,10240
v_lshrrev_b32 v248, 4, v1
mA 244,156,180
s_add_u32 m0, s28, 131072
v_bfe_u32 v249, v1, 2, 2
mA 240,156,176
rB 120,29,12288
v_lshl_add_u32 v250, v248, 3, v249
mA 208,152,176
v_and_b32 v248, 1, v248
v_lshl_add_u32 v248, v248, 2, v249
mA 204,152,172
rB 124,29,14336
mA 236,156,172
dL 31,52,29,0
mA 232,156,168
v_lshrrev_b32 v248, 0, v248
v_lshlrev_b32 v248, 5, v248
mA 200,152,168
v_mul_u32_u24 v250, 256, v250
v_and_b32 v249, 3, v1
mA 196,152,164
v_lshl_add_u32 v250, v249, 3, v250
mA 228,156,164
dL 32,52,29,1024
mA 224,156,160
v_add_u32 v250, 0, v250
s_lshl_b32 s101, s73, 5
mA 192,152,160
v_xad_u32 v51, s101, v248, v250
s_add_u32 s101, s101, 32
v_xad_u32 v52, s101, v248, v250
s_add_u32 s101, s101, 32
dL 33,52,29,2048
v_xad_u32 v53, s101, v248, v250
s_add_u32 s101, s101, 32
s_waitcnt lgkmcnt(0)
s_waitcnt vmcnt(17)
s_barrier
v_xad_u32 v54, s101, v248, v250
s_add_u32 s101, s101, 32
v_xad_u32 v55, s101, v248, v250
s_add_u32 s101, s101, 32
v_xad_u32 v56, s101, v248, v250
s_add_u32 s101, s101, 32
dL 34,52,29,3072
v_xad_u32 v57, s101, v248, v250
s_add_u32 s101, s101, 32
s_cmp_eq_u32 s77, 1
s_cselect_b32 s92, s76, 0x40000000
s_add_u32 s29, s29, 262144
buffer_atomic_add v61, v60, s[60:63], s92 offen offset:128
s_lshl_b32 s35, s2, 15
s_sub_u32 s101, s3, 0
s_lshl_b32 s101, s101, 13
s_add_u32 s35, s35, s101
s_cmp_lt_u32 s101, 32768
s_cselect_b32 s35, s35, 0x80000000
v_lshlrev_b32 v254, 7, v1
buffer_load_dword v254, v254, s[44:47], s35 offen
mA 0,64,96
rT 128,35,0
mA 32,68,96
s_add_u32 s100, s26, s25
s_add_u32 m0, s100, 4096
mA 36,68,100
v_mov_b32 v236, 0
mA 4,64,100
rT 130,35,2048
v_mov_b32 v237, 0
mA 8,64,104
v_lshlrev_b32 v238, 16, v232
mA 40,68,104
rT 132,36,0
v_lshlrev_b32 v239, 16, v224
mA 44,68,108
dL 25,16,27,0
mA 12,64,108
rT 134,36,2048
v_fmac_f32 v236, v238, v239
mA 16,64,112
rT 136,37,0
v_lshlrev_b32 v239, 16, v228
mA 48,68,112
rT 138,37,2048
v_fmac_f32 v237, v238, v239
mA 52,68,116
dL 26,16,27,1024
mA 20,64,116
v_and_b32 v238, 0xffff0000, v232
mA 24,64,120
rT 140,38,0
v_and_b32 v239, 0xffff0000, v224
mA 56,68,120
rT 142,38,2048
v_fmac_f32 v236, v238, v239
mA 60,68,124
rT 144,39,0
mA 28,64,124
dL 27,16,27,2048
mA 92,72,124
v_and_b32 v239, 0xffff0000, v228
mA 124,76,124
rT 146,39,2048
v_fmac_f32 v237, v238, v239
mA 120,76,120
rT 148,40,0
v_lshlrev_b32 v238, 16, v233
mA 88,72,120
v_lshlrev_b32 v239, 16, v225
mA 84,72,116
rT 150,40,2048
mA 116,76,116
dL 28,16,27,3072
mA 112,76,112
v_fmac_f32 v236, v238, v239
mA 80,72,112
rT 152,41,0
v_lshlrev_b32 v239, 16, v229
mA 76,72,108
rT 154,41,2048
v_fmac_f32 v237, v238, v239
mA 108,76,108
s_add_u32 s27, s27, 128
rT 156,42,0
v_and_b32 v238, 0xffff0000, v233
mA 104,76,104
v_and_b32 v239, 0xffff0000, v225
mA 72,72,104
rT 158,42,2048
v_fmac_f32 v236, v238, v239
mA 68,72,100
rB 160,30,0
v_and_b32 v239, 0xffff0000, v229
mA 100,76,100
s_add_u32 s25, s25, 32768
s_cmp_lt_u32 s25, 98304
s_cselect_b32 s25, s25, 0
mA 96,76,96
rB 164,30,2048
v_fmac_f32 v237, v238, v239
mA 64,72,96
rB 168,30,4096
v_lshlrev_b32 v238, 16, v234
mA 128,80,96
rB 172,30,6144
v_lshlrev_b32 v239, 16, v226
mA 160,84,96
s_add_u32 m0, s28, 147456
v_fmac_f32 v236, v238, v239
mA 164,84,100
rB 176,30,8192
v_lshlrev_b32 v239, 16, v230
mA 132,80,100
rB 180,30,10240
mA 136,80,104
v_fmac_f32 v237, v238, v239
mA 168,84,104
rB 184,30,12288
v_and_b32 v238, 0xffff0000, v234
mA 172,84,108
dL 31,52,29,0
mA 140,80,108
rB 188,30,14336
v_and_b32 v239, 0xffff0000, v226
mA 144,80,112
v_fmac_f32 v236, v238, v239
mA 176,84,112
s_add_u32 s24, s24, 32768
s_cmp_lt_u32 s24, 98304
s_cselect_b32 s24, s24, 0
mA 180,84,116
v_and_b32 v239, 0xffff0000, v230
v_add_u32 v29, s24, v20
mA 148,80,116
dL 32,52,29,1024
mA 152,80,120
v_fmac_f32 v237, v238, v239
v_xor_b32 v30, 64, v29
mA 184,84,120
v_lshlrev_b32 v238, 16, v235
v_lshlrev_b32 v239, 16, v227
mA 188,84,124
dL 33,52,29,2048
mA 156,80,124
v_fmac_f32 v236, v238, v239
mA 220,88,124
v_lshlrev_b32 v239, 16, v231
mA 252,92,124
v_fmac_f32 v237, v238, v239
mA 248,92,120
mA 216,88,120
v_and_b32 v238, 0xffff0000, v235
s_waitcnt lgkmcnt(0)
mA 212,88,116
s_waitcnt vmcnt(17)
s_barrier
mA 244,92,116
dL 34,52,29,3072
mA 240,92,112
v_and_b32 v239, 0xffff0000, v227
v_fmac_f32 v236, v238, v239
mA 208,88,112
mA 204,88,108
s_cmp_eq_u32 s77, 2
s_cselect_b32 s92, s76, 0x40000000
s_add_u32 s29, s29, 262144
mA 236,92,108
mA 232,92,104
buffer_atomic_add v61, v60, s[60:63], s92 offen offset:128
mA 200,88,104
mA 196,88,100
s_mov_b32 s96, s74
s_mov_b32 s97, s75
s_mov_b32 s98, 3670016
s_mov_b32 s99, 0x20000
s_lshl_b32 s35, s2, 14
s_sub_u32 s101, s3, 0
s_lshl_b32 s101, s101, 13
s_add_u32 s35, s35, s101
s_cmp_lt_u32 s101, 16384
s_cselect_b32 s35, s35, 0x80000000
v_lshlrev_b32 v253, 7, v1
buffer_load_dword v253, v253, s[96:99], s35 offen
mA 228,92,100
mA 224,92,96
mA 192,88,96
mA 0,128,160
rT 64,35,16384
mA 32,132,160
s_add_u32 s100, s26, s25
s_add_u32 m0, s100, 0
v_and_b32 v239, 0xffff0000, v231
mA 36,132,164
rT 66,35,18432
v_fmac_f32 v237, v238, v239
mA 4,128,164
v_add_f32_dpp v236, v236, v236 row_ror:8 row_mask:0xf bank_mask:0xf
mA 8,128,168
rT 68,36,16384
v_add_f32_dpp v237, v237, v237 row_ror:8 row_mask:0xf bank_mask:0xf
mA 40,132,168
dL 21,16,27,0
mA 44,132,172
rT 70,36,18432
v_add_f32_dpp v236, v236, v236 row_ror:4 row_mask:0xf bank_mask:0xf
mA 12,128,172
rT 72,37,16384
v_add_f32_dpp v237, v237, v237 row_ror:4 row_mask:0xf bank_mask:0xf
mA 16,128,176
mA 48,132,176
v_add_f32_dpp v236, v236, v236 row_ror:2 row_mask:0xf bank_mask:0xf
mA 52,132,180
rT 74,37,18432
v_add_f32_dpp v237, v237, v237 row_ror:2 row_mask:0xf bank_mask:0xf
mA 20,128,180
dL 22,16,27,1024
mA 24,128,184
rT 76,38,16384
v_add_f32_dpp v236, v236, v236 row_ror:1 row_mask:0xf bank_mask:0xf
mA 56,132,184
rT 78,38,18432
v_add_f32_dpp v237, v237, v237 row_ror:1 row_mask:0xf bank_mask:0xf
mA 60,132,188
v_mov_b32 v238, v236
mA 28,128,188
rT 80,39,16384
v_mov_b32 v239, v237
mA 92,136,188
dL 23,16,27,2048
mA 124,140,188
rT 82,39,18432
v_permlane16_swap_b32 v236, v238
mA 120,140,184
v_permlane16_swap_b32 v237, v239
mA 88,136,184
rT 84,40,16384
mA 84,136,180
v_add_f32 v236, v236, v238
mA 116,140,180
rT 86,40,18432
v_add_f32 v237, v237, v239
mA 112,140,176
dL 24,16,27,3072
mA 80,136,176
rT 88,41,16384
v_mov_b32 v238, v236
mA 76,136,172
v_mov_b32 v239, v237
mA 108,140,172
rT 90,41,18432
v_permlane32_swap_b32 v236, v238
mA 104,140,168
rT 92,42,16384
v_permlane32_swap_b32 v237, v239
mA 72,136,168
s_add_u32 m0, s28, 98304
mA 68,136,164
rT 94,42,18432
v_add_f32 v236, v236, v238
mA 100,140,164
v_add_f32 v237, v237, v239
mA 96,140,160
rB 96,29,0
mA 64,136,160
v_mul_f32 v236, 0xbfb8aa3b, v236
mA 128,144,160
rB 100,29,2048
mA 160,148,160
v_exp_f32 v236, v236
mA 164,148,164
dL 31,52,29,0
mA 132,144,164
rB 104,29,4096
v_add_f32 v236, 1.0, v236
mA 136,144,168
rB 108,29,6144
mA 168,148,168
v_rcp_f32 v236, v236
mA 172,148,172
rB 112,29,8192
mA 140,144,172
dL 32,52,29,1024
mA 144,144,176
v_mul_f32 v237, 0xbfb8aa3b, v237
mA 176,148,176
rB 116,29,10240
mA 180,148,180
v_exp_f32 v237, v237
mA 148,144,180
rB 120,29,12288
rB 124,29,14336
mA 152,144,184
v_add_f32 v237, 1.0, v237
mA 184,148,184
dL 33,52,29,2048
mA 188,148,188
v_rcp_f32 v237, v237
mA 156,144,188
v_mov_b32 v238, 2147483648
mA 220,152,188
v_cmp_eq_u32 vcc, 0, v1
mA 252,156,188
dL 34,52,29,3072
mA 248,156,184
v_cndmask_b32 v238, v238, 0, vcc
mA 216,152,184
s_waitcnt lgkmcnt(0)
s_waitcnt vmcnt(20)
s_barrier
mA 212,152,180
buffer_store_dwordx2 v[236:237], v238, s[12:15], s70 offen sc1
mA 244,156,180
mA 240,156,176
mA 208,152,176
s_add_u32 s29, s29, 262144
mA 204,152,172
s_cmp_eq_u32 s77, 3
s_cselect_b32 s92, s76, 0x40000000
mA 236,156,172
mA 232,156,168
buffer_atomic_add v61, v60, s[60:63], s92 offen offset:128
mA 200,152,168
mA 196,152,164
s_mov_b32 s96, s78
s_mov_b32 s97, s79
s_mov_b32 s98, 802816
s_mov_b32 s99, 0x20000
s_lshl_b32 s35, s2, 12
s_sub_u32 s101, s3, 2
s_lshl_b32 s101, s101, 13
s_add_u32 s35, s35, s101
s_cmp_lt_u32 s101, 8192
s_cselect_b32 s35, s35, 0x80000000
v_lshlrev_b32 v246, 7, v1
buffer_load_dword v246, v246, s[96:99], s35 offen
mA 228,156,164
mA 224,156,160
mA 192,152,160
mA 0,64,96
rT 128,35,32768
mA 32,68,96
s_add_u32 s100, s26, s25
s_add_u32 m0, s100, 4096
rT 130,35,34816
mA 36,68,100
mA 4,64,100
rT 132,36,32768
mA 8,64,104
dL 25,16,27,0
mA 40,68,104
rT 134,36,34816
mA 44,68,108
rT 136,37,32768
mA 12,64,108
mA 16,64,112
rT 138,37,34816
mA 48,68,112
dL 26,16,27,1024
mA 52,68,116
rT 140,38,32768
mA 20,64,116
rT 142,38,34816
mA 24,64,120
mA 56,68,120
rT 144,39,32768
mA 60,68,124
dL 27,16,27,2048
mA 28,64,124
rT 146,39,34816
mA 92,72,124
rT 148,40,32768
mA 124,76,124
mA 120,76,120
rT 150,40,34816
mA 88,72,120
dL 28,16,27,3072
mA 84,72,116
rT 152,41,32768
mA 116,76,116
rT 154,41,34816
mA 112,76,112
mA 80,72,112
s_add_u32 s27, s27, 128
rT 156,42,32768
mA 76,72,108
mA 108,76,108
rT 158,42,34816
mA 104,76,104
rB 160,30,0
mA 72,72,104
mA 68,72,100
s_add_u32 s25, s25, 32768
s_cmp_lt_u32 s25, 98304
s_cselect_b32 s25, s25, 0
mA 100,76,100
rB 164,30,2048
mA 96,76,96
rB 168,30,4096
mA 64,72,96
rB 172,30,6144
mA 128,80,96
s_add_u32 m0, s28, 114688
mA 160,84,96
rB 176,30,8192
mA 164,84,100
mA 132,80,100
rB 180,30,10240
mA 136,80,104
rB 184,30,12288
mA 168,84,104
dL 31,52,29,0
mA 172,84,108
rB 188,30,14336
mA 140,80,108
mA 144,80,112
s_add_u32 s24, s24, 32768
s_cmp_lt_u32 s24, 98304
s_cselect_b32 s24, s24, 0
mA 176,84,112
v_add_u32 v29, s24, v20
mA 180,84,116
dL 32,52,29,1024
mA 148,80,116
v_xor_b32 v30, 64, v29
mA 152,80,120
mA 184,84,120
mA 188,84,124
dL 33,52,29,2048
mA 156,80,124
mA 220,88,124
mA 252,92,124
mA 248,92,120
mA 216,88,120
s_waitcnt lgkmcnt(0)
s_waitcnt vmcnt(20)
s_barrier
mA 212,88,116
dL 34,52,29,3072
mA 244,92,116
mA 240,92,112
mA 208,88,112
mA 204,88,108
s_add_u32 s29, s29, 262144
mA 236,92,108
mA 232,92,104
mA 200,88,104
mA 196,88,100
mA 228,92,100
mA 224,92,96
mA 192,88,96
mA 0,128,160
rT 64,35,49152
mA 32,132,160
s_add_u32 s100, s26, s25
s_add_u32 m0, s100, 0
rT 66,35,51200
mA 36,132,164
mA 4,128,164
rT 68,36,49152
mA 8,128,168
mA 40,132,168
dL 21,16,27,0
mA 44,132,172
rT 70,36,51200
mA 12,128,172
rT 72,37,49152
mA 16,128,176
mA 48,132,176
rT 74,37,51200
mA 52,132,180
mA 20,128,180
dL 22,16,27,1024
mA 24,128,184
rT 76,38,49152
mA 56,132,184
rT 78,38,51200
mA 60,132,188
mA 28,128,188
rT 80,39,49152
mA 92,136,188
dL 23,16,27,2048
mA 124,140,188
rT 82,39,51200
mA 120,140,184
rT 84,40,49152
mA 88,136,184
mA 84,136,180
rT 86,40,51200
mA 116,140,180
mA 112,140,176
dL 24,16,27,3072
mA 80,136,176
rT 88,41,49152
mA 76,136,172
rT 90,41,51200
mA 108,140,172
mA 104,140,168
rT 92,42,49152
mA 72,136,168
s_add_u32 m0, s28, 131072
mA 68,136,164
rT 94,42,51200
mA 100,140,164
mA 96,140,160
rB 96,29,0
mA 64,136,160
mA 128,144,160
rB 100,29,2048
mA 160,148,160
dL 31,52,29,0
mA 164,148,164
rB 104,29,4096
mA 132,144,164
rB 108,29,6144
mA 136,144,168
mA 168,148,168
rB 112,29,8192
mA 172,148,172
dL 32,52,29,1024
mA 140,144,172
rB 116,29,10240
mA 144,144,176
mA 176,148,176
rB 120,29,12288
mA 180,148,180
mA 148,144,180
rB 124,29,14336
mA 152,144,184
dL 33,52,29,2048
mA 184,148,184
mA 188,148,188
mA 156,144,188
mA 220,152,188
mA 252,156,188
dL 34,52,29,3072
mA 248,156,184
mA 216,152,184
s_waitcnt lgkmcnt(0)
s_waitcnt vmcnt(19)
s_barrier
mA 212,152,180
mA 244,156,180
mA 240,156,176
mA 208,152,176
s_add_u32 s29, s29, 262144
mA 204,152,172
mA 236,156,172
mA 232,156,168
mA 200,152,168
mA 196,152,164
mA 228,156,164
mA 224,156,160
mA 192,152,160
s_mov_b32 s34, 4
L1_K_loop:
mA 0,64,96
rT 128,35,0
mA 32,68,96
s_add_u32 s100, s26, s25
s_add_u32 m0, s100, 4096
rT 130,35,2048
mA 36,68,100
mA 4,64,100
rT 132,36,0
mA 8,64,104
dL 25,16,27,0
mA 40,68,104
rT 134,36,2048
mA 44,68,108
rT 136,37,0
mA 12,64,108
mA 16,64,112
rT 138,37,2048
mA 48,68,112
dL 26,16,27,1024
mA 52,68,116
rT 140,38,0
mA 20,64,116
rT 142,38,2048
mA 24,64,120
mA 56,68,120
rT 144,39,0
mA 60,68,124
dL 27,16,27,2048
mA 28,64,124
rT 146,39,2048
mA 92,72,124
rT 148,40,0
mA 124,76,124
mA 120,76,120
rT 150,40,2048
mA 88,72,120
dL 28,16,27,3072
mA 84,72,116
rT 152,41,0
mA 116,76,116
rT 154,41,2048
mA 112,76,112
mA 80,72,112
s_add_u32 s27, s27, 128
rT 156,42,0
mA 76,72,108
mA 108,76,108
rT 158,42,2048
mA 104,76,104
rB 160,30,0
mA 72,72,104
mA 68,72,100
s_add_u32 s25, s25, 32768
s_cmp_lt_u32 s25, 98304
s_cselect_b32 s25, s25, 0
mA 100,76,100
rB 164,30,2048
mA 96,76,96
rB 168,30,4096
mA 64,72,96
rB 172,30,6144
mA 128,80,96
s_add_u32 m0, s28, 147456
mA 160,84,96
rB 176,30,8192
mA 164,84,100
mA 132,80,100
rB 180,30,10240
mA 136,80,104
rB 184,30,12288
mA 168,84,104
dL 31,52,29,0
mA 172,84,108
rB 188,30,14336
mA 140,80,108
mA 144,80,112
s_add_u32 s24, s24, 32768
s_cmp_lt_u32 s24, 98304
s_cselect_b32 s24, s24, 0
mA 176,84,112
v_add_u32 v29, s24, v20
mA 180,84,116
dL 32,52,29,1024
mA 148,80,116
v_xor_b32 v30, 64, v29
mA 152,80,120
mA 184,84,120
mA 188,84,124
dL 33,52,29,2048
mA 156,80,124
mA 220,88,124
mA 252,92,124
mA 248,92,120
mA 216,88,120
s_waitcnt lgkmcnt(0)
s_waitcnt vmcnt(15)
s_barrier
mA 212,88,116
dL 34,52,29,3072
mA 244,92,116
mA 240,92,112
mA 208,88,112
mA 204,88,108
s_add_u32 s29, s29, 262144
mA 236,92,108
mA 232,92,104
mA 200,88,104
mA 196,88,100
mA 228,92,100
mA 224,92,96
mA 192,88,96
mA 0,128,160
rT 64,35,16384
mA 32,132,160
s_add_u32 s100, s26, s25
s_add_u32 m0, s100, 0
rT 66,35,18432
mA 36,132,164
mA 4,128,164
rT 68,36,16384
mA 8,128,168
mA 40,132,168
dL 21,16,27,0
mA 44,132,172
rT 70,36,18432
mA 12,128,172
rT 72,37,16384
mA 16,128,176
mA 48,132,176
rT 74,37,18432
mA 52,132,180
mA 20,128,180
dL 22,16,27,1024
mA 24,128,184
rT 76,38,16384
mA 56,132,184
rT 78,38,18432
mA 60,132,188
mA 28,128,188
rT 80,39,16384
mA 92,136,188
dL 23,16,27,2048
mA 124,140,188
rT 82,39,18432
mA 120,140,184
rT 84,40,16384
mA 88,136,184
mA 84,136,180
rT 86,40,18432
mA 116,140,180
mA 112,140,176
dL 24,16,27,3072
mA 80,136,176
rT 88,41,16384
mA 76,136,172
rT 90,41,18432
mA 108,140,172
mA 104,140,168
rT 92,42,16384
mA 72,136,168
s_add_u32 m0, s28, 98304
mA 68,136,164
rT 94,42,18432
mA 100,140,164
mA 96,140,160
rB 96,29,0
mA 64,136,160
mA 128,144,160
rB 100,29,2048
mA 160,148,160
dL 31,52,29,0
mA 164,148,164
rB 104,29,4096
mA 132,144,164
rB 108,29,6144
mA 136,144,168
mA 168,148,168
rB 112,29,8192
mA 172,148,172
dL 32,52,29,1024
mA 140,144,172
rB 116,29,10240
mA 144,144,176
mA 176,148,176
rB 120,29,12288
mA 180,148,180
mA 148,144,180
rB 124,29,14336
mA 152,144,184
dL 33,52,29,2048
mA 184,148,184
mA 188,148,188
mA 156,144,188
mA 220,152,188
mA 252,156,188
dL 34,52,29,3072
mA 248,156,184
mA 216,152,184
s_waitcnt lgkmcnt(0)
s_waitcnt vmcnt(16)
s_barrier
mA 212,152,180
mA 244,156,180
mA 240,156,176
mA 208,152,176
s_add_u32 s29, s29, 262144
mA 204,152,172
mA 236,156,172
mA 232,156,168
mA 200,152,168
mA 196,152,164
mA 228,156,164
mA 224,156,160
mA 192,152,160
mA 0,64,96
rT 128,35,32768
mA 32,68,96
s_add_u32 s100, s26, s25
s_add_u32 m0, s100, 4096
rT 130,35,34816
mA 36,68,100
mA 4,64,100
rT 132,36,32768
mA 8,64,104
dL 25,16,27,0
mA 40,68,104
rT 134,36,34816
mA 44,68,108
rT 136,37,32768
mA 12,64,108
mA 16,64,112
rT 138,37,34816
mA 48,68,112
dL 26,16,27,1024
mA 52,68,116
rT 140,38,32768
mA 20,64,116
rT 142,38,34816
mA 24,64,120
mA 56,68,120
rT 144,39,32768
mA 60,68,124
dL 27,16,27,2048
mA 28,64,124
rT 146,39,34816
mA 92,72,124
rT 148,40,32768
mA 124,76,124
mA 120,76,120
rT 150,40,34816
mA 88,72,120
dL 28,16,27,3072
mA 84,72,116
rT 152,41,32768
mA 116,76,116
rT 154,41,34816
mA 112,76,112
mA 80,72,112
s_add_u32 s27, s27, 128
rT 156,42,32768
mA 76,72,108
mA 108,76,108
rT 158,42,34816
mA 104,76,104
rB 160,30,0
mA 72,72,104
mA 68,72,100
s_add_u32 s25, s25, 32768
s_cmp_lt_u32 s25, 98304
s_cselect_b32 s25, s25, 0
mA 100,76,100
rB 164,30,2048
mA 96,76,96
rB 168,30,4096
mA 64,72,96
rB 172,30,6144
mA 128,80,96
s_add_u32 m0, s28, 114688
mA 160,84,96
rB 176,30,8192
mA 164,84,100
mA 132,80,100
rB 180,30,10240
mA 136,80,104
rB 184,30,12288
mA 168,84,104
dL 31,52,29,0
mA 172,84,108
rB 188,30,14336
mA 140,80,108
mA 144,80,112
s_add_u32 s24, s24, 32768
s_cmp_lt_u32 s24, 98304
s_cselect_b32 s24, s24, 0
mA 176,84,112
v_add_u32 v29, s24, v20
mA 180,84,116
dL 32,52,29,1024
mA 148,80,116
v_xor_b32 v30, 64, v29
mA 152,80,120
mA 184,84,120
mA 188,84,124
dL 33,52,29,2048
mA 156,80,124
mA 220,88,124
mA 252,92,124
mA 248,92,120
mA 216,88,120
s_waitcnt lgkmcnt(0)
s_waitcnt vmcnt(15)
s_barrier
mA 212,88,116
dL 34,52,29,3072
mA 244,92,116
mA 240,92,112
mA 208,88,112
mA 204,88,108
s_add_u32 s29, s29, 262144
mA 236,92,108
mA 232,92,104
mA 200,88,104
mA 196,88,100
mA 228,92,100
mA 224,92,96
mA 192,88,96
mA 0,128,160
rT 64,35,49152
mA 32,132,160
s_add_u32 s100, s26, s25
s_add_u32 m0, s100, 0
rT 66,35,51200
mA 36,132,164
mA 4,128,164
rT 68,36,49152
mA 8,128,168
mA 40,132,168
dL 21,16,27,0
mA 44,132,172
rT 70,36,51200
mA 12,128,172
rT 72,37,49152
mA 16,128,176
mA 48,132,176
rT 74,37,51200
mA 52,132,180
mA 20,128,180
dL 22,16,27,1024
mA 24,128,184
rT 76,38,49152
mA 56,132,184
rT 78,38,51200
mA 60,132,188
mA 28,128,188
rT 80,39,49152
mA 92,136,188
dL 23,16,27,2048
mA 124,140,188
rT 82,39,51200
mA 120,140,184
rT 84,40,49152
mA 88,136,184
mA 84,136,180
rT 86,40,51200
mA 116,140,180
mA 112,140,176
dL 24,16,27,3072
mA 80,136,176
rT 88,41,49152
mA 76,136,172
rT 90,41,51200
mA 108,140,172
mA 104,140,168
rT 92,42,49152
mA 72,136,168
s_add_u32 m0, s28, 131072
mA 68,136,164
rT 94,42,51200
mA 100,140,164
mA 96,140,160
rB 96,29,0
mA 64,136,160
mA 128,144,160
rB 100,29,2048
mA 160,148,160
dL 31,52,29,0
mA 164,148,164
rB 104,29,4096
mA 132,144,164
rB 108,29,6144
mA 136,144,168
mA 168,148,168
rB 112,29,8192
mA 172,148,172
dL 32,52,29,1024
mA 140,144,172
rB 116,29,10240
mA 144,144,176
mA 176,148,176
rB 120,29,12288
mA 180,148,180
mA 148,144,180
rB 124,29,14336
mA 152,144,184
dL 33,52,29,2048
mA 184,148,184
mA 188,148,188
mA 156,144,188
mA 220,152,188
mA 252,156,188
dL 34,52,29,3072
mA 248,156,184
mA 216,152,184
s_waitcnt lgkmcnt(0)
s_waitcnt vmcnt(16)
s_barrier
mA 212,152,180
mA 244,156,180
mA 240,156,176
mA 208,152,176
s_add_u32 s29, s29, 262144
mA 204,152,172
mA 236,156,172
mA 232,156,168
mA 200,152,168
mA 196,152,164
mA 228,156,164
mA 224,156,160
mA 192,152,160
s_sub_u32 s34, s34, 1
s_cmp_lg_u32 s34, 0
s_cbranch_scc1 L1_K_loop
mA 0,64,96
rT 128,35,0
mA 32,68,96
s_add_u32 s100, s26, s25
s_add_u32 m0, s100, 4096
rT 130,35,2048
mA 36,68,100
mA 4,64,100
rT 132,36,0
mA 8,64,104
dL 25,16,27,0
mA 40,68,104
rT 134,36,2048
mA 44,68,108
rT 136,37,0
mA 12,64,108
mA 16,64,112
rT 138,37,2048
mA 48,68,112
dL 26,16,27,1024
mA 52,68,116
rT 140,38,0
mA 20,64,116
rT 142,38,2048
mA 24,64,120
mA 56,68,120
rT 144,39,0
mA 60,68,124
dL 27,16,27,2048
mA 28,64,124
rT 146,39,2048
mA 92,72,124
rT 148,40,0
mA 124,76,124
mA 120,76,120
rT 150,40,2048
mA 88,72,120
dL 28,16,27,3072
mA 84,72,116
rT 152,41,0
mA 116,76,116
rT 154,41,2048
mA 112,76,112
mA 80,72,112
s_add_u32 s27, s27, 128
rT 156,42,0
mA 76,72,108
mA 108,76,108
rT 158,42,2048
mA 104,76,104
rB 160,30,0
mA 72,72,104
mA 68,72,100
s_add_u32 s25, s25, 32768
s_cmp_lt_u32 s25, 98304
s_cselect_b32 s25, s25, 0
mA 100,76,100
rB 164,30,2048
mA 96,76,96
rB 168,30,4096
mA 64,72,96
rB 172,30,6144
mA 128,80,96
s_add_u32 m0, s28, 147456
mA 160,84,96
rB 176,30,8192
mA 164,84,100
mA 132,80,100
rB 180,30,10240
mA 136,80,104
rB 184,30,12288
mA 168,84,104
dL 31,52,29,0
mA 172,84,108
rB 188,30,14336
mA 140,80,108
mA 144,80,112
s_add_u32 s24, s24, 32768
s_cmp_lt_u32 s24, 98304
s_cselect_b32 s24, s24, 0
mA 176,84,112
v_add_u32 v29, s24, v20
mA 180,84,116
dL 32,52,29,1024
mA 148,80,116
v_xor_b32 v30, 64, v29
mA 152,80,120
mA 184,84,120
mA 188,84,124
dL 33,52,29,2048
mA 156,80,124
mA 220,88,124
mA 252,92,124
mA 248,92,120
mA 216,88,120
s_waitcnt lgkmcnt(0)
s_waitcnt vmcnt(15)
s_barrier
mA 212,88,116
dL 34,52,29,3072
mA 244,92,116
mA 240,92,112
mA 208,88,112
mA 204,88,108
s_add_u32 s29, s29, 262144
mA 236,92,108
mA 232,92,104
mA 200,88,104
mA 196,88,100
mA 228,92,100
mA 224,92,96
mA 192,88,96
mA 0,128,160
rT 64,35,16384
mA 32,132,160
s_add_u32 s100, s26, s25
s_add_u32 m0, s100, 0
rT 66,35,18432
mA 36,132,164
mA 4,128,164
rT 68,36,16384
mA 8,128,168
mA 40,132,168
dL 21,16,27,0
mA 44,132,172
rT 70,36,18432
mA 12,128,172
rT 72,37,16384
mA 16,128,176
mA 48,132,176
rT 74,37,18432
mA 52,132,180
mA 20,128,180
dL 22,16,27,1024
mA 24,128,184
rT 76,38,16384
mA 56,132,184
rT 78,38,18432
mA 60,132,188
mA 28,128,188
rT 80,39,16384
mA 92,136,188
dL 23,16,27,2048
mA 124,140,188
rT 82,39,18432
mA 120,140,184
rT 84,40,16384
mA 88,136,184
mA 84,136,180
rT 86,40,18432
mA 116,140,180
mA 112,140,176
dL 24,16,27,3072
mA 80,136,176
rT 88,41,16384
mA 76,136,172
rT 90,41,18432
mA 108,140,172
mA 104,140,168
rT 92,42,16384
mA 72,136,168
s_add_u32 m0, s28, 98304
mA 68,136,164
rT 94,42,18432
mA 100,140,164
mA 96,140,160
rB 96,29,0
mA 64,136,160
mA 128,144,160
rB 100,29,2048
mA 160,148,160
dL 31,52,29,0
mA 164,148,164
rB 104,29,4096
mA 132,144,164
rB 108,29,6144
mA 136,144,168
mA 168,148,168
rB 112,29,8192
mA 172,148,172
dL 32,52,29,1024
mA 140,144,172
rB 116,29,10240
mA 144,144,176
mA 176,148,176
rB 120,29,12288
mA 180,148,180
mA 148,144,180
rB 124,29,14336
mA 152,144,184
dL 33,52,29,2048
mA 184,148,184
mA 188,148,188
mA 156,144,188
mA 220,152,188
mA 252,156,188
dL 34,52,29,3072
mA 248,156,184
mA 216,152,184
s_waitcnt lgkmcnt(0)
s_waitcnt vmcnt(16)
s_barrier
mA 212,152,180
mA 244,156,180
mA 240,156,176
mA 208,152,176
s_add_u32 s29, s29, 262144
mA 204,152,172
mA 236,156,172
mA 232,156,168
mA 200,152,168
mA 196,152,164
mA 228,156,164
mA 224,156,160
mA 192,152,160
mA 0,64,96
rT 128,35,32768
mA 32,68,96
s_add_u32 s100, s26, s25
s_add_u32 m0, s100, 4096
rT 130,35,34816
mA 36,68,100
mA 4,64,100
rT 132,36,32768
mA 8,64,104
dL 25,16,27,0
mA 40,68,104
rT 134,36,34816
mA 44,68,108
rT 136,37,32768
mA 12,64,108
mA 16,64,112
rT 138,37,34816
mA 48,68,112
dL 26,16,27,1024
mA 52,68,116
rT 140,38,32768
mA 20,64,116
rT 142,38,34816
mA 24,64,120
mA 56,68,120
rT 144,39,32768
mA 60,68,124
dL 27,16,27,2048
mA 28,64,124
rT 146,39,34816
mA 92,72,124
rT 148,40,32768
mA 124,76,124
mA 120,76,120
rT 150,40,34816
mA 88,72,120
dL 28,16,27,3072
mA 84,72,116
rT 152,41,32768
mA 116,76,116
rT 154,41,34816
mA 112,76,112
mA 80,72,112
s_add_u32 s27, s27, 128
rT 156,42,32768
mA 76,72,108
mA 108,76,108
rT 158,42,34816
mA 104,76,104
rB 160,30,0
mA 72,72,104
mA 68,72,100
s_add_u32 s25, s25, 32768
s_cmp_lt_u32 s25, 98304
s_cselect_b32 s25, s25, 0
mA 100,76,100
rB 164,30,2048
mA 96,76,96
rB 168,30,4096
mA 64,72,96
rB 172,30,6144
mA 128,80,96
s_add_u32 m0, s28, 114688
mA 160,84,96
rB 176,30,8192
mA 164,84,100
mA 132,80,100
rB 180,30,10240
mA 136,80,104
rB 184,30,12288
mA 168,84,104
dL 31,52,29,0
mA 172,84,108
rB 188,30,14336
mA 140,80,108
mA 144,80,112
s_add_u32 s24, s24, 32768
s_cmp_lt_u32 s24, 98304
s_cselect_b32 s24, s24, 0
mA 176,84,112
v_add_u32 v29, s24, v20
mA 180,84,116
dL 32,52,29,1024
mA 148,80,116
v_xor_b32 v30, 64, v29
mA 152,80,120
mA 184,84,120
mA 188,84,124
dL 33,52,29,2048
mA 156,80,124
mA 220,88,124
mA 252,92,124
mA 248,92,120
mA 216,88,120
s_waitcnt lgkmcnt(0)
s_waitcnt vmcnt(15)
s_barrier
mA 212,88,116
dL 34,52,29,3072
mA 244,92,116
mA 240,92,112
mA 208,88,112
mA 204,88,108
s_add_u32 s29, s29, 262144
mA 236,92,108
mA 232,92,104
mA 200,88,104
mA 196,88,100
mA 228,92,100
mA 224,92,96
mA 192,88,96
mA 0,128,160
rT 64,35,49152
s_add_u32 m0, s28, 131072
mA 32,132,160
rT 66,35,51200
mA 36,132,164
mA 4,128,164
rT 68,36,49152
mA 8,128,168
mA 40,132,168
rT 70,36,51200
mA 44,132,172
mA 12,128,172
rT 72,37,49152
mA 16,128,176
mA 48,132,176
rT 74,37,51200
mA 52,132,180
dL 31,52,29,0
mA 20,128,180
rT 76,38,49152
mA 24,128,184
mA 56,132,184
rT 78,38,51200
mA 60,132,188
mA 28,128,188
rT 80,39,49152
mA 92,136,188
rT 82,39,51200
mA 124,140,188
mA 120,140,184
rT 84,40,49152
mA 88,136,184
mA 84,136,180
dL 32,52,29,1024
mA 116,140,180
rT 86,40,51200
mA 112,140,176
rT 88,41,49152
mA 80,136,176
mA 76,136,172
rT 90,41,51200
mA 108,140,172
mA 104,140,168
rT 92,42,49152
mA 72,136,168
mA 68,136,164
rT 94,42,51200
mA 100,140,164
mA 96,140,160
rB 96,29,0
mA 64,136,160
dL 33,52,29,2048
mA 128,144,160
rB 100,29,2048
mA 160,148,160
rB 104,29,4096
mA 164,148,164
mA 132,144,164
rB 108,29,6144
mA 136,144,168
mA 168,148,168
rB 112,29,8192
mA 172,148,172
mA 140,144,172
rB 116,29,10240
mA 144,144,176
dL 34,52,29,3072
mA 176,148,176
rB 120,29,12288
mA 180,148,180
mA 148,144,180
rB 124,29,14336
mA 152,144,184
mA 184,148,184
mA 188,148,188
mA 156,144,188
mA 220,152,188
mA 252,156,188
mA 248,156,184
s_add_u32 s29, s29, 262144
mA 216,152,184
s_waitcnt lgkmcnt(0)
s_waitcnt vmcnt(12)
s_barrier
mA 212,152,180
mA 244,156,180
mA 240,156,176
mA 208,152,176
mA 204,152,172
mA 236,156,172
mA 232,156,168
mA 200,152,168
mA 196,152,164
mA 228,156,164
mA 224,156,160
mA 192,152,160
mA 0,64,96
rT 128,35,0
s_add_u32 m0, s22, 0
mA 32,68,96
rT 130,35,2048
mA 36,68,100
dL 49,8,23,0
mA 4,64,100
rT 132,36,0
mA 8,64,104
mA 40,68,104
rT 134,36,2048
mA 44,68,108
dL 50,8,23,1024
mA 12,64,108
rT 136,37,0
mA 16,64,112
rT 138,37,2048
s_add_u32 s23, s23, 114688
mA 48,68,112
mA 52,68,116
rT 140,38,0
mA 20,64,116
s_add_u32 m0, s22, 8192
rT 142,38,2048
mA 24,64,120
mA 56,68,120
rT 144,39,0
mA 60,68,124
dL 49,8,23,0
mA 28,64,124
rT 146,39,2048
mA 92,72,124
rT 148,40,0
mA 124,76,124
dL 50,8,23,1024
mA 120,76,120
rT 150,40,2048
mA 88,72,120
s_add_u32 s23, s23, 114688
mA 84,72,116
rT 152,41,0
mA 116,76,116
rT 154,41,2048
mA 112,76,112
s_add_u32 m0, s22, 16384
mA 80,72,112
rT 156,42,0
mA 76,72,108
mA 108,76,108
rT 158,42,2048
mA 104,76,104
dL 49,8,23,0
mA 72,72,104
rB 160,30,0
mA 68,72,100
dL 50,8,23,1024
mA 100,76,100
rB 164,30,2048
mA 96,76,96
rB 168,30,4096
s_add_u32 s23, s23, 114688
mA 64,72,96
rB 172,30,6144
mA 128,80,96
mA 160,84,96
rB 176,30,8192
s_add_u32 m0, s22, 24576
mA 164,84,100
mA 132,80,100
rB 180,30,10240
mA 136,80,104
dL 49,8,23,0
mA 168,84,104
rB 184,30,12288
mA 172,84,108
rB 188,30,14336
mA 140,80,108
dL 50,8,23,1024
mA 144,80,112
s_add_u32 s24, s24, 32768
s_cmp_lt_u32 s24, 98304
s_cselect_b32 s24, s24, 0
mA 176,84,112
v_add_u32 v29, s24, v20
mA 180,84,116
s_add_u32 s23, s23, 114688
mA 148,80,116
v_xor_b32 v30, 64, v29
mA 152,80,120
mA 184,84,120
mA 188,84,124
mA 156,80,124
mA 220,88,124
mA 252,92,124
mA 248,92,120
v_add_u32 v60, s64, v1
mA 216,88,120
s_waitcnt lgkmcnt(0)
s_waitcnt vmcnt(12)
s_barrier
mA 212,88,116
v_and_b32 v60, 7, v60
mA 244,92,116
v_lshlrev_b32 v60, 2, v60
mA 240,92,112
buffer_load_dword v61, v60, s[60:63], 0 offen offset:128 sc1
mA 208,88,112
mA 204,88,108
mA 236,92,108
mA 232,92,104
mA 200,88,104
mA 196,88,100
mA 228,92,100
mA 224,92,96
mA 192,88,96
mA 0,128,160
rT 64,35,16384
s_add_u32 m0, s22, 32768
mA 32,132,160
rT 66,35,18432
mA 36,132,164
dL 49,8,23,0
mA 4,128,164
rT 68,36,16384
mA 8,128,168
mA 40,132,168
dL 50,8,23,1024
mA 44,132,172
rT 70,36,18432
mA 12,128,172
rT 72,37,16384
mA 16,128,176
s_add_u32 s23, s23, 114688
mA 48,132,176
rT 74,37,18432
mA 52,132,180
mA 20,128,180
s_add_u32 m0, s22, 40960
rT 76,38,16384
mA 24,128,184
mA 56,132,184
rT 78,38,18432
mA 60,132,188
dL 49,8,23,0
mA 28,128,188
rT 80,39,16384
mA 92,136,188
dL 50,8,23,1024
mA 124,140,188
rT 82,39,18432
mA 120,140,184
rT 84,40,16384
mA 88,136,184
s_add_u32 s23, s23, 114688
mA 84,136,180
rT 86,40,18432
mA 116,140,180
mA 112,140,176
s_add_u32 m0, s22, 49152
rT 88,41,16384
mA 80,136,176
mA 76,136,172
rT 90,41,18432
mA 108,140,172
dL 49,8,23,0
mA 104,140,168
rT 92,42,16384
mA 72,136,168
mA 68,136,164
dL 50,8,23,1024
mA 100,140,164
rT 94,42,18432
mA 96,140,160
rB 96,29,0
s_add_u32 s23, s23, 114688
mA 64,136,160
mA 128,144,160
rB 100,29,2048
mA 160,148,160
s_add_u32 m0, s22, 57344
rB 104,29,4096
mA 164,148,164
mA 132,144,164
rB 108,29,6144
mA 136,144,168
dL 49,8,23,0
mA 168,148,168
rB 112,29,8192
mA 172,148,172
mA 140,144,172
dL 50,8,23,1024
mA 144,144,176
rB 116,29,10240
mA 176,148,176
rB 120,29,12288
mA 180,148,180
s_add_u32 s23, s23, 114688
mA 148,144,180
rB 124,29,14336
mA 152,144,184
mA 184,148,184
mA 188,148,188
mA 156,144,188
mA 220,152,188
mA 252,156,188
mA 248,156,184
mA 216,152,184
s_waitcnt lgkmcnt(0)
s_waitcnt vmcnt(17)
s_barrier
mA 212,152,180
mA 244,156,180
mA 240,156,176
mA 208,152,176
mA 204,152,172
mA 236,156,172
mA 232,156,168
mA 200,152,168
mA 196,152,164
mA 228,156,164
mA 224,156,160
mA 192,152,160
mA 0,64,96
rT 128,35,32768
s_add_u32 m0, s20, 114688
mA 32,68,96
rT 130,35,34816
mA 36,68,100
mA 4,64,100
rT 132,36,32768
mA 8,64,104
dL 43,4,21,0
mA 40,68,104
rT 134,36,34816
mA 44,68,108
rT 136,37,32768
mA 12,64,108
mA 16,64,112
dL 44,4,21,1024
mA 48,68,112
rT 138,37,34816
mA 52,68,116
rT 140,38,32768
mA 20,64,116
rT 142,38,34816
mA 24,64,120
dL 45,4,21,2048
mA 56,68,120
rT 144,39,32768
mA 60,68,124
mA 28,64,124
rT 146,39,34816
mA 92,72,124
dL 46,4,21,3072
mA 124,76,124
rT 148,40,32768
mA 120,76,120
rT 150,40,34816
mA 88,72,120
mA 84,72,116
rT 152,41,32768
s_add_u32 s21, s21, 128
mA 116,76,116
rT 154,41,34816
mA 112,76,112
mA 80,72,112
rT 156,42,32768
mA 76,72,108
mA 108,76,108
rT 158,42,34816
mA 104,76,104
rB 160,30,0
mA 72,72,104
mA 68,72,100
rB 164,30,2048
mA 100,76,100
mA 96,76,96
s_waitcnt vmcnt(12)
rB 168,30,4096
mA 64,72,96
rB 172,30,6144
mA 128,80,96
v_readfirstlane_b32 s92, v61
v_and_b32 v61, 63, v61
v_cmp_ne_u32 vcc, 32, v61
s_cbranch_vccnz L1_spinAK
L1_spinAK_ret:
s_cmp_eq_u32 s92, s93
s_cselect_b32 s93, 0, 0
mA 160,84,96
rB 176,30,8192
mA 164,84,100
mA 132,80,100
rB 180,30,10240
mA 136,80,104
rB 184,30,12288
mA 168,84,104
mA 172,84,108
rB 188,30,14336
mA 140,80,108
mA 144,80,112
v_lshl_add_u32 v60, s3, 6, v1
mA 176,84,112
s_add_u32 s24, s24, 32768
s_cmp_lt_u32 s24, 98304
s_cselect_b32 s24, s24, 0
mA 180,84,116
v_cmp_eq_u32 vcc, 0, v60
v_add_u32 v29, s24, v20
mA 148,80,116
v_mov_b32 v60, 2147483648
v_xor_b32 v30, 64, v29
mA 152,80,120
v_mov_b32 v61, 1
mA 184,84,120
v_cndmask_b32 v60, v60, 0, vcc
mA 188,84,124
s_lshl_b32 s92, s64, 8
mA 156,80,124
s_add_u32 s92, s92, 80220224
mA 220,88,124
mA 252,92,124
mA 248,92,120
mA 216,88,120
s_waitcnt lgkmcnt(0)
s_barrier
mA 212,88,116
mA 244,92,116
mA 240,92,112
mA 208,88,112
mA 204,88,108
mA 236,92,108
mA 232,92,104
mA 200,88,104
mA 196,88,100
mA 228,92,100
mA 224,92,96
mA 192,88,96
mA 0,128,160
s_add_u32 m0, s20, 131072
mA 32,132,160
mA 36,132,164
dL 43,4,21,0
mA 4,128,164
mA 8,128,168
mA 40,132,168
dL 44,4,21,1024
mA 44,132,172
mA 12,128,172
mA 16,128,176
dL 45,4,21,2048
mA 48,132,176
mA 52,132,180
mA 20,128,180
dL 46,4,21,3072
mA 24,128,184
mA 56,132,184
s_add_u32 s21, s21, 128
mA 60,132,188
mA 28,128,188
mA 92,136,188
s_add_u32 m0, s20, 147456
mA 124,140,188
mA 120,140,184
mA 88,136,184
dL 43,4,21,0
mA 84,136,180
mA 116,140,180
mA 112,140,176
dL 44,4,21,1024
mA 80,136,176
mA 76,136,172
mA 108,140,172
dL 45,4,21,2048
mA 104,140,168
mA 72,136,168
dL 46,4,21,3072
mA 68,136,164
mA 100,140,164
mA 96,140,160
s_add_u32 s21, s21, 128
mA 64,136,160
mA 128,144,160
mA 160,148,160
s_add_u32 m0, s20, 98304
mA 164,148,164
mA 132,144,164
mA 136,144,168
dL 43,4,21,0
mA 168,148,168
mA 172,148,172
dL 44,4,21,1024
mA 140,144,172
mA 144,144,176
mA 176,148,176
dL 45,4,21,2048
mA 180,148,180
mA 148,144,180
mA 152,144,184
dL 46,4,21,3072
mA 184,148,184
mA 188,148,188
mA 156,144,188
s_add_u32 s21, s21, 128
mA 220,152,188
mA 252,156,188
mA 248,156,184
mA 216,152,184
mA 212,152,180
mA 244,156,180
mA 240,156,176
mA 208,152,176
mA 204,152,172
buffer_atomic_add v61, v60, s[12:15], s92 offen
mA 236,156,172
mA 232,156,168
mA 200,152,168
mA 196,152,164
mA 228,156,164
mA 224,156,160
mA 192,152,160
s_waitcnt vmcnt(13)
s_barrier
rT 72,51,0
rT 74,51,1024
rT 76,52,0
rT 78,52,1024
rT 80,53,0
rT 82,53,1024
rT 84,54,0
rT 86,54,1024
rT 88,55,0
rT 90,55,1024
rT 92,56,0
rT 94,56,1024
rT 96,57,0
rT 98,57,1024
rB 64,47,16384
rB 68,47,18432
s_waitcnt lgkmcnt(0)
s_barrier
mVz 192,72,64
rT 108,51,8192
s_add_u32 m0, s22, 0
mVz 196,72,68
rT 110,51,9216
rT 112,52,8192
mVz 204,76,68
rT 114,52,9216
rT 116,53,8192
mVz 200,76,64
rT 118,53,9216
mVz 208,80,64
dL 49,8,23,0
mVz 212,80,68
rT 120,54,8192
rT 122,54,9216
mVz 220,84,68
rT 124,55,8192
rT 126,55,9216
mVz 216,84,64
rT 128,56,8192
rT 130,56,9216
mVz 224,88,64
dL 50,8,23,1024
mVz 228,88,68
rT 132,57,8192
rT 134,57,9216
mVz 236,92,68
rB 100,48,16384
rB 104,48,18432
mVz 232,92,64
s_add_u32 s23, s23, 114688
s_waitcnt lgkmcnt(0)
s_waitcnt vmcnt(11)
mVz 240,96,64
s_barrier
mVz 244,96,68
mV 192,108,100
rT 72,51,16384
s_add_u32 m0, s20, 114688
mV 196,108,104
rT 74,51,17408
rT 76,52,16384
mV 204,112,104
rT 78,52,17408
mV 200,112,100
dL 43,4,21,0
mV 208,116,100
rT 80,53,16384
rT 82,53,17408
mV 212,116,104
rT 84,54,16384
rT 86,54,17408
mV 220,120,104
dL 44,4,21,1024
mV 216,120,100
rT 88,55,16384
rT 90,55,17408
mV 224,124,100
rT 92,56,16384
rT 94,56,17408
mV 228,124,104
dL 45,4,21,2048
mV 236,128,104
rT 96,57,16384
rT 98,57,17408
mV 232,128,100
rB 64,47,32768
rB 68,47,34816
mV 240,132,100
dL 46,4,21,3072
mV 244,132,104
s_add_u32 s21, s21, 128
s_waitcnt lgkmcnt(0)
mV 192,72,64
rT 108,51,24576
s_add_u32 m0, s22, 8192
mV 196,72,68
rT 110,51,25600
rT 112,52,24576
mV 204,76,68
rT 114,52,25600
rT 116,53,24576
mV 200,76,64
rT 118,53,25600
mV 208,80,64
dL 49,8,23,0
mV 212,80,68
rT 120,54,24576
rT 122,54,25600
mV 220,84,68
rT 124,55,24576
rT 126,55,25600
mV 216,84,64
rT 128,56,24576
rT 130,56,25600
mV 224,88,64
dL 50,8,23,1024
mV 228,88,68
rT 132,57,24576
rT 134,57,25600
mV 236,92,68
rB 100,48,32768
rB 104,48,34816
mV 232,92,64
s_add_u32 s23, s23, 114688
s_waitcnt lgkmcnt(0)
s_waitcnt vmcnt(13)
mV 240,96,64
s_barrier
mV 244,96,68
mV 192,108,100
rT 72,51,32768
s_add_u32 m0, s20, 131072
mV 196,108,104
rT 74,51,33792
rT 76,52,32768
mV 204,112,104
dL 43,4,21,0
mV 200,112,100
rT 78,52,33792
rT 80,53,32768
mV 208,116,100
dL 44,4,21,1024
mV 212,116,104
rT 82,53,33792
rT 84,54,32768
mV 220,120,104
rT 86,54,33792
mV 216,120,100
dL 45,4,21,2048
mV 224,124,100
rT 88,55,32768
rT 90,55,33792
mV 228,124,104
dL 46,4,21,3072
mV 236,128,104
rT 92,56,32768
rT 94,56,33792
mV 232,128,100
s_add_u32 s21, s21, 128
rT 96,57,32768
rT 98,57,33792
mV 240,132,100
rB 64,47,49152
s_add_u32 m0, s22, 16384
mV 244,132,104
rB 68,47,51200
dL 49,8,23,0
dL 50,8,23,1024
s_waitcnt lgkmcnt(0)
s_add_u32 s23, s23, 114688
mV 192,72,64
rT 108,51,40960
s_add_u32 m0, s22, 24576
mV 196,72,68
rT 110,51,41984
rT 112,52,40960
mV 204,76,68
rT 114,52,41984
rT 116,53,40960
mV 200,76,64
rT 118,53,41984
mV 208,80,64
dL 49,8,23,0
mV 212,80,68
rT 120,54,40960
rT 122,54,41984
mV 220,84,68
rT 124,55,40960
rT 126,55,41984
mV 216,84,64
rT 128,56,40960
rT 130,56,41984
mV 224,88,64
dL 50,8,23,1024
mV 228,88,68
rT 132,57,40960
rT 134,57,41984
mV 236,92,68
rB 100,48,49152
rB 104,48,51200
mV 232,92,64
s_add_u32 s23, s23, 114688
s_waitcnt lgkmcnt(0)
s_waitcnt vmcnt(17)
mV 240,96,64
s_barrier
mV 244,96,68
mV 192,108,100
rT 72,51,49152
s_add_u32 m0, s20, 147456
mV 196,108,104
rT 74,51,50176
rT 76,52,49152
mV 204,112,104
dL 43,4,21,0
mV 200,112,100
rT 78,52,50176
rT 80,53,49152
mV 208,116,100
dL 44,4,21,1024
mV 212,116,104
rT 82,53,50176
rT 84,54,49152
mV 220,120,104
rT 86,54,50176
mV 216,120,100
dL 45,4,21,2048
mV 224,124,100
rT 88,55,49152
rT 90,55,50176
mV 228,124,104
dL 46,4,21,3072
mV 236,128,104
rT 92,56,49152
rT 94,56,50176
mV 232,128,100
s_add_u32 s21, s21, 128
rT 96,57,49152
rT 98,57,50176
mV 240,132,100
rB 64,47,0
s_add_u32 m0, s22, 32768
mV 244,132,104
rB 68,47,2048
dL 49,8,23,0
dL 50,8,23,1024
s_waitcnt lgkmcnt(0)
s_add_u32 s23, s23, 114688
mV 192,72,64
rT 108,51,57344
s_add_u32 m0, s22, 40960
mV 196,72,68
rT 110,51,58368
rT 112,52,57344
mV 204,76,68
rT 114,52,58368
rT 116,53,57344
mV 200,76,64
rT 118,53,58368
mV 208,80,64
dL 49,8,23,0
mV 212,80,68
rT 120,54,57344
rT 122,54,58368
mV 220,84,68
rT 124,55,57344
rT 126,55,58368
mV 216,84,64
rT 128,56,57344
rT 130,56,58368
mV 224,88,64
dL 50,8,23,1024
mV 228,88,68
rT 132,57,57344
rT 134,57,58368
mV 236,92,68
rB 100,48,0
rB 104,48,2048
mV 232,92,64
s_add_u32 s23, s23, 114688
s_waitcnt lgkmcnt(0)
s_waitcnt vmcnt(16)
mV 240,96,64
s_barrier
mV 244,96,68
mV 192,108,100
rT 72,51,0
rT 74,51,1024
mV 196,108,104
rT 76,52,0
rT 78,52,1024
mV 204,112,104
rT 80,53,0
rT 82,53,1024
mV 200,112,100
rT 84,54,0
rT 86,54,1024
mV 208,116,100
rT 88,55,0
mV 212,116,104
rT 90,55,1024
rT 92,56,0
mV 220,120,104
rT 94,56,1024
rT 96,57,0
mV 216,120,100
rT 98,57,1024
rB 64,47,16384
mV 224,124,100
rB 68,47,18432
mV 228,124,104
mV 236,128,104
mV 232,128,100
s_waitcnt lgkmcnt(0)
mV 240,132,100
mV 244,132,104
mV 192,72,64
rT 108,51,8192
s_add_u32 m0, s32, 65536
mV 196,72,68
rT 110,51,9216
rT 112,52,8192
mV 204,76,68
rT 114,52,9216
mV 200,76,64
dL 8,56,33,0
mV 208,80,64
rT 116,53,8192
rT 118,53,9216
mV 212,80,68
rT 120,54,8192
rT 122,54,9216
mV 220,84,68
dL 9,56,33,1024
mV 216,84,64
rT 124,55,8192
rT 126,55,9216
mV 224,88,64
rT 128,56,8192
mV 228,88,68
dL 10,56,33,2048
mV 236,92,68
rT 130,56,9216
rT 132,57,8192
mV 232,92,64
rT 134,57,9216
rB 100,48,16384
mV 240,96,64
dL 11,56,33,3072
mV 244,96,68
rB 104,48,18432
s_add_u32 s33, s33, 262144
s_waitcnt lgkmcnt(0)
s_waitcnt vmcnt(12)
s_barrier
mV 192,108,100
rT 72,51,16384
s_add_u32 m0, s30, 0
mV 196,108,104
rT 74,51,17408
mV 204,112,104
dL 2,4,31,0
mV 200,112,100
rT 76,52,16384
rT 78,52,17408
mV 208,116,100
dL 3,4,31,1024
mV 212,116,104
rT 80,53,16384
rT 82,53,17408
mV 220,120,104
dL 4,4,31,2048
mV 216,120,100
rT 84,54,16384
rT 86,54,17408
mV 224,124,100
dL 5,4,31,3072
mV 228,124,104
rT 88,55,16384
rT 90,55,17408
mV 236,128,104
s_add_u32 s31, s31, 128
rT 92,56,16384
rT 94,56,17408
mV 232,128,100
s_add_u32 m0, s32, 81920
rT 96,57,16384
rT 98,57,17408
mV 240,132,100
dL 8,56,33,0
mV 244,132,104
rB 64,47,32768
rB 68,47,34816
dL 9,56,33,1024
dL 10,56,33,2048
dL 11,56,33,3072
s_waitcnt lgkmcnt(0)
s_add_u32 s33, s33, 262144
mV 192,72,64
rT 108,51,24576
s_add_u32 m0, s32, 98304
mV 196,72,68
rT 110,51,25600
rT 112,52,24576
mV 204,76,68
rT 114,52,25600
mV 200,76,64
dL 8,56,33,0
mV 208,80,64
rT 116,53,24576
rT 118,53,25600
mV 212,80,68
rT 120,54,24576
rT 122,54,25600
mV 220,84,68
dL 9,56,33,1024
mV 216,84,64
rT 124,55,24576
rT 126,55,25600
mV 224,88,64
rT 128,56,24576
mV 228,88,68
dL 10,56,33,2048
mV 236,92,68
rT 130,56,25600
rT 132,57,24576
mV 232,92,64
rT 134,57,25600
rB 100,48,32768
mV 240,96,64
dL 11,56,33,3072
mV 244,96,68
rB 104,48,34816
s_add_u32 s33, s33, 262144
s_waitcnt lgkmcnt(0)
s_waitcnt vmcnt(16)
s_barrier
mV 192,108,100
rT 72,51,32768
s_add_u32 m0, s30, 49152
mV 196,108,104
rT 74,51,33792
rT 76,52,32768
mV 204,112,104
rT 78,52,33792
mV 200,112,100
dL 2,4,31,0
mV 208,116,100
rT 80,53,32768
rT 82,53,33792
mV 212,116,104
rT 84,54,32768
rT 86,54,33792
mV 220,120,104
dL 3,4,31,1024
mV 216,120,100
rT 88,55,32768
rT 90,55,33792
mV 224,124,100
rT 92,56,32768
mV 228,124,104
dL 4,4,31,2048
mV 236,128,104
rT 94,56,33792
rT 96,57,32768
mV 232,128,100
rT 98,57,33792
rB 64,47,49152
mV 240,132,100
dL 5,4,31,3072
mV 244,132,104
rB 68,47,51200
s_add_u32 s31, s31, 128
s_waitcnt lgkmcnt(0)
mV 192,72,64
rT 108,51,40960
s_add_u32 m0, s32, 114688
mV 196,72,68
rT 110,51,41984
rT 112,52,40960
mV 204,76,68
rT 114,52,41984
mV 200,76,64
dL 8,56,33,0
mV 208,80,64
rT 116,53,40960
rT 118,53,41984
mV 212,80,68
rT 120,54,40960
rT 122,54,41984
mV 220,84,68
dL 9,56,33,1024
mV 216,84,64
rT 124,55,40960
rT 126,55,41984
mV 224,88,64
rT 128,56,40960
mV 228,88,68
dL 10,56,33,2048
mV 236,92,68
rT 130,56,41984
rT 132,57,40960
mV 232,92,64
rT 134,57,41984
rB 100,48,49152
mV 240,96,64
dL 11,56,33,3072
mV 244,96,68
rB 104,48,51200
s_add_u32 s33, s33, 262144
s_waitcnt lgkmcnt(0)
s_barrier
mV 192,108,100
s_add_u32 m0, s32, 131072
mV 196,108,104
mV 204,112,104
dL 8,56,33,0
mV 200,112,100
mV 208,116,100
dL 9,56,33,1024
mV 212,116,104
mV 220,120,104
dL 10,56,33,2048
mV 216,120,100
mV 224,124,100
dL 11,56,33,3072
mV 228,124,104
mV 236,128,104
s_add_u32 s33, s33, 262144
mV 232,128,100
mV 240,132,100
mV 244,132,104
s_add_u32 m0, s30, 32768
s_nop 0
dL 2,4,31,0
dL 3,4,31,1024
dL 4,4,31,2048
dL 5,4,31,3072
s_add_u32 s31, s31, 128
s_add_u32 m0, s32, 147456
s_nop 0
dL 8,56,33,0
dL 9,56,33,1024
dL 10,56,33,2048
dL 11,56,33,3072
s_add_u32 s33, s33, 262144
s_add_u32 m0, s30, 16384
s_nop 0
dL 2,4,31,0
dL 3,4,31,1024
dL 4,4,31,2048
dL 5,4,31,3072
s_add_u32 s31, s31, 128
s_lshl_b32 s35, s67, 7
s_lshl_b32 s73, s66, 4
s_add_u32 s35, s35, s73
s_lshl_b32 s73, s72, 3
s_add_u32 s35, s35, s73
s_lshl_b32 s35, s35, 3
s_lshl_b32 s73, s71, 2
s_add_u32 s35, s35, s73
s_lshl_b32 s35, s35, 10
aR 140,0
aR 141,1
aR 142,2
aR 143,3
aR 144,32
aR 145,33
aR 146,34
aR 147,35
cP 136,140,141
cP 137,142,143
cP 138,144,145
cP 139,146,147
buffer_store_dwordx4 v[136:139], v0, s[12:15], s35 offen offset:0 sc1
v_mov_b32 v63, 0xbdd2d3e8
v_lshlrev_b32 v62, 3, v1
v_mov_b32 v58, 0xbdd2d3e8
v_mov_b32 v59, 0xc0135761
v_mov_b32 v56, 1.0
s_lshl_b32 s37, s69, 3
s_lshl_b32 s38, s3, 1
s_add_u32 s37, s37, s38
s_mul_i32 s37, s37, 56
s_mul_i32 s38, s64, 7
s_add_u32 s37, s37, s38
s_lshl_b32 s37, s37, 9
s_add_u32 s37, s37, 71303168
s_lshl_b32 s92, s64, 8
aR 152,64
aR 153,65
aR 154,66
aR 155,67
aR 156,96
aR 157,97
aR 158,98
aR 159,99
cP 148,152,153
cP 149,154,155
cP 150,156,157
cP 151,158,159
buffer_store_dwordx4 v[148:151], v0, s[12:15], s35 offen offset:1024 sc1
s_add_u32 s92, s92, 80222272
v_mul_f32 v248, v192, v192
v_mul_f32 v249, v193, v193
v_mul_f32 v250, v194, v194
v_mul_f32 v251, v195, v195
v_fmaak_f32 v248, v63, v248, 0xc0135761
v_fmaak_f32 v249, v63, v249, 0xc0135761
v_fmaak_f32 v250, v63, v250, 0xc0135761
v_fmaak_f32 v251, v63, v251, 0xc0135761
v_mul_f32 v248, v192, v248
v_mul_f32 v249, v193, v249
v_mul_f32 v250, v194, v250
v_mul_f32 v251, v195, v251
v_exp_f32 v248, v248
aR 164,128
aR 165,129
aR 166,130
aR 167,131
aR 168,160
aR 169,161
aR 170,162
aR 171,163
cP 160,164,165
cP 161,166,167
cP 162,168,169
cP 163,170,171
buffer_store_dwordx4 v[160:163], v0, s[12:15], s35 offen offset:2048 sc1
v_exp_f32 v249, v249
v_exp_f32 v250, v250
v_exp_f32 v251, v251
v_add_f32 v248, 1.0, v248
v_add_f32 v249, 1.0, v249
v_add_f32 v250, 1.0, v250
v_add_f32 v251, 1.0, v251
v_rcp_f32 v248, v248
v_rcp_f32 v249, v249
v_rcp_f32 v250, v250
v_rcp_f32 v251, v251
v_mul_f32 v192, v192, v248
v_mul_f32 v193, v193, v249
v_mul_f32 v194, v194, v250
aR 176,192
aR 177,193
aR 178,194
aR 179,195
aR 180,224
aR 181,225
aR 182,226
aR 183,227
cP 172,176,177
cP 173,178,179
cP 174,180,181
cP 175,182,183
buffer_store_dwordx4 v[172:175], v0, s[12:15], s35 offen offset:3072 sc1
v_mul_f32 v195, v195, v251
cP 192,192,193
cP 193,194,195
buffer_store_dwordx2 v[192:193], v62, s[12:15], s37 offen offset:0 sc1
v_mul_f32 v252, v200, v200
v_mul_f32 v253, v201, v201
v_mul_f32 v254, v202, v202
v_mul_f32 v255, v203, v203
v_fmaak_f32 v252, v63, v252, 0xc0135761
v_fmaak_f32 v253, v63, v253, 0xc0135761
v_fmaak_f32 v254, v63, v254, 0xc0135761
v_fmaak_f32 v255, v63, v255, 0xc0135761
v_mul_f32 v252, v200, v252
v_mul_f32 v253, v201, v253
s_add_u32 s35, s35, 8192
aR 140,4
aR 141,5
aR 142,6
aR 143,7
aR 144,36
aR 145,37
aR 146,38
aR 147,39
cP 136,140,141
cP 137,142,143
cP 138,144,145
cP 139,146,147
buffer_store_dwordx4 v[136:139], v0, s[12:15], s35 offen offset:0 sc1
v_mul_f32 v254, v202, v254
v_mul_f32 v255, v203, v255
v_exp_f32 v252, v252
v_exp_f32 v253, v253
v_exp_f32 v254, v254
v_exp_f32 v255, v255
v_add_f32 v252, 1.0, v252
v_add_f32 v253, 1.0, v253
v_add_f32 v254, 1.0, v254
v_add_f32 v255, 1.0, v255
v_rcp_f32 v252, v252
v_rcp_f32 v253, v253
v_rcp_f32 v254, v254
v_rcp_f32 v255, v255
aR 152,68
aR 153,69
aR 154,70
aR 155,71
aR 156,100
aR 157,101
aR 158,102
aR 159,103
cP 148,152,153
cP 149,154,155
cP 150,156,157
cP 151,158,159
buffer_store_dwordx4 v[148:151], v0, s[12:15], s35 offen offset:1024 sc1
v_mul_f32 v200, v200, v252
v_mul_f32 v201, v201, v253
v_mul_f32 v202, v202, v254
v_mul_f32 v203, v203, v255
cP 200,200,201
cP 201,202,203
buffer_store_dwordx2 v[200:201], v62, s[12:15], s37 offen offset:512 sc1
v_mul_f32 v248, v208, v208
v_mul_f32 v249, v209, v209
v_mul_f32 v250, v210, v210
v_mul_f32 v251, v211, v211
v_fmaak_f32 v248, v63, v248, 0xc0135761
v_fmaak_f32 v249, v63, v249, 0xc0135761
v_fmaak_f32 v250, v63, v250, 0xc0135761
aR 164,132
aR 165,133
aR 166,134
aR 167,135
aR 168,164
aR 169,165
aR 170,166
aR 171,167
cP 160,164,165
cP 161,166,167
cP 162,168,169
cP 163,170,171
buffer_store_dwordx4 v[160:163], v0, s[12:15], s35 offen offset:2048 sc1
v_fmaak_f32 v251, v63, v251, 0xc0135761
v_mul_f32 v248, v208, v248
v_mul_f32 v249, v209, v249
v_mul_f32 v250, v210, v250
v_mul_f32 v251, v211, v251
v_exp_f32 v248, v248
v_exp_f32 v249, v249
v_exp_f32 v250, v250
v_exp_f32 v251, v251
v_add_f32 v248, 1.0, v248
v_add_f32 v249, 1.0, v249
v_add_f32 v250, 1.0, v250
v_add_f32 v251, 1.0, v251
v_rcp_f32 v248, v248
aR 176,196
aR 177,197
aR 178,198
aR 179,199
aR 180,228
aR 181,229
aR 182,230
aR 183,231
cP 172,176,177
cP 173,178,179
cP 174,180,181
cP 175,182,183
buffer_store_dwordx4 v[172:175], v0, s[12:15], s35 offen offset:3072 sc1
v_rcp_f32 v249, v249
v_rcp_f32 v250, v250
v_rcp_f32 v251, v251
v_mul_f32 v208, v208, v248
v_mul_f32 v209, v209, v249
v_mul_f32 v210, v210, v250
v_mul_f32 v211, v211, v251
cP 208,208,209
cP 209,210,211
buffer_store_dwordx2 v[208:209], v62, s[12:15], s37 offen offset:1024 sc1
v_mul_f32 v252, v216, v216
v_mul_f32 v253, v217, v217
v_mul_f32 v254, v218, v218
v_mul_f32 v255, v219, v219
s_add_u32 s35, s35, 8192
aR 140,8
aR 141,9
aR 142,10
aR 143,11
aR 144,40
aR 145,41
aR 146,42
aR 147,43
cP 136,140,141
cP 137,142,143
cP 138,144,145
cP 139,146,147
buffer_store_dwordx4 v[136:139], v0, s[12:15], s35 offen offset:0 sc1
v_fmaak_f32 v252, v63, v252, 0xc0135761
v_fmaak_f32 v253, v63, v253, 0xc0135761
v_fmaak_f32 v254, v63, v254, 0xc0135761
v_fmaak_f32 v255, v63, v255, 0xc0135761
v_mul_f32 v252, v216, v252
v_mul_f32 v253, v217, v253
v_mul_f32 v254, v218, v254
v_mul_f32 v255, v219, v255
v_exp_f32 v252, v252
v_exp_f32 v253, v253
v_exp_f32 v254, v254
v_exp_f32 v255, v255
v_add_f32 v252, 1.0, v252
v_add_f32 v253, 1.0, v253
aR 152,72
aR 153,73
aR 154,74
aR 155,75
aR 156,104
aR 157,105
aR 158,106
aR 159,107
cP 148,152,153
cP 149,154,155
cP 150,156,157
cP 151,158,159
buffer_store_dwordx4 v[148:151], v0, s[12:15], s35 offen offset:1024 sc1
v_add_f32 v254, 1.0, v254
v_add_f32 v255, 1.0, v255
v_rcp_f32 v252, v252
v_rcp_f32 v253, v253
v_rcp_f32 v254, v254
v_rcp_f32 v255, v255
v_mul_f32 v216, v216, v252
v_mul_f32 v217, v217, v253
v_mul_f32 v218, v218, v254
v_mul_f32 v219, v219, v255
cP 216,216,217
cP 217,218,219
buffer_store_dwordx2 v[216:217], v62, s[12:15], s37 offen offset:1536 sc1
v_mul_f32 v248, v224, v224
aR 164,136
aR 165,137
aR 166,138
aR 167,139
aR 168,168
aR 169,169
aR 170,170
aR 171,171
cP 160,164,165
cP 161,166,167
cP 162,168,169
cP 163,170,171
buffer_store_dwordx4 v[160:163], v0, s[12:15], s35 offen offset:2048 sc1
v_mul_f32 v249, v225, v225
v_mul_f32 v250, v226, v226
v_mul_f32 v251, v227, v227
v_fmaak_f32 v248, v63, v248, 0xc0135761
v_fmaak_f32 v249, v63, v249, 0xc0135761
v_fmaak_f32 v250, v63, v250, 0xc0135761
v_fmaak_f32 v251, v63, v251, 0xc0135761
v_mul_f32 v248, v224, v248
v_mul_f32 v249, v225, v249
v_mul_f32 v250, v226, v250
v_mul_f32 v251, v227, v251
v_exp_f32 v248, v248
v_exp_f32 v249, v249
v_exp_f32 v250, v250
aR 176,200
aR 177,201
aR 178,202
aR 179,203
aR 180,232
aR 181,233
aR 182,234
aR 183,235
cP 172,176,177
cP 173,178,179
cP 174,180,181
cP 175,182,183
buffer_store_dwordx4 v[172:175], v0, s[12:15], s35 offen offset:3072 sc1
v_exp_f32 v251, v251
v_add_f32 v248, 1.0, v248
v_add_f32 v249, 1.0, v249
v_add_f32 v250, 1.0, v250
v_add_f32 v251, 1.0, v251
v_rcp_f32 v248, v248
v_rcp_f32 v249, v249
v_rcp_f32 v250, v250
v_rcp_f32 v251, v251
v_mul_f32 v224, v224, v248
v_mul_f32 v225, v225, v249
v_mul_f32 v226, v226, v250
v_mul_f32 v227, v227, v251
cP 224,224,225
s_add_u32 s35, s35, 8192
aR 140,12
aR 141,13
aR 142,14
aR 143,15
aR 144,44
aR 145,45
aR 146,46
aR 147,47
cP 136,140,141
cP 137,142,143
cP 138,144,145
cP 139,146,147
buffer_store_dwordx4 v[136:139], v0, s[12:15], s35 offen offset:0 sc1
cP 225,226,227
buffer_store_dwordx2 v[224:225], v62, s[12:15], s37 offen offset:2048 sc1
v_mul_f32 v252, v232, v232
v_mul_f32 v253, v233, v233
v_mul_f32 v254, v234, v234
v_mul_f32 v255, v235, v235
v_fmaak_f32 v252, v63, v252, 0xc0135761
v_fmaak_f32 v253, v63, v253, 0xc0135761
v_fmaak_f32 v254, v63, v254, 0xc0135761
v_fmaak_f32 v255, v63, v255, 0xc0135761
v_mul_f32 v252, v232, v252
v_mul_f32 v253, v233, v253
v_mul_f32 v254, v234, v254
v_mul_f32 v255, v235, v255
aR 152,76
aR 153,77
aR 154,78
aR 155,79
aR 156,108
aR 157,109
aR 158,110
aR 159,111
cP 148,152,153
cP 149,154,155
cP 150,156,157
cP 151,158,159
buffer_store_dwordx4 v[148:151], v0, s[12:15], s35 offen offset:1024 sc1
v_exp_f32 v252, v252
v_exp_f32 v253, v253
v_exp_f32 v254, v254
v_exp_f32 v255, v255
v_add_f32 v252, 1.0, v252
v_add_f32 v253, 1.0, v253
v_add_f32 v254, 1.0, v254
v_add_f32 v255, 1.0, v255
v_rcp_f32 v252, v252
v_rcp_f32 v253, v253
v_rcp_f32 v254, v254
v_rcp_f32 v255, v255
v_mul_f32 v232, v232, v252
v_mul_f32 v233, v233, v253
aR 164,140
aR 165,141
aR 166,142
aR 167,143
aR 168,172
aR 169,173
aR 170,174
aR 171,175
cP 160,164,165
cP 161,166,167
cP 162,168,169
cP 163,170,171
buffer_store_dwordx4 v[160:163], v0, s[12:15], s35 offen offset:2048 sc1
v_mul_f32 v234, v234, v254
v_mul_f32 v235, v235, v255
cP 232,232,233
cP 233,234,235
buffer_store_dwordx2 v[232:233], v62, s[12:15], s37 offen offset:2560 sc1
v_mul_f32 v248, v240, v240
v_mul_f32 v249, v241, v241
v_mul_f32 v250, v242, v242
v_mul_f32 v251, v243, v243
v_fmaak_f32 v248, v63, v248, 0xc0135761
v_fmaak_f32 v249, v63, v249, 0xc0135761
v_fmaak_f32 v250, v63, v250, 0xc0135761
v_fmaak_f32 v251, v63, v251, 0xc0135761
v_mul_f32 v248, v240, v248
aR 176,204
aR 177,205
aR 178,206
aR 179,207
aR 180,236
aR 181,237
aR 182,238
aR 183,239
cP 172,176,177
cP 173,178,179
cP 174,180,181
cP 175,182,183
buffer_store_dwordx4 v[172:175], v0, s[12:15], s35 offen offset:3072 sc1
v_mul_f32 v249, v241, v249
v_mul_f32 v250, v242, v250
v_mul_f32 v251, v243, v251
v_exp_f32 v248, v248
v_exp_f32 v249, v249
v_exp_f32 v250, v250
v_exp_f32 v251, v251
v_add_f32 v248, 1.0, v248
v_add_f32 v249, 1.0, v249
v_add_f32 v250, 1.0, v250
v_add_f32 v251, 1.0, v251
v_rcp_f32 v248, v248
v_rcp_f32 v249, v249
v_rcp_f32 v250, v250
v_rcp_f32 v251, v251
s_add_u32 s35, s35, 8192
aR 140,16
aR 141,17
aR 142,18
aR 143,19
aR 144,48
aR 145,49
aR 146,50
aR 147,51
cP 136,140,141
cP 137,142,143
cP 138,144,145
cP 139,146,147
buffer_store_dwordx4 v[136:139], v0, s[12:15], s35 offen offset:0 sc1
v_mul_f32 v240, v240, v248
v_mul_f32 v241, v241, v249
v_mul_f32 v242, v242, v250
v_mul_f32 v243, v243, v251
cP 240,240,241
cP 241,242,243
buffer_store_dwordx2 v[240:241], v62, s[12:15], s37 offen offset:3072 sc1
s_add_u32 s37, s37, 28672
v_mul_f32 v252, v196, v196
v_mul_f32 v253, v197, v197
v_mul_f32 v254, v198, v198
v_mul_f32 v255, v199, v199
v_fmaak_f32 v252, v63, v252, 0xc0135761
v_fmaak_f32 v253, v63, v253, 0xc0135761
aR 152,80
aR 153,81
aR 154,82
aR 155,83
aR 156,112
aR 157,113
aR 158,114
aR 159,115
cP 148,152,153
cP 149,154,155
cP 150,156,157
cP 151,158,159
buffer_store_dwordx4 v[148:151], v0, s[12:15], s35 offen offset:1024 sc1
v_fmaak_f32 v254, v63, v254, 0xc0135761
v_fmaak_f32 v255, v63, v255, 0xc0135761
v_mul_f32 v252, v196, v252
v_mul_f32 v253, v197, v253
v_mul_f32 v254, v198, v254
v_mul_f32 v255, v199, v255
v_exp_f32 v252, v252
v_exp_f32 v253, v253
v_exp_f32 v254, v254
v_exp_f32 v255, v255
v_add_f32 v252, 1.0, v252
v_add_f32 v253, 1.0, v253
v_add_f32 v254, 1.0, v254
v_add_f32 v255, 1.0, v255
aR 164,144
aR 165,145
aR 166,146
aR 167,147
aR 168,176
aR 169,177
aR 170,178
aR 171,179
cP 160,164,165
cP 161,166,167
cP 162,168,169
cP 163,170,171
buffer_store_dwordx4 v[160:163], v0, s[12:15], s35 offen offset:2048 sc1
v_rcp_f32 v252, v252
v_rcp_f32 v253, v253
v_rcp_f32 v254, v254
v_rcp_f32 v255, v255
v_mul_f32 v196, v196, v252
v_mul_f32 v197, v197, v253
v_mul_f32 v198, v198, v254
v_mul_f32 v199, v199, v255
cP 196,196,197
cP 197,198,199
buffer_store_dwordx2 v[196:197], v62, s[12:15], s37 offen offset:0 sc1
v_mul_f32 v248, v204, v204
v_mul_f32 v249, v205, v205
v_mul_f32 v250, v206, v206
aR 176,208
aR 177,209
aR 178,210
aR 179,211
aR 180,240
aR 181,241
aR 182,242
aR 183,243
cP 172,176,177
cP 173,178,179
cP 174,180,181
cP 175,182,183
buffer_store_dwordx4 v[172:175], v0, s[12:15], s35 offen offset:3072 sc1
v_mul_f32 v251, v207, v207
v_fmaak_f32 v248, v63, v248, 0xc0135761
v_fmaak_f32 v249, v63, v249, 0xc0135761
v_fmaak_f32 v250, v63, v250, 0xc0135761
v_fmaak_f32 v251, v63, v251, 0xc0135761
v_mul_f32 v248, v204, v248
v_mul_f32 v249, v205, v249
v_mul_f32 v250, v206, v250
v_mul_f32 v251, v207, v251
v_exp_f32 v248, v248
v_exp_f32 v249, v249
v_exp_f32 v250, v250
v_exp_f32 v251, v251
v_add_f32 v248, 1.0, v248
s_add_u32 s35, s35, 8192
aR 140,20
aR 141,21
aR 142,22
aR 143,23
aR 144,52
aR 145,53
aR 146,54
aR 147,55
cP 136,140,141
cP 137,142,143
cP 138,144,145
cP 139,146,147
buffer_store_dwordx4 v[136:139], v0, s[12:15], s35 offen offset:0 sc1
v_add_f32 v249, 1.0, v249
v_add_f32 v250, 1.0, v250
v_add_f32 v251, 1.0, v251
v_rcp_f32 v248, v248
v_rcp_f32 v249, v249
v_rcp_f32 v250, v250
v_rcp_f32 v251, v251
v_mul_f32 v204, v204, v248
v_mul_f32 v205, v205, v249
v_mul_f32 v206, v206, v250
v_mul_f32 v207, v207, v251
cP 204,204,205
cP 205,206,207
buffer_store_dwordx2 v[204:205], v62, s[12:15], s37 offen offset:512 sc1
aR 152,84
aR 153,85
aR 154,86
aR 155,87
aR 156,116
aR 157,117
aR 158,118
aR 159,119
cP 148,152,153
cP 149,154,155
cP 150,156,157
cP 151,158,159
buffer_store_dwordx4 v[148:151], v0, s[12:15], s35 offen offset:1024 sc1
v_mul_f32 v252, v212, v212
v_mul_f32 v253, v213, v213
v_mul_f32 v254, v214, v214
v_mul_f32 v255, v215, v215
v_fmaak_f32 v252, v63, v252, 0xc0135761
v_fmaak_f32 v253, v63, v253, 0xc0135761
v_fmaak_f32 v254, v63, v254, 0xc0135761
v_fmaak_f32 v255, v63, v255, 0xc0135761
v_mul_f32 v252, v212, v252
v_mul_f32 v253, v213, v253
v_mul_f32 v254, v214, v254
v_mul_f32 v255, v215, v255
v_exp_f32 v252, v252
v_exp_f32 v253, v253
aR 164,148
aR 165,149
aR 166,150
aR 167,151
aR 168,180
aR 169,181
aR 170,182
aR 171,183
cP 160,164,165
cP 161,166,167
cP 162,168,169
cP 163,170,171
buffer_store_dwordx4 v[160:163], v0, s[12:15], s35 offen offset:2048 sc1
v_exp_f32 v254, v254
v_exp_f32 v255, v255
v_add_f32 v252, 1.0, v252
v_add_f32 v253, 1.0, v253
v_add_f32 v254, 1.0, v254
v_add_f32 v255, 1.0, v255
v_rcp_f32 v252, v252
v_rcp_f32 v253, v253
v_rcp_f32 v254, v254
v_rcp_f32 v255, v255
v_mul_f32 v212, v212, v252
v_mul_f32 v213, v213, v253
v_mul_f32 v214, v214, v254
v_mul_f32 v215, v215, v255
aR 176,212
aR 177,213
aR 178,214
aR 179,215
aR 180,244
aR 181,245
aR 182,246
aR 183,247
cP 172,176,177
cP 173,178,179
cP 174,180,181
cP 175,182,183
buffer_store_dwordx4 v[172:175], v0, s[12:15], s35 offen offset:3072 sc1
cP 212,212,213
cP 213,214,215
buffer_store_dwordx2 v[212:213], v62, s[12:15], s37 offen offset:1024 sc1
v_mul_f32 v248, v220, v220
v_mul_f32 v249, v221, v221
v_mul_f32 v250, v222, v222
v_mul_f32 v251, v223, v223
v_fmaak_f32 v248, v63, v248, 0xc0135761
v_fmaak_f32 v249, v63, v249, 0xc0135761
v_fmaak_f32 v250, v63, v250, 0xc0135761
v_fmaak_f32 v251, v63, v251, 0xc0135761
v_mul_f32 v248, v220, v248
v_mul_f32 v249, v221, v249
v_mul_f32 v250, v222, v250
s_add_u32 s35, s35, 8192
aR 140,24
aR 141,25
aR 142,26
aR 143,27
aR 144,56
aR 145,57
aR 146,58
aR 147,59
cP 136,140,141
cP 137,142,143
cP 138,144,145
cP 139,146,147
buffer_store_dwordx4 v[136:139], v0, s[12:15], s35 offen offset:0 sc1
v_mul_f32 v251, v223, v251
v_exp_f32 v248, v248
v_exp_f32 v249, v249
v_exp_f32 v250, v250
v_exp_f32 v251, v251
v_add_f32 v248, 1.0, v248
v_add_f32 v249, 1.0, v249
v_add_f32 v250, 1.0, v250
v_add_f32 v251, 1.0, v251
v_rcp_f32 v248, v248
v_rcp_f32 v249, v249
v_rcp_f32 v250, v250
v_rcp_f32 v251, v251
v_mul_f32 v220, v220, v248
aR 152,88
aR 153,89
aR 154,90
aR 155,91
aR 156,120
aR 157,121
aR 158,122
aR 159,123
cP 148,152,153
cP 149,154,155
cP 150,156,157
cP 151,158,159
buffer_store_dwordx4 v[148:151], v0, s[12:15], s35 offen offset:1024 sc1
v_mul_f32 v221, v221, v249
v_mul_f32 v222, v222, v250
v_mul_f32 v223, v223, v251
cP 220,220,221
cP 221,222,223
buffer_store_dwordx2 v[220:221], v62, s[12:15], s37 offen offset:1536 sc1
v_mul_f32 v252, v228, v228
v_mul_f32 v253, v229, v229
v_mul_f32 v254, v230, v230
v_mul_f32 v255, v231, v231
v_fmaak_f32 v252, v63, v252, 0xc0135761
v_fmaak_f32 v253, v63, v253, 0xc0135761
v_fmaak_f32 v254, v63, v254, 0xc0135761
v_fmaak_f32 v255, v63, v255, 0xc0135761
aR 164,152
aR 165,153
aR 166,154
aR 167,155
aR 168,184
aR 169,185
aR 170,186
aR 171,187
cP 160,164,165
cP 161,166,167
cP 162,168,169
cP 163,170,171
buffer_store_dwordx4 v[160:163], v0, s[12:15], s35 offen offset:2048 sc1
v_mul_f32 v252, v228, v252
v_mul_f32 v253, v229, v253
v_mul_f32 v254, v230, v254
v_mul_f32 v255, v231, v255
v_exp_f32 v252, v252
v_exp_f32 v253, v253
v_exp_f32 v254, v254
v_exp_f32 v255, v255
v_add_f32 v252, 1.0, v252
v_add_f32 v253, 1.0, v253
v_add_f32 v254, 1.0, v254
v_add_f32 v255, 1.0, v255
v_rcp_f32 v252, v252
v_rcp_f32 v253, v253
aR 176,216
aR 177,217
aR 178,218
aR 179,219
aR 180,248
aR 181,249
aR 182,250
aR 183,251
cP 172,176,177
cP 173,178,179
cP 174,180,181
cP 175,182,183
buffer_store_dwordx4 v[172:175], v0, s[12:15], s35 offen offset:3072 sc1
v_rcp_f32 v254, v254
v_rcp_f32 v255, v255
v_mul_f32 v228, v228, v252
v_mul_f32 v229, v229, v253
v_mul_f32 v230, v230, v254
v_mul_f32 v231, v231, v255
cP 228,228,229
cP 229,230,231
buffer_store_dwordx2 v[228:229], v62, s[12:15], s37 offen offset:2048 sc1
v_mul_f32 v248, v236, v236
v_mul_f32 v249, v237, v237
v_mul_f32 v250, v238, v238
v_mul_f32 v251, v239, v239
v_fmaak_f32 v248, v63, v248, 0xc0135761
s_add_u32 s35, s35, 8192
aR 140,28
aR 141,29
aR 142,30
aR 143,31
aR 144,60
aR 145,61
aR 146,62
aR 147,63
cP 136,140,141
cP 137,142,143
cP 138,144,145
cP 139,146,147
buffer_store_dwordx4 v[136:139], v0, s[12:15], s35 offen offset:0 sc1
v_fmaak_f32 v249, v63, v249, 0xc0135761
v_fmaak_f32 v250, v63, v250, 0xc0135761
v_fmaak_f32 v251, v63, v251, 0xc0135761
v_mul_f32 v248, v236, v248
v_mul_f32 v249, v237, v249
v_mul_f32 v250, v238, v250
v_mul_f32 v251, v239, v251
v_exp_f32 v248, v248
v_exp_f32 v249, v249
v_exp_f32 v250, v250
v_exp_f32 v251, v251
v_add_f32 v248, 1.0, v248
v_add_f32 v249, 1.0, v249
v_add_f32 v250, 1.0, v250
aR 152,92
aR 153,93
aR 154,94
aR 155,95
aR 156,124
aR 157,125
aR 158,126
aR 159,127
cP 148,152,153
cP 149,154,155
cP 150,156,157
cP 151,158,159
buffer_store_dwordx4 v[148:151], v0, s[12:15], s35 offen offset:1024 sc1
v_add_f32 v251, 1.0, v251
v_rcp_f32 v248, v248
v_rcp_f32 v249, v249
v_rcp_f32 v250, v250
v_rcp_f32 v251, v251
v_mul_f32 v236, v236, v248
v_mul_f32 v237, v237, v249
v_mul_f32 v238, v238, v250
v_mul_f32 v239, v239, v251
cP 236,236,237
cP 237,238,239
buffer_store_dwordx2 v[236:237], v62, s[12:15], s37 offen offset:2560 sc1
v_mul_f32 v252, v244, v244
v_mul_f32 v253, v245, v245
aR 164,156
aR 165,157
aR 166,158
aR 167,159
aR 168,188
aR 169,189
aR 170,190
aR 171,191
cP 160,164,165
cP 161,166,167
cP 162,168,169
cP 163,170,171
buffer_store_dwordx4 v[160:163], v0, s[12:15], s35 offen offset:2048 sc1
v_mul_f32 v254, v246, v246
v_mul_f32 v255, v247, v247
v_fmaak_f32 v252, v63, v252, 0xc0135761
v_fmaak_f32 v253, v63, v253, 0xc0135761
v_fmaak_f32 v254, v63, v254, 0xc0135761
v_fmaak_f32 v255, v63, v255, 0xc0135761
v_mul_f32 v252, v244, v252
v_mul_f32 v253, v245, v253
v_mul_f32 v254, v246, v254
v_mul_f32 v255, v247, v255
v_exp_f32 v252, v252
v_exp_f32 v253, v253
v_exp_f32 v254, v254
v_exp_f32 v255, v255
aR 176,220
aR 177,221
aR 178,222
aR 179,223
aR 180,252
aR 181,253
aR 182,254
aR 183,255
cP 172,176,177
cP 173,178,179
cP 174,180,181
cP 175,182,183
buffer_store_dwordx4 v[172:175], v0, s[12:15], s35 offen offset:3072 sc1
v_add_f32 v252, 1.0, v252
v_add_f32 v253, 1.0, v253
v_add_f32 v254, 1.0, v254
v_add_f32 v255, 1.0, v255
v_rcp_f32 v252, v252
v_rcp_f32 v253, v253
v_rcp_f32 v254, v254
v_rcp_f32 v255, v255
v_mul_f32 v244, v244, v252
v_mul_f32 v245, v245, v253
v_mul_f32 v246, v246, v254
v_mul_f32 v247, v247, v255
cP 244,244,245
cP 245,246,247
buffer_store_dwordx2 v[244:245], v62, s[12:15], s37 offen offset:3072 sc1
s_add_u32 s35, s35, 8192
s_waitcnt vmcnt(63)
s_barrier
rT 32,12,0
rT 34,12,2048
rT 36,13,0
rT 38,13,2048
rT 40,14,0
rT 42,14,2048
rT 44,15,0
rT 46,15,2048
rT 48,16,0
rT 50,16,2048
rT 52,17,0
rT 54,17,2048
rT 56,18,0
rT 58,18,2048
rT 60,19,0
rT 62,19,2048
rB 64,6,0
rB 68,6,2048
rB 72,6,4096
rB 76,6,6144
s_waitcnt lgkmcnt(0)
s_barrier
mVz 128,32,64
rT 80,12,16384
s_add_u32 m0, s32, 65536
mVz 144,36,64
rT 82,12,18432
rT 84,13,16384
mVz 148,36,68
rT 86,13,18432
mVz 132,32,68
rT 88,14,16384
mVz 136,32,72
rT 90,14,18432
mVz 152,36,72
dL 8,56,33,0
mVz 156,36,76
rT 92,15,16384
rT 94,15,18432
mVz 140,32,76
rT 96,16,16384
mVz 172,40,76
rT 98,16,18432
mVz 188,44,76
rT 100,17,16384
mVz 184,44,72
dL 9,56,33,1024
mVz 168,40,72
rT 102,17,18432
rT 104,18,16384
mVz 164,40,68
rT 106,18,18432
mVz 180,44,68
rT 108,19,16384
mVz 176,44,64
rT 110,19,18432
mVz 160,40,64
dL 10,56,33,2048
mVz 192,48,64
rB 112,7,0
rB 116,7,2048
mVz 208,52,64
rB 120,7,4096
mVz 212,52,68
rB 124,7,6144
mVz 196,48,68
mVz 200,48,72
dL 11,56,33,3072
mVz 216,52,72
mVz 220,52,76
mVz 204,48,76
mVz 236,56,76
mVz 252,60,76
s_add_u32 s33, s33, 262144
s_waitcnt lgkmcnt(0)
mVz 248,60,72
s_barrier
mVz 232,56,72
mVz 228,56,68
mVz 244,60,68
mVz 240,60,64
mVz 224,56,64
mV 128,80,112
rT 32,12,32768
s_add_u32 m0, s30, 0
mV 144,84,112
rT 34,12,34816
rT 36,13,32768
mV 148,84,116
dL 2,4,31,0
mV 132,80,116
rT 38,13,34816
rT 40,14,32768
mV 136,80,120
rT 42,14,34816
mV 152,84,120
dL 3,4,31,1024
mV 156,84,124
rT 44,15,32768
rT 46,15,34816
mV 140,80,124
dL 4,4,31,2048
mV 172,88,124
rT 48,16,32768
rT 50,16,34816
mV 188,92,124
rT 52,17,32768
mV 184,92,120
v_lshl_add_u32 v20, s3, 6, v1
mV 168,88,120
dL 5,4,31,3072
mV 164,88,116
rT 54,17,34816
v_cmp_eq_u32 vcc, 0, v20
mV 180,92,116
rT 56,18,32768
s_add_u32 s31, s31, 128
mV 176,92,112
rT 58,18,34816
v_mov_b32 v20, 2147483648
mV 160,88,112
rT 60,19,32768
rT 62,19,34816
mV 192,96,112
s_add_u32 m0, s32, 81920
v_mov_b32 v21, 1
mV 208,100,112
rB 64,6,49152
rB 68,6,51200
mV 212,100,116
v_cndmask_b32 v20, v20, 0, vcc
mV 196,96,116
rB 72,6,53248
mV 200,96,120
dL 8,56,33,0
mV 216,100,120
rB 76,6,55296
s_lshl_b32 s35, s67, 8
mV 220,100,124
dL 9,56,33,1024
mV 204,96,124
s_add_u32 s35, s35, 80216128
s_waitcnt vmcnt(11)
mV 236,104,124
dL 10,56,33,2048
mV 252,108,124
dL 11,56,33,3072
mV 248,108,120
s_waitcnt lgkmcnt(0)
s_barrier
mV 232,104,120
s_add_u32 s33, s33, 262144
mV 228,104,116
mV 244,108,116
mV 240,108,112
mV 224,104,112
mV 128,32,64
rT 80,12,49152
s_add_u32 m0, s32, 98304
mV 144,36,64
rT 82,12,51200
mV 148,36,68
buffer_atomic_add v21, v20, s[12:15], s35 offen
mV 132,32,68
rT 84,13,49152
rT 86,13,51200
mV 136,32,72
rT 88,14,49152
rT 90,14,51200
mV 152,36,72
dL 8,56,33,0
mV 156,36,76
rT 92,15,49152
rT 94,15,51200
mV 140,32,76
rT 96,16,49152
mV 172,40,76
rT 98,16,51200
mV 188,44,76
rT 100,17,49152
mV 184,44,72
dL 9,56,33,1024
mV 168,40,72
rT 102,17,51200
rT 104,18,49152
mV 164,40,68
rT 106,18,51200
mV 180,44,68
rT 108,19,49152
mV 176,44,64
rT 110,19,51200
mV 160,40,64
dL 10,56,33,2048
mV 192,48,64
rB 112,7,49152
rB 116,7,51200
mV 208,52,64
rB 120,7,53248
mV 212,52,68
rB 124,7,55296
mV 196,48,68
mV 200,48,72
dL 11,56,33,3072
mV 216,52,72
mV 220,52,76
mV 204,48,76
mV 236,56,76
mV 252,60,76
s_add_u32 s33, s33, 262144
s_waitcnt lgkmcnt(0)
mV 248,60,72
s_barrier
mV 232,56,72
mV 228,56,68
mV 244,60,68
mV 240,60,64
mV 224,56,64
mV 128,80,112
v_add_u32 v12, 65536, v12
s_add_u32 m0, s30, 49152
mV 144,84,112
v_add_u32 v13, 65536, v13
v_add_u32 v14, 65536, v14
mV 148,84,116
v_add_u32 v15, 65536, v15
mV 132,80,116
dL 2,4,31,0
mV 136,80,120
v_add_u32 v16, 65536, v16
v_add_u32 v17, 65536, v17
mV 152,84,120
s_getpc_b64 s[46:47]
s_add_u32 s46, s46, mega_jt@rel32@lo+4
s_addc_u32 s47, s47, mega_jt@rel32@hi+12
mV 156,84,124
v_add_u32 v18, 65536, v18
v_add_u32 v19, 65536, v19
mV 140,80,124
dL 3,4,31,1024
mV 172,88,124
rT 32,12,0
rT 34,12,2048
mV 188,92,124
s_lshl_b32 s101, s2, 6
s_add_u32 s46, s46, s101
s_addc_u32 s47, s47, 0
mV 184,92,120
rT 36,13,0
mV 168,88,120
dL 4,4,31,2048
mV 164,88,116
rT 38,13,2048
rT 40,14,0
mV 180,92,116
rT 42,14,2048
s_load_dwordx4 s[76:79], s[46:47], 0
mV 176,92,112
rT 44,15,0
mV 160,88,112
dL 5,4,31,3072
mV 192,96,112
rT 46,15,2048
rT 48,16,0
mV 208,100,112
rT 50,16,2048
rT 52,17,0
mV 212,100,116
s_add_u32 s31, s31, 128
rT 54,17,2048
rT 56,18,0
mV 196,96,116
rT 58,18,2048
s_add_u32 m0, s32, 114688
mV 200,96,120
rT 60,19,0
rT 62,19,2048
mV 216,100,120
rB 64,6,32768
rB 68,6,34816
mV 220,100,124
dL 8,56,33,0
mV 204,96,124
rB 72,6,36864
rB 76,6,38912
mV 236,104,124
dL 9,56,33,1024
mV 252,108,124
dL 10,56,33,2048
mV 248,108,120
dL 11,56,33,3072
mV 232,104,120
s_waitcnt lgkmcnt(0)
s_barrier
mV 228,104,116
s_add_u32 s33, s33, 262144
mV 244,108,116
mV 240,108,112
mV 224,104,112
mV 128,32,64
rT 80,12,16384
s_add_u32 m0, s32, 131072
mV 144,36,64
v_accvgpr_write_b32 a0, 0
mV 148,36,68
rT 82,12,18432
v_accvgpr_write_b32 a1, 0
mV 132,32,68
rT 84,13,16384
rT 86,13,18432
mV 136,32,72
v_accvgpr_write_b32 a2, 0
mV 152,36,72
rT 88,14,16384
v_accvgpr_write_b32 a3, 0
mV 156,36,76
rT 90,14,18432
mV 140,32,76
dL 8,56,33,0
mV 172,40,76
rT 92,15,16384
v_accvgpr_write_b32 a4, 0
mV 188,44,76
rT 94,15,18432
v_accvgpr_write_b32 a5, 0
mV 184,44,72
rT 96,16,16384
rT 98,16,18432
mV 168,40,72
v_accvgpr_write_b32 a6, 0
mV 164,40,68
rT 100,17,16384
mV 180,44,68
dL 9,56,33,1024
mV 176,44,64
v_accvgpr_write_b32 a7, 0
mV 160,40,64
rT 102,17,18432
rT 104,18,16384
mV 192,48,64
v_accvgpr_write_b32 a8, 0
mV 208,52,64
rT 106,18,18432
v_accvgpr_write_b32 a9, 0
mV 212,52,68
rT 108,19,16384
rT 110,19,18432
mV 196,48,68
v_accvgpr_write_b32 a10, 0
mV 200,48,72
dL 10,56,33,2048
mV 216,52,72
rB 112,7,32768
v_accvgpr_write_b32 a11, 0
mV 220,52,76
rB 116,7,34816
rB 120,7,36864
mV 204,48,76
v_accvgpr_write_b32 a12, 0
mV 236,56,76
rB 124,7,38912
v_accvgpr_write_b32 a13, 0
mV 252,60,76
dL 11,56,33,3072
mV 248,60,72
v_accvgpr_write_b32 a14, 0
v_accvgpr_write_b32 a15, 0
mV 232,56,72
v_accvgpr_write_b32 a16, 0
s_add_u32 s33, s33, 262144
mV 228,56,68
v_accvgpr_write_b32 a17, 0
s_waitcnt lgkmcnt(0)
mV 244,60,68
s_waitcnt vmcnt(25)
s_barrier
v_accvgpr_write_b32 a18, 0
mV 240,60,64
v_accvgpr_write_b32 a19, 0
v_accvgpr_write_b32 a20, 0
mV 224,56,64
v_accvgpr_write_b32 a21, 0
mV 128,80,112
v_add_u32 v12, 4294901760, v12
s_add_u32 m0, s30, 32768
mV 144,84,112
v_add_u32 v13, 4294901760, v13
v_accvgpr_write_b32 a22, 0
mV 148,84,116
v_add_u32 v14, 4294901760, v14
v_add_u32 v15, 4294901760, v15
mV 132,80,116
v_accvgpr_write_b32 a23, 0
mV 136,80,120
dL 2,4,31,0
mV 152,84,120
v_add_u32 v16, 4294901760, v16
v_add_u32 v17, 4294901760, v17
mV 156,84,124
v_accvgpr_write_b32 a24, 0
v_add_u32 v18, 4294901760, v18
mV 140,80,124
v_add_u32 v19, 4294901760, v19
mV 172,88,124
dL 3,4,31,1024
mV 188,92,124
v_accvgpr_write_b32 a25, 0
mV 184,92,120
rT 32,12,0
rT 34,12,2048
mV 168,88,120
rT 36,13,0
v_accvgpr_write_b32 a26, 0
mV 164,88,116
dL 4,4,31,2048
mV 180,92,116
rT 38,13,2048
rT 40,14,0
mV 176,92,112
v_accvgpr_write_b32 a27, 0
mV 160,88,112
rT 42,14,2048
rT 44,15,0
mV 192,96,112
v_accvgpr_write_b32 a28, 0
mV 208,100,112
dL 5,4,31,3072
mV 212,100,116
rT 46,15,2048
rT 48,16,0
mV 196,96,116
v_accvgpr_write_b32 a29, 0
mV 200,96,120
rT 50,16,2048
rT 52,17,0
mV 216,100,120
s_add_u32 s31, s31, 128
v_accvgpr_write_b32 a30, 0
mV 220,100,124
rT 54,17,2048
rT 56,18,0
mV 204,96,124
v_accvgpr_write_b32 a31, 0
mV 236,104,124
rT 58,18,2048
s_add_u32 m0, s32, 147456
mV 252,108,124
rT 60,19,0
v_accvgpr_write_b32 a32, 0
mV 248,108,120
rT 62,19,2048
rB 64,6,16384
mV 232,104,120
v_accvgpr_write_b32 a33, 0
mV 228,104,116
rB 68,6,18432
mV 244,108,116
dL 8,56,33,0
mV 240,108,112
rB 72,6,20480
rB 76,6,22528
mV 224,104,112
v_accvgpr_write_b32 a34, 0
dL 9,56,33,1024
v_accvgpr_write_b32 a35, 0
v_accvgpr_write_b32 a36, 0
dL 10,56,33,2048
v_accvgpr_write_b32 a37, 0
v_accvgpr_write_b32 a38, 0
dL 11,56,33,3072
s_waitcnt lgkmcnt(0)
s_waitcnt vmcnt(25)
s_barrier
v_accvgpr_write_b32 a39, 0
s_add_u32 s33, s33, 262144
v_accvgpr_write_b32 a40, 0
v_accvgpr_write_b32 a41, 0
v_accvgpr_write_b32 a42, 0
mV 128,32,64
rT 80,12,16384
s_add_u32 m0, s32, 65536
mV 144,36,64
v_accvgpr_write_b32 a43, 0
mV 148,36,68
rT 82,12,18432
rT 84,13,16384
mV 132,32,68
v_accvgpr_write_b32 a44, 0
mV 136,32,72
rT 86,13,18432
v_accvgpr_write_b32 a45, 0
mV 152,36,72
rT 88,14,16384
rT 90,14,18432
mV 156,36,76
v_accvgpr_write_b32 a46, 0
mV 140,32,76
dL 8,56,33,0
mV 172,40,76
rT 92,15,16384
v_accvgpr_write_b32 a47, 0
mV 188,44,76
rT 94,15,18432
rT 96,16,16384
mV 184,44,72
v_accvgpr_write_b32 a48, 0
mV 168,40,72
rT 98,16,18432
v_accvgpr_write_b32 a49, 0
mV 164,40,68
rT 100,17,16384
mV 180,44,68
dL 9,56,33,1024
mV 176,44,64
rT 102,17,18432
v_accvgpr_write_b32 a50, 0
mV 160,40,64
rT 104,18,16384
v_accvgpr_write_b32 a51, 0
mV 192,48,64
rT 106,18,18432
rT 108,19,16384
mV 208,52,64
v_accvgpr_write_b32 a52, 0
mV 212,52,68
rT 110,19,18432
mV 196,48,68
dL 10,56,33,2048
mV 200,48,72
v_accvgpr_write_b32 a53, 0
mV 216,52,72
rB 112,7,16384
rB 116,7,18432
mV 220,52,76
v_accvgpr_write_b32 a54, 0
mV 204,48,76
rB 120,7,20480
v_accvgpr_write_b32 a55, 0
mV 236,56,76
rB 124,7,22528
v_accvgpr_write_b32 a56, 0
mV 252,60,76
dL 11,56,33,3072
mV 248,60,72
v_accvgpr_write_b32 a57, 0
v_accvgpr_write_b32 a58, 0
mV 232,56,72
v_accvgpr_write_b32 a59, 0
s_add_u32 s33, s33, 262144
mV 228,56,68
s_waitcnt lgkmcnt(0)
s_waitcnt vmcnt(24)
s_barrier
mV 244,60,68
v_accvgpr_write_b32 a60, 0
v_accvgpr_write_b32 a61, 0
mV 240,60,64
v_accvgpr_write_b32 a62, 0
v_accvgpr_write_b32 a63, 0
mV 224,56,64
mV 128,80,112
rT 32,12,32768
s_add_u32 m0, s32, 81920
mV 144,84,112
v_accvgpr_write_b32 a64, 0
mV 148,84,116
rT 34,12,34816
v_accvgpr_write_b32 a65, 0
mV 132,80,116
rT 36,13,32768
rT 38,13,34816
mV 136,80,120
v_accvgpr_write_b32 a66, 0
mV 152,84,120
rT 40,14,32768
v_accvgpr_write_b32 a67, 0
mV 156,84,124
rT 42,14,34816
mV 140,80,124
dL 8,56,33,0
mV 172,88,124
rT 44,15,32768
v_accvgpr_write_b32 a68, 0
mV 188,92,124
rT 46,15,34816
v_accvgpr_write_b32 a69, 0
mV 184,92,120
rT 48,16,32768
rT 50,16,34816
mV 168,88,120
v_accvgpr_write_b32 a70, 0
mV 164,88,116
rT 52,17,32768
mV 180,92,116
dL 9,56,33,1024
mV 176,92,112
v_accvgpr_write_b32 a71, 0
mV 160,88,112
rT 54,17,34816
rT 56,18,32768
mV 192,96,112
v_accvgpr_write_b32 a72, 0
mV 208,100,112
rT 58,18,34816
v_accvgpr_write_b32 a73, 0
mV 212,100,116
rT 60,19,32768
rT 62,19,34816
mV 196,96,116
v_accvgpr_write_b32 a74, 0
mV 200,96,120
dL 10,56,33,2048
mV 216,100,120
rB 64,6,0
v_accvgpr_write_b32 a75, 0
mV 220,100,124
rB 68,6,2048
rB 72,6,4096
mV 204,96,124
v_accvgpr_write_b32 a76, 0
mV 236,104,124
rB 76,6,6144
v_accvgpr_write_b32 a77, 0
mV 252,108,124
dL 11,56,33,3072
mV 248,108,120
v_accvgpr_write_b32 a78, 0
v_accvgpr_write_b32 a79, 0
mV 232,104,120
v_accvgpr_write_b32 a80, 0
s_add_u32 s33, s33, 262144
mV 228,104,116
v_accvgpr_write_b32 a81, 0
s_waitcnt lgkmcnt(0)
mV 244,108,116
s_waitcnt vmcnt(20)
s_barrier
v_accvgpr_write_b32 a82, 0
mV 240,108,112
v_accvgpr_write_b32 a83, 0
v_accvgpr_write_b32 a84, 0
mV 224,104,112
v_accvgpr_write_b32 a85, 0
mV 128,32,64
rT 80,12,49152
rT 82,12,51200
mV 144,36,64
v_accvgpr_write_b32 a86, 0
mV 148,36,68
rT 84,13,49152
s_mov_b32 s36, 80216128
mV 132,32,68
v_accvgpr_write_b32 a87, 0
mV 136,32,72
rT 86,13,51200
rT 88,14,49152
mV 152,36,72
v_accvgpr_write_b32 a88, 0
mV 156,36,76
rT 90,14,51200
v_accvgpr_write_b32 a89, 0
mV 140,32,76
s_lshl_b32 s101, s64, 1
rT 92,15,49152
rT 94,15,51200
mV 172,40,76
v_accvgpr_write_b32 a90, 0
mV 188,44,76
rT 96,16,49152
v_accvgpr_write_b32 a91, 0
mV 184,44,72
rT 98,16,51200
v_and_b32 v2, 1, v1
mV 168,40,72
rT 100,17,49152
v_accvgpr_write_b32 a92, 0
mV 164,40,68
rT 102,17,51200
v_accvgpr_write_b32 a93, 0
mV 180,44,68
rT 104,18,49152
rT 106,18,51200
mV 176,44,64
v_add_u32 v2, s101, v2
v_accvgpr_write_b32 a94, 0
mV 160,40,64
rT 108,19,49152
v_accvgpr_write_b32 a95, 0
mV 192,48,64
rT 110,19,51200
rB 112,7,0
mV 208,52,64
v_accvgpr_write_b32 a96, 0
mV 212,52,68
rB 116,7,2048
v_mov_b32 v4, 8
mV 196,48,68
v_accvgpr_write_b32 a97, 0
mV 200,48,72
rB 120,7,4096
rB 124,7,6144
mV 216,52,72
v_accvgpr_write_b32 a98, 0
v_lshlrev_b32 v2, 8, v2
mV 220,52,76
v_accvgpr_write_b32 a99, 0
v_accvgpr_write_b32 a100, 0
mV 204,48,76
v_accvgpr_write_b32 a101, 0
mV 236,56,76
mV 252,60,76
v_accvgpr_write_b32 a102, 0
s_waitcnt lgkmcnt(0)
mV 248,60,72
s_waitcnt vmcnt(16)
s_barrier
v_accvgpr_write_b32 a103, 0
mV 232,56,72
mV 228,56,68
v_accvgpr_write_b32 a104, 0
mV 244,60,68
v_accvgpr_write_b32 a105, 0
mV 240,60,64
mV 224,56,64
v_accvgpr_write_b32 a106, 0
mV 128,80,112
v_add_u32 v12, 65536, v12
v_accvgpr_write_b32 a107, 0
mV 144,84,112
v_add_u32 v13, 65536, v13
v_add_u32 v14, 65536, v14
mV 148,84,116
v_accvgpr_write_b32 a108, 0
v_add_u32 v15, 65536, v15
mV 132,80,116
v_add_u32 v16, 65536, v16
v_add_u32 v17, 65536, v17
mV 136,80,120
v_accvgpr_write_b32 a109, 0
v_add_u32 v18, 65536, v18
mV 152,84,120
v_add_u32 v19, 65536, v19
v_accvgpr_write_b32 a110, 0
mV 156,84,124
rT 32,12,0
rT 34,12,2048
mV 140,80,124
v_accvgpr_write_b32 a111, 0
mV 172,88,124
rT 36,13,0
rT 38,13,2048
mV 188,92,124
buffer_load_dword v3, v2, s[12:15], s36 offen sc1
mV 184,92,120
v_accvgpr_write_b32 a112, 0
mV 168,88,120
rT 40,14,0
rT 42,14,2048
mV 164,88,116
v_accvgpr_write_b32 a113, 0
mV 180,92,116
rT 44,15,0
rT 46,15,2048
mV 176,92,112
v_accvgpr_write_b32 a114, 0
mV 160,88,112
rT 48,16,0
rT 50,16,2048
mV 192,96,112
v_accvgpr_write_b32 a115, 0
mV 208,100,112
rT 52,17,0
rT 54,17,2048
mV 212,100,116
rT 56,18,0
v_accvgpr_write_b32 a116, 0
mV 196,96,116
rT 58,18,2048
rT 60,19,0
mV 200,96,120
v_accvgpr_write_b32 a117, 0
mV 216,100,120
rT 62,19,2048
rB 64,6,49152
mV 220,100,124
v_accvgpr_write_b32 a118, 0
mV 204,96,124
rB 68,6,51200
rB 72,6,53248
mV 236,104,124
v_accvgpr_write_b32 a119, 0
mV 252,108,124
rB 76,6,55296
v_accvgpr_write_b32 a120, 0
mV 248,108,120
v_accvgpr_write_b32 a121, 0
v_accvgpr_write_b32 a122, 0
mV 232,104,120
v_accvgpr_write_b32 a123, 0
s_waitcnt lgkmcnt(0)
mV 228,104,116
s_waitcnt vmcnt(9)
s_barrier
v_accvgpr_write_b32 a124, 0
mV 244,108,116
v_accvgpr_write_b32 a125, 0
v_accvgpr_write_b32 a126, 0
mV 240,108,112
v_accvgpr_write_b32 a127, 0
mV 224,104,112
mV 128,32,64
rT 80,12,16384
rT 82,12,18432
mV 144,36,64
rT 84,13,16384
mV 148,36,68
rT 86,13,18432
mV 132,32,68
rT 88,14,16384
mV 136,32,72
rT 90,14,18432
mV 152,36,72
rT 92,15,16384
mV 156,36,76
rT 94,15,18432
mV 140,32,76
rT 96,16,16384
mV 172,40,76
rT 98,16,18432
mV 188,44,76
rT 100,17,16384
mV 184,44,72
rT 102,17,18432
mV 168,40,72
rT 104,18,16384
mV 164,40,68
rT 106,18,18432
mV 180,44,68
rT 108,19,16384
mV 176,44,64
rT 110,19,18432
mV 160,40,64
rB 112,7,49152
mV 192,48,64
rB 116,7,51200
mV 208,52,64
rB 120,7,53248
mV 212,52,68
rB 124,7,55296
mV 196,48,68
mV 200,48,72
mV 216,52,72
mV 220,52,76
mV 204,48,76
mV 236,56,76
mV 252,60,76
s_waitcnt lgkmcnt(0)
s_waitcnt vmcnt(5)
s_barrier
mV 248,60,72
s_waitcnt vmcnt(0)
mV 232,56,72
mV 228,56,68
v_cmp_gt_u32 vcc, v4, v3
s_cbranch_vccnz L1_spinKK
L1_spinKK_ret:
mV 244,60,68
mV 240,60,64
mV 224,56,64
mV 128,80,112
v_add_u32 v12, 4294901760, v12
s_lshl_b32 s101, s64, 1
mV 144,84,112
v_add_u32 v13, 4294901760, v13
v_and_b32 v24, 1, v1
mV 148,84,116
v_add_u32 v14, 4294901760, v14
v_add_u32 v24, s101, v24
mV 132,80,116
v_add_u32 v15, 4294901760, v15
v_lshlrev_b32 v24, 8, v24
mV 136,80,120
v_add_u32 v16, 4294901760, v16
v_add_u32 v24, 16, v24
mV 152,84,120
v_add_u32 v17, 4294901760, v17
v_and_b32 v25, 7, v1
mV 156,84,124
v_add_u32 v18, 4294901760, v18
v_add_u32 v25, 16, v25
mV 140,80,124
v_add_u32 v19, 4294901760, v19
v_lshlrev_b32 v25, 8, v25
mV 172,88,124
rT 32,12,0
v_cmp_gt_u32 vcc, 8, v1
mV 188,92,124
rT 34,12,2048
v_mov_b32 v26, 8
mV 184,92,120
rT 36,13,0
v_mov_b32 v27, 32
mV 168,88,120
rT 38,13,2048
v_cndmask_b32 v24, v24, v25, vcc
mV 164,88,116
rT 40,14,0
v_cndmask_b32 v26, v26, v27, vcc
mV 180,92,116
rT 42,14,2048
s_mov_b32 s101, 80216128
mV 176,92,112
rT 44,15,0
v_add_u32 v24, s101, v24
mV 160,88,112
rT 46,15,2048
s_lshl_b32 s64, s3, 13
mV 192,96,112
rT 48,16,0
s_and_b32 s101, s77, 255
mV 208,100,112
rT 50,16,2048
s_lshl_b32 s101, s101, 5
mV 212,100,116
rT 52,17,0
s_and_b32 s58, s78, 255
mV 196,96,116
rT 54,17,2048
s_add_u32 s101, s101, s58
mV 200,96,120
rT 56,18,0
s_lshl_b32 s101, s101, 15
mV 216,100,120
rT 58,18,2048
s_add_u32 s58, s101, s64
mV 220,100,124
rT 60,19,0
s_bfe_u32 s60, s78, 0x80008
mV 204,96,124
rT 62,19,2048
rB 64,6,32768
mV 236,104,124
s_lshl_b32 s60, s60, 15
rB 68,6,34816
s_add_u32 s60, s60, s101
mV 252,108,124
rB 72,6,36864
mV 248,108,120
s_bitcmp1_b32 s76, 0
s_cselect_b32 s60, s60, 0
rB 76,6,38912
mV 232,104,120
s_add_u32 s59, s58, 16777216
s_add_u32 s61, s60, 16777216
mV 228,104,116
s_cmp_lt_u32 s58, s60
s_cselect_b32 s62, s58, 2147483648
s_add_u32 s58, s58, 32768
mV 244,108,116
s_add_u32 m0, s64, 0
s_nop 0
dS 0,12,62,0
mV 240,108,112
dS 0,12,62,1024
mV 224,104,112
dS 0,12,62,2048
dS 0,12,62,3072
s_waitcnt lgkmcnt(0)
s_barrier
s_add_u32 m0, s64, 4096
s_add_u32 s62, s62, 4096
dS 0,12,62,0
dS 0,12,62,1024
dS 0,12,62,2048
dS 0,12,62,3072
mV 128,32,64
rT 80,12,16384
rT 82,12,18432
mV 144,36,64
rT 84,13,16384
mV 148,36,68
rT 86,13,18432
mV 132,32,68
rT 88,14,16384
mV 136,32,72
rT 90,14,18432
mV 152,36,72
rT 92,15,16384
mV 156,36,76
rT 94,15,18432
mV 140,32,76
rT 96,16,16384
mV 172,40,76
rT 98,16,18432
mV 188,44,76
rT 100,17,16384
mV 184,44,72
rT 102,17,18432
mV 168,40,72
rT 104,18,16384
mV 164,40,68
rT 106,18,18432
mV 180,44,68
rT 108,19,16384
mV 176,44,64
rT 110,19,18432
mV 160,40,64
rB 112,7,32768
mV 192,48,64
rB 116,7,34816
mV 208,52,64
rB 120,7,36864
mV 212,52,68
rB 124,7,38912
mV 196,48,68
mV 200,48,72
mV 216,52,72
mV 220,52,76
mV 204,48,76
mV 236,56,76
mV 252,60,76
s_waitcnt lgkmcnt(0)
s_barrier
mV 248,60,72
mV 232,56,72
mV 228,56,68
mV 244,60,68
mV 240,60,64
mV 224,56,64
mV 128,80,112
s_cmp_lt_u32 s58, s60
s_cselect_b32 s62, s58, 2147483648
mV 144,84,112
mV 148,84,116
s_add_u32 s58, s58, 32768
mV 132,80,116
mV 136,80,120
s_add_u32 m0, s64, 32768
mV 152,84,120
mV 156,84,124
dS 0,12,62,0
mV 140,80,124
mV 172,88,124
dS 0,12,62,1024
mV 188,92,124
mV 184,92,120
dS 0,12,62,2048
mV 168,88,120
mV 164,88,116
dS 0,12,62,3072
mV 180,92,116
mV 176,92,112
mV 160,88,112
s_add_u32 m0, s64, 36864
mV 192,96,112
mV 208,100,112
s_add_u32 s62, s62, 4096
mV 212,100,116
mV 196,96,116
dS 0,12,62,0
mV 200,96,120
mV 216,100,120
dS 0,12,62,1024
mV 220,100,124
mV 204,96,124
dS 0,12,62,2048
mV 236,104,124
mV 252,108,124
dS 0,12,62,3072
mV 248,108,120
mV 232,104,120
buffer_load_dword v25, v24, s[12:15], 0 offen sc1
mV 228,104,116
mV 244,108,116
mV 240,108,112
mV 224,104,112
s_branch L1_done
L1_spinAK:
s_sleep 16
buffer_load_dword v61, v60, s[60:63], 0 offen offset:128 sc1
s_waitcnt vmcnt(0)
v_readfirstlane_b32 s92, v61
v_and_b32 v61, 63, v61
v_cmp_ne_u32 vcc, 32, v61
s_cbranch_vccnz L1_spinAK
s_branch L1_spinAK_ret
L1_spinKK:
s_mov_b64 exec, vcc
s_sleep 40
buffer_load_dword v3, v2, s[12:15], s36 offen sc1
s_waitcnt vmcnt(0)
v_cmp_gt_u32 vcc, v4, v3
s_cbranch_vccnz L1_spinKK
s_mov_b64 exec, -1
s_branch L1_spinKK_ret
L1_spin:
s_sleep 16
buffer_load_dword v253, v252, s[60:63], s39 offen sc1
s_waitcnt vmcnt(0)
v_readfirstlane_b32 s73, v253
s_nop 0
s_cmp_ge_u32 s73, 8
s_cbranch_scc0 L1_spin
s_branch L1_spin_ret
L1_spinAV:
s_sleep 16
buffer_load_dword v61, v60, s[60:63], 0 offen offset:128 sc1
s_waitcnt vmcnt(0)
v_readfirstlane_b32 s92, v61
v_and_b32 v61, 63, v61
v_cmp_ne_u32 vcc, 32, v61
s_cbranch_vccnz L1_spinAV
s_branch L1_spinAV_ret
L1_spinKV:
s_mov_b64 exec, vcc
s_sleep 40
buffer_load_dword v27, v26, s[12:15], s36 offen sc1
s_waitcnt vmcnt(0)
v_cmp_gt_u32 vcc, v28, v27
s_cbranch_vccnz L1_spinKV
s_mov_b64 exec, -1
s_branch L1_spinKV_ret
L1_V:
s_mov_b32 s74, s30
s_mov_b32 s75, s31
s_mov_b32 s78, s40
s_mov_b32 s79, s41
s_mov_b32 s52, s28
s_mov_b32 s53, s29
s_mov_b32 s54, 8388608
s_mov_b32 s55, 0x20000
s_mov_b32 s56, s24
s_mov_b32 s57, s25
s_mov_b32 s58, 3670016
s_mov_b32 s59, 0x20000
s_mov_b32 s40, s42
s_mov_b32 s41, s43
s_mov_b32 s42, 896
s_mov_b32 s43, 0x20000
s_mov_b32 s44, s36
s_mov_b32 s45, s37
s_mov_b32 s46, 8388608
s_mov_b32 s47, 0x20000
s_mul_i32 s21, s69, 114688
s_mul_i32 s23, s64, 224
s_add_u32 s23, s23, 1792
s_mul_i32 s20, s3, 28672
s_add_u32 s21, s21, s20
s_mul_i32 s20, s3, 4096
v_lshrrev_b32 v240, 3, v1
v_mul_u32_u24 v240, 896, v240
v_bfe_u32 v242, v1, 4, 1
v_and_b32 v241, 7, v1
v_xor_b32 v241, v241, v242
v_lshl_add_u32 v240, v241, 4, v240
v_add_u32 v43, 0, v240
v_xor_b32 v44, 32, v240
v_add_u32 v44, 6144, v44
v_xor_b32 v45, 64, v240
v_add_u32 v45, 12288, v45
v_xor_b32 v46, 96, v240
v_add_u32 v46, 18432, v46
s_mul_i32 s22, s3, 28672
s_add_u32 s23, s23, s22
s_mul_i32 s22, s3, 2048
v_lshrrev_b32 v240, 4, v1
v_and_b32 v241, 15, v1
v_lshlrev_b32 v242, 1, v240
v_xor_b32 v241, v241, v242
s_and_b32 s101, s3, 1
s_lshl_b32 s101, s101, 3
v_xor_b32 v241, s101, v241
v_lshlrev_b32 v241, 4, v241
v_mul_u32_u24 v240, 3584, v240
v_add_u32 v49, v241, v240
v_xor_b32 v242, 0, v241
v_cmp_gt_u32 vcc, 224, v242
v_mov_b32 v242, 0x80000000
s_nop 0
v_cndmask_b32 v49, v242, v49, vcc
v_add_u32 v50, v241, v240
v_add_u32 v50, 13312, v50
v_xor_b32 v242, 0, v241
v_cmp_gt_u32 vcc, 224, v242
v_mov_b32 v242, 0x80000000
s_nop 0
v_cndmask_b32 v50, v242, v50, vcc
s_add_u32 m0, s20, 98304
s_nop 0
dL 43,4,21,0
dL 44,4,21,1024
dL 45,4,21,2048
dL 46,4,21,3072
s_add_u32 s21, s21, 128
s_add_u32 m0, s22, 0
s_nop 0
dL 49,8,23,0
dL 50,8,23,1024
s_add_u32 s23, s23, 114688
s_add_u32 m0, s22, 8192
s_nop 0
dL 49,8,23,0
dL 50,8,23,1024
s_add_u32 s23, s23, 114688
s_add_u32 m0, s20, 114688
s_nop 0
dL 43,4,21,0
dL 44,4,21,1024
dL 45,4,21,2048
dL 46,4,21,3072
s_add_u32 s21, s21, 128
s_add_u32 m0, s22, 16384
s_nop 0
dL 49,8,23,0
dL 50,8,23,1024
s_add_u32 s23, s23, 114688
s_add_u32 m0, s22, 24576
s_nop 0
dL 49,8,23,0
dL 50,8,23,1024
s_add_u32 s23, s23, 114688
v_lshlrev_b32 v244, 4, v1
v_lshl_add_u32 v244, s3, 10, v244
v_cmp_gt_u32 vcc, 256, v244
v_mov_b32 v245, 2147483648
s_lshl_b32 s101, s2, 8
v_cndmask_b32 v244, v245, v244, vcc
v_mov_b32 v245, 0
s_add_u32 s101, s101, 80216064
buffer_store_dword v245, v244, s[12:15], s101 offen sc1
s_lshl_b32 s73, s3, 5
v_and_b32 v240, 15, v1
v_lshrrev_b32 v241, 1, v240
v_lshrrev_b32 v242, 4, v1
v_xor_b32 v241, v241, v242
v_lshrrev_b32 v242, 2, v240
v_lshlrev_b32 v242, 3, v242
v_and_b32 v240, 3, v240
v_add_u32 v240, v240, v242
v_add_u32 v240, s73, v240
v_lshlrev_b32 v240, 7, v240
v_lshl_add_u32 v47, v241, 4, v240
v_add_u32 v47, 98304, v47
v_xor_b32 v48, 64, v47
s_mov_b32 s34, 0
v_lshrrev_b32 v240, 4, v1
v_bfe_u32 v241, v1, 2, 2
v_lshl_add_u32 v242, v240, 3, v241
v_and_b32 v240, 1, v240
v_lshl_add_u32 v240, v240, 2, v241
v_lshrrev_b32 v240, 0, v240
v_lshlrev_b32 v240, 5, v240
v_mul_u32_u24 v242, 256, v242
v_and_b32 v241, 3, v1
v_lshl_add_u32 v242, v241, 3, v242
v_add_u32 v242, 0, v242
s_lshl_b32 s101, s34, 5
v_xad_u32 v51, s101, v240, v242
s_add_u32 s101, s101, 32
v_xad_u32 v52, s101, v240, v242
s_add_u32 s101, s101, 32
v_xad_u32 v53, s101, v240, v242
s_add_u32 s101, s101, 32
v_xad_u32 v54, s101, v240, v242
s_add_u32 s101, s101, 32
v_xad_u32 v55, s101, v240, v242
s_add_u32 s101, s101, 32
v_xad_u32 v56, s101, v240, v242
s_add_u32 s101, s101, 32
v_xad_u32 v57, s101, v240, v242
s_add_u32 s101, s101, 32
s_lshr_b32 s71, s3, 1
s_and_b32 s72, s3, 1
s_lshl_b32 s27, s66, 19
s_lshl_b32 s29, s67, 9
v_lshlrev_b32 v0, 4, v1
s_lshl_b32 s73, s71, 7
s_mul_i32 s26, s3, 131072
s_add_u32 s27, s27, s26
s_mul_i32 s26, s3, 8192
v_lshrrev_b32 v240, 3, v1
v_mul_u32_u24 v240, 2048, v240
v_bfe_u32 v242, v1, 4, 2
v_and_b32 v241, 7, v1
v_xor_b32 v241, v241, v242
v_lshl_add_u32 v240, v241, 4, v240
v_add_u32 v21, 0, v240
v_xor_b32 v22, 64, v240
v_add_u32 v22, 15360, v22
v_add_u32 v23, 30720, v240
v_add_u32 v24, 30720, v22
v_add_u32 v25, 65536, v240
v_add_u32 v26, 65536, v22
v_add_u32 v27, 96256, v240
v_add_u32 v28, 96256, v22
s_mov_b32 s25, 65536
v_and_b32 v240, 15, v1
v_lshrrev_b32 v241, 1, v240
v_lshrrev_b32 v242, 4, v1
v_xor_b32 v241, v241, v242
v_add_u32 v240, s73, v240
v_lshlrev_b32 v240, 7, v240
v_lshl_add_u32 v29, v241, 4, v240
v_mov_b32 v20, v29
s_mov_b32 s24, 65536
v_add_u32 v29, s24, v20
v_xor_b32 v30, 64, v29
s_lshl_b32 s73, s72, 3
s_mul_i32 s28, s3, 65536
s_add_u32 s29, s29, s28
s_mul_i32 s28, s3, 4096
v_lshrrev_b32 v240, 5, v1
v_and_b32 v241, 31, v1
v_lshlrev_b32 v242, 1, v240
v_xor_b32 v241, v241, v242
s_and_b32 s101, s3, 1
s_lshl_b32 s101, s101, 3
v_xor_b32 v241, s101, v241
v_lshlrev_b32 v241, 4, v241
v_mul_u32_u24 v240, 8192, v240
v_add_u32 v31, v241, v240
v_xor_b32 v32, 64, v241
v_add_u32 v32, v32, v240
v_add_u32 v32, 15360, v32
v_add_u32 v33, v241, v240
v_add_u32 v33, 30720, v33
v_xor_b32 v34, 64, v241
v_add_u32 v34, v34, v240
v_add_u32 v34, 46080, v34
v_lshrrev_b32 v240, 4, v1
v_bfe_u32 v241, v1, 2, 2
v_lshl_add_u32 v242, v240, 3, v241
v_and_b32 v240, 1, v240
v_lshl_add_u32 v240, v240, 2, v241
v_lshrrev_b32 v240, 0, v240
v_lshlrev_b32 v240, 5, v240
v_mul_u32_u24 v242, 512, v242
v_and_b32 v241, 3, v1
v_lshl_add_u32 v242, v241, 3, v242
v_add_u32 v242, 98304, v242
s_lshl_b32 s101, s73, 5
v_xad_u32 v35, s101, v240, v242
s_add_u32 s101, s101, 32
v_xad_u32 v36, s101, v240, v242
s_add_u32 s101, s101, 32
v_xad_u32 v37, s101, v240, v242
s_add_u32 s101, s101, 32
v_xad_u32 v38, s101, v240, v242
s_add_u32 s101, s101, 32
v_xad_u32 v39, s101, v240, v242
s_add_u32 s101, s101, 32
v_xad_u32 v40, s101, v240, v242
s_add_u32 s101, s101, 32
v_xad_u32 v41, s101, v240, v242
s_add_u32 s101, s101, 32
v_xad_u32 v42, s101, v240, v242
s_add_u32 s101, s101, 32
s_waitcnt vmcnt(9)
s_barrier
rB 64,47,0
rB 68,47,512
rT 72,51,0
rT 74,51,1024
rT 76,52,0
rT 78,52,1024
rT 80,53,0
rT 82,53,1024
rT 84,54,0
rT 86,54,1024
rT 88,55,0
rT 90,55,1024
rT 92,56,0
rT 94,56,1024
rT 96,57,0
rT 98,57,1024
s_waitcnt lgkmcnt(0)
s_barrier
mVz 192,64,72
rB 100,48,0
s_add_u32 m0, s20, 131072
mVz 220,68,72
rB 104,48,512
mVz 224,68,76
dL 43,4,21,0
mVz 196,64,76
rT 108,51,8192
rT 110,51,9216
mVz 200,64,80
dL 44,4,21,1024
mVz 228,68,80
rT 112,52,8192
rT 114,52,9216
mVz 232,68,84
dL 45,4,21,2048
mVz 204,64,84
rT 116,53,8192
mVz 208,64,88
dL 46,4,21,3072
mVz 236,68,88
rT 118,53,9216
rT 120,54,8192
mVz 240,68,92
s_add_u32 s21, s21, 128
rT 122,54,9216
rT 124,55,8192
mVz 212,64,92
s_add_u32 m0, s22, 32768
rT 126,55,9216
mVz 216,64,96
dL 49,8,23,0
mVz 244,68,96
rT 128,56,8192
rT 130,56,9216
dL 50,8,23,1024
rT 132,57,8192
rT 134,57,9216
s_add_u32 s23, s23, 114688
s_add_u32 m0, s22, 40960
s_nop 0
dL 49,8,23,0
dL 50,8,23,1024
s_waitcnt lgkmcnt(0)
s_waitcnt vmcnt(9)
s_barrier
s_add_u32 s23, s23, 114688
mV 192,100,108
rB 64,47,16384
s_add_u32 m0, s20, 147456
mV 220,104,108
rB 68,47,16896
mV 224,104,112
dL 43,4,21,0
mV 196,100,112
rT 72,51,16384
rT 74,51,17408
mV 200,100,116
dL 44,4,21,1024
mV 228,104,116
rT 76,52,16384
rT 78,52,17408
mV 232,104,120
dL 45,4,21,2048
mV 204,100,120
rT 80,53,16384
mV 208,100,124
dL 46,4,21,3072
mV 236,104,124
rT 82,53,17408
rT 84,54,16384
mV 240,104,128
s_add_u32 s21, s21, 128
rT 86,54,17408
rT 88,55,16384
mV 212,100,128
s_add_u32 m0, s22, 49152
rT 90,55,17408
mV 216,100,132
dL 49,8,23,0
mV 244,104,132
rT 92,56,16384
rT 94,56,17408
dL 50,8,23,1024
rT 96,57,16384
rT 98,57,17408
s_add_u32 s23, s23, 114688
s_add_u32 m0, s22, 57344
s_nop 0
dL 49,8,23,0
dL 50,8,23,1024
s_waitcnt lgkmcnt(0)
s_add_u32 s23, s23, 114688
mV 192,64,72
rB 100,48,16384
s_add_u32 m0, s22, 0
mV 220,68,72
rB 104,48,16896
mV 224,68,76
dL 49,8,23,0
mV 196,64,76
rT 108,51,24576
rT 110,51,25600
mV 200,64,80
dL 50,8,23,1024
mV 228,68,80
rT 112,52,24576
rT 114,52,25600
mV 232,68,84
s_add_u32 s23, s23, 114688
rT 116,53,24576
s_add_u32 m0, s20, 98304
mV 204,64,84
rT 118,53,25600
rT 120,54,24576
mV 208,64,88
dL 43,4,21,0
mV 236,68,88
rT 122,54,25600
rT 124,55,24576
mV 240,68,92
dL 44,4,21,1024
mV 212,64,92
rT 126,55,25600
mV 216,64,96
dL 45,4,21,2048
mV 244,68,96
rT 128,56,24576
rT 130,56,25600
dL 46,4,21,3072
rT 132,57,24576
rT 134,57,25600
s_add_u32 s21, s21, 128
s_add_u32 m0, s22, 8192
s_nop 0
dL 49,8,23,0
dL 50,8,23,1024
s_waitcnt lgkmcnt(0)
s_waitcnt vmcnt(16)
s_barrier
s_add_u32 s23, s23, 114688
mV 192,100,108
rB 64,47,32768
s_add_u32 m0, s20, 114688
mV 220,104,108
rB 68,47,33280
rT 72,51,32768
mV 224,104,112
dL 43,4,21,0
mV 196,100,112
rT 74,51,33792
rT 76,52,32768
mV 200,100,116
dL 44,4,21,1024
mV 228,104,116
rT 78,52,33792
rT 80,53,32768
mV 232,104,120
rT 82,53,33792
mV 204,100,120
dL 45,4,21,2048
mV 208,100,124
rT 84,54,32768
rT 86,54,33792
mV 236,104,124
dL 46,4,21,3072
mV 240,104,128
rT 88,55,32768
rT 90,55,33792
mV 212,100,128
s_add_u32 s21, s21, 128
rT 92,56,32768
rT 94,56,33792
mV 216,100,132
rT 96,57,32768
s_add_u32 m0, s22, 16384
mV 244,104,132
rT 98,57,33792
dL 49,8,23,0
dL 50,8,23,1024
s_waitcnt lgkmcnt(0)
s_add_u32 s23, s23, 114688
mV 192,64,72
rB 100,48,32768
s_add_u32 m0, s22, 24576
mV 220,68,72
rB 104,48,33280
rT 108,51,40960
mV 224,68,76
rT 110,51,41984
rT 112,52,40960
mV 196,64,76
rT 114,52,41984
mV 200,64,80
dL 49,8,23,0
mV 228,68,80
rT 116,53,40960
rT 118,53,41984
mV 232,68,84
rT 120,54,40960
rT 122,54,41984
mV 204,64,84
rT 124,55,40960
rT 126,55,41984
mV 208,64,88
dL 50,8,23,1024
mV 236,68,88
rT 128,56,40960
rT 130,56,41984
mV 240,68,92
rT 132,57,40960
rT 134,57,41984
mV 212,64,92
s_add_u32 s23, s23, 114688
s_waitcnt lgkmcnt(0)
s_waitcnt vmcnt(16)
mV 216,64,96
s_barrier
mV 244,68,96
mV 192,100,108
rB 64,47,49152
s_add_u32 m0, s20, 131072
mV 220,104,108
rB 68,47,49664
rT 72,51,49152
mV 224,104,112
dL 43,4,21,0
mV 196,100,112
rT 74,51,50176
rT 76,52,49152
mV 200,100,116
dL 44,4,21,1024
mV 228,104,116
rT 78,52,50176
rT 80,53,49152
mV 232,104,120
rT 82,53,50176
mV 204,100,120
dL 45,4,21,2048
mV 208,100,124
rT 84,54,49152
rT 86,54,50176
mV 236,104,124
dL 46,4,21,3072
mV 240,104,128
rT 88,55,49152
rT 90,55,50176
mV 212,100,128
s_add_u32 s21, s21, 128
rT 92,56,49152
rT 94,56,50176
mV 216,100,132
rT 96,57,49152
s_add_u32 m0, s22, 32768
mV 244,104,132
rT 98,57,50176
dL 49,8,23,0
dL 50,8,23,1024
s_waitcnt lgkmcnt(0)
s_add_u32 s23, s23, 114688
mV 192,64,72
rB 100,48,49152
s_add_u32 m0, s22, 40960
mV 220,68,72
rB 104,48,49664
rT 108,51,57344
mV 224,68,76
rT 110,51,58368
rT 112,52,57344
mV 196,64,76
rT 114,52,58368
mV 200,64,80
dL 49,8,23,0
mV 228,68,80
rT 116,53,57344
rT 118,53,58368
mV 232,68,84
rT 120,54,57344
rT 122,54,58368
mV 204,64,84
rT 124,55,57344
rT 126,55,58368
mV 208,64,88
dL 50,8,23,1024
mV 236,68,88
rT 128,56,57344
rT 130,56,58368
mV 240,68,92
rT 132,57,57344
rT 134,57,58368
mV 212,64,92
s_add_u32 s23, s23, 114688
s_waitcnt lgkmcnt(0)
s_waitcnt vmcnt(16)
mV 216,64,96
s_barrier
mV 244,68,96
mV 192,100,108
rB 64,47,0
rB 68,47,512
mV 220,104,108
rT 72,51,0
rT 74,51,1024
mV 224,104,112
rT 76,52,0
rT 78,52,1024
mV 196,100,112
rT 80,53,0
rT 82,53,1024
mV 200,100,116
rT 84,54,0
mV 228,104,116
rT 86,54,1024
rT 88,55,0
mV 232,104,120
rT 90,55,1024
rT 92,56,0
mV 204,100,120
rT 94,56,1024
rT 96,57,0
mV 208,100,124
rT 98,57,1024
mV 236,104,124
mV 240,104,128
mV 212,100,128
s_waitcnt lgkmcnt(0)
mV 216,100,132
mV 244,104,132
mV 192,64,72
rB 100,48,0
mV 220,68,72
s_add_u32 s100, s26, s25
s_add_u32 m0, s100, 0
rB 104,48,512
mV 224,68,76
rT 108,51,8192
rT 110,51,9216
mV 196,64,76
dL 21,16,27,0
mV 200,64,80
rT 112,52,8192
rT 114,52,9216
mV 228,68,80
rT 116,53,8192
rT 118,53,9216
mV 232,68,84
dL 22,16,27,1024
mV 204,64,84
rT 120,54,8192
rT 122,54,9216
mV 208,64,88
rT 124,55,8192
mV 236,68,88
dL 23,16,27,2048
mV 240,68,92
rT 126,55,9216
rT 128,56,8192
mV 212,64,92
rT 130,56,9216
rT 132,57,8192
mV 216,64,96
dL 24,16,27,3072
mV 244,68,96
rT 134,57,9216
s_waitcnt lgkmcnt(0)
s_waitcnt vmcnt(12)
s_barrier
mV 192,100,108
rB 64,47,16384
mV 220,104,108
s_add_u32 s100, s26, s25
s_add_u32 m0, s100, 4096
rB 68,47,16896
mV 224,104,112
rT 72,51,16384
mV 196,100,112
dL 25,16,27,0
mV 200,100,116
rT 74,51,17408
rT 76,52,16384
mV 228,104,116
rT 78,52,17408
mV 232,104,120
dL 26,16,27,1024
mV 204,100,120
rT 80,53,16384
rT 82,53,17408
mV 208,100,124
dL 27,16,27,2048
mV 236,104,124
rT 84,54,16384
rT 86,54,17408
mV 240,104,128
rT 88,55,16384
mV 212,100,128
dL 28,16,27,3072
mV 216,100,132
rT 90,55,17408
rT 92,56,16384
mV 244,104,132
s_add_u32 s27, s27, 128
rT 94,56,17408
rT 96,57,16384
rT 98,57,17408
s_add_u32 s25, s25, 32768
s_cmp_lt_u32 s25, 98304
s_cselect_b32 s25, s25, 0
s_waitcnt lgkmcnt(0)
mV 192,64,72
rB 100,48,16384
s_add_u32 m0, s28, 147456
mV 220,68,72
rB 104,48,16896
rT 108,51,24576
mV 224,68,76
dL 31,52,29,0
mV 196,64,76
rT 110,51,25600
rT 112,52,24576
mV 200,64,80
rT 114,52,25600
mV 228,68,80
dL 32,52,29,1024
mV 232,68,84
rT 116,53,24576
rT 118,53,25600
mV 204,64,84
rT 120,54,24576
mV 208,64,88
dL 33,52,29,2048
mV 236,68,88
rT 122,54,25600
rT 124,55,24576
mV 240,68,92
rT 126,55,25600
mV 212,64,92
dL 34,52,29,3072
mV 216,64,96
rT 128,56,24576
rT 130,56,25600
mV 244,68,96
rT 132,57,24576
s_add_u32 s29, s29, 262144
rT 134,57,25600
s_waitcnt lgkmcnt(0)
s_waitcnt vmcnt(12)
s_barrier
mV 192,100,108
rB 64,47,32768
s_add_u32 m0, s28, 98304
mV 220,104,108
rB 68,47,33280
rT 72,51,32768
mV 224,104,112
dL 31,52,29,0
mV 196,100,112
rT 74,51,33792
rT 76,52,32768
mV 200,100,116
rT 78,52,33792
mV 228,104,116
dL 32,52,29,1024
mV 232,104,120
rT 80,53,32768
rT 82,53,33792
mV 204,100,120
rT 84,54,32768
mV 208,100,124
dL 33,52,29,2048
mV 236,104,124
rT 86,54,33792
rT 88,55,32768
mV 240,104,128
rT 90,55,33792
mV 212,100,128
dL 34,52,29,3072
mV 216,100,132
rT 92,56,32768
rT 94,56,33792
mV 244,104,132
rT 96,57,32768
s_add_u32 s29, s29, 262144
rT 98,57,33792
s_waitcnt lgkmcnt(0)
mV 192,64,72
rB 100,48,32768
mV 220,68,72
s_add_u32 s100, s26, s25
s_add_u32 m0, s100, 0
rB 104,48,33280
mV 224,68,76
rT 108,51,40960
rT 110,51,41984
mV 196,64,76
dL 21,16,27,0
mV 200,64,80
rT 112,52,40960
rT 114,52,41984
mV 228,68,80
rT 116,53,40960
rT 118,53,41984
mV 232,68,84
dL 22,16,27,1024
mV 204,64,84
rT 120,54,40960
rT 122,54,41984
mV 208,64,88
rT 124,55,40960
mV 236,68,88
dL 23,16,27,2048
mV 240,68,92
rT 126,55,41984
rT 128,56,40960
mV 212,64,92
rT 130,56,41984
rT 132,57,40960
mV 216,64,96
dL 24,16,27,3072
mV 244,68,96
rT 134,57,41984
s_waitcnt lgkmcnt(0)
s_barrier
mV 192,100,108
s_add_u32 s100, s26, s25
s_add_u32 m0, s100, 4096
mV 220,104,108
dL 25,16,27,0
mV 224,104,112
dL 26,16,27,1024
mV 196,100,112
dL 27,16,27,2048
mV 200,100,116
dL 28,16,27,3072
mV 228,104,116
s_add_u32 s27, s27, 128
mV 232,104,120
s_add_u32 s25, s25, 32768
s_cmp_lt_u32 s25, 98304
s_cselect_b32 s25, s25, 0
mV 204,100,120
s_add_u32 m0, s28, 114688
mV 208,100,124
dL 31,52,29,0
mV 236,104,124
dL 32,52,29,1024
mV 240,104,128
dL 33,52,29,2048
mV 212,100,128
dL 34,52,29,3072
mV 216,100,132
s_add_u32 s29, s29, 262144
mV 244,104,132
v_lshl_add_u32 v60, s3, 6, v1
v_cmp_eq_u32 vcc, 0, v60
v_mov_b32 v60, 2147483648
s_nop 0
v_cndmask_b32 v60, v60, 0, vcc
s_getreg_b32 s93, hwreg(HW_REG_XCC_ID, 0, 4)
s_mul_i32 s92, s93, s93
s_lshl_b32 s92, s92, 8
s_add_u32 s93, s93, s92
s_lshl_b32 s93, s93, 8
s_add_u32 s93, s93, 1
v_mov_b32 v61, s93
s_lshl_b32 s93, s93, 5
s_lshr_b32 s77, s65, 2
s_lshl_b32 s76, s64, 2
s_lshl_b32 s35, s2, 14
s_sub_u32 s101, s3, 0
s_lshl_b32 s101, s101, 13
s_add_u32 s35, s35, s101
s_cmp_lt_u32 s101, 16384
s_cselect_b32 s35, s35, 0x80000000
v_lshlrev_b32 v255, 7, v1
buffer_load_dword v255, v255, s[56:59], s35 offen
s_waitcnt vmcnt(13)
s_barrier
rB 64,29,0
rB 68,29,2048
rB 72,29,4096
rB 76,29,6144
rB 80,29,8192
rB 84,29,10240
rB 88,29,12288
rB 92,29,14336
rT 96,35,49152
rT 98,35,51200
rT 100,36,49152
rT 102,36,51200
rT 104,37,49152
rT 106,37,51200
rT 108,38,49152
rT 110,38,51200
rT 112,39,49152
rT 114,39,51200
rT 116,40,49152
rT 118,40,51200
rT 120,41,49152
rT 122,41,51200
rT 124,42,49152
rT 126,42,51200
s_waitcnt lgkmcnt(0)
s_barrier
mAz 0,64,96
rB 128,30,0
s_add_u32 m0, s28, 131072
mAz 32,68,96
v_mov_b32 v63, 0xbdd2d3e8
v_mul_f32 v248, v192, v192
mAz 36,68,100
v_mul_f32 v249, v193, v193
mAz 4,64,100
rB 132,30,2048
v_mul_f32 v250, v194, v194
mAz 8,64,104
v_mul_f32 v251, v195, v195
v_fmaak_f32 v248, v63, v248, 0xc0135761
mAz 40,68,104
rB 136,30,4096
v_fmaak_f32 v249, v63, v249, 0xc0135761
mAz 44,68,108
v_fmaak_f32 v250, v63, v250, 0xc0135761
v_fmaak_f32 v251, v63, v251, 0xc0135761
mAz 12,64,108
rB 140,30,6144
v_mul_f32 v248, v192, v248
mAz 16,64,112
v_mul_f32 v249, v193, v249
v_mul_f32 v250, v194, v250
mAz 48,68,112
rB 144,30,8192
v_mul_f32 v251, v195, v251
mAz 52,68,116
v_exp_f32 v248, v248
mAz 20,64,116
rB 148,30,10240
mAz 24,64,120
v_exp_f32 v249, v249
mAz 56,68,120
v_exp_f32 v250, v250
mAz 60,68,124
rB 152,30,12288
mAz 28,64,124
dL 31,52,29,0
mAz 92,72,124
v_exp_f32 v251, v251
mAz 124,76,124
rB 156,30,14336
v_add_f32 v248, 1.0, v248
mAz 120,76,120
v_add_f32 v249, 1.0, v249
v_add_f32 v250, 1.0, v250
mAz 88,72,120
s_add_u32 s24, s24, 32768
s_cmp_lt_u32 s24, 98304
s_cselect_b32 s24, s24, 0
mAz 84,72,116
v_add_f32 v251, 1.0, v251
mAz 116,76,116
v_rcp_f32 v248, v248
mAz 112,76,112
v_add_u32 v29, s24, v20
mAz 80,72,112
v_rcp_f32 v249, v249
mAz 76,72,108
v_rcp_f32 v250, v250
mAz 108,76,108
v_xor_b32 v30, 64, v29
mAz 104,76,104
v_rcp_f32 v251, v251
mAz 72,72,104
rT 160,35,0
v_mul_f32 v192, v192, v248
mAz 68,72,100
v_mul_f32 v193, v193, v249
v_mul_f32 v194, v194, v250
mAz 100,76,100
rT 162,35,2048
mAz 96,76,96
dL 32,52,29,1024
mAz 64,72,96
v_mul_f32 v195, v195, v251
v_mul_f32 v248, v196, v196
mAz 128,80,96
rT 164,36,0
v_mul_f32 v249, v197, v197
mAz 160,84,96
v_mul_f32 v250, v198, v198
v_mul_f32 v251, v199, v199
mAz 164,84,100
rT 166,36,2048
v_fmaak_f32 v248, v63, v248, 0xc0135761
mAz 132,80,100
v_fmaak_f32 v249, v63, v249, 0xc0135761
v_fmaak_f32 v250, v63, v250, 0xc0135761
mAz 136,80,104
rT 168,37,0
v_fmaak_f32 v251, v63, v251, 0xc0135761
mAz 168,84,104
v_mul_f32 v248, v196, v248
v_mul_f32 v249, v197, v249
mAz 172,84,108
rT 170,37,2048
v_mul_f32 v250, v198, v250
mAz 140,80,108
v_mul_f32 v251, v199, v251
mAz 144,80,112
v_exp_f32 v248, v248
mAz 176,84,112
rT 172,38,0
mAz 180,84,116
v_exp_f32 v249, v249
mAz 148,80,116
rT 174,38,2048
mAz 152,80,120
dL 33,52,29,2048
mAz 184,84,120
v_exp_f32 v250, v250
mAz 188,84,124
v_exp_f32 v251, v251
mAz 156,80,124
rT 176,39,0
v_add_f32 v248, 1.0, v248
mAz 220,88,124
v_add_f32 v249, 1.0, v249
mAz 252,92,124
rT 178,39,2048
v_add_f32 v250, 1.0, v250
mAz 248,92,120
v_add_f32 v251, 1.0, v251
mAz 216,88,120
v_rcp_f32 v248, v248
mAz 212,88,116
rT 180,40,0
mAz 244,92,116
v_rcp_f32 v249, v249
mAz 240,92,112
rT 182,40,2048
mAz 208,88,112
v_rcp_f32 v250, v250
mAz 204,88,108
v_rcp_f32 v251, v251
mAz 236,92,108
rT 184,41,0
v_mul_f32 v196, v196, v248
mAz 232,92,104
v_mul_f32 v197, v197, v249
mAz 200,88,104
rT 186,41,2048
mAz 196,88,100
dL 34,52,29,3072
mAz 228,92,100
v_mul_f32 v198, v198, v250
v_mul_f32 v199, v199, v251
mAz 224,92,96
rT 188,42,0
v_mul_f32 v248, v200, v200
mAz 192,88,96
v_mul_f32 v249, v201, v201
v_mul_f32 v250, v202, v202
rT 190,42,2048
v_mul_f32 v251, v203, v203
v_fmaak_f32 v248, v63, v248, 0xc0135761
v_fmaak_f32 v249, v63, v249, 0xc0135761
v_fmaak_f32 v250, v63, v250, 0xc0135761
v_fmaak_f32 v251, v63, v251, 0xc0135761
v_mul_f32 v248, v200, v248
v_mul_f32 v249, v201, v249
v_mul_f32 v250, v202, v250
v_mul_f32 v251, v203, v251
v_exp_f32 v248, v248
v_exp_f32 v249, v249
s_add_u32 s29, s29, 262144
v_exp_f32 v250, v250
s_waitcnt lgkmcnt(0)
s_waitcnt vmcnt(5)
s_barrier
v_exp_f32 v251, v251
v_add_f32 v248, 1.0, v248
v_add_f32 v249, 1.0, v249
v_add_f32 v250, 1.0, v250
v_add_f32 v251, 1.0, v251
v_rcp_f32 v248, v248
s_cmp_eq_u32 s77, 4
s_cselect_b32 s92, s76, 0x40000000
v_rcp_f32 v249, v249
v_rcp_f32 v250, v250
buffer_atomic_add v61, v60, s[60:63], s92 offen offset:128
v_rcp_f32 v251, v251
v_mul_f32 v200, v200, v248
v_mul_f32 v201, v201, v249
v_mul_f32 v202, v202, v250
v_mul_f32 v203, v203, v251
v_mul_f32 v248, v204, v204
v_mul_f32 v249, v205, v205
v_mul_f32 v250, v206, v206
mA 0,128,160
rB 64,29,0
mA 32,132,160
s_add_u32 s100, s26, s25
s_add_u32 m0, s100, 0
v_mul_f32 v251, v207, v207
mA 36,132,164
v_fmaak_f32 v248, v63, v248, 0xc0135761
v_fmaak_f32 v249, v63, v249, 0xc0135761
mA 4,128,164
rB 68,29,2048
v_fmaak_f32 v250, v63, v250, 0xc0135761
mA 8,128,168
v_fmaak_f32 v251, v63, v251, 0xc0135761
v_mul_f32 v248, v204, v248
mA 40,132,168
v_mul_f32 v249, v205, v249
mA 44,132,172
rB 72,29,4096
v_mul_f32 v250, v206, v250
mA 12,128,172
v_mul_f32 v251, v207, v251
mA 16,128,176
dL 21,16,27,0
mA 48,132,176
v_exp_f32 v248, v248
mA 52,132,180
rB 76,29,6144
mA 20,128,180
v_exp_f32 v249, v249
mA 24,128,184
rB 80,29,8192
mA 56,132,184
v_exp_f32 v250, v250
mA 60,132,188
v_exp_f32 v251, v251
mA 28,128,188
rB 84,29,10240
v_add_f32 v248, 1.0, v248
mA 92,136,188
dL 22,16,27,1024
mA 124,140,188
v_add_f32 v249, 1.0, v249
v_add_f32 v250, 1.0, v250
mA 120,140,184
rB 88,29,12288
v_add_f32 v251, 1.0, v251
mA 88,136,184
v_rcp_f32 v248, v248
mA 84,136,180
rB 92,29,14336
mA 116,140,180
v_rcp_f32 v249, v249
mA 112,140,176
v_rcp_f32 v250, v250
mA 80,136,176
rT 96,35,16384
mA 76,136,172
dL 23,16,27,2048
mA 108,140,172
v_rcp_f32 v251, v251
mA 104,140,168
v_mul_f32 v204, v204, v248
mA 72,136,168
rT 98,35,18432
v_mul_f32 v205, v205, v249
mA 68,136,164
v_mul_f32 v206, v206, v250
v_mul_f32 v207, v207, v251
mA 100,140,164
rT 100,36,16384
v_mul_f32 v248, v208, v208
mA 96,140,160
v_mul_f32 v249, v209, v209
mA 64,136,160
dL 24,16,27,3072
mA 128,144,160
v_mul_f32 v250, v210, v210
mA 160,148,160
rT 102,36,18432
v_mul_f32 v251, v211, v211
mA 164,148,164
v_fmaak_f32 v248, v63, v248, 0xc0135761
v_fmaak_f32 v249, v63, v249, 0xc0135761
mA 132,144,164
rT 104,37,16384
v_fmaak_f32 v250, v63, v250, 0xc0135761
mA 136,144,168
v_fmaak_f32 v251, v63, v251, 0xc0135761
v_mul_f32 v248, v208, v248
mA 168,148,168
v_mul_f32 v249, v209, v249
mA 172,148,172
rT 106,37,18432
v_mul_f32 v250, v210, v250
mA 140,144,172
s_add_u32 s100, s26, s25
s_add_u32 m0, s100, 4096
v_mul_f32 v251, v211, v251
mA 144,144,176
v_exp_f32 v248, v248
mA 176,148,176
rT 108,38,16384
mA 180,148,180
v_exp_f32 v249, v249
mA 148,144,180
rT 110,38,18432
mA 152,144,184
v_exp_f32 v250, v250
mA 184,148,184
v_exp_f32 v251, v251
mA 188,148,188
rT 112,39,16384
mA 156,144,188
dL 25,16,27,0
mA 220,152,188
v_add_f32 v248, 1.0, v248
v_add_f32 v249, 1.0, v249
mA 252,156,188
v_add_f32 v250, 1.0, v250
mA 248,156,184
rT 114,39,18432
v_add_f32 v251, 1.0, v251
mA 216,152,184
v_rcp_f32 v248, v248
mA 212,152,180
rT 116,40,16384
mA 244,156,180
v_rcp_f32 v249, v249
mA 240,156,176
v_rcp_f32 v250, v250
mA 208,152,176
dL 26,16,27,1024
mA 204,152,172
rT 118,40,18432
mA 236,156,172
v_rcp_f32 v251, v251
mA 232,156,168
v_mul_f32 v208, v208, v248
mA 200,152,168
rT 120,41,16384
v_mul_f32 v209, v209, v249
mA 196,152,164
v_mul_f32 v210, v210, v250
v_mul_f32 v211, v211, v251
mA 228,156,164
rT 122,41,18432
v_mul_f32 v248, v212, v212
mA 224,156,160
v_mul_f32 v249, v213, v213
mA 192,152,160
dL 27,16,27,2048
v_mul_f32 v250, v214, v214
rT 124,42,16384
v_mul_f32 v251, v215, v215
v_fmaak_f32 v248, v63, v248, 0xc0135761
v_fmaak_f32 v249, v63, v249, 0xc0135761
v_fmaak_f32 v250, v63, v250, 0xc0135761
rT 126,42,18432
v_fmaak_f32 v251, v63, v251, 0xc0135761
v_mul_f32 v248, v212, v248
v_mul_f32 v249, v213, v249
v_mul_f32 v250, v214, v250
dL 28,16,27,3072
v_mul_f32 v251, v215, v251
v_exp_f32 v248, v248
v_exp_f32 v249, v249
v_exp_f32 v250, v250
v_exp_f32 v251, v251
s_add_u32 s27, s27, 128
s_waitcnt lgkmcnt(0)
s_waitcnt vmcnt(9)
s_barrier
v_add_f32 v248, 1.0, v248
v_add_f32 v249, 1.0, v249
v_add_f32 v250, 1.0, v250
v_add_f32 v251, 1.0, v251
v_rcp_f32 v248, v248
v_rcp_f32 v249, v249
s_add_u32 s25, s25, 32768
s_cmp_lt_u32 s25, 98304
s_cselect_b32 s25, s25, 0
v_rcp_f32 v250, v250
s_cmp_eq_u32 s77, 5
s_cselect_b32 s92, s76, 0x40000000
v_rcp_f32 v251, v251
buffer_atomic_add v61, v60, s[60:63], s92 offen offset:128
v_mul_f32 v212, v212, v248
v_mul_f32 v213, v213, v249
v_mul_f32 v214, v214, v250
v_mul_f32 v215, v215, v251
v_mul_f32 v248, v216, v216
v_mul_f32 v249, v217, v217
v_mul_f32 v250, v218, v218
v_mul_f32 v251, v219, v219
v_fmaak_f32 v248, v63, v248, 0xc0135761
v_fmaak_f32 v249, v63, v249, 0xc0135761
v_fmaak_f32 v250, v63, v250, 0xc0135761
mA 0,64,96
rB 128,30,0
s_add_u32 m0, s28, 147456
mA 32,68,96
v_fmaak_f32 v251, v63, v251, 0xc0135761
v_mul_f32 v248, v216, v248
mA 36,68,100
rB 132,30,2048
v_mul_f32 v249, v217, v249
mA 4,64,100
v_mul_f32 v250, v218, v250
mA 8,64,104
dL 31,52,29,0
mA 40,68,104
v_mul_f32 v251, v219, v251
mA 44,68,108
rB 136,30,4096
mA 12,64,108
v_exp_f32 v248, v248
mA 16,64,112
v_exp_f32 v249, v249
mA 48,68,112
rB 140,30,6144
mA 52,68,116
dL 32,52,29,1024
mA 20,64,116
v_exp_f32 v250, v250
mA 24,64,120
rB 144,30,8192
mA 56,68,120
v_exp_f32 v251, v251
mA 60,68,124
dL 33,52,29,2048
mA 28,64,124
v_add_f32 v248, 1.0, v248
mA 92,72,124
rB 148,30,10240
v_add_f32 v249, 1.0, v249
mA 124,76,124
v_add_f32 v250, 1.0, v250
v_add_f32 v251, 1.0, v251
mA 120,76,120
rB 152,30,12288
mA 88,72,120
v_rcp_f32 v248, v248
mA 84,72,116
dL 34,52,29,3072
mA 116,76,116
v_rcp_f32 v249, v249
mA 112,76,112
rB 156,30,14336
mA 80,72,112
v_rcp_f32 v250, v250
mA 76,72,108
s_add_u32 s29, s29, 262144
mA 108,76,108
s_add_u32 s24, s24, 32768
s_cmp_lt_u32 s24, 98304
s_cselect_b32 s24, s24, 0
mA 104,76,104
v_rcp_f32 v251, v251
mA 72,72,104
v_mul_f32 v216, v216, v248
v_add_u32 v29, s24, v20
mA 68,72,100
v_mul_f32 v217, v217, v249
mA 100,76,100
s_add_u32 s100, s26, s25
s_add_u32 m0, s100, 0
v_mul_f32 v218, v218, v250
mA 96,76,96
v_mul_f32 v219, v219, v251
v_xor_b32 v30, 64, v29
mA 64,72,96
v_mul_f32 v248, v220, v220
v_mul_f32 v249, v221, v221
mA 128,80,96
v_mul_f32 v250, v222, v222
mA 160,84,96
rT 160,35,32768
mA 164,84,100
dL 21,16,27,0
mA 132,80,100
v_mul_f32 v251, v223, v223
v_fmaak_f32 v248, v63, v248, 0xc0135761
mA 136,80,104
v_fmaak_f32 v249, v63, v249, 0xc0135761
mA 168,84,104
rT 162,35,34816
v_fmaak_f32 v250, v63, v250, 0xc0135761
mA 172,84,108
dL 22,16,27,1024
mA 140,80,108
v_fmaak_f32 v251, v63, v251, 0xc0135761
mA 144,80,112
rT 164,36,32768
v_mul_f32 v248, v220, v248
mA 176,84,112
v_mul_f32 v249, v221, v249
v_mul_f32 v250, v222, v250
mA 180,84,116
rT 166,36,34816
v_mul_f32 v251, v223, v251
mA 148,80,116
dL 23,16,27,2048
mA 152,80,120
v_exp_f32 v248, v248
mA 184,84,120
rT 168,37,32768
mA 188,84,124
v_exp_f32 v249, v249
mA 156,80,124
v_exp_f32 v250, v250
mA 220,88,124
dL 24,16,27,3072
mA 252,92,124
rT 170,37,34816
mA 248,92,120
v_exp_f32 v251, v251
mA 216,88,120
rT 172,38,32768
v_add_f32 v248, 1.0, v248
mA 212,88,116
s_add_u32 m0, s28, 98304
v_add_f32 v249, 1.0, v249
v_add_f32 v250, 1.0, v250
mA 244,92,116
rT 174,38,34816
v_add_f32 v251, 1.0, v251
mA 240,92,112
v_rcp_f32 v248, v248
mA 208,88,112
dL 31,52,29,0
mA 204,88,108
rT 176,39,32768
mA 236,92,108
v_rcp_f32 v249, v249
mA 232,92,104
v_rcp_f32 v250, v250
mA 200,88,104
rT 178,39,34816
mA 196,88,100
dL 32,52,29,1024
mA 228,92,100
v_rcp_f32 v251, v251
mA 224,92,96
rT 180,40,32768
v_mul_f32 v220, v220, v248
mA 192,88,96
v_mul_f32 v221, v221, v249
v_mul_f32 v222, v222, v250
rT 182,40,34816
dL 33,52,29,2048
v_mul_f32 v223, v223, v251
v_mul_f32 v248, v224, v224
v_mul_f32 v249, v225, v225
rT 184,41,32768
v_mul_f32 v250, v226, v226
v_mul_f32 v251, v227, v227
dL 34,52,29,3072
s_lshl_b32 s35, s2, 15
s_sub_u32 s101, s3, 0
s_lshl_b32 s101, s101, 13
s_add_u32 s35, s35, s101
s_cmp_lt_u32 s101, 32768
s_cselect_b32 s35, s35, 0x80000000
v_lshlrev_b32 v19, 7, v1
buffer_load_dword v19, v19, s[44:47], s35 offen
v_fmaak_f32 v248, v63, v248, 0xc0135761
rT 186,41,34816
v_fmaak_f32 v249, v63, v249, 0xc0135761
v_fmaak_f32 v250, v63, v250, 0xc0135761
v_fmaak_f32 v251, v63, v251, 0xc0135761
rT 188,42,32768
s_add_u32 s29, s29, 262144
v_mul_f32 v248, v224, v248
v_mul_f32 v249, v225, v249
rT 190,42,34816
v_mul_f32 v250, v226, v250
v_mul_f32 v251, v227, v251
v_exp_f32 v248, v248
s_add_u32 m0, s28, 114688
v_exp_f32 v249, v249
v_exp_f32 v250, v250
dL 31,52,29,0
v_exp_f32 v251, v251
v_add_f32 v248, 1.0, v248
v_add_f32 v249, 1.0, v249
dL 32,52,29,1024
v_add_f32 v250, 1.0, v250
v_add_f32 v251, 1.0, v251
s_waitcnt lgkmcnt(0)
s_waitcnt vmcnt(11)
s_barrier
v_rcp_f32 v248, v248
v_rcp_f32 v249, v249
dL 33,52,29,2048
v_rcp_f32 v250, v250
v_rcp_f32 v251, v251
dL 34,52,29,3072
s_cmp_eq_u32 s77, 6
s_cselect_b32 s92, s76, 0x40000000
v_mul_f32 v224, v224, v248
v_mul_f32 v225, v225, v249
v_mul_f32 v226, v226, v250
v_mul_f32 v227, v227, v251
buffer_atomic_add v61, v60, s[60:63], s92 offen offset:128
s_add_u32 s29, s29, 262144
v_mul_f32 v248, v228, v228
v_mul_f32 v249, v229, v229
v_mul_f32 v250, v230, v230
v_mul_f32 v251, v231, v231
v_fmaak_f32 v248, v63, v248, 0xc0135761
v_fmaak_f32 v249, v63, v249, 0xc0135761
v_fmaak_f32 v250, v63, v250, 0xc0135761
v_fmaak_f32 v251, v63, v251, 0xc0135761
v_mul_f32 v248, v228, v248
v_mul_f32 v249, v229, v249
mA 0,128,160
rB 64,29,0
mA 32,132,160
s_add_u32 s100, s26, s25
s_add_u32 m0, s100, 4096
v_mul_f32 v250, v230, v250
mA 36,132,164
v_mul_f32 v251, v231, v251
mA 4,128,164
v_exp_f32 v248, v248
mA 8,128,168
rB 68,29,2048
mA 40,132,168
v_exp_f32 v249, v249
mA 44,132,172
dL 25,16,27,0
mA 12,128,172
v_exp_f32 v250, v250
mA 16,128,176
rB 72,29,4096
mA 48,132,176
v_exp_f32 v251, v251
mA 52,132,180
rB 76,29,6144
v_add_f32 v248, 1.0, v248
mA 20,128,180
v_add_f32 v249, 1.0, v249
mA 24,128,184
dL 26,16,27,1024
mA 56,132,184
v_add_f32 v250, 1.0, v250
mA 60,132,188
rB 80,29,8192
v_add_f32 v251, 1.0, v251
mA 28,128,188
v_rcp_f32 v248, v248
mA 92,136,188
v_rcp_f32 v249, v249
mA 124,140,188
rB 84,29,10240
mA 120,140,184
dL 27,16,27,2048
mA 88,136,184
v_rcp_f32 v250, v250
mA 84,136,180
rB 88,29,12288
mA 116,140,180
v_rcp_f32 v251, v251
mA 112,140,176
v_mul_f32 v228, v228, v248
mA 80,136,176
rB 92,29,14336
v_mul_f32 v229, v229, v249
mA 76,136,172
dL 28,16,27,3072
mA 108,140,172
v_mul_f32 v230, v230, v250
v_mul_f32 v231, v231, v251
mA 104,140,168
rT 96,35,49152
v_mul_f32 v248, v232, v232
mA 72,136,168
v_mul_f32 v249, v233, v233
v_mul_f32 v250, v234, v234
mA 68,136,164
v_mul_f32 v251, v235, v235
s_add_u32 s27, s27, 128
mA 100,140,164
rT 98,35,51200
v_fmaak_f32 v248, v63, v248, 0xc0135761
mA 96,140,160
v_fmaak_f32 v249, v63, v249, 0xc0135761
v_fmaak_f32 v250, v63, v250, 0xc0135761
mA 64,136,160
rT 100,36,49152
v_fmaak_f32 v251, v63, v251, 0xc0135761
mA 128,144,160
v_mul_f32 v248, v232, v248
mA 160,148,160
s_add_u32 s25, s25, 32768
s_cmp_lt_u32 s25, 98304
s_cselect_b32 s25, s25, 0
mA 164,148,164
v_mul_f32 v249, v233, v249
mA 132,144,164
rT 102,36,51200
v_mul_f32 v250, v234, v250
mA 136,144,168
v_mul_f32 v251, v235, v251
mA 168,148,168
v_exp_f32 v248, v248
mA 172,148,172
rT 104,37,49152
mA 140,144,172
v_exp_f32 v249, v249
mA 144,144,176
s_add_u32 s100, s26, s25
s_add_u32 m0, s100, 0
mA 176,148,176
v_exp_f32 v250, v250
mA 180,148,180
rT 106,37,51200
mA 148,144,180
v_exp_f32 v251, v251
mA 152,144,184
rT 108,38,49152
v_add_f32 v248, 1.0, v248
mA 184,148,184
dL 21,16,27,0
mA 188,148,188
v_add_f32 v249, 1.0, v249
v_add_f32 v250, 1.0, v250
mA 156,144,188
rT 110,38,51200
v_add_f32 v251, 1.0, v251
mA 220,152,188
v_rcp_f32 v248, v248
mA 252,156,188
v_rcp_f32 v249, v249
mA 248,156,184
rT 112,39,49152
mA 216,152,184
dL 22,16,27,1024
mA 212,152,180
v_rcp_f32 v250, v250
mA 244,156,180
rT 114,39,51200
mA 240,156,176
v_rcp_f32 v251, v251
mA 208,152,176
v_mul_f32 v232, v232, v248
mA 204,152,172
dL 23,16,27,2048
mA 236,156,172
rT 116,40,49152
v_mul_f32 v233, v233, v249
mA 232,156,168
v_mul_f32 v234, v234, v250
v_mul_f32 v235, v235, v251
mA 200,152,168
rT 118,40,51200
v_mul_f32 v248, v236, v236
mA 196,152,164
v_mul_f32 v249, v237, v237
v_mul_f32 v250, v238, v238
mA 228,156,164
dL 24,16,27,3072
mA 224,156,160
v_mul_f32 v251, v239, v239
mA 192,152,160
rT 120,41,49152
v_fmaak_f32 v248, v63, v248, 0xc0135761
v_fmaak_f32 v249, v63, v249, 0xc0135761
v_fmaak_f32 v250, v63, v250, 0xc0135761
rT 122,41,51200
v_fmaak_f32 v251, v63, v251, 0xc0135761
s_mov_b32 s96, s74
s_mov_b32 s97, s75
s_mov_b32 s98, 3670016
s_mov_b32 s99, 0x20000
s_lshl_b32 s35, s2, 14
s_sub_u32 s101, s3, 0
s_lshl_b32 s101, s101, 13
s_add_u32 s35, s35, s101
s_cmp_lt_u32 s101, 16384
s_cselect_b32 s35, s35, 0x80000000
v_lshlrev_b32 v18, 7, v1
buffer_load_dword v18, v18, s[96:99], s35 offen
v_mul_f32 v248, v236, v248
s_add_u32 m0, s28, 131072
v_mul_f32 v249, v237, v249
rT 124,42,49152
v_mul_f32 v250, v238, v250
v_mul_f32 v251, v239, v251
v_exp_f32 v248, v248
rT 126,42,51200
v_exp_f32 v249, v249
dL 31,52,29,0
v_exp_f32 v250, v250
v_exp_f32 v251, v251
v_add_f32 v248, 1.0, v248
dL 32,52,29,1024
v_add_f32 v249, 1.0, v249
v_add_f32 v250, 1.0, v250
v_add_f32 v251, 1.0, v251
v_rcp_f32 v248, v248
dL 33,52,29,2048
v_rcp_f32 v249, v249
s_waitcnt lgkmcnt(0)
s_waitcnt vmcnt(18)
s_barrier
v_rcp_f32 v250, v250
v_rcp_f32 v251, v251
dL 34,52,29,3072
v_mul_f32 v236, v236, v248
v_mul_f32 v237, v237, v249
v_mul_f32 v238, v238, v250
v_mul_f32 v239, v239, v251
s_cmp_eq_u32 s77, 7
s_cselect_b32 s92, s76, 0x40000000
v_mul_f32 v248, v240, v240
v_mul_f32 v249, v241, v241
s_add_u32 s29, s29, 262144
v_mul_f32 v250, v242, v242
buffer_atomic_add v61, v60, s[60:63], s92 offen offset:128
v_mul_f32 v251, v243, v243
v_fmaak_f32 v248, v63, v248, 0xc0135761
v_fmaak_f32 v249, v63, v249, 0xc0135761
v_fmaak_f32 v250, v63, v250, 0xc0135761
v_fmaak_f32 v251, v63, v251, 0xc0135761
v_mul_f32 v248, v240, v248
v_mul_f32 v249, v241, v249
v_mul_f32 v250, v242, v250
v_mul_f32 v251, v243, v251
v_exp_f32 v248, v248
mA 0,64,96
rB 128,30,0
mA 32,68,96
s_add_u32 s100, s26, s25
s_add_u32 m0, s100, 4096
mA 36,68,100
v_exp_f32 v249, v249
mA 4,64,100
v_exp_f32 v250, v250
mA 8,64,104
rB 132,30,2048
mA 40,68,104
v_exp_f32 v251, v251
mA 44,68,108
rB 136,30,4096
v_add_f32 v248, 1.0, v248
mA 12,64,108
v_add_f32 v249, 1.0, v249
mA 16,64,112
dL 25,16,27,0
mA 48,68,112
rB 140,30,6144
v_add_f32 v250, 1.0, v250
mA 52,68,116
v_add_f32 v251, 1.0, v251
mA 20,64,116
v_rcp_f32 v248, v248
mA 24,64,120
rB 144,30,8192
mA 56,68,120
v_rcp_f32 v249, v249
mA 60,68,124
rB 148,30,10240
mA 28,64,124
v_rcp_f32 v250, v250
mA 92,72,124
dL 26,16,27,1024
mA 124,76,124
v_rcp_f32 v251, v251
mA 120,76,120
rB 152,30,12288
v_mul_f32 v240, v240, v248
mA 88,72,120
v_mul_f32 v241, v241, v249
mA 84,72,116
rB 156,30,14336
v_mul_f32 v242, v242, v250
mA 116,76,116
v_mul_f32 v243, v243, v251
v_mul_f32 v248, v244, v244
mA 112,76,112
s_add_u32 s24, s24, 32768
s_cmp_lt_u32 s24, 98304
s_cselect_b32 s24, s24, 0
mA 80,72,112
v_mul_f32 v249, v245, v245
mA 76,72,108
dL 27,16,27,2048
mA 108,76,108
v_mul_f32 v250, v246, v246
v_mul_f32 v251, v247, v247
mA 104,76,104
v_add_u32 v29, s24, v20
v_fmaak_f32 v248, v63, v248, 0xc0135761
mA 72,72,104
v_fmaak_f32 v249, v63, v249, 0xc0135761
v_fmaak_f32 v250, v63, v250, 0xc0135761
mA 68,72,100
v_xor_b32 v30, 64, v29
v_fmaak_f32 v251, v63, v251, 0xc0135761
mA 100,76,100
v_mul_f32 v248, v244, v248
v_mul_f32 v249, v245, v249
mA 96,76,96
rT 160,35,0
mA 64,72,96
dL 28,16,27,3072
mA 128,80,96
v_mul_f32 v250, v246, v250
v_mul_f32 v251, v247, v251
mA 160,84,96
v_exp_f32 v248, v248
mA 164,84,100
rT 162,35,2048
mA 132,80,100
v_exp_f32 v249, v249
mA 136,80,104
rT 164,36,0
mA 168,84,104
v_exp_f32 v250, v250
mA 172,84,108
s_add_u32 s27, s27, 128
rT 166,36,2048
mA 140,80,108
v_exp_f32 v251, v251
mA 144,80,112
v_add_f32 v248, 1.0, v248
mA 176,84,112
rT 168,37,0
v_add_f32 v249, 1.0, v249
mA 180,84,116
v_add_f32 v250, 1.0, v250
v_add_f32 v251, 1.0, v251
mA 148,80,116
rT 170,37,2048
mA 152,80,120
v_rcp_f32 v248, v248
mA 184,84,120
v_rcp_f32 v249, v249
mA 188,84,124
s_add_u32 s25, s25, 32768
s_cmp_lt_u32 s25, 98304
s_cselect_b32 s25, s25, 0
mA 156,80,124
rT 172,38,0
mA 220,88,124
v_rcp_f32 v250, v250
mA 252,92,124
rT 174,38,2048
mA 248,92,120
v_rcp_f32 v251, v251
mA 216,88,120
v_mul_f32 v244, v244, v248
mA 212,88,116
rT 176,39,0
v_mul_f32 v245, v245, v249
mA 244,92,116
v_mul_f32 v246, v246, v250
s_add_u32 m0, s28, 147456
mA 240,92,112
v_mul_f32 v247, v247, v251
mA 208,88,112
rT 178,39,2048
v_add_f32 v44, v192, v196
mA 204,88,108
v_add_f32 v46, v193, v197
v_add_f32 v48, v194, v198
mA 236,92,108
rT 180,40,0
v_add_f32 v50, v195, v199
mA 232,92,104
v_add_f32 v52, v220, v224
v_add_f32 v54, v221, v225
mA 200,88,104
rT 182,40,2048
v_add_f32 v56, v222, v226
mA 196,88,100
dL 31,52,29,0
mA 228,92,100
v_add_f32 v58, v223, v227
v_add_f32 v44, v44, v200
mA 224,92,96
rT 184,41,0
v_add_f32 v46, v46, v201
mA 192,88,96
v_add_f32 v48, v48, v202
s_mov_b32 s96, s78
s_mov_b32 s97, s79
s_mov_b32 s98, 802816
s_mov_b32 s99, 0x20000
s_lshl_b32 s35, s2, 12
s_sub_u32 s101, s3, 2
s_lshl_b32 s101, s101, 13
s_add_u32 s35, s35, s101
s_cmp_lt_u32 s101, 8192
s_cselect_b32 s35, s35, 0x80000000
v_lshlrev_b32 v17, 7, v1
buffer_load_dword v17, v17, s[96:99], s35 offen
v_add_f32 v50, v50, v203
rT 186,41,2048
v_add_f32 v52, v52, v228
v_add_f32 v54, v54, v229
v_add_f32 v56, v56, v230
rT 188,42,0
dL 32,52,29,1024
v_add_f32 v58, v58, v231
v_add_f32 v44, v44, v204
rT 190,42,2048
v_add_f32 v46, v46, v205
v_add_f32 v48, v48, v206
v_add_f32 v50, v50, v207
v_add_f32 v52, v52, v232
v_add_f32 v54, v54, v233
v_add_f32 v56, v56, v234
dL 33,52,29,2048
v_add_f32 v58, v58, v235
v_add_f32 v44, v44, v208
v_add_f32 v46, v46, v209
v_add_f32 v48, v48, v210
v_add_f32 v50, v50, v211
v_add_f32 v52, v52, v236
v_add_f32 v54, v54, v237
v_add_f32 v56, v56, v238
s_waitcnt lgkmcnt(0)
s_waitcnt vmcnt(18)
s_barrier
dL 34,52,29,3072
v_add_f32 v58, v58, v239
v_add_f32 v44, v44, v212
v_add_f32 v46, v46, v213
v_add_f32 v48, v48, v214
v_add_f32 v50, v50, v215
v_add_f32 v52, v52, v240
v_add_f32 v54, v54, v241
v_add_f32 v56, v56, v242
s_add_u32 s29, s29, 262144
v_add_f32 v58, v58, v243
v_add_f32 v44, v44, v216
v_add_f32 v46, v46, v217
v_add_f32 v48, v48, v218
v_add_f32 v50, v50, v219
v_add_f32 v52, v52, v244
v_add_f32 v54, v54, v245
v_add_f32 v56, v56, v246
v_add_f32 v58, v58, v247
v_add_f32_dpp v44, v44, v44 row_ror:8 row_mask:0xf bank_mask:0xf
v_add_f32_dpp v46, v46, v46 row_ror:8 row_mask:0xf bank_mask:0xf
v_add_f32_dpp v48, v48, v48 row_ror:8 row_mask:0xf bank_mask:0xf
v_add_f32_dpp v50, v50, v50 row_ror:8 row_mask:0xf bank_mask:0xf
v_add_f32_dpp v52, v52, v52 row_ror:8 row_mask:0xf bank_mask:0xf
mA 0,128,160
rB 64,29,0
mA 32,132,160
s_add_u32 s100, s26, s25
s_add_u32 m0, s100, 0
v_add_f32_dpp v54, v54, v54 row_ror:8 row_mask:0xf bank_mask:0xf
mA 36,132,164
v_add_f32_dpp v56, v56, v56 row_ror:8 row_mask:0xf bank_mask:0xf
v_add_f32_dpp v58, v58, v58 row_ror:8 row_mask:0xf bank_mask:0xf
mA 4,128,164
rB 68,29,2048
v_add_f32_dpp v44, v44, v44 row_ror:4 row_mask:0xf bank_mask:0xf
mA 8,128,168
v_add_f32_dpp v46, v46, v46 row_ror:4 row_mask:0xf bank_mask:0xf
v_add_f32_dpp v48, v48, v48 row_ror:4 row_mask:0xf bank_mask:0xf
mA 40,132,168
v_add_f32_dpp v50, v50, v50 row_ror:4 row_mask:0xf bank_mask:0xf
mA 44,132,172
rB 72,29,4096
v_add_f32_dpp v52, v52, v52 row_ror:4 row_mask:0xf bank_mask:0xf
mA 12,128,172
v_add_f32_dpp v54, v54, v54 row_ror:4 row_mask:0xf bank_mask:0xf
v_add_f32_dpp v56, v56, v56 row_ror:4 row_mask:0xf bank_mask:0xf
mA 16,128,176
dL 21,16,27,0
mA 48,132,176
rB 76,29,6144
v_add_f32_dpp v58, v58, v58 row_ror:4 row_mask:0xf bank_mask:0xf
mA 52,132,180
v_add_f32_dpp v44, v44, v44 row_ror:2 row_mask:0xf bank_mask:0xf
v_add_f32_dpp v46, v46, v46 row_ror:2 row_mask:0xf bank_mask:0xf
mA 20,128,180
rB 80,29,8192
v_add_f32_dpp v48, v48, v48 row_ror:2 row_mask:0xf bank_mask:0xf
mA 24,128,184
v_add_f32_dpp v50, v50, v50 row_ror:2 row_mask:0xf bank_mask:0xf
v_add_f32_dpp v52, v52, v52 row_ror:2 row_mask:0xf bank_mask:0xf
mA 56,132,184
v_add_f32_dpp v54, v54, v54 row_ror:2 row_mask:0xf bank_mask:0xf
mA 60,132,188
rB 84,29,10240
v_add_f32_dpp v56, v56, v56 row_ror:2 row_mask:0xf bank_mask:0xf
mA 28,128,188
v_add_f32_dpp v58, v58, v58 row_ror:2 row_mask:0xf bank_mask:0xf
mA 92,136,188
dL 22,16,27,1024
mA 124,140,188
v_add_f32_dpp v44, v44, v44 row_ror:1 row_mask:0xf bank_mask:0xf
mA 120,140,184
rB 88,29,12288
v_add_f32_dpp v46, v46, v46 row_ror:1 row_mask:0xf bank_mask:0xf
mA 88,136,184
v_add_f32_dpp v48, v48, v48 row_ror:1 row_mask:0xf bank_mask:0xf
v_add_f32_dpp v50, v50, v50 row_ror:1 row_mask:0xf bank_mask:0xf
mA 84,136,180
rB 92,29,14336
v_add_f32_dpp v52, v52, v52 row_ror:1 row_mask:0xf bank_mask:0xf
mA 116,140,180
v_add_f32_dpp v54, v54, v54 row_ror:1 row_mask:0xf bank_mask:0xf
v_add_f32_dpp v56, v56, v56 row_ror:1 row_mask:0xf bank_mask:0xf
mA 112,140,176
rT 96,35,16384
v_add_f32_dpp v58, v58, v58 row_ror:1 row_mask:0xf bank_mask:0xf
mA 80,136,176
v_mul_f32 v44, 0x3c124925, v44
v_mul_f32 v46, 0x3c124925, v46
mA 76,136,172
dL 23,16,27,2048
mA 108,140,172
v_mul_f32 v48, 0x3c124925, v48
mA 104,140,168
rT 98,35,18432
v_mul_f32 v50, 0x3c124925, v50
mA 72,136,168
v_mul_f32 v52, 0x3c124925, v52
v_mul_f32 v54, 0x3c124925, v54
mA 68,136,164
rT 100,36,16384
v_mul_f32 v56, 0x3c124925, v56
mA 100,140,164
v_mul_f32 v58, 0x3c124925, v58
v_sub_f32 v248, v192, v44
mA 96,140,160
rT 102,36,18432
v_sub_f32 v249, v193, v46
mA 64,136,160
v_sub_f32 v250, v194, v48
v_sub_f32 v251, v195, v50
mA 128,144,160
dL 24,16,27,3072
mA 160,148,160
v_mul_f32 v45, v248, v248
mA 164,148,164
rT 104,37,16384
v_mul_f32 v47, v249, v249
mA 132,144,164
v_mul_f32 v49, v250, v250
v_mul_f32 v51, v251, v251
mA 136,144,168
rT 106,37,18432
v_sub_f32 v248, v220, v52
mA 168,148,168
v_sub_f32 v249, v221, v54
v_sub_f32 v250, v222, v56
mA 172,148,172
rT 108,38,16384
v_sub_f32 v251, v223, v58
mA 140,144,172
v_mul_f32 v53, v248, v248
s_add_u32 m0, s28, 98304
mA 144,144,176
v_mul_f32 v55, v249, v249
mA 176,148,176
rT 110,38,18432
v_mul_f32 v57, v250, v250
mA 180,148,180
v_mul_f32 v59, v251, v251
v_sub_f32 v248, v196, v44
mA 148,144,180
v_sub_f32 v249, v197, v46
mA 152,144,184
rT 112,39,16384
v_sub_f32 v250, v198, v48
mA 184,148,184
v_sub_f32 v251, v199, v50
v_fmac_f32 v45, v248, v248
mA 188,148,188
rT 114,39,18432
v_fmac_f32 v47, v249, v249
mA 156,144,188
v_fmac_f32 v49, v250, v250
mA 220,152,188
dL 31,52,29,0
mA 252,156,188
v_fmac_f32 v51, v251, v251
mA 248,156,184
rT 116,40,16384
v_sub_f32 v248, v224, v52
mA 216,152,184
v_sub_f32 v249, v225, v54
v_sub_f32 v250, v226, v56
mA 212,152,180
v_sub_f32 v251, v227, v58
mA 244,156,180
rT 118,40,18432
v_fmac_f32 v53, v248, v248
mA 240,156,176
v_fmac_f32 v55, v249, v249
v_fmac_f32 v57, v250, v250
mA 208,152,176
rT 120,41,16384
v_fmac_f32 v59, v251, v251
mA 204,152,172
v_sub_f32 v248, v200, v44
mA 236,156,172
dL 32,52,29,1024
mA 232,156,168
v_sub_f32 v249, v201, v46
mA 200,152,168
rT 122,41,18432
v_sub_f32 v250, v202, v48
mA 196,152,164
v_sub_f32 v251, v203, v50
v_fmac_f32 v45, v248, v248
mA 228,156,164
rT 124,42,16384
v_fmac_f32 v47, v249, v249
mA 224,156,160
v_fmac_f32 v49, v250, v250
v_fmac_f32 v51, v251, v251
mA 192,152,160
v_sub_f32 v248, v228, v52
rT 126,42,18432
v_sub_f32 v249, v229, v54
dL 33,52,29,2048
v_sub_f32 v250, v230, v56
v_sub_f32 v251, v231, v58
v_fmac_f32 v53, v248, v248
v_fmac_f32 v55, v249, v249
v_fmac_f32 v57, v250, v250
v_fmac_f32 v59, v251, v251
v_sub_f32 v248, v204, v44
v_sub_f32 v249, v205, v46
v_sub_f32 v250, v206, v48
v_sub_f32 v251, v207, v50
dL 34,52,29,3072
v_fmac_f32 v45, v248, v248
v_fmac_f32 v47, v249, v249
s_waitcnt lgkmcnt(0)
s_waitcnt vmcnt(18)
s_barrier
v_fmac_f32 v49, v250, v250
v_fmac_f32 v51, v251, v251
v_sub_f32 v248, v232, v52
v_sub_f32 v249, v233, v54
v_sub_f32 v250, v234, v56
v_sub_f32 v251, v235, v58
v_fmac_f32 v53, v248, v248
v_fmac_f32 v55, v249, v249
s_add_u32 s29, s29, 262144
v_fmac_f32 v57, v250, v250
v_fmac_f32 v59, v251, v251
v_sub_f32 v248, v208, v44
v_sub_f32 v249, v209, v46
v_sub_f32 v250, v210, v48
v_sub_f32 v251, v211, v50
v_fmac_f32 v45, v248, v248
v_fmac_f32 v47, v249, v249
v_fmac_f32 v49, v250, v250
v_fmac_f32 v51, v251, v251
v_sub_f32 v248, v236, v52
v_sub_f32 v249, v237, v54
v_sub_f32 v250, v238, v56
v_sub_f32 v251, v239, v58
v_fmac_f32 v53, v248, v248
mA 0,64,96
rB 128,30,0
mA 32,68,96
s_add_u32 s100, s26, s25
s_add_u32 m0, s100, 4096
v_fmac_f32 v55, v249, v249
mA 36,68,100
v_fmac_f32 v57, v250, v250
v_fmac_f32 v59, v251, v251
mA 4,64,100
rB 132,30,2048
v_sub_f32 v248, v212, v44
mA 8,64,104
v_sub_f32 v249, v213, v46
v_sub_f32 v250, v214, v48
mA 40,68,104
rB 136,30,4096
v_sub_f32 v251, v215, v50
mA 44,68,108
v_fmac_f32 v45, v248, v248
mA 12,64,108
dL 25,16,27,0
mA 16,64,112
rB 140,30,6144
v_fmac_f32 v47, v249, v249
mA 48,68,112
v_fmac_f32 v49, v250, v250
v_fmac_f32 v51, v251, v251
mA 52,68,116
rB 144,30,8192
v_sub_f32 v248, v240, v52
mA 20,64,116
v_sub_f32 v249, v241, v54
v_sub_f32 v250, v242, v56
mA 24,64,120
rB 148,30,10240
v_sub_f32 v251, v243, v58
mA 56,68,120
v_fmac_f32 v53, v248, v248
mA 60,68,124
dL 26,16,27,1024
mA 28,64,124
v_fmac_f32 v55, v249, v249
mA 92,72,124
rB 152,30,12288
v_fmac_f32 v57, v250, v250
mA 124,76,124
v_fmac_f32 v59, v251, v251
v_sub_f32 v248, v216, v44
mA 120,76,120
rB 156,30,14336
v_sub_f32 v249, v217, v46
mA 88,72,120
v_sub_f32 v250, v218, v48
v_sub_f32 v251, v219, v50
mA 84,72,116
s_add_u32 s24, s24, 32768
s_cmp_lt_u32 s24, 98304
s_cselect_b32 s24, s24, 0
mA 116,76,116
v_fmac_f32 v45, v248, v248
mA 112,76,112
dL 27,16,27,2048
mA 80,72,112
v_fmac_f32 v47, v249, v249
v_fmac_f32 v49, v250, v250
mA 76,72,108
v_add_u32 v29, s24, v20
v_fmac_f32 v51, v251, v251
mA 108,76,108
v_sub_f32 v248, v244, v52
v_sub_f32 v249, v245, v54
mA 104,76,104
v_xor_b32 v30, 64, v29
v_sub_f32 v250, v246, v56
mA 72,72,104
v_sub_f32 v251, v247, v58
v_fmac_f32 v53, v248, v248
mA 68,72,100
rT 160,35,32768
mA 100,76,100
dL 28,16,27,3072
mA 96,76,96
v_fmac_f32 v55, v249, v249
v_fmac_f32 v57, v250, v250
mA 64,72,96
v_fmac_f32 v59, v251, v251
mA 128,80,96
rT 162,35,34816
v_add_f32_dpp v45, v45, v45 row_ror:8 row_mask:0xf bank_mask:0xf
mA 160,84,96
v_add_f32_dpp v47, v47, v47 row_ror:8 row_mask:0xf bank_mask:0xf
v_add_f32_dpp v49, v49, v49 row_ror:8 row_mask:0xf bank_mask:0xf
mA 164,84,100
rT 164,36,32768
v_add_f32_dpp v51, v51, v51 row_ror:8 row_mask:0xf bank_mask:0xf
mA 132,80,100
v_add_f32_dpp v53, v53, v53 row_ror:8 row_mask:0xf bank_mask:0xf
s_add_u32 s27, s27, 128
mA 136,80,104
v_add_f32_dpp v55, v55, v55 row_ror:8 row_mask:0xf bank_mask:0xf
mA 168,84,104
rT 166,36,34816
v_add_f32_dpp v57, v57, v57 row_ror:8 row_mask:0xf bank_mask:0xf
mA 172,84,108
v_add_f32_dpp v59, v59, v59 row_ror:8 row_mask:0xf bank_mask:0xf
mA 140,80,108
rT 168,37,32768
v_add_f32_dpp v45, v45, v45 row_ror:4 row_mask:0xf bank_mask:0xf
mA 144,80,112
v_add_f32_dpp v47, v47, v47 row_ror:4 row_mask:0xf bank_mask:0xf
v_add_f32_dpp v49, v49, v49 row_ror:4 row_mask:0xf bank_mask:0xf
mA 176,84,112
rT 170,37,34816
v_add_f32_dpp v51, v51, v51 row_ror:4 row_mask:0xf bank_mask:0xf
mA 180,84,116
v_add_f32_dpp v53, v53, v53 row_ror:4 row_mask:0xf bank_mask:0xf
v_add_f32_dpp v55, v55, v55 row_ror:4 row_mask:0xf bank_mask:0xf
mA 148,80,116
s_add_u32 s25, s25, 32768
s_cmp_lt_u32 s25, 98304
s_cselect_b32 s25, s25, 0
mA 152,80,120
rT 172,38,32768
v_add_f32_dpp v57, v57, v57 row_ror:4 row_mask:0xf bank_mask:0xf
mA 184,84,120
v_add_f32_dpp v59, v59, v59 row_ror:4 row_mask:0xf bank_mask:0xf
v_add_f32_dpp v45, v45, v45 row_ror:2 row_mask:0xf bank_mask:0xf
mA 188,84,124
rT 174,38,34816
v_add_f32_dpp v47, v47, v47 row_ror:2 row_mask:0xf bank_mask:0xf
mA 156,80,124
v_add_f32_dpp v49, v49, v49 row_ror:2 row_mask:0xf bank_mask:0xf
v_add_f32_dpp v51, v51, v51 row_ror:2 row_mask:0xf bank_mask:0xf
mA 220,88,124
rT 176,39,32768
v_add_f32_dpp v53, v53, v53 row_ror:2 row_mask:0xf bank_mask:0xf
mA 252,92,124
v_add_f32_dpp v55, v55, v55 row_ror:2 row_mask:0xf bank_mask:0xf
s_add_u32 m0, s28, 114688
mA 248,92,120
v_add_f32_dpp v57, v57, v57 row_ror:2 row_mask:0xf bank_mask:0xf
mA 216,88,120
rT 178,39,34816
v_add_f32_dpp v59, v59, v59 row_ror:2 row_mask:0xf bank_mask:0xf
mA 212,88,116
v_add_f32_dpp v45, v45, v45 row_ror:1 row_mask:0xf bank_mask:0xf
v_add_f32_dpp v47, v47, v47 row_ror:1 row_mask:0xf bank_mask:0xf
mA 244,92,116
rT 180,40,32768
v_add_f32_dpp v49, v49, v49 row_ror:1 row_mask:0xf bank_mask:0xf
mA 240,92,112
v_add_f32_dpp v51, v51, v51 row_ror:1 row_mask:0xf bank_mask:0xf
v_add_f32_dpp v53, v53, v53 row_ror:1 row_mask:0xf bank_mask:0xf
mA 208,88,112
rT 182,40,34816
v_add_f32_dpp v55, v55, v55 row_ror:1 row_mask:0xf bank_mask:0xf
mA 204,88,108
dL 31,52,29,0
mA 236,92,108
v_add_f32_dpp v57, v57, v57 row_ror:1 row_mask:0xf bank_mask:0xf
v_add_f32_dpp v59, v59, v59 row_ror:1 row_mask:0xf bank_mask:0xf
mA 232,92,104
rT 184,41,32768
s_lshl_b32 s38, s69, 7
mA 200,88,104
s_lshl_b32 s73, s3, 5
s_add_u32 s38, s38, s73
s_lshl_b32 s38, s38, 3
mA 196,88,100
s_add_u32 s38, s38, 79691776
s_lshl_b32 s73, s64, 14
s_add_u32 s37, s38, s73
mA 228,92,100
v_lshrrev_b32 v252, 4, v1
mA 224,92,96
rT 186,41,34816
v_lshlrev_b32 v252, 6, v252
mA 192,88,96
v_and_b32 v253, 15, v1
v_cmp_eq_u32 vcc, 0, v253
rT 188,42,32768
dL 32,52,29,1024
v_mov_b32 v253, 2147483648
v_cndmask_b32 v253, v253, v252, vcc
buffer_store_dwordx4 v[44:47], v253, s[12:15], s37 offen offset:0 sc1
rT 190,42,34816
buffer_store_dwordx4 v[48:51], v253, s[12:15], s37 offen offset:16 sc1
buffer_store_dwordx4 v[52:55], v253, s[12:15], s37 offen offset:32 sc1
dL 33,52,29,2048
buffer_store_dwordx4 v[56:59], v253, s[12:15], s37 offen offset:48 sc1
cP 192,192,193
cP 193,194,195
cP 194,220,221
cP 195,222,223
cP 196,196,197
cP 197,198,199
s_waitcnt lgkmcnt(0)
s_waitcnt vmcnt(19)
s_barrier
cP 198,224,225
dL 34,52,29,3072
cP 199,226,227
cP 200,200,201
cP 201,202,203
cP 202,228,229
cP 203,230,231
cP 204,204,205
cP 205,206,207
cP 206,232,233
s_add_u32 s29, s29, 262144
cP 207,234,235
cP 208,208,209
cP 209,210,211
cP 210,236,237
cP 211,238,239
cP 212,212,213
cP 213,214,215
cP 214,240,241
cP 215,242,243
cP 216,216,217
cP 217,218,219
cP 218,244,245
cP 219,246,247
mA 0,128,160
rB 64,29,0
mA 32,132,160
s_add_u32 s100, s26, s25
s_add_u32 m0, s100, 0
s_lshl_b32 s70, s2, 3
mA 36,132,164
rB 68,29,2048
s_lshl_b32 s101, s3, 1
mA 4,128,164
rB 72,29,4096
mA 8,128,168
s_add_u32 s70, s70, s101
mA 40,132,168
dL 21,16,27,0
mA 44,132,172
rB 76,29,6144
s_add_u32 s70, s70, 0
mA 12,128,172
rB 80,29,8192
mA 16,128,176
s_mul_i32 s101, s70, 896
mA 48,132,176
rB 84,29,10240
mA 52,132,180
v_lshlrev_b32 v236, 4, v1
mA 20,128,180
dL 22,16,27,1024
mA 24,128,184
rB 88,29,12288
v_mov_b32 v238, 2147483648
mA 56,132,184
rB 92,29,14336
mA 60,132,188
mA 28,128,188
v_cmp_gt_u32 vcc, 56, v1
mA 92,136,188
rT 96,35,49152
mA 124,140,188
dL 23,16,27,2048
mA 120,140,184
rT 98,35,51200
v_cndmask_b32 v236, v238, v236, vcc
mA 88,136,184
rT 100,36,49152
mA 84,136,180
buffer_load_dwordx4 v[232:235], v236, s[40:43], 0 offen
mA 116,140,180
rT 102,36,51200
mA 112,140,176
buffer_load_dwordx4 v[224:227], v236, s[4:7], s101 offen
mA 80,136,176
dL 24,16,27,3072
mA 76,136,172
rT 104,37,49152
mA 108,140,172
buffer_load_dwordx4 v[228:231], v236, s[4:7], s101 offen offset:896
mA 104,140,168
rT 106,37,51200
s_lshl_b32 s70, s70, 2
mA 72,136,168
rT 108,38,49152
s_add_u32 m0, s28, 131072
mA 68,136,164
s_add_u32 s70, s70, 79953920
rT 110,38,51200
mA 100,140,164
mA 96,140,160
rT 112,39,49152
mA 64,136,160
s_mul_i32 s31, s95, 114688
s_lshl_b32 s33, s94, 9
s_lshl_b32 s73, s72, 6
mA 128,144,160
rT 114,39,51200
s_mul_i32 s30, s3, 28672
mA 160,148,160
s_add_u32 s31, s31, s30
dL 31,52,29,0
mA 164,148,164
s_mul_i32 s30, s3, 4096
v_lshrrev_b32 v248, 3, v1
mA 132,144,164
rT 116,40,49152
v_mul_u32_u24 v248, 896, v248
mA 136,144,168
v_bfe_u32 v250, v1, 4, 2
v_and_b32 v249, 7, v1
mA 168,148,168
v_xor_b32 v249, v249, v250
mA 172,148,172
rT 118,40,51200
v_lshl_add_u32 v248, v249, 4, v248
mA 140,144,172
v_add_u32 v2, 0, v248
v_xor_b32 v3, 64, v248
mA 144,144,176
rT 120,41,49152
v_add_u32 v3, 6144, v3
mA 176,148,176
v_add_u32 v4, 12288, v248
v_add_u32 v5, 12288, v3
mA 180,148,180
dL 32,52,29,1024
mA 148,144,180
v_and_b32 v248, 15, v1
mA 152,144,184
rT 122,41,51200
v_lshrrev_b32 v249, 1, v248
mA 184,148,184
v_lshrrev_b32 v250, 4, v1
v_xor_b32 v249, v249, v250
mA 188,148,188
v_add_u32 v248, s73, v248
mA 156,144,188
rT 124,42,49152
v_lshlrev_b32 v248, 7, v248
mA 220,152,188
v_lshl_add_u32 v6, v249, 4, v248
v_xor_b32 v7, 64, v6
mA 252,156,188
s_lshl_b32 s73, s71, 3
rT 126,42,51200
s_mul_i32 s32, s3, 65536
mA 248,156,184
s_add_u32 s33, s33, s32
dL 33,52,29,2048
mA 216,152,184
s_mul_i32 s32, s3, 4096
v_lshrrev_b32 v248, 5, v1
v_and_b32 v249, 31, v1
mA 212,152,180
v_lshlrev_b32 v250, 1, v248
v_xor_b32 v249, v249, v250
mA 244,156,180
s_and_b32 s101, s3, 1
s_lshl_b32 s101, s101, 3
v_xor_b32 v249, s101, v249
mA 240,156,176
v_lshlrev_b32 v249, 4, v249
v_mul_u32_u24 v248, 8192, v248
mA 208,152,176
v_add_u32 v8, v249, v248
v_xor_b32 v9, 64, v249
mA 204,152,172
dL 34,52,29,3072
mA 236,156,172
v_add_u32 v9, v9, v248
v_add_u32 v9, 15360, v9
mA 232,156,168
v_add_u32 v10, v249, v248
s_waitcnt lgkmcnt(0)
mA 200,152,168
s_waitcnt vmcnt(23)
s_barrier
v_add_u32 v10, 30720, v10
mA 196,152,164
v_xor_b32 v11, 64, v249
v_add_u32 v11, v11, v248
mA 228,156,164
v_add_u32 v11, 46080, v11
v_lshrrev_b32 v248, 4, v1
mA 224,156,160
v_bfe_u32 v249, v1, 2, 2
v_lshl_add_u32 v250, v248, 3, v249
mA 192,152,160
v_and_b32 v248, 1, v248
s_add_u32 s29, s29, 262144
v_lshl_add_u32 v248, v248, 2, v249
v_lshrrev_b32 v248, 0, v248
v_lshlrev_b32 v248, 5, v248
v_mul_u32_u24 v250, 512, v250
v_and_b32 v249, 3, v1
v_lshl_add_u32 v250, v249, 3, v250
v_add_u32 v250, 65536, v250
s_lshl_b32 s101, s73, 5
v_xad_u32 v12, s101, v248, v250
s_add_u32 s101, s101, 32
v_xad_u32 v13, s101, v248, v250
s_add_u32 s101, s101, 32
v_xad_u32 v14, s101, v248, v250
s_add_u32 s101, s101, 32
v_xad_u32 v15, s101, v248, v250
s_add_u32 s101, s101, 32
v_xad_u32 v16, s101, v248, v250
s_add_u32 s101, s101, 32
v_xad_u32 v17, s101, v248, v250
s_add_u32 s101, s101, 32
v_xad_u32 v18, s101, v248, v250
s_add_u32 s101, s101, 32
v_xad_u32 v19, s101, v248, v250
s_add_u32 s101, s101, 32
mA 0,64,96
rB 128,30,0
mA 32,68,96
s_add_u32 s100, s26, s25
s_add_u32 m0, s100, 4096
rB 132,30,2048
mA 36,68,100
mA 4,64,100
s_waitcnt vmcnt(4)
rB 136,30,4096
v_mov_b32 v236, 0
mA 8,64,104
v_mov_b32 v237, 0
v_lshlrev_b32 v238, 16, v232
mA 40,68,104
dL 25,16,27,0
mA 44,68,108
rB 140,30,6144
v_lshlrev_b32 v239, 16, v224
mA 12,64,108
v_fmac_f32 v236, v238, v239
v_lshlrev_b32 v239, 16, v228
mA 16,64,112
rB 144,30,8192
v_fmac_f32 v237, v238, v239
mA 48,68,112
v_and_b32 v238, 0xffff0000, v232
mA 52,68,116
rB 148,30,10240
v_and_b32 v239, 0xffff0000, v224
mA 20,64,116
v_fmac_f32 v236, v238, v239
mA 24,64,120
dL 26,16,27,1024
mA 56,68,120
v_and_b32 v239, 0xffff0000, v228
mA 60,68,124
rB 152,30,12288
v_fmac_f32 v237, v238, v239
mA 28,64,124
v_lshlrev_b32 v238, 16, v233
mA 92,72,124
rB 156,30,14336
v_lshlrev_b32 v239, 16, v225
mA 124,76,124
v_fmac_f32 v236, v238, v239
v_lshlrev_b32 v239, 16, v229
mA 120,76,120
s_add_u32 s24, s24, 32768
s_cmp_lt_u32 s24, 98304
s_cselect_b32 s24, s24, 0
mA 88,72,120
v_fmac_f32 v237, v238, v239
mA 84,72,116
dL 27,16,27,2048
mA 116,76,116
v_and_b32 v238, 0xffff0000, v233
v_and_b32 v239, 0xffff0000, v225
mA 112,76,112
v_add_u32 v29, s24, v20
v_fmac_f32 v236, v238, v239
mA 80,72,112
v_and_b32 v239, 0xffff0000, v229
v_xor_b32 v30, 64, v29
mA 76,72,108
v_fmac_f32 v237, v238, v239
v_lshlrev_b32 v238, 16, v234
mA 108,76,108
v_lshlrev_b32 v239, 16, v226
mA 104,76,104
rT 160,35,0
mA 72,72,104
dL 28,16,27,3072
mA 68,72,100
v_fmac_f32 v236, v238, v239
v_lshlrev_b32 v239, 16, v230
mA 100,76,100
rT 162,35,2048
v_fmac_f32 v237, v238, v239
mA 96,76,96
v_and_b32 v238, 0xffff0000, v234
v_and_b32 v239, 0xffff0000, v226
mA 64,72,96
rT 164,36,0
v_fmac_f32 v236, v238, v239
mA 128,80,96
v_and_b32 v239, 0xffff0000, v230
s_add_u32 s27, s27, 128
mA 160,84,96
v_fmac_f32 v237, v238, v239
mA 164,84,100
rT 166,36,2048
v_lshlrev_b32 v238, 16, v235
mA 132,80,100
v_lshlrev_b32 v239, 16, v227
mA 136,80,104
rT 168,37,0
v_fmac_f32 v236, v238, v239
mA 168,84,104
v_lshlrev_b32 v239, 16, v231
v_fmac_f32 v237, v238, v239
mA 172,84,108
rT 170,37,2048
v_and_b32 v238, 0xffff0000, v235
mA 140,80,108
v_and_b32 v239, 0xffff0000, v227
mA 144,80,112
s_add_u32 s25, s25, 32768
s_cmp_lt_u32 s25, 98304
s_cselect_b32 s25, s25, 0
mA 176,84,112
rT 172,38,0
v_fmac_f32 v236, v238, v239
mA 180,84,116
rT 174,38,2048
rT 176,39,0
mA 148,80,116
v_lshl_add_u32 v252, s3, 6, v1
s_add_u32 m0, s28, 147456
mA 152,80,120
rT 178,39,2048
v_cmp_eq_u32 vcc, 0, v252
mA 184,84,120
rT 180,40,0
rT 182,40,2048
mA 188,84,124
s_lshl_b32 s39, s69, 2
dL 31,52,29,0
mA 156,80,124
rT 184,41,0
v_mov_b32 v252, 2147483648
mA 220,88,124
rT 186,41,2048
rT 188,42,0
mA 252,92,124
dL 32,52,29,1024
mA 248,92,120
v_cndmask_b32 v252, v252, 0, vcc
mA 216,88,120
rT 190,42,2048
v_mov_b32 v253, 1
mA 212,88,116
dL 33,52,29,2048
mA 244,92,116
s_waitcnt lgkmcnt(0)
mA 240,92,112
s_barrier
dL 34,52,29,3072
mA 208,88,112
mA 204,88,108
s_add_u32 s29, s29, 262144
mA 236,92,108
mA 232,92,104
mA 200,88,104
mA 196,88,100
mA 228,92,100
mA 224,92,96
mA 192,88,96
mA 0,128,160
rB 64,29,0
mA 32,132,160
s_add_u32 s100, s26, s25
s_add_u32 m0, s100, 0
mA 36,132,164
buffer_atomic_add v253, v252, s[60:63], s39 offen
mA 4,128,164
rB 68,29,2048
v_and_b32 v239, 0xffff0000, v231
mA 8,128,168
rB 72,29,4096
v_fmac_f32 v237, v238, v239
mA 40,132,168
v_add_f32_dpp v236, v236, v236 row_ror:8 row_mask:0xf bank_mask:0xf
mA 44,132,172
dL 21,16,27,0
mA 12,128,172
v_add_f32_dpp v237, v237, v237 row_ror:8 row_mask:0xf bank_mask:0xf
mA 16,128,176
rB 76,29,6144
v_add_f32_dpp v236, v236, v236 row_ror:4 row_mask:0xf bank_mask:0xf
mA 48,132,176
v_add_f32_dpp v237, v237, v237 row_ror:4 row_mask:0xf bank_mask:0xf
v_add_f32_dpp v236, v236, v236 row_ror:2 row_mask:0xf bank_mask:0xf
mA 52,132,180
rB 80,29,8192
v_add_f32_dpp v237, v237, v237 row_ror:2 row_mask:0xf bank_mask:0xf
mA 20,128,180
v_add_f32_dpp v236, v236, v236 row_ror:1 row_mask:0xf bank_mask:0xf
mA 24,128,184
rB 84,29,10240
v_add_f32_dpp v237, v237, v237 row_ror:1 row_mask:0xf bank_mask:0xf
mA 56,132,184
v_mov_b32 v238, v236
v_mov_b32 v239, v237
mA 60,132,188
dL 22,16,27,1024
mA 28,128,188
rB 88,29,12288
v_permlane16_swap_b32 v236, v238
mA 92,136,188
v_permlane16_swap_b32 v237, v239
v_add_f32 v236, v236, v238
mA 124,140,188
rB 92,29,14336
v_add_f32 v237, v237, v239
mA 120,140,184
v_mov_b32 v238, v236
v_mov_b32 v239, v237
mA 88,136,184
rT 96,35,16384
v_permlane32_swap_b32 v236, v238
mA 84,136,180
v_permlane32_swap_b32 v237, v239
v_add_f32 v236, v236, v238
mA 116,140,180
dL 23,16,27,2048
mA 112,140,176
rT 98,35,18432
v_add_f32 v237, v237, v239
mA 80,136,176
v_mul_f32 v236, 0xbfb8aa3b, v236
mA 76,136,172
v_exp_f32 v236, v236
mA 108,140,172
rT 100,36,16384
v_add_f32 v236, 1.0, v236
mA 104,140,168
v_rcp_f32 v236, v236
mA 72,136,168
rT 102,36,18432
v_mul_f32 v237, 0xbfb8aa3b, v237
mA 68,136,164
dL 24,16,27,3072
mA 100,140,164
v_exp_f32 v237, v237
mA 96,140,160
rT 104,37,16384
v_add_f32 v237, 1.0, v237
mA 64,136,160
v_rcp_f32 v237, v237
mA 128,144,160
rT 106,37,18432
v_mov_b32 v238, 2147483648
mA 160,148,160
v_cmp_eq_u32 vcc, 0, v1
mA 164,148,164
rT 108,38,16384
v_cndmask_b32 v238, v238, 0, vcc
mA 132,144,164
buffer_store_dwordx2 v[236:237], v238, s[12:15], s70 offen sc1
mA 136,144,168
s_add_u32 m0, s28, 98304
rT 110,38,18432
rT 112,39,16384
mA 168,148,168
rT 114,39,18432
mA 172,148,172
dL 31,52,29,0
mA 140,144,172
rT 116,40,16384
rT 118,40,18432
mA 144,144,176
rT 120,41,16384
mA 176,148,176
dL 32,52,29,1024
mA 180,148,180
rT 122,41,18432
rT 124,42,16384
mA 148,144,180
rT 126,42,18432
mA 152,144,184
dL 33,52,29,2048
mA 184,148,184
mA 188,148,188
mA 156,144,188
mA 220,152,188
mA 252,156,188
dL 34,52,29,3072
mA 248,156,184
mA 216,152,184
s_waitcnt lgkmcnt(0)
s_waitcnt vmcnt(18)
s_barrier
mA 212,152,180
mA 244,156,180
mA 240,156,176
mA 208,152,176
s_add_u32 s29, s29, 262144
mA 204,152,172
mA 236,156,172
mA 232,156,168
mA 200,152,168
mA 196,152,164
mA 228,156,164
mA 224,156,160
mA 192,152,160
mA 0,64,96
rB 128,30,0
mA 32,68,96
s_add_u32 s100, s26, s25
s_add_u32 m0, s100, 4096
rB 132,30,2048
mA 36,68,100
mA 4,64,100
rB 136,30,4096
mA 8,64,104
dL 25,16,27,0
mA 40,68,104
rB 140,30,6144
mA 44,68,108
rB 144,30,8192
mA 12,64,108
mA 16,64,112
rB 148,30,10240
mA 48,68,112
dL 26,16,27,1024
mA 52,68,116
rB 152,30,12288
mA 20,64,116
rB 156,30,14336
mA 24,64,120
mA 56,68,120
s_add_u32 s24, s24, 32768
s_cmp_lt_u32 s24, 98304
s_cselect_b32 s24, s24, 0
mA 60,68,124
dL 27,16,27,2048
mA 28,64,124
v_add_u32 v29, s24, v20
mA 92,72,124
v_xor_b32 v30, 64, v29
mA 124,76,124
mA 120,76,120
rT 160,35,32768
mA 88,72,120
dL 28,16,27,3072
mA 84,72,116
rT 162,35,34816
mA 116,76,116
rT 164,36,32768
mA 112,76,112
mA 80,72,112
s_add_u32 s27, s27, 128
rT 166,36,34816
mA 76,72,108
mA 108,76,108
rT 168,37,32768
mA 104,76,104
rT 170,37,34816
mA 72,72,104
mA 68,72,100
s_add_u32 s25, s25, 32768
s_cmp_lt_u32 s25, 98304
s_cselect_b32 s25, s25, 0
mA 100,76,100
rT 172,38,32768
mA 96,76,96
rT 174,38,34816
mA 64,72,96
rT 176,39,32768
mA 128,80,96
s_add_u32 m0, s28, 114688
mA 160,84,96
rT 178,39,34816
mA 164,84,100
mA 132,80,100
rT 180,40,32768
mA 136,80,104
rT 182,40,34816
mA 168,84,104
dL 31,52,29,0
mA 172,84,108
rT 184,41,32768
mA 140,80,108
mA 144,80,112
rT 186,41,34816
mA 176,84,112
rT 188,42,32768
mA 180,84,116
dL 32,52,29,1024
mA 148,80,116
rT 190,42,34816
mA 152,80,120
mA 184,84,120
mA 188,84,124
dL 33,52,29,2048
mA 156,80,124
mA 220,88,124
mA 252,92,124
mA 248,92,120
mA 216,88,120
s_waitcnt lgkmcnt(0)
s_waitcnt vmcnt(17)
s_barrier
mA 212,88,116
dL 34,52,29,3072
mA 244,92,116
mA 240,92,112
mA 208,88,112
mA 204,88,108
s_add_u32 s29, s29, 262144
mA 236,92,108
mA 232,92,104
mA 200,88,104
mA 196,88,100
mA 228,92,100
mA 224,92,96
mA 192,88,96
s_mov_b32 s34, 3
L1_V_loop:
mA 0,128,160
rB 64,29,0
mA 32,132,160
s_add_u32 s100, s26, s25
s_add_u32 m0, s100, 0
rB 68,29,2048
mA 36,132,164
mA 4,128,164
rB 72,29,4096
mA 8,128,168
mA 40,132,168
dL 21,16,27,0
mA 44,132,172
rB 76,29,6144
mA 12,128,172
rB 80,29,8192
mA 16,128,176
mA 48,132,176
rB 84,29,10240
mA 52,132,180
mA 20,128,180
dL 22,16,27,1024
mA 24,128,184
rB 88,29,12288
mA 56,132,184
rB 92,29,14336
mA 60,132,188
mA 28,128,188
rT 96,35,49152
mA 92,136,188
dL 23,16,27,2048
mA 124,140,188
rT 98,35,51200
mA 120,140,184
rT 100,36,49152
mA 88,136,184
mA 84,136,180
rT 102,36,51200
mA 116,140,180
mA 112,140,176
dL 24,16,27,3072
mA 80,136,176
rT 104,37,49152
mA 76,136,172
rT 106,37,51200
mA 108,140,172
mA 104,140,168
rT 108,38,49152
mA 72,136,168
s_add_u32 m0, s28, 131072
mA 68,136,164
rT 110,38,51200
mA 100,140,164
mA 96,140,160
rT 112,39,49152
mA 64,136,160
mA 128,144,160
rT 114,39,51200
mA 160,148,160
dL 31,52,29,0
mA 164,148,164
rT 116,40,49152
mA 132,144,164
rT 118,40,51200
mA 136,144,168
mA 168,148,168
rT 120,41,49152
mA 172,148,172
dL 32,52,29,1024
mA 140,144,172
rT 122,41,51200
mA 144,144,176
mA 176,148,176
rT 124,42,49152
mA 180,148,180
mA 148,144,180
rT 126,42,51200
mA 152,144,184
dL 33,52,29,2048
mA 184,148,184
mA 188,148,188
mA 156,144,188
mA 220,152,188
mA 252,156,188
dL 34,52,29,3072
mA 248,156,184
mA 216,152,184
s_waitcnt lgkmcnt(0)
s_waitcnt vmcnt(16)
s_barrier
mA 212,152,180
mA 244,156,180
mA 240,156,176
mA 208,152,176
s_add_u32 s29, s29, 262144
mA 204,152,172
mA 236,156,172
mA 232,156,168
mA 200,152,168
mA 196,152,164
mA 228,156,164
mA 224,156,160
mA 192,152,160
mA 0,64,96
rB 128,30,0
mA 32,68,96
s_add_u32 s100, s26, s25
s_add_u32 m0, s100, 4096
rB 132,30,2048
mA 36,68,100
mA 4,64,100
rB 136,30,4096
mA 8,64,104
dL 25,16,27,0
mA 40,68,104
rB 140,30,6144
mA 44,68,108
rB 144,30,8192
mA 12,64,108
mA 16,64,112
rB 148,30,10240
mA 48,68,112
dL 26,16,27,1024
mA 52,68,116
rB 152,30,12288
mA 20,64,116
rB 156,30,14336
mA 24,64,120
mA 56,68,120
s_add_u32 s24, s24, 32768
s_cmp_lt_u32 s24, 98304
s_cselect_b32 s24, s24, 0
mA 60,68,124
dL 27,16,27,2048
mA 28,64,124
v_add_u32 v29, s24, v20
mA 92,72,124
v_xor_b32 v30, 64, v29
mA 124,76,124
mA 120,76,120
rT 160,35,0
mA 88,72,120
dL 28,16,27,3072
mA 84,72,116
rT 162,35,2048
mA 116,76,116
rT 164,36,0
mA 112,76,112
mA 80,72,112
s_add_u32 s27, s27, 128
rT 166,36,2048
mA 76,72,108
mA 108,76,108
rT 168,37,0
mA 104,76,104
rT 170,37,2048
mA 72,72,104
mA 68,72,100
s_add_u32 s25, s25, 32768
s_cmp_lt_u32 s25, 98304
s_cselect_b32 s25, s25, 0
mA 100,76,100
rT 172,38,0
mA 96,76,96
rT 174,38,2048
mA 64,72,96
rT 176,39,0
mA 128,80,96
s_add_u32 m0, s28, 147456
mA 160,84,96
rT 178,39,2048
mA 164,84,100
mA 132,80,100
rT 180,40,0
mA 136,80,104
rT 182,40,2048
mA 168,84,104
dL 31,52,29,0
mA 172,84,108
rT 184,41,0
mA 140,80,108
mA 144,80,112
rT 186,41,2048
mA 176,84,112
rT 188,42,0
mA 180,84,116
dL 32,52,29,1024
mA 148,80,116
rT 190,42,2048
mA 152,80,120
mA 184,84,120
mA 188,84,124
dL 33,52,29,2048
mA 156,80,124
mA 220,88,124
mA 252,92,124
mA 248,92,120
mA 216,88,120
s_waitcnt lgkmcnt(0)
s_waitcnt vmcnt(15)
s_barrier
mA 212,88,116
dL 34,52,29,3072
mA 244,92,116
mA 240,92,112
mA 208,88,112
mA 204,88,108
s_add_u32 s29, s29, 262144
mA 236,92,108
mA 232,92,104
mA 200,88,104
mA 196,88,100
mA 228,92,100
mA 224,92,96
mA 192,88,96
mA 0,128,160
rB 64,29,0
mA 32,132,160
s_add_u32 s100, s26, s25
s_add_u32 m0, s100, 0
rB 68,29,2048
mA 36,132,164
mA 4,128,164
rB 72,29,4096
mA 8,128,168
mA 40,132,168
dL 21,16,27,0
mA 44,132,172
rB 76,29,6144
mA 12,128,172
rB 80,29,8192
mA 16,128,176
mA 48,132,176
rB 84,29,10240
mA 52,132,180
mA 20,128,180
dL 22,16,27,1024
mA 24,128,184
rB 88,29,12288
mA 56,132,184
rB 92,29,14336
mA 60,132,188
mA 28,128,188
rT 96,35,16384
mA 92,136,188
dL 23,16,27,2048
mA 124,140,188
rT 98,35,18432
mA 120,140,184
rT 100,36,16384
mA 88,136,184
mA 84,136,180
rT 102,36,18432
mA 116,140,180
mA 112,140,176
dL 24,16,27,3072
mA 80,136,176
rT 104,37,16384
mA 76,136,172
rT 106,37,18432
mA 108,140,172
mA 104,140,168
rT 108,38,16384
mA 72,136,168
s_add_u32 m0, s28, 98304
mA 68,136,164
rT 110,38,18432
mA 100,140,164
mA 96,140,160
rT 112,39,16384
mA 64,136,160
mA 128,144,160
rT 114,39,18432
mA 160,148,160
dL 31,52,29,0
mA 164,148,164
rT 116,40,16384
mA 132,144,164
rT 118,40,18432
mA 136,144,168
mA 168,148,168
rT 120,41,16384
mA 172,148,172
dL 32,52,29,1024
mA 140,144,172
rT 122,41,18432
mA 144,144,176
mA 176,148,176
rT 124,42,16384
mA 180,148,180
mA 148,144,180
rT 126,42,18432
mA 152,144,184
dL 33,52,29,2048
mA 184,148,184
mA 188,148,188
mA 156,144,188
mA 220,152,188
mA 252,156,188
dL 34,52,29,3072
mA 248,156,184
mA 216,152,184
s_waitcnt lgkmcnt(0)
s_waitcnt vmcnt(16)
s_barrier
mA 212,152,180
mA 244,156,180
mA 240,156,176
mA 208,152,176
s_add_u32 s29, s29, 262144
mA 204,152,172
mA 236,156,172
mA 232,156,168
mA 200,152,168
mA 196,152,164
mA 228,156,164
mA 224,156,160
mA 192,152,160
mA 0,64,96
rB 128,30,0
mA 32,68,96
s_add_u32 s100, s26, s25
s_add_u32 m0, s100, 4096
rB 132,30,2048
mA 36,68,100
mA 4,64,100
rB 136,30,4096
mA 8,64,104
dL 25,16,27,0
mA 40,68,104
rB 140,30,6144
mA 44,68,108
rB 144,30,8192
mA 12,64,108
mA 16,64,112
rB 148,30,10240
mA 48,68,112
dL 26,16,27,1024
mA 52,68,116
rB 152,30,12288
mA 20,64,116
rB 156,30,14336
mA 24,64,120
mA 56,68,120
s_add_u32 s24, s24, 32768
s_cmp_lt_u32 s24, 98304
s_cselect_b32 s24, s24, 0
mA 60,68,124
dL 27,16,27,2048
mA 28,64,124
v_add_u32 v29, s24, v20
mA 92,72,124
v_xor_b32 v30, 64, v29
mA 124,76,124
mA 120,76,120
rT 160,35,32768
mA 88,72,120
dL 28,16,27,3072
mA 84,72,116
rT 162,35,34816
mA 116,76,116
rT 164,36,32768
mA 112,76,112
mA 80,72,112
s_add_u32 s27, s27, 128
rT 166,36,34816
mA 76,72,108
mA 108,76,108
rT 168,37,32768
mA 104,76,104
rT 170,37,34816
mA 72,72,104
mA 68,72,100
s_add_u32 s25, s25, 32768
s_cmp_lt_u32 s25, 98304
s_cselect_b32 s25, s25, 0
mA 100,76,100
rT 172,38,32768
mA 96,76,96
rT 174,38,34816
mA 64,72,96
rT 176,39,32768
mA 128,80,96
s_add_u32 m0, s28, 114688
mA 160,84,96
rT 178,39,34816
mA 164,84,100
mA 132,80,100
rT 180,40,32768
mA 136,80,104
rT 182,40,34816
mA 168,84,104
dL 31,52,29,0
mA 172,84,108
rT 184,41,32768
mA 140,80,108
mA 144,80,112
rT 186,41,34816
mA 176,84,112
rT 188,42,32768
mA 180,84,116
dL 32,52,29,1024
mA 148,80,116
rT 190,42,34816
mA 152,80,120
mA 184,84,120
mA 188,84,124
dL 33,52,29,2048
mA 156,80,124
mA 220,88,124
mA 252,92,124
mA 248,92,120
mA 216,88,120
s_waitcnt lgkmcnt(0)
s_waitcnt vmcnt(15)
s_barrier
mA 212,88,116
dL 34,52,29,3072
mA 244,92,116
mA 240,92,112
mA 208,88,112
mA 204,88,108
s_add_u32 s29, s29, 262144
mA 236,92,108
mA 232,92,104
mA 200,88,104
mA 196,88,100
mA 228,92,100
mA 224,92,96
mA 192,88,96
s_sub_u32 s34, s34, 1
s_cmp_lg_u32 s34, 0
s_cbranch_scc1 L1_V_loop
mA 0,128,160
rB 64,29,0
mA 32,132,160
s_add_u32 s100, s26, s25
s_add_u32 m0, s100, 0
rB 68,29,2048
mA 36,132,164
mA 4,128,164
rB 72,29,4096
mA 8,128,168
mA 40,132,168
dL 21,16,27,0
mA 44,132,172
rB 76,29,6144
mA 12,128,172
rB 80,29,8192
mA 16,128,176
mA 48,132,176
rB 84,29,10240
mA 52,132,180
mA 20,128,180
dL 22,16,27,1024
mA 24,128,184
rB 88,29,12288
mA 56,132,184
rB 92,29,14336
mA 60,132,188
mA 28,128,188
rT 96,35,49152
mA 92,136,188
dL 23,16,27,2048
mA 124,140,188
rT 98,35,51200
mA 120,140,184
rT 100,36,49152
mA 88,136,184
mA 84,136,180
rT 102,36,51200
mA 116,140,180
mA 112,140,176
dL 24,16,27,3072
mA 80,136,176
rT 104,37,49152
mA 76,136,172
rT 106,37,51200
mA 108,140,172
mA 104,140,168
rT 108,38,49152
mA 72,136,168
s_add_u32 m0, s28, 131072
mA 68,136,164
rT 110,38,51200
mA 100,140,164
mA 96,140,160
rT 112,39,49152
mA 64,136,160
mA 128,144,160
rT 114,39,51200
mA 160,148,160
dL 31,52,29,0
mA 164,148,164
rT 116,40,49152
mA 132,144,164
rT 118,40,51200
mA 136,144,168
mA 168,148,168
rT 120,41,49152
mA 172,148,172
dL 32,52,29,1024
mA 140,144,172
rT 122,41,51200
mA 144,144,176
mA 176,148,176
rT 124,42,49152
mA 180,148,180
mA 148,144,180
rT 126,42,51200
mA 152,144,184
dL 33,52,29,2048
mA 184,148,184
mA 188,148,188
mA 156,144,188
mA 220,152,188
mA 252,156,188
dL 34,52,29,3072
mA 248,156,184
mA 216,152,184
s_waitcnt lgkmcnt(0)
s_waitcnt vmcnt(16)
s_barrier
mA 212,152,180
mA 244,156,180
mA 240,156,176
mA 208,152,176
s_add_u32 s29, s29, 262144
mA 204,152,172
mA 236,156,172
mA 232,156,168
mA 200,152,168
mA 196,152,164
mA 228,156,164
mA 224,156,160
mA 192,152,160
mA 0,64,96
rB 128,30,0
mA 32,68,96
s_add_u32 s100, s26, s25
s_add_u32 m0, s100, 4096
rB 132,30,2048
mA 36,68,100
mA 4,64,100
rB 136,30,4096
mA 8,64,104
dL 25,16,27,0
mA 40,68,104
rB 140,30,6144
mA 44,68,108
rB 144,30,8192
mA 12,64,108
mA 16,64,112
rB 148,30,10240
mA 48,68,112
dL 26,16,27,1024
mA 52,68,116
rB 152,30,12288
mA 20,64,116
rB 156,30,14336
mA 24,64,120
mA 56,68,120
s_add_u32 s24, s24, 32768
s_cmp_lt_u32 s24, 98304
s_cselect_b32 s24, s24, 0
mA 60,68,124
dL 27,16,27,2048
mA 28,64,124
v_add_u32 v29, s24, v20
mA 92,72,124
v_xor_b32 v30, 64, v29
mA 124,76,124
mA 120,76,120
rT 160,35,0
mA 88,72,120
dL 28,16,27,3072
mA 84,72,116
rT 162,35,2048
mA 116,76,116
rT 164,36,0
mA 112,76,112
mA 80,72,112
s_add_u32 s27, s27, 128
rT 166,36,2048
mA 76,72,108
mA 108,76,108
rT 168,37,0
mA 104,76,104
rT 170,37,2048
mA 72,72,104
mA 68,72,100
s_add_u32 s25, s25, 32768
s_cmp_lt_u32 s25, 98304
s_cselect_b32 s25, s25, 0
mA 100,76,100
rT 172,38,0
mA 96,76,96
rT 174,38,2048
mA 64,72,96
rT 176,39,0
mA 128,80,96
s_add_u32 m0, s28, 147456
mA 160,84,96
rT 178,39,2048
mA 164,84,100
mA 132,80,100
rT 180,40,0
mA 136,80,104
rT 182,40,2048
mA 168,84,104
dL 31,52,29,0
mA 172,84,108
rT 184,41,0
mA 140,80,108
mA 144,80,112
rT 186,41,2048
mA 176,84,112
rT 188,42,0
mA 180,84,116
dL 32,52,29,1024
mA 148,80,116
rT 190,42,2048
mA 152,80,120
mA 184,84,120
mA 188,84,124
dL 33,52,29,2048
mA 156,80,124
mA 220,88,124
mA 252,92,124
mA 248,92,120
mA 216,88,120
s_waitcnt lgkmcnt(0)
s_waitcnt vmcnt(15)
s_barrier
mA 212,88,116
dL 34,52,29,3072
mA 244,92,116
mA 240,92,112
mA 208,88,112
mA 204,88,108
s_add_u32 s29, s29, 262144
mA 236,92,108
mA 232,92,104
mA 200,88,104
mA 196,88,100
mA 228,92,100
mA 224,92,96
mA 192,88,96
mA 0,128,160
rB 64,29,0
mA 32,132,160
s_add_u32 s100, s26, s25
s_add_u32 m0, s100, 0
v_mov_b32 v252, 0
mA 36,132,164
rB 68,29,2048
mA 4,128,164
buffer_load_dword v253, v252, s[60:63], s39 offen sc1
mA 8,128,168
rB 72,29,4096
mA 40,132,168
dL 21,16,27,0
mA 44,132,172
rB 76,29,6144
mA 12,128,172
v_and_b32 v254, 7, v1
mA 16,128,176
rB 80,29,8192
mA 48,132,176
rB 84,29,10240
mA 52,132,180
v_lshlrev_b32 v254, 14, v254
mA 20,128,180
dL 22,16,27,1024
mA 24,128,184
rB 88,29,12288
mA 56,132,184
rB 92,29,14336
mA 60,132,188
v_lshrrev_b32 v255, 3, v1
mA 28,128,188
rT 96,35,16384
mA 92,136,188
dL 23,16,27,2048
mA 124,140,188
rT 98,35,18432
mA 120,140,184
v_lshl_add_u32 v254, v255, 5, v254
mA 88,136,184
rT 100,36,16384
mA 84,136,180
rT 102,36,18432
mA 116,140,180
s_waitcnt vmcnt(3)
mA 112,140,176
dL 24,16,27,3072
mA 80,136,176
rT 104,37,16384
mA 76,136,172
rT 106,37,18432
mA 108,140,172
v_readfirstlane_b32 s73, v253
s_nop 0
s_cmp_ge_u32 s73, 8
s_cbranch_scc0 L1_spin
L1_spin_ret:
mA 104,140,168
rT 108,38,16384
mA 72,136,168
s_add_u32 m0, s28, 98304
mA 68,136,164
rT 110,38,18432
mA 100,140,164
buffer_load_dwordx4 v[220:223], v254, s[12:15], s38 offen sc1
mA 96,140,160
rT 112,39,16384
mA 64,136,160
mA 128,144,160
rT 114,39,18432
mA 160,148,160
buffer_load_dwordx4 v[224:227], v254, s[12:15], s38 offen offset:16 sc1
mA 164,148,164
dL 31,52,29,0
mA 132,144,164
rT 116,40,16384
rT 118,40,18432
mA 136,144,168
mA 168,148,168
rT 120,41,16384
mA 172,148,172
dL 32,52,29,1024
mA 140,144,172
rT 122,41,18432
mA 144,144,176
mA 176,148,176
rT 124,42,16384
mA 180,148,180
mA 148,144,180
rT 126,42,18432
mA 152,144,184
dL 33,52,29,2048
mA 184,148,184
mA 188,148,188
mA 156,144,188
mA 220,152,188
mA 252,156,188
dL 34,52,29,3072
mA 248,156,184
mA 216,152,184
s_waitcnt lgkmcnt(0)
s_barrier
mA 212,152,180
mA 244,156,180
mA 240,156,176
mA 208,152,176
s_add_u32 s29, s29, 262144
mA 204,152,172
mA 236,156,172
mA 232,156,168
mA 200,152,168
mA 196,152,164
mA 228,156,164
mA 224,156,160
mA 192,152,160
mA 0,64,96
rB 128,30,0
mA 32,68,96
s_add_u32 s100, s26, s25
s_add_u32 m0, s100, 4096
s_waitcnt vmcnt(4)
mA 36,68,100
v_add_f32_dpp v228, v220, v220 quad_perm:[1,0,3,2] row_mask:0xf bank_mask:0xf
v_add_f32_dpp v229, v222, v222 quad_perm:[1,0,3,2] row_mask:0xf bank_mask:0xf
mA 4,64,100
rB 132,30,2048
v_add_f32_dpp v230, v224, v224 quad_perm:[1,0,3,2] row_mask:0xf bank_mask:0xf
mA 8,64,104
rB 136,30,4096
v_add_f32_dpp v231, v226, v226 quad_perm:[1,0,3,2] row_mask:0xf bank_mask:0xf
mA 40,68,104
v_add_f32_dpp v228, v228, v228 quad_perm:[2,3,0,1] row_mask:0xf bank_mask:0xf
mA 44,68,108
dL 25,16,27,0
mA 12,64,108
rB 140,30,6144
v_add_f32_dpp v229, v229, v229 quad_perm:[2,3,0,1] row_mask:0xf bank_mask:0xf
mA 16,64,112
v_add_f32_dpp v230, v230, v230 quad_perm:[2,3,0,1] row_mask:0xf bank_mask:0xf
mA 48,68,112
rB 144,30,8192
v_add_f32_dpp v231, v231, v231 quad_perm:[2,3,0,1] row_mask:0xf bank_mask:0xf
mA 52,68,116
rB 148,30,10240
v_add_f32_dpp v228, v228, v228 row_half_mirror row_mask:0xf bank_mask:0xf
mA 20,64,116
dL 26,16,27,1024
mA 24,64,120
v_add_f32_dpp v229, v229, v229 row_half_mirror row_mask:0xf bank_mask:0xf
mA 56,68,120
rB 152,30,12288
v_add_f32_dpp v230, v230, v230 row_half_mirror row_mask:0xf bank_mask:0xf
mA 60,68,124
rB 156,30,14336
v_add_f32_dpp v231, v231, v231 row_half_mirror row_mask:0xf bank_mask:0xf
mA 28,64,124
v_mul_f32 v228, 0x3e000000, v228
mA 92,72,124
s_add_u32 s24, s24, 32768
s_cmp_lt_u32 s24, 98304
s_cselect_b32 s24, s24, 0
mA 124,76,124
dL 27,16,27,2048
mA 120,76,120
v_mul_f32 v229, 0x3e000000, v229
v_add_u32 v29, s24, v20
mA 88,72,120
v_mul_f32 v230, 0x3e000000, v230
v_mul_f32 v231, 0x3e000000, v231
mA 84,72,116
v_xor_b32 v30, 64, v29
v_sub_f32 v232, v220, v228
mA 116,76,116
v_sub_f32 v233, v222, v229
mA 112,76,112
rT 160,35,32768
mA 80,72,112
dL 28,16,27,3072
mA 76,72,108
v_sub_f32 v234, v224, v230
mA 108,76,108
rT 162,35,34816
v_sub_f32 v235, v226, v231
mA 104,76,104
v_mul_f32 v232, v232, v232
mA 72,72,104
rT 164,36,32768
v_mul_f32 v233, v233, v233
mA 68,72,100
s_add_u32 s27, s27, 128
rT 166,36,34816
v_mul_f32 v234, v234, v234
mA 100,76,100
v_mul_f32 v235, v235, v235
mA 96,76,96
rT 168,37,32768
v_fmamk_f32 v232, v232, 0x42e00000, v221
mA 64,72,96
rT 170,37,34816
v_fmamk_f32 v233, v233, 0x42e00000, v223
mA 128,80,96
v_fmamk_f32 v234, v234, 0x42e00000, v225
mA 160,84,96
s_add_u32 s25, s25, 32768
s_cmp_lt_u32 s25, 98304
s_cselect_b32 s25, s25, 0
mA 164,84,100
rT 172,38,32768
v_fmamk_f32 v235, v235, 0x42e00000, v227
mA 132,80,100
v_add_f32_dpp v232, v232, v232 quad_perm:[1,0,3,2] row_mask:0xf bank_mask:0xf
mA 136,80,104
rT 174,38,34816
v_add_f32_dpp v233, v233, v233 quad_perm:[1,0,3,2] row_mask:0xf bank_mask:0xf
mA 168,84,104
rT 176,39,32768
v_add_f32_dpp v234, v234, v234 quad_perm:[1,0,3,2] row_mask:0xf bank_mask:0xf
mA 172,84,108
s_add_u32 m0, s28, 114688
v_add_f32_dpp v235, v235, v235 quad_perm:[1,0,3,2] row_mask:0xf bank_mask:0xf
mA 140,80,108
rT 178,39,34816
v_add_f32_dpp v232, v232, v232 quad_perm:[2,3,0,1] row_mask:0xf bank_mask:0xf
mA 144,80,112
rT 180,40,32768
v_add_f32_dpp v233, v233, v233 quad_perm:[2,3,0,1] row_mask:0xf bank_mask:0xf
mA 176,84,112
v_add_f32_dpp v234, v234, v234 quad_perm:[2,3,0,1] row_mask:0xf bank_mask:0xf
mA 180,84,116
rT 182,40,34816
mA 148,80,116
dL 31,52,29,0
mA 152,80,120
v_add_f32_dpp v235, v235, v235 quad_perm:[2,3,0,1] row_mask:0xf bank_mask:0xf
mA 184,84,120
rT 184,41,32768
v_add_f32_dpp v232, v232, v232 row_half_mirror row_mask:0xf bank_mask:0xf
mA 188,84,124
v_add_f32_dpp v233, v233, v233 row_half_mirror row_mask:0xf bank_mask:0xf
mA 156,80,124
rT 186,41,34816
v_add_f32_dpp v234, v234, v234 row_half_mirror row_mask:0xf bank_mask:0xf
mA 220,88,124
v_add_f32_dpp v235, v235, v235 row_half_mirror row_mask:0xf bank_mask:0xf
mA 252,92,124
rT 188,42,32768
s_lshl_b32 s36, s65, 2
mA 248,92,120
dL 32,52,29,1024
mA 216,88,120
v_mul_f32 v232, 0x3a924925, v232
s_add_u32 s36, s36, s3
mA 212,88,116
rT 190,42,34816
v_mul_f32 v233, 0x3a924925, v233
mA 244,92,116
s_lshl_b32 s36, s36, 15
v_mul_f32 v234, 0x3a924925, v234
v_mul_f32 v235, 0x3a924925, v235
mA 240,92,112
s_lshl_b32 s101, s64, 10
dL 33,52,29,2048
mA 208,88,112
v_add_f32 v232, 0x3727c5ac, v232
s_add_u32 s36, s36, s101
mA 204,88,108
v_add_f32 v233, 0x3727c5ac, v233
v_lshrrev_b32 v62, 3, v1
mA 236,92,108
v_add_f32 v234, 0x3727c5ac, v234
v_lshlrev_b32 v62, 13, v62
mA 232,92,104
v_add_f32 v235, 0x3727c5ac, v235
s_waitcnt lgkmcnt(0)
mA 200,88,104
s_barrier
mA 196,88,100
v_rsq_f32 v232, v232
mA 228,92,100
dL 34,52,29,3072
mA 224,92,96
v_and_b32 v61, 7, v1
v_lshl_add_u32 v62, v61, 7, v62
mA 192,88,96
v_rsq_f32 v233, v233
v_cmp_gt_u32 vcc, 32, v1
v_rsq_f32 v234, v234
v_mov_b32 v61, 2147483648
s_add_u32 s29, s29, 262144
v_cndmask_b32 v62, v61, v62, vcc
v_rsq_f32 v235, v235
buffer_load_dword v62, v62, s[56:59], s36 offen
v_mul_f32 v228, v228, v232
v_mul_f32 v229, v229, v233
v_mul_f32 v230, v230, v234
v_mul_f32 v231, v231, v235
mA 0,128,160
rB 64,29,0
s_add_u32 m0, s28, 131072
mA 32,132,160
v_mov_b32 v44, v232
v_mov_b32 v45, v233
mA 36,132,164
rB 68,29,2048
v_mov_b32 v46, v234
mA 4,128,164
v_mov_b32 v47, v235
mA 8,128,168
rB 72,29,4096
v_mov_b32_dpp v44, v232 row_ror:8 row_mask:0xf bank_mask:0x3
mA 40,132,168
v_mov_b32_dpp v45, v233 row_ror:8 row_mask:0xf bank_mask:0x3
mA 44,132,172
rB 76,29,6144
v_mov_b32_dpp v46, v234 row_ror:8 row_mask:0xf bank_mask:0x3
mA 12,128,172
rB 80,29,8192
v_mov_b32_dpp v47, v235 row_ror:8 row_mask:0xf bank_mask:0x3
mA 16,128,176
v_mov_b32_dpp v232, v232 row_ror:8 row_mask:0xf bank_mask:0xc
mA 48,132,176
rB 84,29,10240
v_mov_b32_dpp v233, v233 row_ror:8 row_mask:0xf bank_mask:0xc
mA 52,132,180
dL 31,52,29,0
mA 20,128,180
v_mov_b32_dpp v234, v234 row_ror:8 row_mask:0xf bank_mask:0xc
mA 24,128,184
rB 88,29,12288
v_mov_b32_dpp v235, v235 row_ror:8 row_mask:0xf bank_mask:0xc
mA 56,132,184
v_mov_b32 v48, v228
mA 60,132,188
rB 92,29,14336
v_mov_b32 v49, v229
mA 28,128,188
rT 96,35,49152
v_mov_b32 v50, v230
mA 92,136,188
v_mov_b32 v51, v231
mA 124,140,188
rT 98,35,51200
v_mov_b32_dpp v48, v228 row_ror:8 row_mask:0xf bank_mask:0x3
mA 120,140,184
v_mov_b32_dpp v49, v229 row_ror:8 row_mask:0xf bank_mask:0x3
mA 88,136,184
rT 100,36,49152
v_mov_b32_dpp v50, v230 row_ror:8 row_mask:0xf bank_mask:0x3
mA 84,136,180
dL 32,52,29,1024
mA 116,140,180
v_mov_b32_dpp v51, v231 row_ror:8 row_mask:0xf bank_mask:0x3
mA 112,140,176
rT 102,36,51200
v_mov_b32_dpp v228, v228 row_ror:8 row_mask:0xf bank_mask:0xc
mA 80,136,176
v_mov_b32_dpp v229, v229 row_ror:8 row_mask:0xf bank_mask:0xc
mA 76,136,172
rT 104,37,49152
v_mov_b32_dpp v230, v230 row_ror:8 row_mask:0xf bank_mask:0xc
mA 108,140,172
rT 106,37,51200
v_mov_b32_dpp v231, v231 row_ror:8 row_mask:0xf bank_mask:0xc
mA 104,140,168
s_lshl_b32 s37, s69, 2
s_add_u32 s37, s37, s3
s_mul_i32 s37, s37, 56
mA 72,136,168
rT 108,38,49152
s_mul_i32 s73, s64, 7
mA 68,136,164
s_add_u32 s37, s37, s73
s_lshl_b32 s37, s37, 10
s_add_u32 s37, s37, 75497472
mA 100,140,164
v_lshlrev_b32 v248, 16, v192
mA 96,140,160
rT 110,38,51200
v_and_b32 v249, 0xffff0000, v192
mA 64,136,160
v_lshlrev_b32 v250, 16, v193
mA 128,144,160
rT 112,39,49152
mA 160,148,160
dL 33,52,29,2048
mA 164,148,164
v_and_b32 v251, 0xffff0000, v193
v_fma_f32 v248, v248, v232, -v228
mA 132,144,164
rT 114,39,51200
v_fma_f32 v249, v249, v233, -v229
mA 136,144,168
rT 116,40,49152
v_fma_f32 v250, v250, v234, -v230
mA 168,148,168
v_fma_f32 v251, v251, v235, -v231
mA 172,148,172
rT 118,40,51200
cP 192,248,249
mA 140,144,172
cP 193,250,251
mA 144,144,176
rT 120,41,49152
v_lshlrev_b32 v248, 16, v194
mA 176,148,176
v_and_b32 v249, 0xffff0000, v194
mA 180,148,180
rT 122,41,51200
v_lshlrev_b32 v250, 16, v195
mA 148,144,180
dL 34,52,29,3072
mA 152,144,184
rT 124,42,49152
v_and_b32 v251, 0xffff0000, v195
mA 184,148,184
v_fma_f32 v248, v248, v44, -v48
mA 188,148,188
rT 126,42,51200
v_fma_f32 v249, v249, v45, -v49
mA 156,144,188
v_fma_f32 v250, v250, v46, -v50
v_fma_f32 v251, v251, v47, -v51
mA 220,152,188
cP 194,248,249
cP 195,250,251
mA 252,156,188
buffer_store_dwordx4 v[192:195], v0, s[12:15], s37 offen offset:0 sc1
mA 248,156,184
s_add_u32 s29, s29, 262144
mA 216,152,184
v_lshlrev_b32 v248, 16, v196
s_waitcnt lgkmcnt(0)
mA 212,152,180
s_waitcnt vmcnt(14)
s_barrier
v_and_b32 v249, 0xffff0000, v196
mA 244,156,180
v_lshlrev_b32 v250, 16, v197
mA 240,156,176
v_and_b32 v251, 0xffff0000, v197
mA 208,152,176
v_fma_f32 v248, v248, v232, -v228
mA 204,152,172
v_add_u32 v60, s64, v1
v_fma_f32 v249, v249, v233, -v229
mA 236,156,172
v_fma_f32 v250, v250, v234, -v230
v_and_b32 v60, 7, v60
mA 232,156,168
v_fma_f32 v251, v251, v235, -v231
mA 200,152,168
v_lshlrev_b32 v60, 2, v60
cP 196,248,249
mA 196,152,164
buffer_load_dword v61, v60, s[60:63], 0 offen offset:128 sc1
mA 228,156,164
cP 197,250,251
v_lshlrev_b32 v248, 16, v198
mA 224,156,160
v_and_b32 v249, 0xffff0000, v198
mA 192,152,160
v_lshlrev_b32 v250, 16, v199
mA 0,64,96
rB 128,30,0
s_add_u32 m0, s30, 0
mA 32,68,96
v_and_b32 v251, 0xffff0000, v199
mA 36,68,100
rB 132,30,2048
v_fma_f32 v248, v248, v44, -v48
mA 4,64,100
v_fma_f32 v249, v249, v45, -v49
mA 8,64,104
rB 136,30,4096
v_fma_f32 v250, v250, v46, -v50
mA 40,68,104
rB 140,30,6144
v_fma_f32 v251, v251, v47, -v51
mA 44,68,108
cP 198,248,249
mA 12,64,108
rB 144,30,8192
cP 199,250,251
mA 16,64,112
dL 2,4,31,0
mA 48,68,112
rB 148,30,10240
mA 52,68,116
buffer_store_dwordx4 v[196:199], v0, s[12:15], s37 offen offset:1024 sc1
mA 20,64,116
rB 152,30,12288
v_lshlrev_b32 v248, 16, v200
mA 24,64,120
v_and_b32 v249, 0xffff0000, v200
mA 56,68,120
rB 156,30,14336
v_lshlrev_b32 v250, 16, v201
mA 60,68,124
s_add_u32 s24, s24, 32768
s_cmp_lt_u32 s24, 98304
s_cselect_b32 s24, s24, 0
mA 28,64,124
v_and_b32 v251, 0xffff0000, v201
v_fma_f32 v248, v248, v232, -v228
mA 92,72,124
dL 3,4,31,1024
mA 124,76,124
v_add_u32 v29, s24, v20
v_fma_f32 v249, v249, v233, -v229
mA 120,76,120
v_xor_b32 v30, 64, v29
v_fma_f32 v250, v250, v234, -v230
mA 88,72,120
v_fma_f32 v251, v251, v235, -v231
mA 84,72,116
rT 160,35,0
cP 200,248,249
mA 116,76,116
rT 162,35,2048
cP 201,250,251
mA 112,76,112
v_lshlrev_b32 v248, 16, v202
mA 80,72,112
rT 164,36,0
v_and_b32 v249, 0xffff0000, v202
mA 76,72,108
dL 4,4,31,2048
mA 108,76,108
v_lshlrev_b32 v250, 16, v203
mA 104,76,104
rT 166,36,2048
v_and_b32 v251, 0xffff0000, v203
mA 72,72,104
rT 168,37,0
v_fma_f32 v248, v248, v44, -v48
mA 68,72,100
v_fma_f32 v249, v249, v45, -v49
mA 100,76,100
rT 170,37,2048
v_fma_f32 v250, v250, v46, -v50
mA 96,76,96
rT 172,38,0
v_fma_f32 v251, v251, v47, -v51
mA 64,72,96
cP 202,248,249
mA 128,80,96
dL 5,4,31,3072
mA 160,84,96
rT 174,38,2048
cP 203,250,251
mA 164,84,100
rT 176,39,0
mA 132,80,100
buffer_store_dwordx4 v[200:203], v0, s[12:15], s37 offen offset:2048 sc1
mA 136,80,104
rT 178,39,2048
v_lshlrev_b32 v248, 16, v204
mA 168,84,104
v_and_b32 v249, 0xffff0000, v204
mA 172,84,108
rT 180,40,0
v_lshlrev_b32 v250, 16, v205
mA 140,80,108
rT 182,40,2048
v_and_b32 v251, 0xffff0000, v205
mA 144,80,112
s_add_u32 s31, s31, 128
v_fma_f32 v248, v248, v232, -v228
mA 176,84,112
rT 184,41,0
v_fma_f32 v249, v249, v233, -v229
mA 180,84,116
rT 186,41,2048
v_fma_f32 v250, v250, v234, -v230
mA 148,80,116
v_fma_f32 v251, v251, v235, -v231
mA 152,80,120
rT 188,42,0
cP 204,248,249
mA 184,84,120
rT 190,42,2048
cP 205,250,251
mA 188,84,124
v_lshlrev_b32 v248, 16, v206
v_and_b32 v249, 0xffff0000, v206
mA 156,80,124
v_lshlrev_b32 v250, 16, v207
v_and_b32 v251, 0xffff0000, v207
mA 220,88,124
v_fma_f32 v248, v248, v44, -v48
mA 252,92,124
v_fma_f32 v249, v249, v45, -v49
mA 248,92,120
mA 216,88,120
v_fma_f32 v250, v250, v46, -v50
s_waitcnt lgkmcnt(0)
mA 212,88,116
s_waitcnt vmcnt(13)
s_barrier
v_fma_f32 v251, v251, v47, -v51
mA 244,92,116
cP 206,248,249
mA 240,92,112
cP 207,250,251
mA 208,88,112
buffer_store_dwordx4 v[204:207], v0, s[12:15], s37 offen offset:3072 sc1
mA 204,88,108
mA 236,92,108
s_add_u32 s37, s37, 4096
v_lshlrev_b32 v248, 16, v208
mA 232,92,104
v_and_b32 v249, 0xffff0000, v208
mA 200,88,104
v_lshlrev_b32 v250, 16, v209
mA 196,88,100
v_and_b32 v251, 0xffff0000, v209
mA 228,92,100
v_fma_f32 v248, v248, v232, -v228
mA 224,92,96
mA 192,88,96
v_fma_f32 v249, v249, v233, -v229
mA 0,128,160
rB 64,29,0
s_add_u32 m0, s32, 98304
mA 32,132,160
v_fma_f32 v250, v250, v234, -v230
v_fma_f32 v251, v251, v235, -v231
mA 36,132,164
rB 68,29,2048
cP 208,248,249
mA 4,128,164
dL 8,56,33,0
mA 8,128,168
cP 209,250,251
mA 40,132,168
rB 72,29,4096
v_lshlrev_b32 v248, 16, v210
mA 44,132,172
dL 9,56,33,1024
mA 12,128,172
v_and_b32 v249, 0xffff0000, v210
mA 16,128,176
rB 76,29,6144
v_lshlrev_b32 v250, 16, v211
mA 48,132,176
dL 10,56,33,2048
mA 52,132,180
v_and_b32 v251, 0xffff0000, v211
mA 20,128,180
rB 80,29,8192
v_fma_f32 v248, v248, v44, -v48
mA 24,128,184
rB 84,29,10240
v_fma_f32 v249, v249, v45, -v49
mA 56,132,184
dL 11,56,33,3072
mA 60,132,188
v_fma_f32 v250, v250, v46, -v50
mA 28,128,188
rB 88,29,12288
v_fma_f32 v251, v251, v47, -v51
mA 92,136,188
s_add_u32 s33, s33, 262144
cP 210,248,249
mA 124,140,188
rB 92,29,14336
cP 211,250,251
mA 120,140,184
buffer_store_dwordx4 v[208:211], v0, s[12:15], s37 offen offset:0 sc1
mA 88,136,184
s_add_u32 m0, s30, 32768
rT 96,35,16384
rT 98,35,18432
mA 84,136,180
v_lshlrev_b32 v248, 16, v212
mA 116,140,180
dL 2,4,31,0
mA 112,140,176
v_and_b32 v249, 0xffff0000, v212
mA 80,136,176
rT 100,36,16384
v_lshlrev_b32 v250, 16, v213
mA 76,136,172
dL 3,4,31,1024
mA 108,140,172
v_and_b32 v251, 0xffff0000, v213
mA 104,140,168
rT 102,36,18432
v_fma_f32 v248, v248, v232, -v228
mA 72,136,168
v_fma_f32 v249, v249, v233, -v229
mA 68,136,164
dL 4,4,31,2048
mA 100,140,164
rT 104,37,16384
v_fma_f32 v250, v250, v234, -v230
mA 96,140,160
rT 106,37,18432
v_fma_f32 v251, v251, v235, -v231
mA 64,136,160
dL 5,4,31,3072
mA 128,144,160
cP 212,248,249
mA 160,148,160
rT 108,38,16384
cP 213,250,251
mA 164,148,164
s_add_u32 s31, s31, 128
v_lshlrev_b32 v248, 16, v214
mA 132,144,164
rT 110,38,18432
v_and_b32 v249, 0xffff0000, v214
mA 136,144,168
v_lshlrev_b32 v250, 16, v215
s_add_u32 m0, s30, 49152
mA 168,148,168
rT 112,39,16384
v_and_b32 v251, 0xffff0000, v215
mA 172,148,172
rT 114,39,18432
v_fma_f32 v248, v248, v44, -v48
mA 140,144,172
dL 2,4,31,0
mA 144,144,176
v_fma_f32 v249, v249, v45, -v49
mA 176,148,176
rT 116,40,16384
v_fma_f32 v250, v250, v46, -v50
mA 180,148,180
dL 3,4,31,1024
mA 148,144,180
v_fma_f32 v251, v251, v47, -v51
mA 152,144,184
rT 118,40,18432
cP 214,248,249
mA 184,148,184
cP 215,250,251
mA 188,148,188
dL 4,4,31,2048
mA 156,144,188
rT 120,41,16384
mA 220,152,188
buffer_store_dwordx4 v[212:215], v0, s[12:15], s37 offen offset:1024 sc1
mA 252,156,188
rT 122,41,18432
mA 248,156,184
dL 5,4,31,3072
mA 216,152,184
v_lshlrev_b32 v248, 16, v216
mA 212,152,180
rT 124,42,16384
v_and_b32 v249, 0xffff0000, v216
mA 244,156,180
s_add_u32 s31, s31, 128
v_lshlrev_b32 v250, 16, v217
mA 240,156,176
rT 126,42,18432
v_and_b32 v251, 0xffff0000, v217
mA 208,152,176
v_fma_f32 v248, v248, v232, -v228
v_fma_f32 v249, v249, v233, -v229
mA 204,152,172
v_fma_f32 v250, v250, v234, -v230
v_fma_f32 v251, v251, v235, -v231
mA 236,156,172
cP 216,248,249
cP 217,250,251
mA 232,156,168
s_waitcnt lgkmcnt(0)
s_waitcnt vmcnt(23)
s_barrier
mA 200,152,168
v_lshlrev_b32 v248, 16, v218
s_waitcnt vmcnt(21)
mA 196,152,164
v_and_b32 v249, 0xffff0000, v218
v_lshlrev_b32 v250, 16, v219
mA 228,156,164
v_readfirstlane_b32 s92, v61
v_and_b32 v61, 63, v61
v_cmp_ne_u32 vcc, 32, v61
s_cbranch_vccnz L1_spinAV
L1_spinAV_ret:
s_cmp_eq_u32 s92, s93
s_cselect_b32 s93, 0, 0
mA 224,156,160
v_and_b32 v251, 0xffff0000, v219
v_fma_f32 v248, v248, v44, -v48
mA 192,152,160
v_fma_f32 v249, v249, v45, -v49
v_fma_f32 v250, v250, v46, -v50
v_fma_f32 v251, v251, v47, -v51
cP 218,248,249
cP 219,250,251
buffer_store_dwordx4 v[216:219], v0, s[12:15], s37 offen offset:2048 sc1
mA 0,64,96
rB 128,30,0
s_add_u32 m0, s32, 114688
mA 32,68,96
rB 132,30,2048
mA 36,68,100
mA 4,64,100
rB 136,30,4096
mA 8,64,104
dL 8,56,33,0
mA 40,68,104
rB 140,30,6144
mA 44,68,108
rB 144,30,8192
mA 12,64,108
dL 9,56,33,1024
mA 16,64,112
rB 148,30,10240
mA 48,68,112
mA 52,68,116
rB 152,30,12288
mA 20,64,116
dL 10,56,33,2048
mA 24,64,120
rB 156,30,14336
mA 56,68,120
s_add_u32 s24, s24, 32768
s_cmp_lt_u32 s24, 98304
s_cselect_b32 s24, s24, 0
mA 60,68,124
mA 28,64,124
dL 11,56,33,3072
mA 92,72,124
v_add_u32 v29, s24, v20
v_xor_b32 v30, 64, v29
mA 124,76,124
mA 120,76,120
rT 160,35,32768
s_add_u32 s33, s33, 262144
mA 88,72,120
mA 84,72,116
rT 162,35,34816
mA 116,76,116
rT 164,36,32768
mA 112,76,112
s_add_u32 m0, s30, 16384
mA 80,72,112
rT 166,36,34816
mA 76,72,108
mA 108,76,108
rT 168,37,32768
mA 104,76,104
dL 2,4,31,0
mA 72,72,104
rT 170,37,34816
mA 68,72,100
rT 172,38,32768
mA 100,76,100
mA 96,76,96
dL 3,4,31,1024
mA 64,72,96
rT 174,38,34816
rT 176,39,32768
mA 128,80,96
mA 160,84,96
rT 178,39,34816
mA 164,84,100
dL 4,4,31,2048
mA 132,80,100
rT 180,40,32768
mA 136,80,104
rT 182,40,34816
mA 168,84,104
dL 5,4,31,3072
mA 172,84,108
rT 184,41,32768
mA 140,80,108
mA 144,80,112
rT 186,41,34816
mA 176,84,112
s_add_u32 s31, s31, 128
rT 188,42,32768
mA 180,84,116
mA 148,80,116
rT 190,42,34816
mA 152,80,120
mA 184,84,120
mA 188,84,124
v_lshl_add_u32 v44, s3, 6, v1
v_cmp_eq_u32 vcc, 0, v44
mA 156,80,124
v_mov_b32 v44, 2147483648
v_mov_b32 v45, 1
mA 220,88,124
v_cndmask_b32 v44, v44, 0, vcc
s_lshl_b32 s92, s64, 8
mA 252,92,124
s_add_u32 s92, s92, 80220224
s_waitcnt vmcnt(8)
mA 248,92,120
mA 216,88,120
s_waitcnt lgkmcnt(0)
s_barrier
mA 212,88,116
mA 244,92,116
mA 240,92,112
mA 208,88,112
mA 204,88,108
mA 236,92,108
mA 232,92,104
mA 200,88,104
mA 196,88,100
mA 228,92,100
mA 224,92,96
mA 192,88,96
mA 0,128,160
s_add_u32 m0, s32, 131072
mA 32,132,160
mA 36,132,164
dL 8,56,33,0
mA 4,128,164
mA 8,128,168
dL 9,56,33,1024
mA 40,132,168
mA 44,132,172
dL 10,56,33,2048
mA 12,128,172
mA 16,128,176
dL 11,56,33,3072
mA 48,132,176
mA 52,132,180
s_add_u32 s33, s33, 262144
mA 20,128,180
mA 24,128,184
s_add_u32 m0, s32, 147456
mA 56,132,184
mA 60,132,188
dL 8,56,33,0
mA 28,128,188
mA 92,136,188
dL 9,56,33,1024
mA 124,140,188
mA 120,140,184
dL 10,56,33,2048
mA 88,136,184
mA 84,136,180
dL 11,56,33,3072
mA 116,140,180
mA 112,140,176
s_add_u32 s33, s33, 262144
mA 80,136,176
mA 76,136,172
s_add_u32 m0, s32, 65536
mA 108,140,172
mA 104,140,168
dL 8,56,33,0
mA 72,136,168
mA 68,136,164
dL 9,56,33,1024
mA 100,140,164
mA 96,140,160
dL 10,56,33,2048
mA 64,136,160
mA 128,144,160
dL 11,56,33,3072
mA 160,148,160
mA 164,148,164
s_add_u32 s33, s33, 262144
mA 132,144,164
mA 136,144,168
s_add_u32 m0, s32, 81920
mA 168,148,168
mA 172,148,172
dL 8,56,33,0
mA 140,144,172
mA 144,144,176
dL 9,56,33,1024
mA 176,148,176
mA 180,148,180
dL 10,56,33,2048
mA 148,144,180
mA 152,144,184
dL 11,56,33,3072
mA 184,148,184
mA 188,148,188
s_add_u32 s33, s33, 262144
mA 156,144,188
mA 220,152,188
mA 252,156,188
mA 248,156,184
buffer_atomic_add v45, v44, s[12:15], s92 offen
mA 216,152,184
mA 212,152,180
mA 244,156,180
mA 240,156,176
mA 208,152,176
mA 204,152,172
mA 236,156,172
mA 232,156,168
mA 200,152,168
mA 196,152,164
mA 228,156,164
mA 224,156,160
mA 192,152,160
s_lshl_b32 s35, s67, 6
s_lshl_b32 s73, s66, 3
s_add_u32 s35, s35, s73
s_lshl_b32 s73, s71, 2
s_add_u32 s35, s35, s73
s_lshl_b32 s35, s35, 4
s_lshl_b32 s73, s72, 3
s_add_u32 s35, s35, s73
s_lshl_b32 s35, s35, 10
s_add_u32 s35, s35, 16777216
aR 132,0
aR 133,1
aR 134,2
aR 135,3
aR 136,32
aR 137,33
aR 138,34
aR 139,35
cP 128,132,133
cP 129,134,135
cP 130,136,137
cP 131,138,139
buffer_store_dwordx4 v[128:131], v0, s[12:15], s35 offen offset:0 sc1
aR 144,4
aR 145,5
aR 146,6
aR 147,7
aR 148,36
aR 149,37
aR 150,38
aR 151,39
cP 140,144,145
cP 141,146,147
cP 142,148,149
cP 143,150,151
buffer_store_dwordx4 v[140:143], v0, s[12:15], s35 offen offset:1024 sc1
aR 156,8
aR 157,9
aR 158,10
aR 159,11
aR 160,40
aR 161,41
aR 162,42
aR 163,43
cP 152,156,157
cP 153,158,159
cP 154,160,161
cP 155,162,163
buffer_store_dwordx4 v[152:155], v0, s[12:15], s35 offen offset:2048 sc1
aR 168,12
aR 169,13
aR 170,14
aR 171,15
aR 172,44
aR 173,45
aR 174,46
aR 175,47
cP 164,168,169
cP 165,170,171
cP 166,172,173
cP 167,174,175
buffer_store_dwordx4 v[164:167], v0, s[12:15], s35 offen offset:3072 sc1
s_add_u32 s35, s35, 4096
aR 132,16
aR 133,17
aR 134,18
aR 135,19
aR 136,48
aR 137,49
aR 138,50
aR 139,51
cP 128,132,133
cP 129,134,135
cP 130,136,137
cP 131,138,139
buffer_store_dwordx4 v[128:131], v0, s[12:15], s35 offen offset:0 sc1
aR 144,20
aR 145,21
aR 146,22
aR 147,23
aR 148,52
aR 149,53
aR 150,54
aR 151,55
cP 140,144,145
cP 141,146,147
cP 142,148,149
cP 143,150,151
buffer_store_dwordx4 v[140:143], v0, s[12:15], s35 offen offset:1024 sc1
aR 156,24
aR 157,25
aR 158,26
aR 159,27
aR 160,56
aR 161,57
aR 162,58
aR 163,59
cP 152,156,157
cP 153,158,159
cP 154,160,161
cP 155,162,163
buffer_store_dwordx4 v[152:155], v0, s[12:15], s35 offen offset:2048 sc1
aR 168,28
aR 169,29
aR 170,30
aR 171,31
aR 172,60
aR 173,61
aR 174,62
aR 175,63
cP 164,168,169
cP 165,170,171
cP 166,172,173
cP 167,174,175
buffer_store_dwordx4 v[164:167], v0, s[12:15], s35 offen offset:3072 sc1
s_add_u32 s35, s35, 12288
aR 132,64
aR 133,65
aR 134,66
aR 135,67
aR 136,96
aR 137,97
aR 138,98
aR 139,99
cP 128,132,133
cP 129,134,135
cP 130,136,137
cP 131,138,139
buffer_store_dwordx4 v[128:131], v0, s[12:15], s35 offen offset:0 sc1
aR 144,68
aR 145,69
aR 146,70
aR 147,71
aR 148,100
aR 149,101
aR 150,102
aR 151,103
cP 140,144,145
cP 141,146,147
cP 142,148,149
cP 143,150,151
buffer_store_dwordx4 v[140:143], v0, s[12:15], s35 offen offset:1024 sc1
aR 156,72
aR 157,73
aR 158,74
aR 159,75
aR 160,104
aR 161,105
aR 162,106
aR 163,107
cP 152,156,157
cP 153,158,159
cP 154,160,161
cP 155,162,163
buffer_store_dwordx4 v[152:155], v0, s[12:15], s35 offen offset:2048 sc1
aR 168,76
aR 169,77
aR 170,78
aR 171,79
aR 172,108
aR 173,109
aR 174,110
aR 175,111
cP 164,168,169
cP 165,170,171
cP 166,172,173
cP 167,174,175
buffer_store_dwordx4 v[164:167], v0, s[12:15], s35 offen offset:3072 sc1
s_add_u32 s35, s35, 4096
aR 132,80
aR 133,81
aR 134,82
aR 135,83
aR 136,112
aR 137,113
aR 138,114
aR 139,115
cP 128,132,133
cP 129,134,135
cP 130,136,137
cP 131,138,139
buffer_store_dwordx4 v[128:131], v0, s[12:15], s35 offen offset:0 sc1
aR 144,84
aR 145,85
aR 146,86
aR 147,87
aR 148,116
aR 149,117
aR 150,118
aR 151,119
cP 140,144,145
cP 141,146,147
cP 142,148,149
cP 143,150,151
buffer_store_dwordx4 v[140:143], v0, s[12:15], s35 offen offset:1024 sc1
aR 156,88
aR 157,89
aR 158,90
aR 159,91
aR 160,120
aR 161,121
aR 162,122
aR 163,123
cP 152,156,157
cP 153,158,159
cP 154,160,161
cP 155,162,163
buffer_store_dwordx4 v[152:155], v0, s[12:15], s35 offen offset:2048 sc1
aR 168,92
aR 169,93
aR 170,94
aR 171,95
aR 172,124
aR 173,125
aR 174,126
aR 175,127
cP 164,168,169
cP 165,170,171
cP 166,172,173
cP 167,174,175
buffer_store_dwordx4 v[164:167], v0, s[12:15], s35 offen offset:3072 sc1
s_add_u32 s35, s35, 12288
aR 132,128
aR 133,129
aR 134,130
aR 135,131
aR 136,160
aR 137,161
aR 138,162
aR 139,163
cP 128,132,133
cP 129,134,135
cP 130,136,137
cP 131,138,139
buffer_store_dwordx4 v[128:131], v0, s[12:15], s35 offen offset:0 sc1
aR 144,132
aR 145,133
aR 146,134
aR 147,135
aR 148,164
aR 149,165
aR 150,166
aR 151,167
cP 140,144,145
cP 141,146,147
cP 142,148,149
cP 143,150,151
buffer_store_dwordx4 v[140:143], v0, s[12:15], s35 offen offset:1024 sc1
aR 156,136
aR 157,137
aR 158,138
aR 159,139
aR 160,168
aR 161,169
aR 162,170
aR 163,171
cP 152,156,157
cP 153,158,159
cP 154,160,161
cP 155,162,163
buffer_store_dwordx4 v[152:155], v0, s[12:15], s35 offen offset:2048 sc1
aR 168,140
aR 169,141
aR 170,142
aR 171,143
aR 172,172
aR 173,173
aR 174,174
aR 175,175
cP 164,168,169
cP 165,170,171
cP 166,172,173
cP 167,174,175
buffer_store_dwordx4 v[164:167], v0, s[12:15], s35 offen offset:3072 sc1
s_add_u32 s35, s35, 4096
aR 132,144
aR 133,145
aR 134,146
aR 135,147
aR 136,176
aR 137,177
aR 138,178
aR 139,179
cP 128,132,133
cP 129,134,135
cP 130,136,137
cP 131,138,139
buffer_store_dwordx4 v[128:131], v0, s[12:15], s35 offen offset:0 sc1
aR 144,148
aR 145,149
aR 146,150
aR 147,151
aR 148,180
aR 149,181
aR 150,182
aR 151,183
cP 140,144,145
cP 141,146,147
cP 142,148,149
cP 143,150,151
buffer_store_dwordx4 v[140:143], v0, s[12:15], s35 offen offset:1024 sc1
aR 156,152
aR 157,153
aR 158,154
aR 159,155
aR 160,184
aR 161,185
aR 162,186
aR 163,187
cP 152,156,157
cP 153,158,159
cP 154,160,161
cP 155,162,163
buffer_store_dwordx4 v[152:155], v0, s[12:15], s35 offen offset:2048 sc1
aR 168,156
aR 169,157
aR 170,158
aR 171,159
aR 172,188
aR 173,189
aR 174,190
aR 175,191
cP 164,168,169
cP 165,170,171
cP 166,172,173
cP 167,174,175
buffer_store_dwordx4 v[164:167], v0, s[12:15], s35 offen offset:3072 sc1
s_add_u32 s35, s35, 12288
aR 132,192
aR 133,193
aR 134,194
aR 135,195
aR 136,224
aR 137,225
aR 138,226
aR 139,227
cP 128,132,133
cP 129,134,135
cP 130,136,137
cP 131,138,139
buffer_store_dwordx4 v[128:131], v0, s[12:15], s35 offen offset:0 sc1
aR 144,196
aR 145,197
aR 146,198
aR 147,199
aR 148,228
aR 149,229
aR 150,230
aR 151,231
cP 140,144,145
cP 141,146,147
cP 142,148,149
cP 143,150,151
buffer_store_dwordx4 v[140:143], v0, s[12:15], s35 offen offset:1024 sc1
aR 156,200
aR 157,201
aR 158,202
aR 159,203
aR 160,232
aR 161,233
aR 162,234
aR 163,235
cP 152,156,157
cP 153,158,159
cP 154,160,161
cP 155,162,163
buffer_store_dwordx4 v[152:155], v0, s[12:15], s35 offen offset:2048 sc1
aR 168,204
aR 169,205
aR 170,206
aR 171,207
aR 172,236
aR 173,237
aR 174,238
aR 175,239
cP 164,168,169
cP 165,170,171
cP 166,172,173
cP 167,174,175
buffer_store_dwordx4 v[164:167], v0, s[12:15], s35 offen offset:3072 sc1
s_add_u32 s35, s35, 4096
aR 132,208
aR 133,209
aR 134,210
aR 135,211
aR 136,240
aR 137,241
aR 138,242
aR 139,243
cP 128,132,133
cP 129,134,135
cP 130,136,137
cP 131,138,139
buffer_store_dwordx4 v[128:131], v0, s[12:15], s35 offen offset:0 sc1
aR 144,212
aR 145,213
aR 146,214
aR 147,215
aR 148,244
aR 149,245
aR 150,246
aR 151,247
cP 140,144,145
cP 141,146,147
cP 142,148,149
cP 143,150,151
buffer_store_dwordx4 v[140:143], v0, s[12:15], s35 offen offset:1024 sc1
aR 156,216
aR 157,217
aR 158,218
aR 159,219
aR 160,248
aR 161,249
aR 162,250
aR 163,251
cP 152,156,157
cP 153,158,159
cP 154,160,161
cP 155,162,163
buffer_store_dwordx4 v[152:155], v0, s[12:15], s35 offen offset:2048 sc1
aR 168,220
aR 169,221
aR 170,222
aR 171,223
aR 172,252
aR 173,253
aR 174,254
aR 175,255
cP 164,168,169
cP 165,170,171
cP 166,172,173
cP 167,174,175
buffer_store_dwordx4 v[164:167], v0, s[12:15], s35 offen offset:3072 sc1
s_add_u32 s35, s35, 12288
s_waitcnt vmcnt(53)
s_barrier
rT 32,12,32768
rT 34,12,34816
rT 36,13,32768
rT 38,13,34816
rT 40,14,32768
rT 42,14,34816
rT 44,15,32768
rT 46,15,34816
rT 48,16,32768
rT 50,16,34816
rT 52,17,32768
rT 54,17,34816
rT 56,18,32768
rT 58,18,34816
rT 60,19,32768
rT 62,19,34816
rB 64,6,0
rB 68,6,2048
rB 72,6,4096
rB 76,6,6144
s_waitcnt lgkmcnt(0)
s_barrier
mVz 128,32,64
rT 80,12,49152
s_add_u32 m0, s32, 98304
mVz 144,36,64
rT 82,12,51200
rT 84,13,49152
mVz 148,36,68
rT 86,13,51200
mVz 132,32,68
rT 88,14,49152
mVz 136,32,72
rT 90,14,51200
mVz 152,36,72
dL 8,56,33,0
mVz 156,36,76
rT 92,15,49152
rT 94,15,51200
mVz 140,32,76
rT 96,16,49152
mVz 172,40,76
rT 98,16,51200
mVz 188,44,76
rT 100,17,49152
mVz 184,44,72
dL 9,56,33,1024
mVz 168,40,72
rT 102,17,51200
rT 104,18,49152
mVz 164,40,68
rT 106,18,51200
mVz 180,44,68
rT 108,19,49152
mVz 176,44,64
rT 110,19,51200
mVz 160,40,64
dL 10,56,33,2048
mVz 192,48,64
rB 112,7,0
rB 116,7,2048
mVz 208,52,64
rB 120,7,4096
mVz 212,52,68
rB 124,7,6144
mVz 196,48,68
mVz 200,48,72
dL 11,56,33,3072
mVz 216,52,72
mVz 220,52,76
mVz 204,48,76
mVz 236,56,76
mVz 252,60,76
s_add_u32 s33, s33, 262144
s_waitcnt lgkmcnt(0)
s_waitcnt vmcnt(49)
mVz 248,60,72
s_barrier
mVz 232,56,72
mVz 228,56,68
mVz 244,60,68
mVz 240,60,64
mVz 224,56,64
mV 128,80,112
v_add_u32 v12, 65536, v12
s_add_u32 m0, s30, 0
mV 144,84,112
v_add_u32 v13, 65536, v13
v_add_u32 v14, 65536, v14
mV 148,84,116
v_add_u32 v15, 65536, v15
mV 132,80,116
dL 2,4,31,0
mV 136,80,120
v_add_u32 v16, 65536, v16
v_add_u32 v17, 65536, v17
mV 152,84,120
v_add_u32 v18, 65536, v18
v_add_u32 v19, 65536, v19
mV 156,84,124
dL 3,4,31,1024
mV 140,80,124
rT 32,12,0
rT 34,12,2048
mV 172,88,124
rT 36,13,0
mV 188,92,124
dL 4,4,31,2048
mV 184,92,120
rT 38,13,2048
rT 40,14,0
mV 168,88,120
rT 42,14,2048
rT 44,15,0
mV 164,88,116
v_lshl_add_u32 v20, s3, 6, v1
mV 180,92,116
dL 5,4,31,3072
mV 176,92,112
rT 46,15,2048
rT 48,16,0
mV 160,88,112
v_cmp_eq_u32 vcc, 0, v20
mV 192,96,112
rT 50,16,2048
rT 52,17,0
mV 208,100,112
s_add_u32 s31, s31, 128
rT 54,17,2048
v_mov_b32 v20, 2147483648
mV 212,100,116
rT 56,18,0
rT 58,18,2048
mV 196,96,116
s_add_u32 m0, s32, 114688
v_mov_b32 v21, 1
mV 200,96,120
rT 60,19,0
rT 62,19,2048
mV 216,100,120
rB 64,6,32768
v_cndmask_b32 v20, v20, 0, vcc
mV 220,100,124
rB 68,6,34816
mV 204,96,124
dL 8,56,33,0
mV 236,104,124
rB 72,6,36864
s_lshl_b32 s35, s67, 8
mV 252,108,124
rB 76,6,38912
mV 248,108,120
dL 9,56,33,1024
mV 232,104,120
s_add_u32 s35, s35, 80216144
s_waitcnt vmcnt(10)
mV 228,104,116
dL 10,56,33,2048
mV 244,108,116
dL 11,56,33,3072
mV 240,108,112
s_waitcnt lgkmcnt(0)
s_barrier
mV 224,104,112
s_add_u32 s33, s33, 262144
mV 128,32,64
rT 80,12,16384
s_add_u32 m0, s32, 131072
mV 144,36,64
rT 82,12,18432
mV 148,36,68
buffer_atomic_add v21, v20, s[12:15], s35 offen
mV 132,32,68
rT 84,13,16384
rT 86,13,18432
mV 136,32,72
rT 88,14,16384
rT 90,14,18432
mV 152,36,72
dL 8,56,33,0
mV 156,36,76
rT 92,15,16384
rT 94,15,18432
mV 140,32,76
rT 96,16,16384
mV 172,40,76
rT 98,16,18432
mV 188,44,76
rT 100,17,16384
mV 184,44,72
dL 9,56,33,1024
mV 168,40,72
rT 102,17,18432
rT 104,18,16384
mV 164,40,68
rT 106,18,18432
mV 180,44,68
rT 108,19,16384
mV 176,44,64
rT 110,19,18432
mV 160,40,64
dL 10,56,33,2048
mV 192,48,64
rB 112,7,32768
rB 116,7,34816
mV 208,52,64
rB 120,7,36864
mV 212,52,68
rB 124,7,38912
mV 196,48,68
mV 200,48,72
dL 11,56,33,3072
mV 216,52,72
mV 220,52,76
mV 204,48,76
mV 236,56,76
mV 252,60,76
s_add_u32 s33, s33, 262144
s_waitcnt lgkmcnt(0)
mV 248,60,72
s_barrier
mV 232,56,72
mV 228,56,68
mV 244,60,68
mV 240,60,64
mV 224,56,64
mV 128,80,112
v_add_u32 v12, 4294901760, v12
s_add_u32 m0, s30, 32768
mV 144,84,112
v_add_u32 v13, 4294901760, v13
v_add_u32 v14, 4294901760, v14
mV 148,84,116
v_add_u32 v15, 4294901760, v15
mV 132,80,116
dL 2,4,31,0
mV 136,80,120
v_add_u32 v16, 4294901760, v16
v_add_u32 v17, 4294901760, v17
mV 152,84,120
s_getpc_b64 s[46:47]
s_add_u32 s46, s46, mega_jt@rel32@lo+4
s_addc_u32 s47, s47, mega_jt@rel32@hi+12
mV 156,84,124
v_add_u32 v18, 4294901760, v18
v_add_u32 v19, 4294901760, v19
mV 140,80,124
dL 3,4,31,1024
mV 172,88,124
rT 32,12,0
rT 34,12,2048
mV 188,92,124
s_lshl_b32 s101, s2, 6
s_add_u32 s46, s46, s101
s_addc_u32 s47, s47, 0
mV 184,92,120
rT 36,13,0
mV 168,88,120
dL 4,4,31,2048
mV 164,88,116
rT 38,13,2048
rT 40,14,0
mV 180,92,116
rT 42,14,2048
s_load_dwordx4 s[76:79], s[46:47], 0
mV 176,92,112
rT 44,15,0
mV 160,88,112
dL 5,4,31,3072
mV 192,96,112
rT 46,15,2048
rT 48,16,0
mV 208,100,112
rT 50,16,2048
rT 52,17,0
mV 212,100,116
s_add_u32 s31, s31, 128
rT 54,17,2048
rT 56,18,0
mV 196,96,116
rT 58,18,2048
s_add_u32 m0, s32, 147456
mV 200,96,120
rT 60,19,0
rT 62,19,2048
mV 216,100,120
rB 64,6,49152
rB 68,6,51200
mV 220,100,124
dL 8,56,33,0
mV 204,96,124
rB 72,6,53248
rB 76,6,55296
mV 236,104,124
dL 9,56,33,1024
mV 252,108,124
dL 10,56,33,2048
mV 248,108,120
dL 11,56,33,3072
mV 232,104,120
s_waitcnt lgkmcnt(0)
s_barrier
mV 228,104,116
s_add_u32 s33, s33, 262144
mV 244,108,116
mV 240,108,112
mV 224,104,112
mV 128,32,64
rT 80,12,16384
s_add_u32 m0, s32, 65536
mV 144,36,64
v_accvgpr_write_b32 a0, 0
mV 148,36,68
rT 82,12,18432
v_accvgpr_write_b32 a1, 0
mV 132,32,68
rT 84,13,16384
rT 86,13,18432
mV 136,32,72
v_accvgpr_write_b32 a2, 0
mV 152,36,72
rT 88,14,16384
v_accvgpr_write_b32 a3, 0
mV 156,36,76
rT 90,14,18432
mV 140,32,76
dL 8,56,33,0
mV 172,40,76
rT 92,15,16384
v_accvgpr_write_b32 a4, 0
mV 188,44,76
rT 94,15,18432
v_accvgpr_write_b32 a5, 0
mV 184,44,72
rT 96,16,16384
rT 98,16,18432
mV 168,40,72
v_accvgpr_write_b32 a6, 0
mV 164,40,68
rT 100,17,16384
mV 180,44,68
dL 9,56,33,1024
mV 176,44,64
v_accvgpr_write_b32 a7, 0
mV 160,40,64
rT 102,17,18432
rT 104,18,16384
mV 192,48,64
v_accvgpr_write_b32 a8, 0
mV 208,52,64
rT 106,18,18432
v_accvgpr_write_b32 a9, 0
mV 212,52,68
rT 108,19,16384
rT 110,19,18432
mV 196,48,68
v_accvgpr_write_b32 a10, 0
mV 200,48,72
dL 10,56,33,2048
mV 216,52,72
rB 112,7,49152
v_accvgpr_write_b32 a11, 0
mV 220,52,76
rB 116,7,51200
rB 120,7,53248
mV 204,48,76
v_accvgpr_write_b32 a12, 0
mV 236,56,76
rB 124,7,55296
v_accvgpr_write_b32 a13, 0
mV 252,60,76
dL 11,56,33,3072
mV 248,60,72
v_accvgpr_write_b32 a14, 0
v_accvgpr_write_b32 a15, 0
mV 232,56,72
v_accvgpr_write_b32 a16, 0
s_add_u32 s33, s33, 262144
mV 228,56,68
v_accvgpr_write_b32 a17, 0
s_waitcnt lgkmcnt(0)
mV 244,60,68
s_waitcnt vmcnt(25)
s_barrier
v_accvgpr_write_b32 a18, 0
mV 240,60,64
v_accvgpr_write_b32 a19, 0
v_accvgpr_write_b32 a20, 0
mV 224,56,64
v_accvgpr_write_b32 a21, 0
mV 128,80,112
rT 32,12,32768
s_add_u32 m0, s30, 49152
mV 144,84,112
rT 34,12,34816
v_accvgpr_write_b32 a22, 0
mV 148,84,116
rT 36,13,32768
v_accvgpr_write_b32 a23, 0
mV 132,80,116
dL 2,4,31,0
mV 136,80,120
rT 38,13,34816
rT 40,14,32768
mV 152,84,120
v_accvgpr_write_b32 a24, 0
mV 156,84,124
rT 42,14,34816
mV 140,80,124
dL 3,4,31,1024
mV 172,88,124
v_accvgpr_write_b32 a25, 0
mV 188,92,124
rT 44,15,32768
rT 46,15,34816
mV 184,92,120
v_accvgpr_write_b32 a26, 0
mV 168,88,120
dL 4,4,31,2048
mV 164,88,116
rT 48,16,32768
v_accvgpr_write_b32 a27, 0
mV 180,92,116
rT 50,16,34816
rT 52,17,32768
mV 176,92,112
v_accvgpr_write_b32 a28, 0
mV 160,88,112
dL 5,4,31,3072
mV 192,96,112
rT 54,17,34816
v_accvgpr_write_b32 a29, 0
mV 208,100,112
rT 56,18,32768
s_add_u32 s31, s31, 128
mV 212,100,116
rT 58,18,34816
v_accvgpr_write_b32 a30, 0
mV 196,96,116
rT 60,19,32768
v_accvgpr_write_b32 a31, 0
mV 200,96,120
rT 62,19,34816
s_add_u32 m0, s32, 81920
mV 216,100,120
rB 64,6,16384
v_accvgpr_write_b32 a32, 0
mV 220,100,124
rB 68,6,18432
v_accvgpr_write_b32 a33, 0
mV 204,96,124
rB 72,6,20480
mV 236,104,124
dL 8,56,33,0
mV 252,108,124
rB 76,6,22528
v_accvgpr_write_b32 a34, 0
mV 248,108,120
dL 9,56,33,1024
mV 232,104,120
v_accvgpr_write_b32 a35, 0
v_accvgpr_write_b32 a36, 0
mV 228,104,116
dL 10,56,33,2048
mV 244,108,116
v_accvgpr_write_b32 a37, 0
v_accvgpr_write_b32 a38, 0
mV 240,108,112
dL 11,56,33,3072
mV 224,104,112
s_waitcnt lgkmcnt(0)
s_waitcnt vmcnt(25)
s_barrier
v_accvgpr_write_b32 a39, 0
s_add_u32 s33, s33, 262144
v_accvgpr_write_b32 a40, 0
v_accvgpr_write_b32 a41, 0
v_accvgpr_write_b32 a42, 0
mV 128,32,64
rT 80,12,49152
s_add_u32 m0, s32, 98304
mV 144,36,64
v_accvgpr_write_b32 a43, 0
mV 148,36,68
rT 82,12,51200
rT 84,13,49152
mV 132,32,68
v_accvgpr_write_b32 a44, 0
mV 136,32,72
rT 86,13,51200
v_accvgpr_write_b32 a45, 0
mV 152,36,72
rT 88,14,49152
rT 90,14,51200
mV 156,36,76
v_accvgpr_write_b32 a46, 0
mV 140,32,76
dL 8,56,33,0
mV 172,40,76
rT 92,15,49152
v_accvgpr_write_b32 a47, 0
mV 188,44,76
rT 94,15,51200
rT 96,16,49152
mV 184,44,72
v_accvgpr_write_b32 a48, 0
mV 168,40,72
rT 98,16,51200
v_accvgpr_write_b32 a49, 0
mV 164,40,68
rT 100,17,49152
mV 180,44,68
dL 9,56,33,1024
mV 176,44,64
rT 102,17,51200
v_accvgpr_write_b32 a50, 0
mV 160,40,64
rT 104,18,49152
v_accvgpr_write_b32 a51, 0
mV 192,48,64
rT 106,18,51200
rT 108,19,49152
mV 208,52,64
v_accvgpr_write_b32 a52, 0
mV 212,52,68
rT 110,19,51200
mV 196,48,68
dL 10,56,33,2048
mV 200,48,72
v_accvgpr_write_b32 a53, 0
mV 216,52,72
rB 112,7,16384
rB 116,7,18432
mV 220,52,76
v_accvgpr_write_b32 a54, 0
mV 204,48,76
rB 120,7,20480
v_accvgpr_write_b32 a55, 0
mV 236,56,76
rB 124,7,22528
v_accvgpr_write_b32 a56, 0
mV 252,60,76
dL 11,56,33,3072
mV 248,60,72
v_accvgpr_write_b32 a57, 0
v_accvgpr_write_b32 a58, 0
mV 232,56,72
v_accvgpr_write_b32 a59, 0
s_add_u32 s33, s33, 262144
mV 228,56,68
s_waitcnt lgkmcnt(0)
s_waitcnt vmcnt(24)
s_barrier
mV 244,60,68
v_accvgpr_write_b32 a60, 0
v_accvgpr_write_b32 a61, 0
mV 240,60,64
v_accvgpr_write_b32 a62, 0
v_accvgpr_write_b32 a63, 0
mV 224,56,64
mV 128,80,112
v_add_u32 v12, 65536, v12
s_add_u32 m0, s32, 114688
mV 144,84,112
v_accvgpr_write_b32 a64, 0
v_add_u32 v13, 65536, v13
mV 148,84,116
v_add_u32 v14, 65536, v14
v_accvgpr_write_b32 a65, 0
mV 132,80,116
v_add_u32 v15, 65536, v15
v_add_u32 v16, 65536, v16
mV 136,80,120
v_accvgpr_write_b32 a66, 0
v_add_u32 v17, 65536, v17
mV 152,84,120
v_add_u32 v18, 65536, v18
v_accvgpr_write_b32 a67, 0
mV 156,84,124
v_add_u32 v19, 65536, v19
mV 140,80,124
dL 8,56,33,0
mV 172,88,124
rT 32,12,0
v_accvgpr_write_b32 a68, 0
mV 188,92,124
rT 34,12,2048
rT 36,13,0
mV 184,92,120
v_accvgpr_write_b32 a69, 0
mV 168,88,120
rT 38,13,2048
rT 40,14,0
mV 164,88,116
v_accvgpr_write_b32 a70, 0
mV 180,92,116
rT 42,14,2048
rT 44,15,0
mV 176,92,112
dL 9,56,33,1024
mV 160,88,112
rT 46,15,2048
v_accvgpr_write_b32 a71, 0
mV 192,96,112
rT 48,16,0
rT 50,16,2048
mV 208,100,112
v_accvgpr_write_b32 a72, 0
mV 212,100,116
rT 52,17,0
rT 54,17,2048
mV 196,96,116
v_accvgpr_write_b32 a73, 0
mV 200,96,120
rT 56,18,0
rT 58,18,2048
mV 216,100,120
v_accvgpr_write_b32 a74, 0
mV 220,100,124
dL 10,56,33,2048
mV 204,96,124
rT 60,19,0
rT 62,19,2048
mV 236,104,124
v_accvgpr_write_b32 a75, 0
mV 252,108,124
rB 64,6,0
rB 68,6,2048
mV 248,108,120
v_accvgpr_write_b32 a76, 0
mV 232,104,120
rB 72,6,4096
rB 76,6,6144
mV 228,104,116
v_accvgpr_write_b32 a77, 0
mV 244,108,116
dL 11,56,33,3072
mV 240,108,112
v_accvgpr_write_b32 a78, 0
v_accvgpr_write_b32 a79, 0
mV 224,104,112
v_accvgpr_write_b32 a80, 0
s_add_u32 s33, s33, 262144
v_accvgpr_write_b32 a81, 0
s_waitcnt lgkmcnt(0)
s_waitcnt vmcnt(20)
s_barrier
v_accvgpr_write_b32 a82, 0
v_accvgpr_write_b32 a83, 0
v_accvgpr_write_b32 a84, 0
v_accvgpr_write_b32 a85, 0
mV 128,32,64
rT 80,12,16384
rT 82,12,18432
mV 144,36,64
v_accvgpr_write_b32 a86, 0
mV 148,36,68
rT 84,13,16384
s_mov_b32 s36, 80216128
mV 132,32,68
v_accvgpr_write_b32 a87, 0
mV 136,32,72
rT 86,13,18432
rT 88,14,16384
mV 152,36,72
v_accvgpr_write_b32 a88, 0
mV 156,36,76
rT 90,14,18432
v_accvgpr_write_b32 a89, 0
mV 140,32,76
s_lshl_b32 s101, s64, 1
rT 92,15,16384
rT 94,15,18432
mV 172,40,76
v_accvgpr_write_b32 a90, 0
mV 188,44,76
rT 96,16,16384
v_accvgpr_write_b32 a91, 0
mV 184,44,72
rT 98,16,18432
v_and_b32 v26, 1, v1
mV 168,40,72
rT 100,17,16384
v_accvgpr_write_b32 a92, 0
mV 164,40,68
rT 102,17,18432
v_accvgpr_write_b32 a93, 0
mV 180,44,68
rT 104,18,16384
rT 106,18,18432
mV 176,44,64
v_add_u32 v26, s101, v26
v_accvgpr_write_b32 a94, 0
mV 160,40,64
rT 108,19,16384
v_accvgpr_write_b32 a95, 0
mV 192,48,64
rT 110,19,18432
rB 112,7,0
mV 208,52,64
v_accvgpr_write_b32 a96, 0
mV 212,52,68
rB 116,7,2048
v_mov_b32 v28, 8
mV 196,48,68
v_accvgpr_write_b32 a97, 0
mV 200,48,72
rB 120,7,4096
rB 124,7,6144
mV 216,52,72
v_accvgpr_write_b32 a98, 0
v_lshlrev_b32 v26, 8, v26
mV 220,52,76
v_accvgpr_write_b32 a99, 0
v_accvgpr_write_b32 a100, 0
mV 204,48,76
v_accvgpr_write_b32 a101, 0
mV 236,56,76
mV 252,60,76
v_accvgpr_write_b32 a102, 0
s_waitcnt lgkmcnt(0)
mV 248,60,72
s_waitcnt vmcnt(16)
s_barrier
v_accvgpr_write_b32 a103, 0
mV 232,56,72
mV 228,56,68
v_accvgpr_write_b32 a104, 0
mV 244,60,68
v_accvgpr_write_b32 a105, 0
mV 240,60,64
mV 224,56,64
v_accvgpr_write_b32 a106, 0
mV 128,80,112
v_add_u32 v12, 4294901760, v12
v_accvgpr_write_b32 a107, 0
mV 144,84,112
v_add_u32 v13, 4294901760, v13
v_add_u32 v14, 4294901760, v14
mV 148,84,116
v_accvgpr_write_b32 a108, 0
v_add_u32 v15, 4294901760, v15
mV 132,80,116
v_add_u32 v16, 4294901760, v16
v_add_u32 v17, 4294901760, v17
mV 136,80,120
v_accvgpr_write_b32 a109, 0
v_add_u32 v18, 4294901760, v18
mV 152,84,120
v_add_u32 v19, 4294901760, v19
v_accvgpr_write_b32 a110, 0
mV 156,84,124
rT 32,12,0
rT 34,12,2048
mV 140,80,124
v_accvgpr_write_b32 a111, 0
mV 172,88,124
rT 36,13,0
rT 38,13,2048
mV 188,92,124
buffer_load_dword v27, v26, s[12:15], s36 offen sc1
mV 184,92,120
v_accvgpr_write_b32 a112, 0
mV 168,88,120
rT 40,14,0
rT 42,14,2048
mV 164,88,116
v_accvgpr_write_b32 a113, 0
mV 180,92,116
rT 44,15,0
rT 46,15,2048
mV 176,92,112
v_accvgpr_write_b32 a114, 0
mV 160,88,112
rT 48,16,0
rT 50,16,2048
mV 192,96,112
v_accvgpr_write_b32 a115, 0
mV 208,100,112
rT 52,17,0
rT 54,17,2048
mV 212,100,116
rT 56,18,0
v_accvgpr_write_b32 a116, 0
mV 196,96,116
rT 58,18,2048
rT 60,19,0
mV 200,96,120
v_accvgpr_write_b32 a117, 0
mV 216,100,120
rT 62,19,2048
rB 64,6,32768
mV 220,100,124
v_accvgpr_write_b32 a118, 0
mV 204,96,124
rB 68,6,34816
rB 72,6,36864
mV 236,104,124
v_accvgpr_write_b32 a119, 0
mV 252,108,124
rB 76,6,38912
v_accvgpr_write_b32 a120, 0
mV 248,108,120
v_accvgpr_write_b32 a121, 0
v_accvgpr_write_b32 a122, 0
mV 232,104,120
v_accvgpr_write_b32 a123, 0
s_waitcnt lgkmcnt(0)
mV 228,104,116
s_waitcnt vmcnt(9)
s_barrier
v_accvgpr_write_b32 a124, 0
mV 244,108,116
v_accvgpr_write_b32 a125, 0
v_accvgpr_write_b32 a126, 0
mV 240,108,112
v_accvgpr_write_b32 a127, 0
mV 224,104,112
mV 128,32,64
rT 80,12,16384
rT 82,12,18432
mV 144,36,64
rT 84,13,16384
mV 148,36,68
rT 86,13,18432
mV 132,32,68
rT 88,14,16384
mV 136,32,72
rT 90,14,18432
mV 152,36,72
rT 92,15,16384
mV 156,36,76
rT 94,15,18432
mV 140,32,76
rT 96,16,16384
mV 172,40,76
rT 98,16,18432
mV 188,44,76
rT 100,17,16384
mV 184,44,72
rT 102,17,18432
mV 168,40,72
rT 104,18,16384
mV 164,40,68
rT 106,18,18432
mV 180,44,68
rT 108,19,16384
mV 176,44,64
rT 110,19,18432
mV 160,40,64
rB 112,7,32768
mV 192,48,64
rB 116,7,34816
mV 208,52,64
rB 120,7,36864
mV 212,52,68
rB 124,7,38912
mV 196,48,68
mV 200,48,72
mV 216,52,72
mV 220,52,76
mV 204,48,76
mV 236,56,76
mV 252,60,76
s_waitcnt lgkmcnt(0)
s_waitcnt vmcnt(5)
s_barrier
mV 248,60,72
s_waitcnt vmcnt(0)
mV 232,56,72
mV 228,56,68
v_cmp_gt_u32 vcc, v28, v27
s_cbranch_vccnz L1_spinKV
L1_spinKV_ret:
mV 244,60,68
mV 240,60,64
mV 224,56,64
mV 128,80,112
rT 32,12,32768
s_lshl_b32 s101, s64, 1
mV 144,84,112
v_and_b32 v24, 1, v1
mV 148,84,116
rT 34,12,34816
v_add_u32 v24, s101, v24
mV 132,80,116
rT 36,13,32768
v_lshlrev_b32 v24, 8, v24
mV 136,80,120
v_add_u32 v24, 16, v24
mV 152,84,120
rT 38,13,34816
v_and_b32 v25, 7, v1
mV 156,84,124
rT 40,14,32768
v_add_u32 v25, 16, v25
mV 140,80,124
rT 42,14,34816
v_lshlrev_b32 v25, 8, v25
mV 172,88,124
v_cmp_gt_u32 vcc, 8, v1
mV 188,92,124
rT 44,15,32768
v_mov_b32 v26, 8
mV 184,92,120
rT 46,15,34816
v_mov_b32 v27, 32
mV 168,88,120
rT 48,16,32768
v_cndmask_b32 v24, v24, v25, vcc
mV 164,88,116
v_cndmask_b32 v26, v26, v27, vcc
mV 180,92,116
rT 50,16,34816
s_mov_b32 s101, 80216128
mV 176,92,112
rT 52,17,32768
v_add_u32 v24, s101, v24
mV 160,88,112
rT 54,17,34816
s_lshl_b32 s64, s3, 13
mV 192,96,112
s_and_b32 s101, s77, 255
rT 56,18,32768
s_lshl_b32 s101, s101, 5
mV 208,100,112
rT 58,18,34816
s_and_b32 s58, s78, 255
mV 212,100,116
rT 60,19,32768
s_add_u32 s101, s101, s58
mV 196,96,116
s_lshl_b32 s101, s101, 15
rT 62,19,34816
s_add_u32 s58, s101, s64
mV 200,96,120
rB 64,6,49152
s_bfe_u32 s60, s78, 0x80008
mV 216,100,120
rB 68,6,51200
s_lshl_b32 s60, s60, 15
mV 220,100,124
s_add_u32 s60, s60, s101
rB 72,6,53248
mV 204,96,124
s_bitcmp1_b32 s76, 0
s_cselect_b32 s60, s60, 0
rB 76,6,55296
mV 236,104,124
s_add_u32 s59, s58, 16777216
s_add_u32 s61, s60, 16777216
mV 252,108,124
s_cmp_lt_u32 s58, s60
s_cselect_b32 s62, s58, 2147483648
s_add_u32 s58, s58, 32768
mV 248,108,120
s_add_u32 m0, s64, 0
s_nop 0
dS 0,12,62,0
mV 232,104,120
dS 0,12,62,1024
mV 228,104,116
dS 0,12,62,2048
mV 244,108,116
dS 0,12,62,3072
mV 240,108,112
s_waitcnt lgkmcnt(0)
s_barrier
mV 224,104,112
s_add_u32 m0, s64, 4096
s_add_u32 s62, s62, 4096
dS 0,12,62,0
dS 0,12,62,1024
dS 0,12,62,2048
dS 0,12,62,3072
mV 128,32,64
rT 80,12,49152
rT 82,12,51200
mV 144,36,64
rT 84,13,49152
mV 148,36,68
rT 86,13,51200
mV 132,32,68
rT 88,14,49152
mV 136,32,72
rT 90,14,51200
mV 152,36,72
rT 92,15,49152
mV 156,36,76
rT 94,15,51200
mV 140,32,76
rT 96,16,49152
mV 172,40,76
rT 98,16,51200
mV 188,44,76
rT 100,17,49152
mV 184,44,72
rT 102,17,51200
mV 168,40,72
rT 104,18,49152
mV 164,40,68
rT 106,18,51200
mV 180,44,68
rT 108,19,49152
mV 176,44,64
rT 110,19,51200
mV 160,40,64
rB 112,7,49152
mV 192,48,64
rB 116,7,51200
mV 208,52,64
rB 120,7,53248
mV 212,52,68
rB 124,7,55296
mV 196,48,68
mV 200,48,72
mV 216,52,72
mV 220,52,76
mV 204,48,76
mV 236,56,76
mV 252,60,76
s_waitcnt lgkmcnt(0)
s_barrier
mV 248,60,72
mV 232,56,72
mV 228,56,68
mV 244,60,68
mV 240,60,64
mV 224,56,64
mV 128,80,112
s_cmp_lt_u32 s58, s60
s_cselect_b32 s62, s58, 2147483648
mV 144,84,112
mV 148,84,116
s_add_u32 s58, s58, 32768
mV 132,80,116
mV 136,80,120
s_add_u32 m0, s64, 32768
mV 152,84,120
mV 156,84,124
dS 0,12,62,0
mV 140,80,124
mV 172,88,124
dS 0,12,62,1024
mV 188,92,124
mV 184,92,120
dS 0,12,62,2048
mV 168,88,120
mV 164,88,116
dS 0,12,62,3072
mV 180,92,116
mV 176,92,112
mV 160,88,112
s_add_u32 m0, s64, 36864
mV 192,96,112
mV 208,100,112
s_add_u32 s62, s62, 4096
mV 212,100,116
mV 196,96,116
dS 0,12,62,0
mV 200,96,120
mV 216,100,120
dS 0,12,62,1024
mV 220,100,124
mV 204,96,124
dS 0,12,62,2048
mV 236,104,124
mV 252,108,124
dS 0,12,62,3072
mV 248,108,120
mV 232,104,120
buffer_load_dword v25, v24, s[12:15], 0 offen sc1
mV 228,104,116
mV 244,108,116
mV 240,108,112
mV 224,104,112
s_mov_b32 s92, 2147483648
L1_done:
s_load_dwordx2 s[30:31], s[0:1], 40
s_load_dwordx8 s[36:43], s[0:1], 64
s_load_dwordx2 s[44:45], s[0:1], 96
s_mov_b32 s29, 0
s_mov_b32 s18, s92
s_load_dword s28, s[46:47], 52
s_mov_b32 s17, 0
s_lshr_b32 s19, s94, 1
s_lshl_b32 s19, s19, 8
s_add_u32 s19, s19, 80216096
s_lshl_b32 s16, s94, 4
s_add_u32 s16, s16, s95
s_lshl_b32 s16, s16, 16
s_add_u32 s16, s16, 33554432
s_bitcmp1_b32 s76, 10
s_cselect_b32 s16, 2147483648, s16
v_mov_b32 v2, 0x3db8aa3b
s_and_b32 s100, s3, 1
s_lshl_b32 s100, s100, 15
s_lshr_b32 s101, s3, 1
s_lshl_b32 s101, s101, 12
s_add_u32 s100, s100, s101
s_add_u32 s100, s100, 0x10000
v_add_u32 v4, s100, v0
v_pk_mul_f32 v[128:129], v[128:129], v[2:3] op_sel_hi:[1,0]
v_pk_mul_f32 v[130:131], v[130:131], v[2:3] op_sel_hi:[1,0]
v_pk_mul_f32 v[144:145], v[144:145], v[2:3] op_sel_hi:[1,0]
v_pk_mul_f32 v[146:147], v[146:147], v[2:3] op_sel_hi:[1,0]
cP 72,128,129
cP 73,130,131
cP 74,144,145
cP 75,146,147
ds_write_b128 v4, v[72:75] offset:0
v_pk_mul_f32 v[132:133], v[132:133], v[2:3] op_sel_hi:[1,0]
v_pk_mul_f32 v[134:135], v[134:135], v[2:3] op_sel_hi:[1,0]
v_pk_mul_f32 v[148:149], v[148:149], v[2:3] op_sel_hi:[1,0]
v_pk_mul_f32 v[150:151], v[150:151], v[2:3] op_sel_hi:[1,0]
cP 76,132,133
cP 77,134,135
cP 78,148,149
cP 79,150,151
ds_write_b128 v4, v[76:79] offset:8192
v_pk_mul_f32 v[136:137], v[136:137], v[2:3] op_sel_hi:[1,0]
v_pk_mul_f32 v[138:139], v[138:139], v[2:3] op_sel_hi:[1,0]
v_pk_mul_f32 v[152:153], v[152:153], v[2:3] op_sel_hi:[1,0]
v_pk_mul_f32 v[154:155], v[154:155], v[2:3] op_sel_hi:[1,0]
cP 80,136,137
cP 81,138,139
cP 82,152,153
cP 83,154,155
ds_write_b128 v4, v[80:83] offset:16384
v_pk_mul_f32 v[140:141], v[140:141], v[2:3] op_sel_hi:[1,0]
v_pk_mul_f32 v[142:143], v[142:143], v[2:3] op_sel_hi:[1,0]
v_pk_mul_f32 v[156:157], v[156:157], v[2:3] op_sel_hi:[1,0]
v_pk_mul_f32 v[158:159], v[158:159], v[2:3] op_sel_hi:[1,0]
cP 84,140,141
cP 85,142,143
cP 86,156,157
cP 87,158,159
ds_write_b128 v4, v[84:87] offset:24576
v_pk_mul_f32 v[160:161], v[160:161], v[2:3] op_sel_hi:[1,0]
v_pk_mul_f32 v[162:163], v[162:163], v[2:3] op_sel_hi:[1,0]
v_pk_mul_f32 v[176:177], v[176:177], v[2:3] op_sel_hi:[1,0]
v_pk_mul_f32 v[178:179], v[178:179], v[2:3] op_sel_hi:[1,0]
cP 88,160,161
cP 89,162,163
cP 90,176,177
cP 91,178,179
ds_write_b128 v4, v[88:91] offset:1024
v_pk_mul_f32 v[164:165], v[164:165], v[2:3] op_sel_hi:[1,0]
v_pk_mul_f32 v[166:167], v[166:167], v[2:3] op_sel_hi:[1,0]
v_pk_mul_f32 v[180:181], v[180:181], v[2:3] op_sel_hi:[1,0]
v_pk_mul_f32 v[182:183], v[182:183], v[2:3] op_sel_hi:[1,0]
cP 92,164,165
cP 93,166,167
cP 94,180,181
cP 95,182,183
ds_write_b128 v4, v[92:95] offset:9216
v_pk_mul_f32 v[168:169], v[168:169], v[2:3] op_sel_hi:[1,0]
v_pk_mul_f32 v[170:171], v[170:171], v[2:3] op_sel_hi:[1,0]
v_pk_mul_f32 v[184:185], v[184:185], v[2:3] op_sel_hi:[1,0]
v_pk_mul_f32 v[186:187], v[186:187], v[2:3] op_sel_hi:[1,0]
cP 96,168,169
cP 97,170,171
cP 98,184,185
cP 99,186,187
ds_write_b128 v4, v[96:99] offset:17408
v_pk_mul_f32 v[172:173], v[172:173], v[2:3] op_sel_hi:[1,0]
v_pk_mul_f32 v[174:175], v[174:175], v[2:3] op_sel_hi:[1,0]
v_pk_mul_f32 v[188:189], v[188:189], v[2:3] op_sel_hi:[1,0]
v_pk_mul_f32 v[190:191], v[190:191], v[2:3] op_sel_hi:[1,0]
cP 100,172,173
cP 101,174,175
cP 102,188,189
cP 103,190,191
ds_write_b128 v4, v[100:103] offset:25600
v_pk_mul_f32 v[192:193], v[192:193], v[2:3] op_sel_hi:[1,0]
v_pk_mul_f32 v[194:195], v[194:195], v[2:3] op_sel_hi:[1,0]
v_pk_mul_f32 v[208:209], v[208:209], v[2:3] op_sel_hi:[1,0]
v_pk_mul_f32 v[210:211], v[210:211], v[2:3] op_sel_hi:[1,0]
cP 104,192,193
cP 105,194,195
cP 106,208,209
cP 107,210,211
ds_write_b128 v4, v[104:107] offset:2048
v_pk_mul_f32 v[196:197], v[196:197], v[2:3] op_sel_hi:[1,0]
v_pk_mul_f32 v[198:199], v[198:199], v[2:3] op_sel_hi:[1,0]
v_pk_mul_f32 v[212:213], v[212:213], v[2:3] op_sel_hi:[1,0]
v_pk_mul_f32 v[214:215], v[214:215], v[2:3] op_sel_hi:[1,0]
cP 108,196,197
cP 109,198,199
cP 110,212,213
cP 111,214,215
ds_write_b128 v4, v[108:111] offset:10240
v_pk_mul_f32 v[200:201], v[200:201], v[2:3] op_sel_hi:[1,0]
v_pk_mul_f32 v[202:203], v[202:203], v[2:3] op_sel_hi:[1,0]
v_pk_mul_f32 v[216:217], v[216:217], v[2:3] op_sel_hi:[1,0]
v_pk_mul_f32 v[218:219], v[218:219], v[2:3] op_sel_hi:[1,0]
cP 112,200,201
cP 113,202,203
cP 114,216,217
cP 115,218,219
ds_write_b128 v4, v[112:115] offset:18432
v_pk_mul_f32 v[204:205], v[204:205], v[2:3] op_sel_hi:[1,0]
v_pk_mul_f32 v[206:207], v[206:207], v[2:3] op_sel_hi:[1,0]
v_pk_mul_f32 v[220:221], v[220:221], v[2:3] op_sel_hi:[1,0]
v_pk_mul_f32 v[222:223], v[222:223], v[2:3] op_sel_hi:[1,0]
cP 116,204,205
cP 117,206,207
cP 118,220,221
cP 119,222,223
ds_write_b128 v4, v[116:119] offset:26624
v_pk_mul_f32 v[224:225], v[224:225], v[2:3] op_sel_hi:[1,0]
v_pk_mul_f32 v[226:227], v[226:227], v[2:3] op_sel_hi:[1,0]
v_pk_mul_f32 v[240:241], v[240:241], v[2:3] op_sel_hi:[1,0]
v_pk_mul_f32 v[242:243], v[242:243], v[2:3] op_sel_hi:[1,0]
cP 120,224,225
cP 121,226,227
cP 122,240,241
cP 123,242,243
ds_write_b128 v4, v[120:123] offset:3072
v_pk_mul_f32 v[228:229], v[228:229], v[2:3] op_sel_hi:[1,0]
v_pk_mul_f32 v[230:231], v[230:231], v[2:3] op_sel_hi:[1,0]
v_pk_mul_f32 v[244:245], v[244:245], v[2:3] op_sel_hi:[1,0]
v_pk_mul_f32 v[246:247], v[246:247], v[2:3] op_sel_hi:[1,0]
cP 124,228,229
cP 125,230,231
cP 126,244,245
cP 127,246,247
ds_write_b128 v4, v[124:127] offset:11264
v_pk_mul_f32 v[232:233], v[232:233], v[2:3] op_sel_hi:[1,0]
v_pk_mul_f32 v[234:235], v[234:235], v[2:3] op_sel_hi:[1,0]
v_pk_mul_f32 v[248:249], v[248:249], v[2:3] op_sel_hi:[1,0]
v_pk_mul_f32 v[250:251], v[250:251], v[2:3] op_sel_hi:[1,0]
cP 128,232,233
cP 129,234,235
cP 130,248,249
cP 131,250,251
ds_write_b128 v4, v[128:131] offset:19456
v_pk_mul_f32 v[236:237], v[236:237], v[2:3] op_sel_hi:[1,0]
v_pk_mul_f32 v[238:239], v[238:239], v[2:3] op_sel_hi:[1,0]
v_pk_mul_f32 v[252:253], v[252:253], v[2:3] op_sel_hi:[1,0]
v_pk_mul_f32 v[254:255], v[254:255], v[2:3] op_sel_hi:[1,0]
cP 132,236,237
cP 133,238,239
cP 134,252,253
cP 135,254,255
ds_write_b128 v4, v[132:135] offset:27648
s_waitcnt vmcnt(0)
MG_pv:
v_cmp_gt_u32 vcc, v26, v25
s_cbranch_vccz MG_pvok
s_mov_b64 exec, vcc
s_sleep 8
buffer_load_dword v25, v24, s[12:15], 0 offen sc1
s_waitcnt vmcnt(0)
s_branch MG_pv
MG_pvok:
s_mov_b64 exec, -1
s_waitcnt lgkmcnt(0)
s_barrier
s_and_b32 s50, s77, 255
s_bfe_u32 s51, s77, 0x80008
s_lshr_b32 s55, s77, 16
s_and_b32 s52, s78, 255
s_bfe_u32 s53, s78, 0x80008
s_lshr_b32 s54, s78, 16
s_mov_b32 s56, s79
s_add_u32 s46, s46, 16
s_addc_u32 s47, s47, 0
s_bitcmp1_b32 s76, 9
s_cbranch_scc1 ATT_warm
s_lshl_b32 s63, s94, 4
s_add_u32 s63, s63, s95
s_lshr_b32 s19, s94, 1
s_lshl_b32 s19, s19, 8
s_add_u32 s19, s19, 80216096
s_lshl_b32 s63, s63, 16
s_and_b32 s69, s3, 1
s_lshl_b32 s69, s69, 15
s_add_u32 s63, s63, s69
s_lshr_b32 s69, s3, 1
s_lshl_b32 s69, s69, 12
s_add_u32 s63, s63, s69
s_add_u32 s63, s63, 33554432
buffer_store_dwordx4 v[72:75], v0, s[12:15], s63 offen offset:0 sc1
buffer_store_dwordx4 v[88:91], v0, s[12:15], s63 offen offset:1024 sc1
buffer_store_dwordx4 v[104:107], v0, s[12:15], s63 offen offset:2048 sc1
buffer_store_dwordx4 v[120:123], v0, s[12:15], s63 offen offset:3072 sc1
s_add_u32 s63, s63, 8192
buffer_store_dwordx4 v[76:79], v0, s[12:15], s63 offen offset:0 sc1
buffer_store_dwordx4 v[92:95], v0, s[12:15], s63 offen offset:1024 sc1
buffer_store_dwordx4 v[108:111], v0, s[12:15], s63 offen offset:2048 sc1
buffer_store_dwordx4 v[124:127], v0, s[12:15], s63 offen offset:3072 sc1
s_add_u32 s63, s63, 8192
buffer_store_dwordx4 v[80:83], v0, s[12:15], s63 offen offset:0 sc1
buffer_store_dwordx4 v[96:99], v0, s[12:15], s63 offen offset:1024 sc1
buffer_store_dwordx4 v[112:115], v0, s[12:15], s63 offen offset:2048 sc1
buffer_store_dwordx4 v[128:131], v0, s[12:15], s63 offen offset:3072 sc1
s_add_u32 s63, s63, 8192
buffer_store_dwordx4 v[84:87], v0, s[12:15], s63 offen offset:0 sc1
buffer_store_dwordx4 v[100:103], v0, s[12:15], s63 offen offset:1024 sc1
buffer_store_dwordx4 v[116:119], v0, s[12:15], s63 offen offset:2048 sc1
buffer_store_dwordx4 v[132:135], v0, s[12:15], s63 offen offset:3072 sc1
s_add_u32 s63, s63, 8192
s_waitcnt vmcnt(0)
s_barrier
v_lshl_add_u32 v4, s3, 6, v1
v_cmp_eq_u32 vcc, 0, v4
v_mov_b32 v4, 0x40000000
v_mov_b32 v5, 1
v_cndmask_b32 v4, v4, 0, vcc
buffer_atomic_add v5, v4, s[12:15], s18 offen
buffer_atomic_add v5, v4, s[12:15], s19 offen
s_mov_b32 s18, 0x80000000
s_mov_b32 s19, 0x80000000
s_bitcmp1_b32 s76, 0
s_cbranch_scc1 ATT_semi
s_branch MG_disp
ATT_warm:
s_cmp_eq_u32 s16, 2147483648
s_cbranch_scc0 ATT_warm2
v_mov_b32 v2, v0
v_add_u32 v3, 0x10000, v0
v_mov_b32 v13, 0xff800000
v_lshrrev_b32 v12, 4, v1
v_lshlrev_b32 v12, 2, v12
v_and_b32 v6, 15, v1
v_sub_u32 v12, v12, v6
s_lshl_b32 s67, s51, 1
s_sub_u32 s67, s67, s52
s_sub_u32 s67, s67, s54
s_lshl_b32 s67, s67, 6
s_lshl_b32 s57, s3, 4
s_add_u32 s67, s67, s57
s_mov_b32 s57, 1
v_mov_b32 v4, 0
v_mov_b32 v5, 0
s_add_u32 s33, s54, 1
s_min_u32 s33, s33, s53
s_lshl_b32 s68, s3, 13
v_add_u32 v6, s68, v3
rB 40,2,0
rB 44,2,8192
rB 136,6,0
rB 168,6,32768
rB 48,2,1024
rB 52,2,9216
rB 56,2,2048
rB 60,2,10240
rB 140,6,1024
rB 172,6,33792
rB 144,6,2048
rB 176,6,34816
rB 148,6,3072
rB 180,6,35840
rB 152,6,4096
rB 184,6,36864
rB 156,6,5120
rB 188,6,37888
rB 160,6,6144
rB 192,6,38912
rB 164,6,7168
rB 196,6,39936
s_waitcnt lgkmcnt(0)
s_barrier
mVz 72,40,136
rB 64,2,3072
rB 68,2,11264
mVz 76,40,168
s_cmp_lt_u32 s59, s61
s_cselect_b32 s62, s59, 2147483648
s_add_u32 s59, s59, 32768
mVz 84,44,168
s_add_u32 m0, s64, 65536
mVz 80,44,136
mV 72,48,140
rB 40,2,4096
rB 44,2,12288
mV 76,48,172
dS 0,12,62,0
mV 84,52,172
dS 0,12,62,1024
mV 80,52,140
dS 0,12,62,2048
mV 72,56,144
rB 48,2,5120
rB 52,2,13312
mV 76,56,176
dS 0,12,62,3072
mV 84,60,176
s_add_u32 m0, s64, 69632
mV 80,60,144
s_waitcnt lgkmcnt(4)
s_add_u32 s62, s62, 4096
mV 72,64,148
rB 56,2,6144
rB 60,2,14336
mV 76,64,180
dS 0,12,62,0
mV 84,68,180
dS 0,12,62,1024
mV 80,68,148
s_waitcnt lgkmcnt(4)
dS 0,12,62,2048
mV 72,40,152
rB 64,2,7168
rB 68,2,15360
mV 76,40,184
dS 0,12,62,3072
mV 84,44,184
s_cmp_lt_u32 s58, s60
s_cselect_b32 s62, s58, 2147483648
mV 80,44,152
s_waitcnt lgkmcnt(4)
mV 72,48,156
rB 40,2,16384
rB 44,2,24576
mV 76,48,188
s_add_u32 s58, s58, 32768
s_add_u32 m0, s64, 98304
mV 84,52,188
dS 0,12,62,0
mV 80,52,156
s_waitcnt lgkmcnt(4)
mV 72,56,160
rB 48,2,17408
rB 52,2,25600
mV 76,56,192
dS 0,12,62,1024
mV 84,60,192
dS 0,12,62,2048
mV 80,60,160
s_waitcnt lgkmcnt(4)
dS 0,12,62,3072
mV 72,64,164
rB 56,2,18432
rB 60,2,26624
mV 76,64,196
s_add_u32 m0, s64, 102400
mV 84,68,196
s_add_u32 s62, s62, 4096
mV 80,68,164
s_waitcnt lgkmcnt(4)
dS 0,12,62,0
mVz 88,40,136
rB 64,2,19456
rB 68,2,27648
mVz 92,40,168
dS 0,12,62,1024
mVz 100,44,168
dS 0,12,62,2048
mVz 96,44,136
s_waitcnt lgkmcnt(4)
dS 0,12,62,3072
mV 88,48,140
rB 40,2,20480
rB 44,2,28672
mV 92,48,172
s_cmp_lt_u32 s59, s61
s_cselect_b32 s65, s59, 2147483648
mV 100,52,172
s_add_u32 s59, s59, 32768
mV 96,52,140
s_waitcnt lgkmcnt(4)
mV 88,56,144
rB 48,2,21504
rB 52,2,29696
mV 92,56,176
mV 100,60,176
mV 96,60,144
s_waitcnt lgkmcnt(4)
mV 88,64,148
rB 56,2,22528
rB 60,2,30720
mV 92,64,180
mV 100,68,180
mV 96,68,148
s_waitcnt lgkmcnt(4)
mV 88,40,152
rB 64,2,23552
rB 68,2,31744
mV 92,40,184
mV 100,44,184
mV 96,44,152
s_waitcnt lgkmcnt(4)
mV 88,48,156
mV 92,48,188
mV 100,52,188
mV 96,52,156
s_waitcnt lgkmcnt(2)
mV 88,56,160
mV 92,56,192
s_waitcnt lgkmcnt(0)
s_waitcnt vmcnt(16)
s_barrier
mV 100,60,192
rB 40,2,32768
rB 44,2,40960
mV 96,60,160
rB 48,2,33792
rB 52,2,41984
mV 88,64,164
mV 92,64,196
rB 56,2,34816
rB 60,2,43008
mV 100,68,196
mV 96,68,164
s_waitcnt lgkmcnt(4)
s_branch ATT_join
ATT_warm2:
v_mov_b32 v2, v0
v_add_u32 v3, 0x10000, v0
v_mov_b32 v13, 0xff800000
v_lshrrev_b32 v12, 4, v1
v_lshlrev_b32 v12, 2, v12
v_and_b32 v6, 15, v1
v_sub_u32 v12, v12, v6
s_lshl_b32 s67, s51, 1
s_sub_u32 s67, s67, s52
s_sub_u32 s67, s67, s54
s_lshl_b32 s67, s67, 6
s_lshl_b32 s57, s3, 4
s_add_u32 s67, s67, s57
s_mov_b32 s57, 1
v_mov_b32 v4, 0
v_mov_b32 v5, 0
s_add_u32 s33, s54, 1
s_min_u32 s33, s33, s53
s_lshl_b32 s68, s3, 13
v_add_u32 v6, s68, v3
rB 40,2,0
rB 44,2,8192
rB 136,6,0
rB 168,6,32768
rB 48,2,1024
rB 52,2,9216
rB 56,2,2048
rB 60,2,10240
rB 140,6,1024
rB 172,6,33792
rB 144,6,2048
rB 176,6,34816
rB 148,6,3072
rB 180,6,35840
rB 152,6,4096
rB 184,6,36864
rB 156,6,5120
rB 188,6,37888
rB 160,6,6144
rB 192,6,38912
rB 164,6,7168
rB 196,6,39936
s_waitcnt lgkmcnt(0)
s_barrier
mVz 72,40,136
rB 64,2,3072
rB 68,2,11264
mVz 76,40,168
s_lshl_b32 s69, s3, 13
s_add_u32 s63, s16, s69
mVz 84,44,168
buffer_store_dwordx4 v[136:139], v0, s[12:15], s63 offen offset:0 sc1
mVz 80,44,136
buffer_store_dwordx4 v[140:143], v0, s[12:15], s63 offen offset:1024 sc1
mV 72,48,140
rB 40,2,4096
rB 44,2,12288
mV 76,48,172
buffer_store_dwordx4 v[144:147], v0, s[12:15], s63 offen offset:2048 sc1
mV 84,52,172
buffer_store_dwordx4 v[148:151], v0, s[12:15], s63 offen offset:3072 sc1
mV 80,52,140
s_add_u32 s63, s63, 4096
mV 72,56,144
rB 48,2,5120
rB 52,2,13312
mV 76,56,176
buffer_store_dwordx4 v[152:155], v0, s[12:15], s63 offen offset:0 sc1
mV 84,60,176
buffer_store_dwordx4 v[156:159], v0, s[12:15], s63 offen offset:1024 sc1
mV 80,60,144
s_waitcnt lgkmcnt(4)
buffer_store_dwordx4 v[160:163], v0, s[12:15], s63 offen offset:2048 sc1
mV 72,64,148
rB 56,2,6144
rB 60,2,14336
mV 76,64,180
buffer_store_dwordx4 v[164:167], v0, s[12:15], s63 offen offset:3072 sc1
mV 84,68,180
s_add_u32 s63, s63, 28672
buffer_store_dwordx4 v[168:171], v0, s[12:15], s63 offen offset:0 sc1
mV 80,68,148
s_waitcnt lgkmcnt(4)
buffer_store_dwordx4 v[172:175], v0, s[12:15], s63 offen offset:1024 sc1
mV 72,40,152
rB 64,2,7168
rB 68,2,15360
mV 76,40,184
buffer_store_dwordx4 v[176:179], v0, s[12:15], s63 offen offset:2048 sc1
mV 84,44,184
buffer_store_dwordx4 v[180:183], v0, s[12:15], s63 offen offset:3072 sc1
mV 80,44,152
s_waitcnt lgkmcnt(4)
s_add_u32 s63, s63, 4096
mV 72,48,156
rB 40,2,16384
rB 44,2,24576
mV 76,48,188
buffer_store_dwordx4 v[184:187], v0, s[12:15], s63 offen offset:0 sc1
mV 84,52,188
buffer_store_dwordx4 v[188:191], v0, s[12:15], s63 offen offset:1024 sc1
mV 80,52,156
s_waitcnt lgkmcnt(4)
buffer_store_dwordx4 v[192:195], v0, s[12:15], s63 offen offset:2048 sc1
mV 72,56,160
rB 48,2,17408
rB 52,2,25600
mV 76,56,192
buffer_store_dwordx4 v[196:199], v0, s[12:15], s63 offen offset:3072 sc1
mV 84,60,192
s_add_u32 s63, s63, 4096
s_cmp_lt_u32 s59, s61
s_cselect_b32 s62, s59, 2147483648
mV 80,60,160
s_waitcnt lgkmcnt(4)
s_add_u32 s59, s59, 32768
s_add_u32 m0, s64, 65536
mV 72,64,164
rB 56,2,18432
rB 60,2,26624
mV 76,64,196
dS 0,12,62,0
mV 84,68,196
dS 0,12,62,1024
mV 80,68,164
s_waitcnt lgkmcnt(4)
dS 0,12,62,2048
mVz 88,40,136
rB 64,2,19456
rB 68,2,27648
mVz 92,40,168
dS 0,12,62,3072
mVz 100,44,168
s_add_u32 m0, s64, 69632
s_add_u32 s62, s62, 4096
mVz 96,44,136
s_waitcnt lgkmcnt(4)
dS 0,12,62,0
mV 88,48,140
rB 40,2,20480
rB 44,2,28672
mV 92,48,172
dS 0,12,62,1024
mV 100,52,172
dS 0,12,62,2048
mV 96,52,140
s_waitcnt lgkmcnt(4)
dS 0,12,62,3072
mV 88,56,144
rB 48,2,21504
rB 52,2,29696
mV 92,56,176
s_cmp_lt_u32 s58, s60
s_cselect_b32 s62, s58, 2147483648
s_add_u32 s58, s58, 32768
mV 100,60,176
s_add_u32 m0, s64, 98304
s_nop 0
dS 0,12,62,0
mV 96,60,144
s_waitcnt lgkmcnt(4)
dS 0,12,62,1024
mV 88,64,148
rB 56,2,22528
rB 60,2,30720
mV 92,64,180
dS 0,12,62,2048
mV 100,68,180
dS 0,12,62,3072
mV 96,68,148
s_waitcnt lgkmcnt(4)
s_add_u32 m0, s64, 102400
s_add_u32 s62, s62, 4096
mV 88,40,152
rB 64,2,23552
rB 68,2,31744
mV 92,40,184
dS 0,12,62,0
mV 100,44,184
dS 0,12,62,1024
mV 96,44,152
s_waitcnt lgkmcnt(4)
dS 0,12,62,2048
mV 88,48,156
dS 0,12,62,3072
mV 92,48,188
s_cmp_lt_u32 s59, s61
s_cselect_b32 s65, s59, 2147483648
s_add_u32 s59, s59, 32768
mV 100,52,188
mV 96,52,156
s_waitcnt lgkmcnt(2)
mV 88,56,160
mV 92,56,192
s_waitcnt lgkmcnt(0)
s_waitcnt vmcnt(32)
s_barrier
mV 100,60,192
rB 40,2,32768
rB 44,2,40960
mV 96,60,160
rB 48,2,33792
rB 52,2,41984
mV 88,64,164
mV 92,64,196
rB 56,2,34816
rB 60,2,43008
mV 100,68,196
mV 96,68,164
s_waitcnt lgkmcnt(4)
s_branch ATT_join
ATT_semi:
s_lshl_b32 s63, s50, 4
s_add_u32 s63, s63, s51
s_cmp_ge_u32 s17, 32
s_cbranch_scc1 ATT_s_qok
s_lshr_b32 s69, s50, 1
s_lshl_b32 s69, s69, 8
s_add_u32 s69, s69, 80216096
v_mov_b32 v200, 0
ATT_s_qpoll:
buffer_load_dword v201, v200, s[12:15], s69 offen sc1
s_waitcnt vmcnt(0)
v_readfirstlane_b32 s17, v201
s_nop 0
s_cmp_ge_u32 s17, 32
s_cbranch_scc1 ATT_s_qok
s_sleep 20
s_branch ATT_s_qpoll
ATT_s_qok:
s_lshl_b32 s63, s63, 16
s_lshl_b32 s69, s3, 13
s_add_u32 s63, s63, s69
s_add_u32 s63, s63, 33554432
s_add_u32 s69, s63, 32768
buffer_load_dwordx4 v[136:139], v0, s[12:15], s63 offen offset:0 sc1
v_mov_b32 v2, v0
v_add_u32 v3, 0x10000, v0
v_mov_b32 v13, 0xff800000
v_lshrrev_b32 v12, 4, v1
v_lshlrev_b32 v12, 2, v12
v_and_b32 v6, 15, v1
v_sub_u32 v12, v12, v6
s_lshl_b32 s67, s51, 1
s_sub_u32 s67, s67, s52
buffer_load_dwordx4 v[168:171], v0, s[12:15], s69 offen offset:0 sc1
s_sub_u32 s67, s67, s54
s_lshl_b32 s67, s67, 6
s_lshl_b32 s57, s3, 4
s_add_u32 s67, s67, s57
s_mov_b32 s57, 1
v_mov_b32 v4, 0
v_mov_b32 v5, 0
s_add_u32 s33, s54, 1
s_min_u32 s33, s33, s53
buffer_load_dwordx4 v[140:143], v0, s[12:15], s63 offen offset:1024 sc1
v_accvgpr_write_b32 a0, 0
v_accvgpr_write_b32 a1, 0
v_accvgpr_write_b32 a2, 0
v_accvgpr_write_b32 a3, 0
v_accvgpr_write_b32 a4, 0
v_accvgpr_write_b32 a5, 0
v_accvgpr_write_b32 a6, 0
v_accvgpr_write_b32 a7, 0
v_accvgpr_write_b32 a8, 0
buffer_load_dwordx4 v[172:175], v0, s[12:15], s69 offen offset:1024 sc1
v_accvgpr_write_b32 a9, 0
v_accvgpr_write_b32 a10, 0
v_accvgpr_write_b32 a11, 0
v_accvgpr_write_b32 a12, 0
v_accvgpr_write_b32 a13, 0
v_accvgpr_write_b32 a14, 0
v_accvgpr_write_b32 a15, 0
v_accvgpr_write_b32 a16, 0
v_accvgpr_write_b32 a17, 0
buffer_load_dwordx4 v[144:147], v0, s[12:15], s63 offen offset:2048 sc1
v_accvgpr_write_b32 a18, 0
v_accvgpr_write_b32 a19, 0
v_accvgpr_write_b32 a20, 0
v_accvgpr_write_b32 a21, 0
v_accvgpr_write_b32 a22, 0
v_accvgpr_write_b32 a23, 0
v_accvgpr_write_b32 a24, 0
v_accvgpr_write_b32 a25, 0
v_accvgpr_write_b32 a26, 0
buffer_load_dwordx4 v[176:179], v0, s[12:15], s69 offen offset:2048 sc1
v_accvgpr_write_b32 a27, 0
v_accvgpr_write_b32 a28, 0
v_accvgpr_write_b32 a29, 0
v_accvgpr_write_b32 a30, 0
v_accvgpr_write_b32 a31, 0
v_accvgpr_write_b32 a32, 0
v_accvgpr_write_b32 a33, 0
v_accvgpr_write_b32 a34, 0
v_accvgpr_write_b32 a35, 0
buffer_load_dwordx4 v[148:151], v0, s[12:15], s63 offen offset:3072 sc1
v_accvgpr_write_b32 a36, 0
v_accvgpr_write_b32 a37, 0
v_accvgpr_write_b32 a38, 0
v_accvgpr_write_b32 a39, 0
v_accvgpr_write_b32 a40, 0
v_accvgpr_write_b32 a41, 0
v_accvgpr_write_b32 a42, 0
v_accvgpr_write_b32 a43, 0
v_accvgpr_write_b32 a44, 0
buffer_load_dwordx4 v[180:183], v0, s[12:15], s69 offen offset:3072 sc1
v_accvgpr_write_b32 a45, 0
v_accvgpr_write_b32 a46, 0
v_accvgpr_write_b32 a47, 0
v_accvgpr_write_b32 a48, 0
v_accvgpr_write_b32 a49, 0
v_accvgpr_write_b32 a50, 0
v_accvgpr_write_b32 a51, 0
v_accvgpr_write_b32 a52, 0
v_accvgpr_write_b32 a53, 0
s_add_u32 s63, s63, 4096
s_add_u32 s69, s69, 4096
buffer_load_dwordx4 v[152:155], v0, s[12:15], s63 offen offset:0 sc1
v_accvgpr_write_b32 a54, 0
v_accvgpr_write_b32 a55, 0
v_accvgpr_write_b32 a56, 0
v_accvgpr_write_b32 a57, 0
v_accvgpr_write_b32 a58, 0
v_accvgpr_write_b32 a59, 0
v_accvgpr_write_b32 a60, 0
v_accvgpr_write_b32 a61, 0
v_accvgpr_write_b32 a62, 0
buffer_load_dwordx4 v[184:187], v0, s[12:15], s69 offen offset:0 sc1
v_accvgpr_write_b32 a63, 0
v_accvgpr_write_b32 a64, 0
v_accvgpr_write_b32 a65, 0
v_accvgpr_write_b32 a66, 0
v_accvgpr_write_b32 a67, 0
v_accvgpr_write_b32 a68, 0
v_accvgpr_write_b32 a69, 0
v_accvgpr_write_b32 a70, 0
v_accvgpr_write_b32 a71, 0
buffer_load_dwordx4 v[156:159], v0, s[12:15], s63 offen offset:1024 sc1
v_accvgpr_write_b32 a72, 0
v_accvgpr_write_b32 a73, 0
v_accvgpr_write_b32 a74, 0
v_accvgpr_write_b32 a75, 0
v_accvgpr_write_b32 a76, 0
v_accvgpr_write_b32 a77, 0
v_accvgpr_write_b32 a78, 0
v_accvgpr_write_b32 a79, 0
v_accvgpr_write_b32 a80, 0
buffer_load_dwordx4 v[188:191], v0, s[12:15], s69 offen offset:1024 sc1
v_accvgpr_write_b32 a81, 0
v_accvgpr_write_b32 a82, 0
v_accvgpr_write_b32 a83, 0
v_accvgpr_write_b32 a84, 0
v_accvgpr_write_b32 a85, 0
v_accvgpr_write_b32 a86, 0
v_accvgpr_write_b32 a87, 0
v_accvgpr_write_b32 a88, 0
v_accvgpr_write_b32 a89, 0
buffer_load_dwordx4 v[160:163], v0, s[12:15], s63 offen offset:2048 sc1
v_accvgpr_write_b32 a90, 0
v_accvgpr_write_b32 a91, 0
v_accvgpr_write_b32 a92, 0
v_accvgpr_write_b32 a93, 0
v_accvgpr_write_b32 a94, 0
v_accvgpr_write_b32 a95, 0
v_accvgpr_write_b32 a96, 0
v_accvgpr_write_b32 a97, 0
v_accvgpr_write_b32 a98, 0
buffer_load_dwordx4 v[192:195], v0, s[12:15], s69 offen offset:2048 sc1
v_accvgpr_write_b32 a99, 0
v_accvgpr_write_b32 a100, 0
v_accvgpr_write_b32 a101, 0
v_accvgpr_write_b32 a102, 0
v_accvgpr_write_b32 a103, 0
v_accvgpr_write_b32 a104, 0
v_accvgpr_write_b32 a105, 0
v_accvgpr_write_b32 a106, 0
v_accvgpr_write_b32 a107, 0
buffer_load_dwordx4 v[164:167], v0, s[12:15], s63 offen offset:3072 sc1
v_accvgpr_write_b32 a108, 0
v_accvgpr_write_b32 a109, 0
v_accvgpr_write_b32 a110, 0
v_accvgpr_write_b32 a111, 0
v_accvgpr_write_b32 a112, 0
v_accvgpr_write_b32 a113, 0
v_accvgpr_write_b32 a114, 0
v_accvgpr_write_b32 a115, 0
v_accvgpr_write_b32 a116, 0
buffer_load_dwordx4 v[196:199], v0, s[12:15], s69 offen offset:3072 sc1
v_accvgpr_write_b32 a117, 0
v_accvgpr_write_b32 a118, 0
v_accvgpr_write_b32 a119, 0
v_accvgpr_write_b32 a120, 0
v_accvgpr_write_b32 a121, 0
v_accvgpr_write_b32 a122, 0
v_accvgpr_write_b32 a123, 0
v_accvgpr_write_b32 a124, 0
v_accvgpr_write_b32 a125, 0
v_accvgpr_write_b32 a126, 0
v_accvgpr_write_b32 a127, 0
rB 40,2,0
rB 44,2,8192
rB 48,2,1024
rB 52,2,9216
rB 56,2,2048
rB 60,2,10240
s_waitcnt vmcnt(14)
s_waitcnt lgkmcnt(4)
mVz 72,40,136
rB 64,2,3072
rB 68,2,11264
mVz 76,40,168
s_cmp_lt_u32 s59, s61
s_cselect_b32 s62, s59, 2147483648
s_add_u32 s59, s59, 32768
mVz 84,44,168
s_waitcnt vmcnt(12)
mVz 80,44,136
s_waitcnt lgkmcnt(4)
s_add_u32 m0, s64, 65536
mV 72,48,140
rB 40,2,4096
rB 44,2,12288
mV 76,48,172
dS 0,12,62,0
mV 84,52,172
s_waitcnt vmcnt(11)
mV 80,52,140
s_waitcnt lgkmcnt(4)
dS 0,12,62,1024
mV 72,56,144
rB 48,2,5120
rB 52,2,13312
mV 76,56,176
dS 0,12,62,2048
mV 84,60,176
s_waitcnt vmcnt(11)
dS 0,12,62,3072
mV 80,60,144
s_waitcnt lgkmcnt(4)
mV 72,64,148
rB 56,2,6144
rB 60,2,14336
mV 76,64,180
s_add_u32 m0, s64, 69632
mV 84,68,180
s_waitcnt vmcnt(10)
s_add_u32 s62, s62, 4096
mV 80,68,148
s_waitcnt lgkmcnt(4)
mV 72,40,152
rB 64,2,7168
rB 68,2,15360
mV 76,40,184
dS 0,12,62,0
mV 84,44,184
s_waitcnt vmcnt(9)
dS 0,12,62,1024
mV 80,44,152
s_waitcnt lgkmcnt(4)
dS 0,12,62,2048
mV 72,48,156
rB 40,2,16384
rB 44,2,24576
mV 76,48,188
dS 0,12,62,3072
mV 84,52,188
s_waitcnt vmcnt(10)
mV 80,52,156
s_waitcnt lgkmcnt(4)
s_cmp_lt_u32 s58, s60
s_cselect_b32 s62, s58, 2147483648
mV 72,56,160
rB 48,2,17408
rB 52,2,25600
mV 76,56,192
s_add_u32 s58, s58, 32768
mV 84,60,192
s_waitcnt vmcnt(8)
s_add_u32 m0, s64, 98304
mV 80,60,160
s_waitcnt lgkmcnt(4)
mV 72,64,164
rB 56,2,18432
rB 60,2,26624
mV 76,64,196
dS 0,12,62,0
mV 84,68,196
dS 0,12,62,1024
mV 80,68,164
s_waitcnt lgkmcnt(4)
mVz 88,40,136
rB 64,2,19456
rB 68,2,27648
mVz 92,40,168
dS 0,12,62,2048
mVz 100,44,168
dS 0,12,62,3072
mVz 96,44,136
s_waitcnt lgkmcnt(4)
s_add_u32 m0, s64, 102400
mV 88,48,140
rB 40,2,20480
rB 44,2,28672
mV 92,48,172
s_add_u32 s62, s62, 4096
mV 100,52,172
mV 96,52,140
s_waitcnt lgkmcnt(4)
dS 0,12,62,0
mV 88,56,144
rB 48,2,21504
rB 52,2,29696
mV 92,56,176
dS 0,12,62,1024
mV 100,60,176
dS 0,12,62,2048
mV 96,60,144
s_waitcnt lgkmcnt(4)
mV 88,64,148
rB 56,2,22528
rB 60,2,30720
mV 92,64,180
dS 0,12,62,3072
mV 100,68,180
s_cmp_lt_u32 s59, s61
s_cselect_b32 s65, s59, 2147483648
mV 96,68,148
s_waitcnt lgkmcnt(4)
mV 88,40,152
rB 64,2,23552
rB 68,2,31744
mV 92,40,184
s_add_u32 s59, s59, 32768
mV 100,44,184
mV 96,44,152
s_waitcnt lgkmcnt(4)
mV 88,48,156
mV 92,48,188
mV 100,52,188
mV 96,52,156
s_waitcnt lgkmcnt(2)
mV 88,56,160
mV 92,56,192
s_waitcnt lgkmcnt(0)
s_barrier
mV 100,60,192
rB 40,2,32768
rB 44,2,40960
mV 96,60,160
rB 48,2,33792
rB 52,2,41984
mV 88,64,164
mV 92,64,196
rB 56,2,34816
rB 60,2,43008
mV 100,68,196
mV 96,68,164
s_waitcnt lgkmcnt(4)
s_branch ATT_join
ATT_job:
s_lshl_b32 s64, s3, 13
s_lshl_b32 s62, s50, 5
s_add_u32 s62, s62, s52
s_lshl_b32 s62, s62, 15
s_add_u32 s58, s62, s64
s_lshl_b32 s63, s53, 15
s_add_u32 s60, s62, s63
s_add_u32 s59, s58, 16777216
s_add_u32 s61, s60, 16777216
v_lshlrev_b32 v0, 4, v1
s_cmp_lt_u32 s58, s60
s_cselect_b32 s62, s58, 2147483648
s_add_u32 s58, s58, 32768
s_add_u32 m0, s64, 0
s_nop 0
dS 0,12,62,0
v_mov_b32 v2, v0
v_add_u32 v3, 0x10000, v0
v_mov_b32 v13, 0xff800000
v_lshrrev_b32 v12, 4, v1
v_lshlrev_b32 v12, 2, v12
dS 0,12,62,1024
v_and_b32 v6, 15, v1
v_sub_u32 v12, v12, v6
s_lshl_b32 s67, s51, 1
s_sub_u32 s67, s67, s52
s_sub_u32 s67, s67, s54
dS 0,12,62,2048
s_lshl_b32 s67, s67, 6
s_lshl_b32 s57, s3, 4
s_add_u32 s67, s67, s57
s_mov_b32 s57, 1
v_mov_b32 v4, 0
dS 0,12,62,3072
v_mov_b32 v5, 0
s_add_u32 s33, s54, 1
s_min_u32 s33, s33, s53
v_accvgpr_write_b32 a0, 0
v_accvgpr_write_b32 a1, 0
s_add_u32 m0, s64, 4096
s_add_u32 s62, s62, 4096
dS 0,12,62,0
v_accvgpr_write_b32 a2, 0
v_accvgpr_write_b32 a3, 0
v_accvgpr_write_b32 a4, 0
v_accvgpr_write_b32 a5, 0
v_accvgpr_write_b32 a6, 0
dS 0,12,62,1024
v_accvgpr_write_b32 a7, 0
v_accvgpr_write_b32 a8, 0
v_accvgpr_write_b32 a9, 0
v_accvgpr_write_b32 a10, 0
v_accvgpr_write_b32 a11, 0
dS 0,12,62,2048
v_accvgpr_write_b32 a12, 0
v_accvgpr_write_b32 a13, 0
v_accvgpr_write_b32 a14, 0
v_accvgpr_write_b32 a15, 0
v_accvgpr_write_b32 a16, 0
dS 0,12,62,3072
v_accvgpr_write_b32 a17, 0
v_accvgpr_write_b32 a18, 0
v_accvgpr_write_b32 a19, 0
v_accvgpr_write_b32 a20, 0
v_accvgpr_write_b32 a21, 0
s_lshl_b32 s63, s50, 4
s_add_u32 s63, s63, s51
s_cmp_ge_u32 s17, 32
s_cbranch_scc1 ATT_c_qok
s_lshr_b32 s69, s50, 1
s_lshl_b32 s69, s69, 8
s_add_u32 s69, s69, 80216096
v_mov_b32 v200, 0
ATT_c_qpoll:
buffer_load_dword v201, v200, s[12:15], s69 offen sc1
s_waitcnt vmcnt(0)
v_readfirstlane_b32 s17, v201
s_nop 0
s_cmp_ge_u32 s17, 32
s_cbranch_scc1 ATT_c_qok
s_sleep 20
s_branch ATT_c_qpoll
ATT_c_qok:
s_lshl_b32 s63, s63, 16
s_lshl_b32 s69, s3, 13
s_add_u32 s63, s63, s69
s_add_u32 s63, s63, 33554432
s_add_u32 s69, s63, 32768
buffer_load_dwordx4 v[136:139], v0, s[12:15], s63 offen offset:0 sc1
v_accvgpr_write_b32 a22, 0
v_accvgpr_write_b32 a23, 0
v_accvgpr_write_b32 a24, 0
v_accvgpr_write_b32 a25, 0
v_accvgpr_write_b32 a26, 0
buffer_load_dwordx4 v[168:171], v0, s[12:15], s69 offen offset:0 sc1
v_accvgpr_write_b32 a27, 0
v_accvgpr_write_b32 a28, 0
v_accvgpr_write_b32 a29, 0
v_accvgpr_write_b32 a30, 0
v_accvgpr_write_b32 a31, 0
buffer_load_dwordx4 v[140:143], v0, s[12:15], s63 offen offset:1024 sc1
v_accvgpr_write_b32 a32, 0
v_accvgpr_write_b32 a33, 0
v_accvgpr_write_b32 a34, 0
v_accvgpr_write_b32 a35, 0
v_accvgpr_write_b32 a36, 0
buffer_load_dwordx4 v[172:175], v0, s[12:15], s69 offen offset:1024 sc1
v_accvgpr_write_b32 a37, 0
v_accvgpr_write_b32 a38, 0
v_accvgpr_write_b32 a39, 0
v_accvgpr_write_b32 a40, 0
v_accvgpr_write_b32 a41, 0
buffer_load_dwordx4 v[144:147], v0, s[12:15], s63 offen offset:2048 sc1
v_accvgpr_write_b32 a42, 0
v_accvgpr_write_b32 a43, 0
v_accvgpr_write_b32 a44, 0
v_accvgpr_write_b32 a45, 0
v_accvgpr_write_b32 a46, 0
buffer_load_dwordx4 v[176:179], v0, s[12:15], s69 offen offset:2048 sc1
v_accvgpr_write_b32 a47, 0
v_accvgpr_write_b32 a48, 0
v_accvgpr_write_b32 a49, 0
v_accvgpr_write_b32 a50, 0
v_accvgpr_write_b32 a51, 0
buffer_load_dwordx4 v[148:151], v0, s[12:15], s63 offen offset:3072 sc1
v_accvgpr_write_b32 a52, 0
v_accvgpr_write_b32 a53, 0
v_accvgpr_write_b32 a54, 0
v_accvgpr_write_b32 a55, 0
v_accvgpr_write_b32 a56, 0
buffer_load_dwordx4 v[180:183], v0, s[12:15], s69 offen offset:3072 sc1
v_accvgpr_write_b32 a57, 0
v_accvgpr_write_b32 a58, 0
v_accvgpr_write_b32 a59, 0
v_accvgpr_write_b32 a60, 0
v_accvgpr_write_b32 a61, 0
s_add_u32 s63, s63, 4096
s_add_u32 s69, s69, 4096
buffer_load_dwordx4 v[152:155], v0, s[12:15], s63 offen offset:0 sc1
v_accvgpr_write_b32 a62, 0
v_accvgpr_write_b32 a63, 0
v_accvgpr_write_b32 a64, 0
v_accvgpr_write_b32 a65, 0
v_accvgpr_write_b32 a66, 0
buffer_load_dwordx4 v[184:187], v0, s[12:15], s69 offen offset:0 sc1
v_accvgpr_write_b32 a67, 0
v_accvgpr_write_b32 a68, 0
v_accvgpr_write_b32 a69, 0
v_accvgpr_write_b32 a70, 0
v_accvgpr_write_b32 a71, 0
buffer_load_dwordx4 v[156:159], v0, s[12:15], s63 offen offset:1024 sc1
v_accvgpr_write_b32 a72, 0
v_accvgpr_write_b32 a73, 0
v_accvgpr_write_b32 a74, 0
v_accvgpr_write_b32 a75, 0
v_accvgpr_write_b32 a76, 0
buffer_load_dwordx4 v[188:191], v0, s[12:15], s69 offen offset:1024 sc1
v_accvgpr_write_b32 a77, 0
v_accvgpr_write_b32 a78, 0
v_accvgpr_write_b32 a79, 0
v_accvgpr_write_b32 a80, 0
v_accvgpr_write_b32 a81, 0
buffer_load_dwordx4 v[160:163], v0, s[12:15], s63 offen offset:2048 sc1
v_accvgpr_write_b32 a82, 0
v_accvgpr_write_b32 a83, 0
v_accvgpr_write_b32 a84, 0
v_accvgpr_write_b32 a85, 0
v_accvgpr_write_b32 a86, 0
buffer_load_dwordx4 v[192:195], v0, s[12:15], s69 offen offset:2048 sc1
v_accvgpr_write_b32 a87, 0
v_accvgpr_write_b32 a88, 0
v_accvgpr_write_b32 a89, 0
v_accvgpr_write_b32 a90, 0
v_accvgpr_write_b32 a91, 0
buffer_load_dwordx4 v[164:167], v0, s[12:15], s63 offen offset:3072 sc1
v_accvgpr_write_b32 a92, 0
v_accvgpr_write_b32 a93, 0
v_accvgpr_write_b32 a94, 0
v_accvgpr_write_b32 a95, 0
v_accvgpr_write_b32 a96, 0
buffer_load_dwordx4 v[196:199], v0, s[12:15], s69 offen offset:3072 sc1
v_accvgpr_write_b32 a97, 0
v_accvgpr_write_b32 a98, 0
v_accvgpr_write_b32 a99, 0
v_accvgpr_write_b32 a100, 0
v_accvgpr_write_b32 a101, 0
s_cmp_lt_u32 s58, s60
s_cselect_b32 s62, s58, 2147483648
s_add_u32 s58, s58, 32768
s_add_u32 m0, s64, 32768
s_nop 0
dS 0,12,62,0
v_accvgpr_write_b32 a102, 0
v_accvgpr_write_b32 a103, 0
v_accvgpr_write_b32 a104, 0
v_accvgpr_write_b32 a105, 0
v_accvgpr_write_b32 a106, 0
dS 0,12,62,1024
v_accvgpr_write_b32 a107, 0
v_accvgpr_write_b32 a108, 0
v_accvgpr_write_b32 a109, 0
v_accvgpr_write_b32 a110, 0
v_accvgpr_write_b32 a111, 0
dS 0,12,62,2048
v_accvgpr_write_b32 a112, 0
v_accvgpr_write_b32 a113, 0
v_accvgpr_write_b32 a114, 0
v_accvgpr_write_b32 a115, 0
v_accvgpr_write_b32 a116, 0
dS 0,12,62,3072
v_accvgpr_write_b32 a117, 0
v_accvgpr_write_b32 a118, 0
v_accvgpr_write_b32 a119, 0
v_accvgpr_write_b32 a120, 0
v_accvgpr_write_b32 a121, 0
s_add_u32 m0, s64, 36864
s_add_u32 s62, s62, 4096
dS 0,12,62,0
v_accvgpr_write_b32 a122, 0
v_accvgpr_write_b32 a123, 0
v_accvgpr_write_b32 a124, 0
v_accvgpr_write_b32 a125, 0
v_accvgpr_write_b32 a126, 0
dS 0,12,62,1024
v_accvgpr_write_b32 a127, 0
dS 0,12,62,2048
dS 0,12,62,3072
s_waitcnt vmcnt(24)
s_barrier
rB 40,2,0
rB 44,2,8192
rB 48,2,1024
rB 52,2,9216
rB 56,2,2048
rB 60,2,10240
v_lshl_add_u32 v200, s3, 6, v1
v_cmp_eq_u32 vcc, 0, v200
v_mov_b32 v200, 0x40000000
v_mov_b32 v201, 1
v_cndmask_b32 v200, v200, 0, vcc
buffer_atomic_add v201, v200, s[12:15], s18 offen
buffer_atomic_add v201, v200, s[12:15], s19 offen
s_mov_b32 s18, 0x80000000
s_mov_b32 s19, 0x80000000
s_waitcnt vmcnt(24)
s_waitcnt lgkmcnt(4)
mVz 72,40,136
rB 64,2,3072
rB 68,2,11264
mVz 76,40,168
s_cmp_lt_u32 s59, s61
s_cselect_b32 s62, s59, 2147483648
s_add_u32 s59, s59, 32768
mVz 84,44,168
s_waitcnt vmcnt(22)
mVz 80,44,136
s_waitcnt lgkmcnt(4)
s_add_u32 m0, s64, 65536
mV 72,48,140
rB 40,2,4096
rB 44,2,12288
mV 76,48,172
dS 0,12,62,0
mV 84,52,172
s_waitcnt vmcnt(21)
mV 80,52,140
s_waitcnt lgkmcnt(4)
dS 0,12,62,1024
mV 72,56,144
rB 48,2,5120
rB 52,2,13312
mV 76,56,176
dS 0,12,62,2048
mV 84,60,176
s_waitcnt vmcnt(21)
dS 0,12,62,3072
mV 80,60,144
s_waitcnt lgkmcnt(4)
mV 72,64,148
rB 56,2,6144
rB 60,2,14336
mV 76,64,180
s_add_u32 m0, s64, 69632
mV 84,68,180
s_waitcnt vmcnt(20)
s_add_u32 s62, s62, 4096
mV 80,68,148
s_waitcnt lgkmcnt(4)
mV 72,40,152
rB 64,2,7168
rB 68,2,15360
mV 76,40,184
dS 0,12,62,0
mV 84,44,184
s_waitcnt vmcnt(19)
dS 0,12,62,1024
mV 80,44,152
s_waitcnt lgkmcnt(4)
dS 0,12,62,2048
mV 72,48,156
rB 40,2,16384
rB 44,2,24576
mV 76,48,188
dS 0,12,62,3072
mV 84,52,188
s_waitcnt vmcnt(20)
mV 80,52,156
s_waitcnt lgkmcnt(4)
s_cmp_lt_u32 s58, s60
s_cselect_b32 s62, s58, 2147483648
mV 72,56,160
rB 48,2,17408
rB 52,2,25600
mV 76,56,192
s_add_u32 s58, s58, 32768
mV 84,60,192
s_waitcnt vmcnt(18)
s_add_u32 m0, s64, 98304
mV 80,60,160
s_waitcnt lgkmcnt(4)
mV 72,64,164
rB 56,2,18432
rB 60,2,26624
mV 76,64,196
dS 0,12,62,0
mV 84,68,196
dS 0,12,62,1024
mV 80,68,164
s_waitcnt lgkmcnt(4)
mVz 88,40,136
rB 64,2,19456
rB 68,2,27648
mVz 92,40,168
dS 0,12,62,2048
mVz 100,44,168
dS 0,12,62,3072
mVz 96,44,136
s_waitcnt lgkmcnt(4)
s_add_u32 m0, s64, 102400
mV 88,48,140
rB 40,2,20480
rB 44,2,28672
mV 92,48,172
s_add_u32 s62, s62, 4096
mV 100,52,172
mV 96,52,140
s_waitcnt lgkmcnt(4)
dS 0,12,62,0
mV 88,56,144
rB 48,2,21504
rB 52,2,29696
mV 92,56,176
dS 0,12,62,1024
mV 100,60,176
dS 0,12,62,2048
mV 96,60,144
s_waitcnt lgkmcnt(4)
mV 88,64,148
rB 56,2,22528
rB 60,2,30720
mV 92,64,180
dS 0,12,62,3072
mV 100,68,180
s_cmp_lt_u32 s59, s61
s_cselect_b32 s65, s59, 2147483648
mV 96,68,148
s_waitcnt lgkmcnt(4)
mV 88,40,152
rB 64,2,23552
rB 68,2,31744
mV 92,40,184
s_add_u32 s59, s59, 32768
mV 100,44,184
mV 96,44,152
s_waitcnt lgkmcnt(4)
mV 88,48,156
mV 92,48,188
mV 100,52,188
mV 96,52,156
s_waitcnt lgkmcnt(2)
mV 88,56,160
mV 92,56,192
s_waitcnt lgkmcnt(0)
s_waitcnt vmcnt(18)
s_barrier
mV 100,60,192
rB 40,2,32768
rB 44,2,40960
mV 96,60,160
rB 48,2,33792
rB 52,2,41984
mV 88,64,164
mV 92,64,196
rB 56,2,34816
rB 60,2,43008
mV 100,68,196
mV 96,68,164
s_waitcnt lgkmcnt(4)
ATT_join:
s_cmp_eq_u32 s54, 0
s_cbranch_scc0 ATT_nomask0
s_nop 7
v_subrev_u32 v9, s67, v12
v_add_u32 v8, 48, v9
s_sub_u32 s67, s67, 64
v_cmp_lt_i32 s[70:71], 48, v8
v_cmp_lt_i32 s[72:73], 47, v8
v_cmp_lt_i32 s[74:75], 46, v8
v_cndmask_b32 v72, v72, v13, s[70:71]
v_cndmask_b32 v73, v73, v13, s[72:73]
v_cndmask_b32 v74, v74, v13, s[74:75]
v_cmp_lt_i32 s[70:71], 45, v8
v_cmp_lt_i32 s[72:73], 64, v9
v_cmp_lt_i32 s[74:75], 63, v9
v_cndmask_b32 v75, v75, v13, s[70:71]
v_cndmask_b32 v76, v76, v13, s[72:73]
v_cndmask_b32 v77, v77, v13, s[74:75]
v_cmp_lt_i32 s[70:71], 62, v9
v_cmp_lt_i32 s[72:73], 61, v9
v_cmp_lt_i32 s[74:75], 32, v8
v_cndmask_b32 v78, v78, v13, s[70:71]
v_cndmask_b32 v79, v79, v13, s[72:73]
v_cndmask_b32 v80, v80, v13, s[74:75]
v_cmp_lt_i32 s[70:71], 31, v8
v_cmp_lt_i32 s[72:73], 30, v8
v_cmp_lt_i32 s[74:75], 29, v8
v_cndmask_b32 v81, v81, v13, s[70:71]
v_cndmask_b32 v82, v82, v13, s[72:73]
v_cndmask_b32 v83, v83, v13, s[74:75]
v_cmp_lt_i32 s[70:71], 48, v9
v_cmp_lt_i32 s[72:73], 47, v9
v_cmp_lt_i32 s[74:75], 46, v9
v_cndmask_b32 v84, v84, v13, s[70:71]
v_cndmask_b32 v85, v85, v13, s[72:73]
v_cndmask_b32 v86, v86, v13, s[74:75]
v_cmp_lt_i32 s[70:71], 45, v9
v_cmp_lt_i32 s[72:73], 16, v8
v_cmp_lt_i32 s[74:75], 15, v8
v_cndmask_b32 v87, v87, v13, s[70:71]
v_cndmask_b32 v88, v88, v13, s[72:73]
v_cndmask_b32 v89, v89, v13, s[74:75]
v_cmp_lt_i32 s[70:71], 14, v8
v_cmp_lt_i32 s[72:73], 13, v8
v_cmp_lt_i32 s[74:75], 32, v9
v_cndmask_b32 v90, v90, v13, s[70:71]
v_cndmask_b32 v91, v91, v13, s[72:73]
v_cndmask_b32 v92, v92, v13, s[74:75]
v_cmp_lt_i32 s[70:71], 31, v9
v_cmp_lt_i32 s[72:73], 30, v9
v_cmp_lt_i32 s[74:75], 29, v9
v_cndmask_b32 v93, v93, v13, s[70:71]
v_cndmask_b32 v94, v94, v13, s[72:73]
v_cndmask_b32 v95, v95, v13, s[74:75]
v_cmp_lt_i32 s[70:71], 0, v8
v_cmp_lt_i32 s[72:73], -1, v8
v_cmp_lt_i32 s[74:75], -2, v8
v_cndmask_b32 v96, v96, v13, s[70:71]
v_cndmask_b32 v97, v97, v13, s[72:73]
v_cndmask_b32 v98, v98, v13, s[74:75]
v_cmp_lt_i32 s[70:71], -3, v8
v_cmp_lt_i32 s[72:73], 64, v8
v_cmp_lt_i32 s[74:75], 63, v8
v_cndmask_b32 v99, v99, v13, s[70:71]
v_cndmask_b32 v100, v100, v13, s[72:73]
v_cndmask_b32 v101, v101, v13, s[74:75]
v_cmp_lt_i32 s[70:71], 62, v8
v_cmp_lt_i32 s[72:73], 61, v8
s_nop 0
v_cndmask_b32 v102, v102, v13, s[70:71]
v_cndmask_b32 v103, v103, v13, s[72:73]
ATT_nomask0:
v_max3_f32 v200, v72, v73, v74
v_max3_f32 v201, v76, v77, v78
v_max3_f32 v200, v200, v75, v80
v_max3_f32 v201, v201, v79, v84
v_max3_f32 v200, v200, v81, v82
v_max3_f32 v201, v201, v85, v86
v_max3_f32 v200, v200, v83, v88
v_max3_f32 v201, v201, v87, v92
v_max3_f32 v200, v200, v89, v90
v_max3_f32 v201, v201, v93, v94
v_max3_f32 v200, v200, v91, v96
v_max3_f32 v201, v201, v95, v100
v_max3_f32 v200, v200, v97, v98
v_max3_f32 v201, v201, v101, v102
v_max_f32 v200, v200, v99
v_max_f32 v201, v201, v103
v_mov_b32 v202, v200
v_mov_b32 v203, v201
s_nop 0
v_permlane16_swap_b32 v200, v202
v_permlane16_swap_b32 v201, v203
v_max_f32 v200, v200, v202
v_max_f32 v201, v201, v203
v_mov_b32 v202, v200
v_mov_b32 v203, v201
s_nop 0
v_permlane32_swap_b32 v200, v202
v_permlane32_swap_b32 v201, v203
v_max_f32 v200, v200, v202
v_max_f32 v201, v201, v203
v_max_f32 v200, 0xf149f2ca, v200
v_max_f32 v201, 0xf149f2ca, v201
v_sub_f32 v16, 0, v200
v_sub_f32 v17, 0, v200
v_sub_f32 v18, 0, v200
v_sub_f32 v19, 0, v200
v_sub_f32 v20, 0, v201
v_sub_f32 v21, 0, v201
v_sub_f32 v22, 0, v201
v_sub_f32 v23, 0, v201
v_pk_add_f32 v[72:73], v[72:73], v[16:17]
v_pk_add_f32 v[74:75], v[74:75], v[16:17]
v_pk_add_f32 v[76:77], v[76:77], v[20:21]
v_pk_add_f32 v[78:79], v[78:79], v[20:21]
v_pk_add_f32 v[80:81], v[80:81], v[16:17]
v_pk_add_f32 v[82:83], v[82:83], v[16:17]
v_pk_add_f32 v[84:85], v[84:85], v[20:21]
v_pk_add_f32 v[86:87], v[86:87], v[20:21]
v_pk_add_f32 v[88:89], v[88:89], v[16:17]
v_pk_add_f32 v[90:91], v[90:91], v[16:17]
v_pk_add_f32 v[92:93], v[92:93], v[20:21]
v_pk_add_f32 v[94:95], v[94:95], v[20:21]
v_pk_add_f32 v[96:97], v[96:97], v[16:17]
v_pk_add_f32 v[98:99], v[98:99], v[16:17]
v_pk_add_f32 v[100:101], v[100:101], v[20:21]
v_pk_add_f32 v[102:103], v[102:103], v[20:21]
s_cmp_ge_u32 s57, s33
s_cbranch_scc1 ATT_G0
ATT_A0:
v_mfma_f32_16x16x32_bf16 v[104:107], v[40:43], v[136:139], v[16:19]
rB 64,2,35840
rB 68,2,44032
v_mfma_f32_16x16x32_bf16 v[108:111], v[40:43], v[168:171], v[20:23]
s_add_u32 m0, s64, 0
v_exp_f32 v72, v72
v_mfma_f32_16x16x32_bf16 v[116:119], v[44:47], v[168:171], v[20:23]
dS 0,12,65,0
v_mfma_f32_16x16x32_bf16 v[112:115], v[44:47], v[136:139], v[16:19]
s_waitcnt lgkmcnt(4)
v_exp_f32 v73, v73
mV 104,48,140
rB 40,2,36864
rB 44,2,45056
mV 108,48,172
v_exp_f32 v74, v74
mV 116,52,172
v_exp_f32 v75, v75
mV 112,52,140
s_waitcnt lgkmcnt(4)
v_exp_f32 v80, v80
mV 104,56,144
rB 48,2,37888
rB 52,2,46080
mV 108,56,176
v_exp_f32 v81, v81
mV 116,60,176
dS 0,12,65,1024
mV 112,60,144
s_waitcnt lgkmcnt(4)
v_exp_f32 v82, v82
mV 104,64,148
rB 56,2,38912
rB 60,2,47104
mV 108,64,180
v_exp_f32 v83, v83
mV 116,68,180
cP 24,72,73
cP 25,74,75
mV 112,68,148
s_waitcnt lgkmcnt(4)
cP 26,80,81
cP 27,82,83
mV 104,40,152
rB 64,2,39936
rB 68,2,48128
mV 108,40,184
v_exp_f32 v76, v76
mV 116,44,184
dS 0,12,65,2048
mV 112,44,152
s_waitcnt lgkmcnt(4)
v_exp_f32 v77, v77
mV 104,48,156
rB 40,2,49152
rB 44,2,57344
mV 108,48,188
v_exp_f32 v78, v78
mV 116,52,188
v_exp_f32 v79, v79
mV 112,52,156
s_waitcnt lgkmcnt(4)
v_exp_f32 v84, v84
mV 104,56,160
rB 48,2,50176
rB 52,2,58368
mV 108,56,192
v_exp_f32 v85, v85
mV 116,60,192
dS 0,12,65,3072
mV 112,60,160
s_waitcnt lgkmcnt(4)
v_exp_f32 v86, v86
mV 104,64,164
rB 56,2,51200
rB 60,2,59392
mV 108,64,196
s_add_u32 m0, s64, 4096
v_exp_f32 v87, v87
mV 116,68,196
s_add_u32 s65, s65, 4096
cP 28,76,77
cP 29,78,79
mV 112,68,164
s_waitcnt lgkmcnt(4)
cP 30,84,85
cP 31,86,87
v_mfma_f32_16x16x32_bf16 v[120:123], v[40:43], v[136:139], v[16:19]
rB 64,2,52224
rB 68,2,60416
v_mfma_f32_16x16x32_bf16 v[124:127], v[40:43], v[168:171], v[20:23]
v_exp_f32 v88, v88
v_mfma_f32_16x16x32_bf16 v[132:135], v[44:47], v[168:171], v[20:23]
dS 0,12,65,0
v_mfma_f32_16x16x32_bf16 v[128:131], v[44:47], v[136:139], v[16:19]
s_waitcnt lgkmcnt(4)
v_exp_f32 v89, v89
mV 120,48,140
rB 40,2,53248
rB 44,2,61440
mV 124,48,172
v_exp_f32 v90, v90
mV 132,52,172
v_exp_f32 v91, v91
mV 128,52,140
s_waitcnt lgkmcnt(4)
v_exp_f32 v96, v96
mV 120,56,144
rB 48,2,54272
rB 52,2,62464
mV 124,56,176
v_exp_f32 v97, v97
mV 132,60,176
dS 0,12,65,1024
mV 128,60,144
s_waitcnt lgkmcnt(4)
v_exp_f32 v98, v98
mV 120,64,148
rB 56,2,55296
rB 60,2,63488
mV 124,64,180
v_exp_f32 v99, v99
mV 132,68,180
cP 32,88,89
cP 33,90,91
mV 128,68,148
s_waitcnt lgkmcnt(4)
cP 34,96,97
cP 35,98,99
mV 120,40,152
rB 64,2,56320
rB 68,2,64512
mV 124,40,184
mV 132,44,184
dS 0,12,65,2048
mV 128,44,152
s_waitcnt lgkmcnt(4)
mV 120,48,156
mV 124,48,188
s_cmp_lt_u32 s58, s60
s_cselect_b32 s66, s58, 2147483648
mV 132,52,188
s_add_u32 s58, s58, 32768
mV 128,52,156
s_waitcnt lgkmcnt(2)
mV 120,56,160
mV 124,56,192
s_waitcnt lgkmcnt(0)
s_waitcnt vmcnt(15)
s_barrier
mV 132,60,192
rB 40,3,0
rB 44,3,1024
mV 128,60,160
rB 48,3,2048
rB 52,3,3072
mV 120,64,164
s_cmp_ge_u32 s57, s54
mV 124,64,196
rB 56,3,4096
rB 60,3,5120
mV 132,68,196
dS 0,12,65,3072
mV 128,68,164
s_waitcnt lgkmcnt(4)
s_cbranch_scc1 ATT_B0m
mA 0,40,24
rB 64,3,6144
rB 68,3,7168
mA 4,40,28
s_add_u32 m0, s64, 32768
v_exp_f32 v92, v92
mA 12,44,28
dS 0,12,66,0
mA 8,44,24
s_waitcnt lgkmcnt(4)
v_exp_f32 v93, v93
mA 16,48,24
rB 40,3,8192
rB 44,3,9216
mA 20,48,28
v_exp_f32 v94, v94
mA 28,52,28
s_cmp_lg_u32 s19, 2147483648
s_cbranch_scc1 ATT_hk
ATT_hk_ret:
mA 24,52,24
s_waitcnt lgkmcnt(4)
v_exp_f32 v95, v95
mA 32,56,24
rB 48,3,10240
rB 52,3,11264
mA 36,56,28
v_exp_f32 v100, v100
mA 44,60,28
dS 0,12,66,1024
mA 40,60,24
s_waitcnt lgkmcnt(4)
v_exp_f32 v101, v101
mA 48,64,24
rB 56,3,12288
rB 60,3,13312
mA 52,64,28
v_exp_f32 v102, v102
mA 60,68,28
v_exp_f32 v103, v103
mA 56,68,24
s_waitcnt lgkmcnt(4)
cP 36,92,93
cP 37,94,95
mA 64,40,24
rB 64,3,14336
rB 68,3,15360
mA 68,40,28
cP 38,100,101
cP 39,102,103
mA 76,44,28
dS 0,12,66,2048
mA 72,44,24
s_waitcnt lgkmcnt(4)
v_add_f32 v4, v4, v72
v_max3_f32 v6, v104, v105, v106
mA 80,48,24
rB 40,3,16384
rB 44,3,17408
mA 84,48,28
v_add_f32 v5, v5, v76
v_max3_f32 v7, v107, v108, v109
mA 92,52,28
v_add_f32 v4, v4, v73
v_add_f32 v5, v5, v77
mA 88,52,24
s_waitcnt lgkmcnt(4)
v_max3_f32 v6, v6, v110, v111
v_add_f32 v4, v4, v74
mA 96,56,24
rB 48,3,18432
rB 52,3,19456
mA 100,56,28
v_add_f32 v5, v5, v78
v_max3_f32 v7, v7, v112, v113
mA 108,60,28
dS 0,12,66,3072
mA 104,60,24
s_waitcnt lgkmcnt(4)
v_add_f32 v4, v4, v75
v_add_f32 v5, v5, v79
mA 112,64,24
rB 56,3,20480
rB 60,3,21504
mA 116,64,28
s_add_u32 m0, s64, 36864
v_max3_f32 v6, v6, v114, v115
v_add_f32 v4, v4, v80
mA 124,68,28
s_add_u32 s66, s66, 4096
v_add_f32 v5, v5, v84
v_max3_f32 v7, v7, v116, v117
mA 120,68,24
s_waitcnt lgkmcnt(4)
v_add_f32 v4, v4, v81
v_max3_f32 v6, v6, v118, v119
mA 0,40,32
rB 64,3,22528
rB 68,3,23552
mA 4,40,36
v_add_f32 v5, v5, v85
v_add_f32 v4, v4, v82
mA 12,44,36
dS 0,12,66,0
mA 8,44,32
s_waitcnt lgkmcnt(4)
v_max3_f32 v7, v7, v120, v121
v_add_f32 v5, v5, v86
mA 16,48,32
rB 40,3,24576
rB 44,3,25600
mA 20,48,36
v_add_f32 v4, v4, v83
v_max3_f32 v6, v6, v122, v123
mA 28,52,36
v_add_f32 v5, v5, v87
v_add_f32 v4, v4, v88
mA 24,52,32
s_waitcnt lgkmcnt(4)
v_max3_f32 v7, v7, v124, v125
v_add_f32 v5, v5, v92
mA 32,56,32
rB 48,3,26624
rB 52,3,27648
mA 36,56,36
v_max3_f32 v6, v6, v126, v127
v_add_f32 v4, v4, v89
mA 44,60,36
dS 0,12,66,1024
mA 40,60,32
s_waitcnt lgkmcnt(4)
v_add_f32 v5, v5, v93
v_max3_f32 v7, v7, v128, v129
mA 48,64,32
rB 56,3,28672
rB 60,3,29696
mA 52,64,36
v_add_f32 v4, v4, v90
v_add_f32 v5, v5, v94
mA 60,68,36
v_max3_f32 v6, v6, v130, v131
v_add_f32 v4, v4, v91
mA 56,68,32
s_waitcnt lgkmcnt(4)
v_add_f32 v5, v5, v95
v_max3_f32 v7, v7, v132, v133
mA 64,40,32
rB 64,3,30720
rB 68,3,31744
mA 68,40,36
v_add_f32 v4, v4, v96
v_add_f32 v5, v5, v100
mA 76,44,36
dS 0,12,66,2048
mA 72,44,32
s_waitcnt lgkmcnt(4)
v_max3_f32 v6, v6, v134, v135
v_add_f32 v4, v4, v97
mA 80,48,32
v_max_f32 v6, v6, v7
v_add_f32 v5, v5, v101
mA 84,48,36
s_cmp_lt_u32 s59, s61
s_cselect_b32 s65, s59, 2147483648
v_add_f32 v4, v4, v98
mA 92,52,36
s_add_u32 s59, s59, 32768
v_cmp_lt_f32 vcc, 0x41000000, v6
v_add_f32 v5, v5, v102
mA 88,52,32
s_waitcnt lgkmcnt(2)
v_add_f32 v4, v4, v99
v_add_f32 v5, v5, v103
mA 96,56,32
s_add_u32 s57, s57, 1
mA 100,56,36
s_waitcnt lgkmcnt(0)
s_waitcnt vmcnt(15)
s_barrier
mA 108,60,36
rB 40,3,32768
rB 44,3,40960
mA 104,60,32
rB 48,3,33792
rB 52,3,41984
mA 112,64,32
s_cmp_ge_u32 s57, s33
mA 116,64,36
rB 56,3,34816
rB 60,3,43008
mA 124,68,36
dS 0,12,66,3072
mA 120,68,32
s_waitcnt lgkmcnt(4)
s_cbranch_vccnz ATT_S1
ATT_D1:
s_cbranch_scc1 ATT_G1
v_mfma_f32_16x16x32_bf16 v[72:75], v[40:43], v[136:139], v[16:19]
rB 64,3,35840
rB 68,3,44032
v_mfma_f32_16x16x32_bf16 v[76:79], v[40:43], v[168:171], v[20:23]
s_add_u32 m0, s64, 65536
v_exp_f32 v104, v104
v_mfma_f32_16x16x32_bf16 v[84:87], v[44:47], v[168:171], v[20:23]
dS 0,12,65,0
v_mfma_f32_16x16x32_bf16 v[80:83], v[44:47], v[136:139], v[16:19]
s_waitcnt lgkmcnt(4)
v_exp_f32 v105, v105
mV 72,48,140
rB 40,3,36864
rB 44,3,45056
mV 76,48,172
v_exp_f32 v106, v106
mV 84,52,172
v_exp_f32 v107, v107
mV 80,52,140
s_waitcnt lgkmcnt(4)
v_exp_f32 v112, v112
mV 72,56,144
rB 48,3,37888
rB 52,3,46080
mV 76,56,176
v_exp_f32 v113, v113
mV 84,60,176
dS 0,12,65,1024
mV 80,60,144
s_waitcnt lgkmcnt(4)
v_exp_f32 v114, v114
mV 72,64,148
rB 56,3,38912
rB 60,3,47104
mV 76,64,180
v_exp_f32 v115, v115
mV 84,68,180
cP 24,104,105
cP 25,106,107
mV 80,68,148
s_waitcnt lgkmcnt(4)
cP 26,112,113
cP 27,114,115
mV 72,40,152
rB 64,3,39936
rB 68,3,48128
mV 76,40,184
v_exp_f32 v108, v108
mV 84,44,184
dS 0,12,65,2048
mV 80,44,152
s_waitcnt lgkmcnt(4)
v_exp_f32 v109, v109
mV 72,48,156
rB 40,3,49152
rB 44,3,57344
mV 76,48,188
v_exp_f32 v110, v110
mV 84,52,188
v_exp_f32 v111, v111
mV 80,52,156
s_waitcnt lgkmcnt(4)
v_exp_f32 v116, v116
mV 72,56,160
rB 48,3,50176
rB 52,3,58368
mV 76,56,192
v_exp_f32 v117, v117
mV 84,60,192
dS 0,12,65,3072
mV 80,60,160
s_waitcnt lgkmcnt(4)
v_exp_f32 v118, v118
mV 72,64,164
rB 56,3,51200
rB 60,3,59392
mV 76,64,196
s_add_u32 m0, s64, 69632
v_exp_f32 v119, v119
mV 84,68,196
s_add_u32 s65, s65, 4096
cP 28,108,109
cP 29,110,111
mV 80,68,164
s_waitcnt lgkmcnt(4)
cP 30,116,117
cP 31,118,119
v_mfma_f32_16x16x32_bf16 v[88:91], v[40:43], v[136:139], v[16:19]
rB 64,3,52224
rB 68,3,60416
v_mfma_f32_16x16x32_bf16 v[92:95], v[40:43], v[168:171], v[20:23]
v_exp_f32 v120, v120
v_mfma_f32_16x16x32_bf16 v[100:103], v[44:47], v[168:171], v[20:23]
dS 0,12,65,0
v_mfma_f32_16x16x32_bf16 v[96:99], v[44:47], v[136:139], v[16:19]
s_waitcnt lgkmcnt(4)
v_exp_f32 v121, v121
mV 88,48,140
rB 40,3,53248
rB 44,3,61440
mV 92,48,172
v_exp_f32 v122, v122
mV 100,52,172
v_exp_f32 v123, v123
mV 96,52,140
s_waitcnt lgkmcnt(4)
v_exp_f32 v128, v128
mV 88,56,144
rB 48,3,54272
rB 52,3,62464
mV 92,56,176
v_exp_f32 v129, v129
mV 100,60,176
dS 0,12,65,1024
mV 96,60,144
s_waitcnt lgkmcnt(4)
v_exp_f32 v130, v130
mV 88,64,148
rB 56,3,55296
rB 60,3,63488
mV 92,64,180
v_exp_f32 v131, v131
mV 100,68,180
cP 32,120,121
cP 33,122,123
mV 96,68,148
s_waitcnt lgkmcnt(4)
cP 34,128,129
cP 35,130,131
mV 88,40,152
rB 64,3,56320
rB 68,3,64512
mV 92,40,184
mV 100,44,184
dS 0,12,65,2048
mV 96,44,152
s_waitcnt lgkmcnt(4)
mV 88,48,156
mV 92,48,188
s_cmp_lt_u32 s58, s60
s_cselect_b32 s66, s58, 2147483648
mV 100,52,188
s_add_u32 s58, s58, 32768
mV 96,52,156
s_waitcnt lgkmcnt(2)
mV 88,56,160
mV 92,56,192
s_waitcnt lgkmcnt(0)
s_waitcnt vmcnt(15)
s_barrier
mV 100,60,192
rB 40,2,0
rB 44,2,1024
mV 96,60,160
rB 48,2,2048
rB 52,2,3072
mV 88,64,164
s_cmp_ge_u32 s57, s54
mV 92,64,196
rB 56,2,4096
rB 60,2,5120
mV 100,68,196
dS 0,12,65,3072
mV 96,68,164
s_waitcnt lgkmcnt(4)
s_cbranch_scc1 ATT_B1m
mA 0,40,24
rB 64,2,6144
rB 68,2,7168
mA 4,40,28
s_add_u32 m0, s64, 98304
v_exp_f32 v124, v124
mA 12,44,28
dS 0,12,66,0
mA 8,44,24
s_waitcnt lgkmcnt(4)
v_exp_f32 v125, v125
mA 16,48,24
rB 40,2,8192
rB 44,2,9216
mA 20,48,28
v_exp_f32 v126, v126
mA 28,52,28
v_exp_f32 v127, v127
mA 24,52,24
s_waitcnt lgkmcnt(4)
v_exp_f32 v132, v132
mA 32,56,24
rB 48,2,10240
rB 52,2,11264
mA 36,56,28
v_exp_f32 v133, v133
mA 44,60,28
dS 0,12,66,1024
mA 40,60,24
s_waitcnt lgkmcnt(4)
v_exp_f32 v134, v134
mA 48,64,24
rB 56,2,12288
rB 60,2,13312
mA 52,64,28
v_exp_f32 v135, v135
mA 60,68,28
cP 36,124,125
cP 37,126,127
mA 56,68,24
s_waitcnt lgkmcnt(4)
cP 38,132,133
cP 39,134,135
mA 64,40,24
rB 64,2,14336
rB 68,2,15360
mA 68,40,28
v_add_f32 v4, v4, v104
v_max3_f32 v6, v72, v73, v74
mA 76,44,28
dS 0,12,66,2048
mA 72,44,24
s_waitcnt lgkmcnt(4)
v_add_f32 v5, v5, v108
v_max3_f32 v7, v75, v76, v77
mA 80,48,24
rB 40,2,16384
rB 44,2,17408
mA 84,48,28
v_add_f32 v4, v4, v105
v_add_f32 v5, v5, v109
mA 92,52,28
v_max3_f32 v6, v6, v78, v79
v_add_f32 v4, v4, v106
mA 88,52,24
s_waitcnt lgkmcnt(4)
v_add_f32 v5, v5, v110
v_max3_f32 v7, v7, v80, v81
mA 96,56,24
rB 48,2,18432
rB 52,2,19456
mA 100,56,28
v_add_f32 v4, v4, v107
v_add_f32 v5, v5, v111
mA 108,60,28
dS 0,12,66,3072
mA 104,60,24
s_waitcnt lgkmcnt(4)
v_max3_f32 v6, v6, v82, v83
v_add_f32 v4, v4, v112
mA 112,64,24
rB 56,2,20480
rB 60,2,21504
mA 116,64,28
s_add_u32 m0, s64, 102400
v_add_f32 v5, v5, v116
v_max3_f32 v7, v7, v84, v85
mA 124,68,28
s_add_u32 s66, s66, 4096
v_add_f32 v4, v4, v113
v_max3_f32 v6, v6, v86, v87
mA 120,68,24
s_waitcnt lgkmcnt(4)
v_add_f32 v5, v5, v117
v_add_f32 v4, v4, v114
mA 0,40,32
rB 64,2,22528
rB 68,2,23552
mA 4,40,36
v_max3_f32 v7, v7, v88, v89
v_add_f32 v5, v5, v118
mA 12,44,36
dS 0,12,66,0
mA 8,44,32
s_waitcnt lgkmcnt(4)
v_add_f32 v4, v4, v115
v_max3_f32 v6, v6, v90, v91
mA 16,48,32
rB 40,2,24576
rB 44,2,25600
mA 20,48,36
v_add_f32 v5, v5, v119
v_add_f32 v4, v4, v120
mA 28,52,36
v_max3_f32 v7, v7, v92, v93
v_add_f32 v5, v5, v124
mA 24,52,32
s_waitcnt lgkmcnt(4)
v_max3_f32 v6, v6, v94, v95
v_add_f32 v4, v4, v121
mA 32,56,32
rB 48,2,26624
rB 52,2,27648
mA 36,56,36
v_add_f32 v5, v5, v125
v_max3_f32 v7, v7, v96, v97
mA 44,60,36
dS 0,12,66,1024
mA 40,60,32
s_waitcnt lgkmcnt(4)
v_add_f32 v4, v4, v122
v_add_f32 v5, v5, v126
mA 48,64,32
rB 56,2,28672
rB 60,2,29696
mA 52,64,36
v_max3_f32 v6, v6, v98, v99
v_add_f32 v4, v4, v123
mA 60,68,36
v_add_f32 v5, v5, v127
v_max3_f32 v7, v7, v100, v101
mA 56,68,32
s_waitcnt lgkmcnt(4)
v_add_f32 v4, v4, v128
v_add_f32 v5, v5, v132
mA 64,40,32
rB 64,2,30720
rB 68,2,31744
mA 68,40,36
v_max3_f32 v6, v6, v102, v103
v_add_f32 v4, v4, v129
mA 76,44,36
dS 0,12,66,2048
mA 72,44,32
s_waitcnt lgkmcnt(4)
v_max_f32 v6, v6, v7
v_add_f32 v5, v5, v133
mA 80,48,32
v_add_f32 v4, v4, v130
v_cmp_lt_f32 vcc, 0x41000000, v6
mA 84,48,36
s_cmp_lt_u32 s59, s61
s_cselect_b32 s65, s59, 2147483648
v_add_f32 v5, v5, v134
mA 92,52,36
s_add_u32 s59, s59, 32768
v_add_f32 v4, v4, v131
v_add_f32 v5, v5, v135
mA 88,52,32
s_waitcnt lgkmcnt(2)
mA 96,56,32
s_add_u32 s57, s57, 1
mA 100,56,36
s_waitcnt lgkmcnt(0)
s_waitcnt vmcnt(15)
s_barrier
mA 108,60,36
rB 40,2,32768
rB 44,2,40960
mA 104,60,32
rB 48,2,33792
rB 52,2,41984
mA 112,64,32
s_cmp_ge_u32 s57, s33
mA 116,64,36
rB 56,2,34816
rB 60,2,43008
mA 124,68,36
dS 0,12,66,3072
mA 120,68,32
s_waitcnt lgkmcnt(4)
s_cbranch_vccnz ATT_S0
ATT_D0:
s_cbranch_scc0 ATT_A0
ATT_G0:
s_cmp_eq_u32 s54, s53
s_cbranch_scc1 ATT_F0
s_cmp_ge_u32 s57, s53
s_cbranch_scc1 ATT_H0
v_mfma_f32_16x16x32_bf16 v[108:111], v[40:43], v[168:171], v[20:23]
rB 64,2,35840
s_add_u32 m0, s64, 0
v_mfma_f32_16x16x32_bf16 v[116:119], v[44:47], v[168:171], v[20:23]
rB 68,2,44032
v_exp_f32 v72, v72
v_exp_f32 v73, v73
s_waitcnt lgkmcnt(4)
mV 108,48,172
rB 40,2,36864
v_exp_f32 v74, v74
dS 0,12,65,0
mV 116,52,172
rB 44,2,45056
v_exp_f32 v75, v75
s_waitcnt lgkmcnt(4)
mV 108,56,176
rB 48,2,37888
v_exp_f32 v80, v80
v_exp_f32 v81, v81
mV 116,60,176
rB 52,2,46080
dS 0,12,65,1024
v_exp_f32 v82, v82
s_waitcnt lgkmcnt(4)
mV 108,64,180
rB 56,2,38912
v_exp_f32 v83, v83
cP 24,72,73
mV 116,68,180
rB 60,2,47104
dS 0,12,65,2048
s_waitcnt lgkmcnt(4)
mV 108,40,184
rB 64,2,39936
cP 25,74,75
cP 26,80,81
mV 116,44,184
rB 68,2,48128
cP 27,82,83
dS 0,12,65,3072
s_waitcnt lgkmcnt(4)
mV 108,48,188
rB 40,2,49152
v_exp_f32 v76, v76
mV 116,52,188
rB 44,2,57344
v_exp_f32 v77, v77
v_exp_f32 v78, v78
s_waitcnt lgkmcnt(4)
mV 108,56,192
rB 48,2,50176
s_add_u32 m0, s64, 4096
v_exp_f32 v79, v79
mV 116,60,192
rB 52,2,58368
v_exp_f32 v84, v84
v_exp_f32 v85, v85
s_waitcnt lgkmcnt(4)
mV 108,64,196
rB 56,2,51200
s_add_u32 s65, s65, 4096
mV 116,68,196
rB 60,2,59392
v_exp_f32 v86, v86
v_exp_f32 v87, v87
s_waitcnt lgkmcnt(4)
v_mfma_f32_16x16x32_bf16 v[124:127], v[40:43], v[168:171], v[20:23]
rB 64,2,52224
cP 28,76,77
dS 0,12,65,0
v_mfma_f32_16x16x32_bf16 v[132:135], v[44:47], v[168:171], v[20:23]
rB 68,2,60416
cP 29,78,79
s_waitcnt lgkmcnt(4)
mV 124,48,172
rB 40,2,53248
cP 30,84,85
cP 31,86,87
mV 132,52,172
rB 44,2,61440
dS 0,12,65,1024
v_exp_f32 v88, v88
s_waitcnt lgkmcnt(4)
mV 124,56,176
rB 48,2,54272
v_exp_f32 v89, v89
v_exp_f32 v90, v90
mV 132,60,176
rB 52,2,62464
dS 0,12,65,2048
s_waitcnt lgkmcnt(4)
mV 124,64,180
rB 56,2,55296
v_exp_f32 v91, v91
v_exp_f32 v96, v96
mV 132,68,180
rB 60,2,63488
v_exp_f32 v97, v97
s_cmp_lt_u32 s58, s60
s_cselect_b32 s66, s58, 2147483648
s_waitcnt lgkmcnt(4)
mV 124,40,184
rB 64,2,56320
v_exp_f32 v98, v98
mV 132,44,184
rB 68,2,64512
v_exp_f32 v99, v99
cP 32,88,89
s_waitcnt lgkmcnt(4)
mV 124,48,188
s_add_u32 s58, s58, 32768
cP 33,90,91
mV 132,52,188
cP 34,96,97
cP 35,98,99
s_waitcnt lgkmcnt(2)
mV 124,56,192
s_waitcnt lgkmcnt(0)
s_waitcnt vmcnt(15)
s_barrier
rB 40,3,0
rB 44,3,1024
rB 48,3,2048
rB 52,3,3072
rB 56,3,4096
mV 132,60,192
rB 60,3,5120
dS 0,12,65,3072
mV 124,64,196
mV 132,68,196
s_waitcnt lgkmcnt(4)
s_branch ATT_B0m
ATT_H0:
s_waitcnt vmcnt(0)
s_barrier
rB 40,3,0
rB 44,3,1024
rB 48,3,2048
rB 52,3,3072
rB 56,3,4096
rB 60,3,5120
v_exp_f32 v76, v76
v_exp_f32 v77, v77
v_exp_f32 v78, v78
v_exp_f32 v79, v79
v_exp_f32 v84, v84
v_exp_f32 v85, v85
v_exp_f32 v86, v86
v_exp_f32 v87, v87
cP 28,76,77
cP 29,78,79
cP 30,84,85
cP 31,86,87
v_and_b32 v12, 15, v1
s_lshl_b32 s62, s3, 4
v_add_u32 v12, s62, v12
v_lshlrev_b32 v6, 2, v12
v_lshlrev_b32 v12, 3, v12
s_lshl_b32 s62, s51, 9
s_add_u32 s62, s62, 79953920
s_lshl_b32 s63, s56, 10
s_add_u32 s63, s63, 80740352
buffer_load_dword v14, v6, s[12:15], s62 offen offset:0 sc1
buffer_load_dword v15, v6, s[12:15], s62 offen offset:256 sc1
s_lshr_b32 s69, s50, 1
s_lshl_b32 s69, s69, 8
s_add_u32 s69, s69, 80216096
v_mov_b32 v240, 0
buffer_load_dword v240, v240, s[12:15], s69 offen sc1
s_lshl_b32 s69, s56, 16
s_lshl_b32 s68, s3, 10
s_add_u32 s69, s69, s68
s_add_u32 s69, s69, 83886080
s_cmp_eq_u32 s55, 2
s_cbranch_scc0 ATT_h0_nomerge
s_lshl_b32 s68, s56, 8
s_add_u32 s68, s68, 80216064
v_mov_b32 v212, 0
ATT_h0_poll:
buffer_load_dword v213, v212, s[12:15], s68 offen sc1
s_waitcnt vmcnt(0)
v_readfirstlane_b32 s57, v213
s_nop 0
s_cmp_lg_u32 s57, 0
s_cbranch_scc1 ATT_h0_pok
s_sleep 20
s_branch ATT_h0_poll
ATT_h0_pok:
buffer_load_dwordx2 v[212:213], v12, s[12:15], s63 offen offset:0 sc1
buffer_load_dwordx2 v[214:215], v12, s[12:15], s63 offen offset:512 sc1
s_mov_b32 s68, s69
buffer_load_dwordx4 v[136:139], v0, s[12:15], s68 offen offset:0 sc1
s_add_u32 s68, s68, 4096
buffer_load_dwordx4 v[168:171], v0, s[12:15], s68 offen offset:0 sc1
s_add_u32 s68, s68, 4096
buffer_load_dwordx4 v[140:143], v0, s[12:15], s68 offen offset:0 sc1
s_add_u32 s68, s68, 4096
buffer_load_dwordx4 v[172:175], v0, s[12:15], s68 offen offset:0 sc1
s_add_u32 s68, s68, 4096
buffer_load_dwordx4 v[144:147], v0, s[12:15], s68 offen offset:0 sc1
s_add_u32 s68, s68, 4096
buffer_load_dwordx4 v[176:179], v0, s[12:15], s68 offen offset:0 sc1
s_add_u32 s68, s68, 4096
buffer_load_dwordx4 v[148:151], v0, s[12:15], s68 offen offset:0 sc1
s_add_u32 s68, s68, 4096
buffer_load_dwordx4 v[180:183], v0, s[12:15], s68 offen offset:0 sc1
s_add_u32 s68, s68, 4096
buffer_load_dwordx4 v[152:155], v0, s[12:15], s68 offen offset:0 sc1
s_add_u32 s68, s68, 4096
buffer_load_dwordx4 v[184:187], v0, s[12:15], s68 offen offset:0 sc1
s_add_u32 s68, s68, 4096
buffer_load_dwordx4 v[156:159], v0, s[12:15], s68 offen offset:0 sc1
s_add_u32 s68, s68, 4096
buffer_load_dwordx4 v[188:191], v0, s[12:15], s68 offen offset:0 sc1
s_add_u32 s68, s68, 4096
buffer_load_dwordx4 v[160:163], v0, s[12:15], s68 offen offset:0 sc1
s_add_u32 s68, s68, 4096
buffer_load_dwordx4 v[192:195], v0, s[12:15], s68 offen offset:0 sc1
s_add_u32 s68, s68, 4096
buffer_load_dwordx4 v[164:167], v0, s[12:15], s68 offen offset:0 sc1
s_add_u32 s68, s68, 4096
buffer_load_dwordx4 v[196:199], v0, s[12:15], s68 offen offset:0 sc1
s_add_u32 s68, s68, 4096
ATT_h0_nomerge:
s_mul_i32 s68, s51, 156
s_lshl_b32 s62, s50, 3
s_add_u32 s68, s68, s62
s_lshl_b32 s68, s68, 13
s_lshl_b32 s62, s3, 10
s_add_u32 s68, s68, s62
s_add_u32 s68, s68, 50331648
v_exp_f32 v92, v92
v_exp_f32 v93, v93
v_exp_f32 v94, v94
v_exp_f32 v95, v95
s_waitcnt lgkmcnt(4)
mA 4,40,28
rB 64,3,6144
v_exp_f32 v100, v100
mA 12,44,28
rB 68,3,7168
v_exp_f32 v101, v101
s_waitcnt lgkmcnt(4)
mA 20,48,28
rB 40,3,8192
v_exp_f32 v102, v102
mA 28,52,28
rB 44,3,9216
v_exp_f32 v103, v103
s_waitcnt lgkmcnt(4)
mA 36,56,28
rB 48,3,10240
cP 36,92,93
mA 44,60,28
rB 52,3,11264
cP 37,94,95
s_waitcnt lgkmcnt(4)
mA 52,64,28
rB 56,3,12288
cP 38,100,101
mA 60,68,28
rB 60,3,13312
cP 39,102,103
v_add_f32 v5, v5, v76
s_waitcnt lgkmcnt(4)
mA 68,40,28
rB 64,3,14336
v_add_f32 v5, v5, v77
mA 76,44,28
rB 68,3,15360
v_add_f32 v5, v5, v78
s_waitcnt lgkmcnt(4)
mA 84,48,28
rB 40,3,16384
v_add_f32 v5, v5, v79
mA 92,52,28
rB 44,3,17408
v_add_f32 v5, v5, v84
s_waitcnt lgkmcnt(4)
mA 100,56,28
rB 48,3,18432
v_add_f32 v5, v5, v85
mA 108,60,28
rB 52,3,19456
v_add_f32 v5, v5, v86
s_waitcnt lgkmcnt(4)
mA 116,64,28
rB 56,3,20480
v_add_f32 v5, v5, v87
mA 124,68,28
rB 60,3,21504
v_add_f32 v5, v5, v92
v_add_f32 v5, v5, v93
s_waitcnt lgkmcnt(4)
mA 4,40,36
rB 64,3,22528
v_add_f32 v5, v5, v94
mA 12,44,36
rB 68,3,23552
v_add_f32 v5, v5, v95
s_waitcnt lgkmcnt(4)
mA 20,48,36
rB 40,3,24576
v_add_f32 v5, v5, v100
mA 28,52,36
rB 44,3,25600
v_add_f32 v5, v5, v101
s_waitcnt lgkmcnt(4)
mA 36,56,36
rB 48,3,26624
v_add_f32 v5, v5, v102
mA 44,60,36
rB 52,3,27648
v_add_f32 v5, v5, v103
s_waitcnt lgkmcnt(4)
mA 52,64,36
rB 56,3,28672
v_mov_b32 v200, v4
mA 60,68,36
rB 60,3,29696
v_mov_b32 v201, v5
v_permlane16_swap_b32 v4, v200
s_waitcnt lgkmcnt(4)
mA 68,40,36
rB 64,3,30720
v_permlane16_swap_b32 v5, v201
mA 76,44,36
rB 68,3,31744
v_add_f32 v4, v4, v200
s_waitcnt lgkmcnt(4)
mA 84,48,36
v_add_f32 v5, v5, v201
mA 92,52,36
v_mov_b32 v200, v4
s_waitcnt lgkmcnt(2)
mA 100,56,36
v_mov_b32 v201, v5
mA 108,60,36
v_permlane32_swap_b32 v4, v200
s_waitcnt lgkmcnt(0)
mA 116,64,36
v_permlane32_swap_b32 v5, v201
mA 124,68,36
v_add_f32 v4, v4, v200
v_add_f32 v5, v5, v201
s_branch ATT_E
ATT_G1:
s_cmp_eq_u32 s54, s53
s_cbranch_scc1 ATT_F1
s_cmp_ge_u32 s57, s53
s_cbranch_scc1 ATT_H1
v_mfma_f32_16x16x32_bf16 v[76:79], v[40:43], v[168:171], v[20:23]
rB 64,3,35840
s_add_u32 m0, s64, 65536
v_mfma_f32_16x16x32_bf16 v[84:87], v[44:47], v[168:171], v[20:23]
rB 68,3,44032
v_exp_f32 v104, v104
v_exp_f32 v105, v105
s_waitcnt lgkmcnt(4)
mV 76,48,172
rB 40,3,36864
v_exp_f32 v106, v106
dS 0,12,65,0
mV 84,52,172
rB 44,3,45056
v_exp_f32 v107, v107
s_waitcnt lgkmcnt(4)
mV 76,56,176
rB 48,3,37888
v_exp_f32 v112, v112
v_exp_f32 v113, v113
mV 84,60,176
rB 52,3,46080
dS 0,12,65,1024
v_exp_f32 v114, v114
s_waitcnt lgkmcnt(4)
mV 76,64,180
rB 56,3,38912
v_exp_f32 v115, v115
cP 24,104,105
mV 84,68,180
rB 60,3,47104
dS 0,12,65,2048
s_waitcnt lgkmcnt(4)
mV 76,40,184
rB 64,3,39936
cP 25,106,107
cP 26,112,113
mV 84,44,184
rB 68,3,48128
cP 27,114,115
dS 0,12,65,3072
s_waitcnt lgkmcnt(4)
mV 76,48,188
rB 40,3,49152
v_exp_f32 v108, v108
mV 84,52,188
rB 44,3,57344
v_exp_f32 v109, v109
v_exp_f32 v110, v110
s_waitcnt lgkmcnt(4)
mV 76,56,192
rB 48,3,50176
s_add_u32 m0, s64, 69632
v_exp_f32 v111, v111
mV 84,60,192
rB 52,3,58368
v_exp_f32 v116, v116
v_exp_f32 v117, v117
s_waitcnt lgkmcnt(4)
mV 76,64,196
rB 56,3,51200
s_add_u32 s65, s65, 4096
mV 84,68,196
rB 60,3,59392
v_exp_f32 v118, v118
v_exp_f32 v119, v119
s_waitcnt lgkmcnt(4)
v_mfma_f32_16x16x32_bf16 v[92:95], v[40:43], v[168:171], v[20:23]
rB 64,3,52224
cP 28,108,109
dS 0,12,65,0
v_mfma_f32_16x16x32_bf16 v[100:103], v[44:47], v[168:171], v[20:23]
rB 68,3,60416
cP 29,110,111
s_waitcnt lgkmcnt(4)
mV 92,48,172
rB 40,3,53248
cP 30,116,117
cP 31,118,119
mV 100,52,172
rB 44,3,61440
dS 0,12,65,1024
v_exp_f32 v120, v120
s_waitcnt lgkmcnt(4)
mV 92,56,176
rB 48,3,54272
v_exp_f32 v121, v121
v_exp_f32 v122, v122
mV 100,60,176
rB 52,3,62464
dS 0,12,65,2048
s_waitcnt lgkmcnt(4)
mV 92,64,180
rB 56,3,55296
v_exp_f32 v123, v123
v_exp_f32 v128, v128
mV 100,68,180
rB 60,3,63488
v_exp_f32 v129, v129
s_cmp_lt_u32 s58, s60
s_cselect_b32 s66, s58, 2147483648
s_waitcnt lgkmcnt(4)
mV 92,40,184
rB 64,3,56320
v_exp_f32 v130, v130
mV 100,44,184
rB 68,3,64512
v_exp_f32 v131, v131
cP 32,120,121
s_waitcnt lgkmcnt(4)
mV 92,48,188
s_add_u32 s58, s58, 32768
cP 33,122,123
mV 100,52,188
cP 34,128,129
cP 35,130,131
s_waitcnt lgkmcnt(2)
mV 92,56,192
s_waitcnt lgkmcnt(0)
s_waitcnt vmcnt(15)
s_barrier
rB 40,2,0
rB 44,2,1024
rB 48,2,2048
rB 52,2,3072
rB 56,2,4096
mV 100,60,192
rB 60,2,5120
dS 0,12,65,3072
mV 92,64,196
mV 100,68,196
s_waitcnt lgkmcnt(4)
s_branch ATT_B1m
ATT_H1:
s_waitcnt vmcnt(0)
s_barrier
rB 40,2,0
rB 44,2,1024
rB 48,2,2048
rB 52,2,3072
rB 56,2,4096
rB 60,2,5120
v_exp_f32 v108, v108
v_exp_f32 v109, v109
v_exp_f32 v110, v110
v_exp_f32 v111, v111
v_exp_f32 v116, v116
v_exp_f32 v117, v117
v_exp_f32 v118, v118
v_exp_f32 v119, v119
cP 28,108,109
cP 29,110,111
cP 30,116,117
cP 31,118,119
v_and_b32 v12, 15, v1
s_lshl_b32 s62, s3, 4
v_add_u32 v12, s62, v12
v_lshlrev_b32 v6, 2, v12
v_lshlrev_b32 v12, 3, v12
s_lshl_b32 s62, s51, 9
s_add_u32 s62, s62, 79953920
s_lshl_b32 s63, s56, 10
s_add_u32 s63, s63, 80740352
buffer_load_dword v14, v6, s[12:15], s62 offen offset:0 sc1
buffer_load_dword v15, v6, s[12:15], s62 offen offset:256 sc1
s_lshr_b32 s69, s50, 1
s_lshl_b32 s69, s69, 8
s_add_u32 s69, s69, 80216096
v_mov_b32 v240, 0
buffer_load_dword v240, v240, s[12:15], s69 offen sc1
s_lshl_b32 s69, s56, 16
s_lshl_b32 s68, s3, 10
s_add_u32 s69, s69, s68
s_add_u32 s69, s69, 83886080
s_cmp_eq_u32 s55, 2
s_cbranch_scc0 ATT_h1_nomerge
s_lshl_b32 s68, s56, 8
s_add_u32 s68, s68, 80216064
v_mov_b32 v212, 0
ATT_h1_poll:
buffer_load_dword v213, v212, s[12:15], s68 offen sc1
s_waitcnt vmcnt(0)
v_readfirstlane_b32 s57, v213
s_nop 0
s_cmp_lg_u32 s57, 0
s_cbranch_scc1 ATT_h1_pok
s_sleep 20
s_branch ATT_h1_poll
ATT_h1_pok:
buffer_load_dwordx2 v[212:213], v12, s[12:15], s63 offen offset:0 sc1
buffer_load_dwordx2 v[214:215], v12, s[12:15], s63 offen offset:512 sc1
s_mov_b32 s68, s69
buffer_load_dwordx4 v[136:139], v0, s[12:15], s68 offen offset:0 sc1
s_add_u32 s68, s68, 4096
buffer_load_dwordx4 v[168:171], v0, s[12:15], s68 offen offset:0 sc1
s_add_u32 s68, s68, 4096
buffer_load_dwordx4 v[140:143], v0, s[12:15], s68 offen offset:0 sc1
s_add_u32 s68, s68, 4096
buffer_load_dwordx4 v[172:175], v0, s[12:15], s68 offen offset:0 sc1
s_add_u32 s68, s68, 4096
buffer_load_dwordx4 v[144:147], v0, s[12:15], s68 offen offset:0 sc1
s_add_u32 s68, s68, 4096
buffer_load_dwordx4 v[176:179], v0, s[12:15], s68 offen offset:0 sc1
s_add_u32 s68, s68, 4096
buffer_load_dwordx4 v[148:151], v0, s[12:15], s68 offen offset:0 sc1
s_add_u32 s68, s68, 4096
buffer_load_dwordx4 v[180:183], v0, s[12:15], s68 offen offset:0 sc1
s_add_u32 s68, s68, 4096
buffer_load_dwordx4 v[152:155], v0, s[12:15], s68 offen offset:0 sc1
s_add_u32 s68, s68, 4096
buffer_load_dwordx4 v[184:187], v0, s[12:15], s68 offen offset:0 sc1
s_add_u32 s68, s68, 4096
buffer_load_dwordx4 v[156:159], v0, s[12:15], s68 offen offset:0 sc1
s_add_u32 s68, s68, 4096
buffer_load_dwordx4 v[188:191], v0, s[12:15], s68 offen offset:0 sc1
s_add_u32 s68, s68, 4096
buffer_load_dwordx4 v[160:163], v0, s[12:15], s68 offen offset:0 sc1
s_add_u32 s68, s68, 4096
buffer_load_dwordx4 v[192:195], v0, s[12:15], s68 offen offset:0 sc1
s_add_u32 s68, s68, 4096
buffer_load_dwordx4 v[164:167], v0, s[12:15], s68 offen offset:0 sc1
s_add_u32 s68, s68, 4096
buffer_load_dwordx4 v[196:199], v0, s[12:15], s68 offen offset:0 sc1
s_add_u32 s68, s68, 4096
ATT_h1_nomerge:
s_mul_i32 s68, s51, 156
s_lshl_b32 s62, s50, 3
s_add_u32 s68, s68, s62
s_lshl_b32 s68, s68, 13
s_lshl_b32 s62, s3, 10
s_add_u32 s68, s68, s62
s_add_u32 s68, s68, 50331648
v_exp_f32 v124, v124
v_exp_f32 v125, v125
v_exp_f32 v126, v126
v_exp_f32 v127, v127
s_waitcnt lgkmcnt(4)
mA 4,40,28
rB 64,2,6144
v_exp_f32 v132, v132
mA 12,44,28
rB 68,2,7168
v_exp_f32 v133, v133
s_waitcnt lgkmcnt(4)
mA 20,48,28
rB 40,2,8192
v_exp_f32 v134, v134
mA 28,52,28
rB 44,2,9216
v_exp_f32 v135, v135
s_waitcnt lgkmcnt(4)
mA 36,56,28
rB 48,2,10240
cP 36,124,125
mA 44,60,28
rB 52,2,11264
cP 37,126,127
s_waitcnt lgkmcnt(4)
mA 52,64,28
rB 56,2,12288
cP 38,132,133
mA 60,68,28
rB 60,2,13312
cP 39,134,135
v_add_f32 v5, v5, v108
s_waitcnt lgkmcnt(4)
mA 68,40,28
rB 64,2,14336
v_add_f32 v5, v5, v109
mA 76,44,28
rB 68,2,15360
v_add_f32 v5, v5, v110
s_waitcnt lgkmcnt(4)
mA 84,48,28
rB 40,2,16384
v_add_f32 v5, v5, v111
mA 92,52,28
rB 44,2,17408
v_add_f32 v5, v5, v116
s_waitcnt lgkmcnt(4)
mA 100,56,28
rB 48,2,18432
v_add_f32 v5, v5, v117
mA 108,60,28
rB 52,2,19456
v_add_f32 v5, v5, v118
s_waitcnt lgkmcnt(4)
mA 116,64,28
rB 56,2,20480
v_add_f32 v5, v5, v119
mA 124,68,28
rB 60,2,21504
v_add_f32 v5, v5, v124
v_add_f32 v5, v5, v125
s_waitcnt lgkmcnt(4)
mA 4,40,36
rB 64,2,22528
v_add_f32 v5, v5, v126
mA 12,44,36
rB 68,2,23552
v_add_f32 v5, v5, v127
s_waitcnt lgkmcnt(4)
mA 20,48,36
rB 40,2,24576
v_add_f32 v5, v5, v132
mA 28,52,36
rB 44,2,25600
v_add_f32 v5, v5, v133
s_waitcnt lgkmcnt(4)
mA 36,56,36
rB 48,2,26624
v_add_f32 v5, v5, v134
mA 44,60,36
rB 52,2,27648
v_add_f32 v5, v5, v135
s_waitcnt lgkmcnt(4)
mA 52,64,36
rB 56,2,28672
v_mov_b32 v200, v4
mA 60,68,36
rB 60,2,29696
v_mov_b32 v201, v5
v_permlane16_swap_b32 v4, v200
s_waitcnt lgkmcnt(4)
mA 68,40,36
rB 64,2,30720
v_permlane16_swap_b32 v5, v201
mA 76,44,36
rB 68,2,31744
v_add_f32 v4, v4, v200
s_waitcnt lgkmcnt(4)
mA 84,48,36
v_add_f32 v5, v5, v201
mA 92,52,36
v_mov_b32 v200, v4
s_waitcnt lgkmcnt(2)
mA 100,56,36
v_mov_b32 v201, v5
mA 108,60,36
v_permlane32_swap_b32 v4, v200
s_waitcnt lgkmcnt(0)
mA 116,64,36
v_permlane32_swap_b32 v5, v201
mA 124,68,36
v_add_f32 v4, v4, v200
v_add_f32 v5, v5, v201
s_branch ATT_E
ATT_F0:
s_waitcnt vmcnt(0)
s_barrier
rB 40,3,0
rB 44,3,1024
rB 48,3,2048
rB 52,3,3072
rB 56,3,4096
rB 60,3,5120
v_exp_f32 v72, v72
v_exp_f32 v73, v73
v_exp_f32 v74, v74
v_exp_f32 v75, v75
v_exp_f32 v80, v80
v_exp_f32 v81, v81
v_exp_f32 v82, v82
v_exp_f32 v83, v83
v_exp_f32 v76, v76
v_exp_f32 v77, v77
v_exp_f32 v78, v78
v_exp_f32 v79, v79
v_exp_f32 v84, v84
v_exp_f32 v85, v85
v_exp_f32 v86, v86
v_exp_f32 v87, v87
cP 24,72,73
cP 25,74,75
cP 26,80,81
cP 27,82,83
cP 28,76,77
cP 29,78,79
cP 30,84,85
cP 31,86,87
v_and_b32 v12, 15, v1
s_lshl_b32 s62, s3, 4
v_add_u32 v12, s62, v12
v_lshlrev_b32 v6, 2, v12
v_lshlrev_b32 v12, 3, v12
s_lshl_b32 s62, s51, 9
s_add_u32 s62, s62, 79953920
s_lshl_b32 s63, s56, 10
s_add_u32 s63, s63, 80740352
buffer_load_dword v14, v6, s[12:15], s62 offen offset:0 sc1
buffer_load_dword v15, v6, s[12:15], s62 offen offset:256 sc1
s_lshr_b32 s69, s50, 1
s_lshl_b32 s69, s69, 8
s_add_u32 s69, s69, 80216096
v_mov_b32 v240, 0
buffer_load_dword v240, v240, s[12:15], s69 offen sc1
s_lshl_b32 s69, s56, 16
s_lshl_b32 s68, s3, 10
s_add_u32 s69, s69, s68
s_add_u32 s69, s69, 83886080
s_cmp_eq_u32 s55, 2
s_cbranch_scc0 ATT_f0_nomerge
s_lshl_b32 s68, s56, 8
s_add_u32 s68, s68, 80216064
v_mov_b32 v212, 0
ATT_f0_poll:
buffer_load_dword v213, v212, s[12:15], s68 offen sc1
s_waitcnt vmcnt(0)
v_readfirstlane_b32 s57, v213
s_nop 0
s_cmp_lg_u32 s57, 0
s_cbranch_scc1 ATT_f0_pok
s_sleep 20
s_branch ATT_f0_poll
ATT_f0_pok:
buffer_load_dwordx2 v[212:213], v12, s[12:15], s63 offen offset:0 sc1
buffer_load_dwordx2 v[214:215], v12, s[12:15], s63 offen offset:512 sc1
s_mov_b32 s68, s69
buffer_load_dwordx4 v[136:139], v0, s[12:15], s68 offen offset:0 sc1
s_add_u32 s68, s68, 4096
buffer_load_dwordx4 v[168:171], v0, s[12:15], s68 offen offset:0 sc1
s_add_u32 s68, s68, 4096
buffer_load_dwordx4 v[140:143], v0, s[12:15], s68 offen offset:0 sc1
s_add_u32 s68, s68, 4096
buffer_load_dwordx4 v[172:175], v0, s[12:15], s68 offen offset:0 sc1
s_add_u32 s68, s68, 4096
buffer_load_dwordx4 v[144:147], v0, s[12:15], s68 offen offset:0 sc1
s_add_u32 s68, s68, 4096
buffer_load_dwordx4 v[176:179], v0, s[12:15], s68 offen offset:0 sc1
s_add_u32 s68, s68, 4096
buffer_load_dwordx4 v[148:151], v0, s[12:15], s68 offen offset:0 sc1
s_add_u32 s68, s68, 4096
buffer_load_dwordx4 v[180:183], v0, s[12:15], s68 offen offset:0 sc1
s_add_u32 s68, s68, 4096
buffer_load_dwordx4 v[152:155], v0, s[12:15], s68 offen offset:0 sc1
s_add_u32 s68, s68, 4096
buffer_load_dwordx4 v[184:187], v0, s[12:15], s68 offen offset:0 sc1
s_add_u32 s68, s68, 4096
buffer_load_dwordx4 v[156:159], v0, s[12:15], s68 offen offset:0 sc1
s_add_u32 s68, s68, 4096
buffer_load_dwordx4 v[188:191], v0, s[12:15], s68 offen offset:0 sc1
s_add_u32 s68, s68, 4096
buffer_load_dwordx4 v[160:163], v0, s[12:15], s68 offen offset:0 sc1
s_add_u32 s68, s68, 4096
buffer_load_dwordx4 v[192:195], v0, s[12:15], s68 offen offset:0 sc1
s_add_u32 s68, s68, 4096
buffer_load_dwordx4 v[164:167], v0, s[12:15], s68 offen offset:0 sc1
s_add_u32 s68, s68, 4096
buffer_load_dwordx4 v[196:199], v0, s[12:15], s68 offen offset:0 sc1
s_add_u32 s68, s68, 4096
ATT_f0_nomerge:
s_mul_i32 s68, s51, 156
s_lshl_b32 s62, s50, 3
s_add_u32 s68, s68, s62
s_lshl_b32 s68, s68, 13
s_lshl_b32 s62, s3, 10
s_add_u32 s68, s68, s62
s_add_u32 s68, s68, 50331648
s_waitcnt lgkmcnt(4)
mA 0,40,24
rB 64,3,6144
rB 68,3,7168
mA 4,40,28
v_exp_f32 v88, v88
mA 12,44,28
v_exp_f32 v89, v89
mA 8,44,24
s_waitcnt lgkmcnt(4)
v_exp_f32 v90, v90
mA 16,48,24
rB 40,3,8192
rB 44,3,9216
mA 20,48,28
v_exp_f32 v91, v91
mA 28,52,28
v_exp_f32 v96, v96
mA 24,52,24
s_waitcnt lgkmcnt(4)
v_exp_f32 v97, v97
mA 32,56,24
rB 48,3,10240
rB 52,3,11264
mA 36,56,28
v_exp_f32 v98, v98
mA 44,60,28
v_exp_f32 v99, v99
mA 40,60,24
s_waitcnt lgkmcnt(4)
cP 32,88,89
cP 33,90,91
mA 48,64,24
rB 56,3,12288
rB 60,3,13312
mA 52,64,28
cP 34,96,97
cP 35,98,99
mA 60,68,28
v_exp_f32 v92, v92
mA 56,68,24
s_waitcnt lgkmcnt(4)
v_exp_f32 v93, v93
mA 64,40,24
rB 64,3,14336
rB 68,3,15360
mA 68,40,28
v_exp_f32 v94, v94
mA 76,44,28
v_exp_f32 v95, v95
mA 72,44,24
s_waitcnt lgkmcnt(4)
v_exp_f32 v100, v100
mA 80,48,24
rB 40,3,16384
rB 44,3,17408
mA 84,48,28
v_exp_f32 v101, v101
mA 92,52,28
v_exp_f32 v102, v102
mA 88,52,24
s_waitcnt lgkmcnt(4)
v_exp_f32 v103, v103
mA 96,56,24
rB 48,3,18432
rB 52,3,19456
mA 100,56,28
cP 36,92,93
cP 37,94,95
mA 108,60,28
cP 38,100,101
cP 39,102,103
mA 104,60,24
s_waitcnt lgkmcnt(4)
v_add_f32 v4, v4, v72
v_add_f32 v5, v5, v76
mA 112,64,24
rB 56,3,20480
rB 60,3,21504
mA 116,64,28
v_add_f32 v4, v4, v73
v_add_f32 v5, v5, v77
mA 124,68,28
v_add_f32 v4, v4, v74
v_add_f32 v5, v5, v78
mA 120,68,24
s_waitcnt lgkmcnt(4)
v_add_f32 v4, v4, v75
v_add_f32 v5, v5, v79
mA 0,40,32
rB 64,3,22528
rB 68,3,23552
mA 4,40,36
v_add_f32 v4, v4, v80
v_add_f32 v5, v5, v84
mA 12,44,36
v_add_f32 v4, v4, v81
v_add_f32 v5, v5, v85
mA 8,44,32
s_waitcnt lgkmcnt(4)
v_add_f32 v4, v4, v82
v_add_f32 v5, v5, v86
mA 16,48,32
rB 40,3,24576
rB 44,3,25600
mA 20,48,36
v_add_f32 v4, v4, v83
v_add_f32 v5, v5, v87
mA 28,52,36
v_add_f32 v4, v4, v88
v_add_f32 v5, v5, v92
mA 24,52,32
s_waitcnt lgkmcnt(4)
v_add_f32 v4, v4, v89
v_add_f32 v5, v5, v93
mA 32,56,32
rB 48,3,26624
rB 52,3,27648
mA 36,56,36
v_add_f32 v4, v4, v90
v_add_f32 v5, v5, v94
mA 44,60,36
v_add_f32 v4, v4, v91
v_add_f32 v5, v5, v95
mA 40,60,32
s_waitcnt lgkmcnt(4)
v_add_f32 v4, v4, v96
v_add_f32 v5, v5, v100
mA 48,64,32
rB 56,3,28672
rB 60,3,29696
mA 52,64,36
v_add_f32 v4, v4, v97
v_add_f32 v5, v5, v101
mA 60,68,36
v_add_f32 v4, v4, v98
v_add_f32 v5, v5, v102
mA 56,68,32
s_waitcnt lgkmcnt(4)
v_add_f32 v4, v4, v99
v_add_f32 v5, v5, v103
mA 64,40,32
rB 64,3,30720
rB 68,3,31744
mA 68,40,36
v_mov_b32 v200, v4
v_mov_b32 v201, v5
mA 76,44,36
v_permlane16_swap_b32 v4, v200
v_permlane16_swap_b32 v5, v201
mA 72,44,32
s_waitcnt lgkmcnt(4)
v_add_f32 v4, v4, v200
v_add_f32 v5, v5, v201
mA 80,48,32
v_mov_b32 v200, v4
v_mov_b32 v201, v5
mA 84,48,36
v_permlane32_swap_b32 v4, v200
v_permlane32_swap_b32 v5, v201
mA 92,52,36
v_add_f32 v4, v4, v200
v_add_f32 v5, v5, v201
mA 88,52,32
s_waitcnt lgkmcnt(2)
mA 96,56,32
mA 100,56,36
mA 108,60,36
mA 104,60,32
s_waitcnt lgkmcnt(0)
mA 112,64,32
mA 116,64,36
mA 124,68,36
mA 120,68,32
s_branch ATT_E
ATT_B0m:
mA 0,40,24
rB 64,3,6144
rB 68,3,7168
mA 4,40,28
s_add_u32 m0, s64, 32768
v_exp_f32 v92, v92
mA 12,44,28
dS 0,12,66,0
mA 8,44,24
s_waitcnt lgkmcnt(4)
v_exp_f32 v93, v93
mA 16,48,24
rB 40,3,8192
rB 44,3,9216
mA 20,48,28
v_exp_f32 v94, v94
mA 28,52,28
s_cmp_lg_u32 s19, 2147483648
s_cbranch_scc1 ATT_hkm
ATT_hkm_ret:
mA 24,52,24
s_waitcnt lgkmcnt(4)
v_exp_f32 v95, v95
mA 32,56,24
rB 48,3,10240
rB 52,3,11264
mA 36,56,28
v_exp_f32 v100, v100
mA 44,60,28
dS 0,12,66,1024
mA 40,60,24
s_waitcnt lgkmcnt(4)
v_exp_f32 v101, v101
mA 48,64,24
rB 56,3,12288
rB 60,3,13312
mA 52,64,28
v_exp_f32 v102, v102
mA 60,68,28
v_exp_f32 v103, v103
mA 56,68,24
s_waitcnt lgkmcnt(4)
cP 36,92,93
cP 37,94,95
mA 64,40,24
rB 64,3,14336
rB 68,3,15360
mA 68,40,28
cP 38,100,101
cP 39,102,103
mA 76,44,28
dS 0,12,66,2048
mA 72,44,24
s_waitcnt lgkmcnt(4)
v_subrev_u32 v9, s67, v12
v_add_f32 v4, v4, v72
mA 80,48,24
rB 40,3,16384
rB 44,3,17408
mA 84,48,28
v_add_u32 v8, 48, v9
s_sub_u32 s67, s67, 64
mA 92,52,28
v_cmp_lt_i32 s[70:71], 48, v8
v_add_f32 v5, v5, v76
mA 88,52,24
s_waitcnt lgkmcnt(4)
v_cmp_lt_i32 s[72:73], 47, v8
v_cmp_lt_i32 s[74:75], 46, v8
mA 96,56,24
rB 48,3,18432
rB 52,3,19456
mA 100,56,28
v_cndmask_b32 v104, v104, v13, s[70:71]
v_cndmask_b32 v105, v105, v13, s[72:73]
mA 108,60,28
dS 0,12,66,3072
mA 104,60,24
s_waitcnt lgkmcnt(4)
v_add_f32 v4, v4, v73
v_cndmask_b32 v106, v106, v13, s[74:75]
mA 112,64,24
rB 56,3,20480
rB 60,3,21504
mA 116,64,28
s_add_u32 m0, s64, 36864
v_cmp_lt_i32 s[70:71], 45, v8
v_cmp_lt_i32 s[72:73], 64, v9
mA 124,68,28
s_add_u32 s66, s66, 4096
v_cmp_lt_i32 s[74:75], 63, v9
v_add_f32 v5, v5, v77
mA 120,68,24
s_waitcnt lgkmcnt(4)
v_cndmask_b32 v107, v107, v13, s[70:71]
v_cndmask_b32 v108, v108, v13, s[72:73]
mA 0,40,32
rB 64,3,22528
rB 68,3,23552
mA 4,40,36
v_cndmask_b32 v109, v109, v13, s[74:75]
v_cmp_lt_i32 s[70:71], 62, v9
mA 12,44,36
dS 0,12,66,0
mA 8,44,32
s_waitcnt lgkmcnt(4)
v_add_f32 v4, v4, v74
v_cmp_lt_i32 s[72:73], 61, v9
mA 16,48,32
rB 40,3,24576
rB 44,3,25600
mA 20,48,36
v_cmp_lt_i32 s[74:75], 32, v8
v_cndmask_b32 v110, v110, v13, s[70:71]
mA 28,52,36
v_cndmask_b32 v111, v111, v13, s[72:73]
v_add_f32 v5, v5, v78
mA 24,52,32
s_waitcnt lgkmcnt(4)
v_cndmask_b32 v112, v112, v13, s[74:75]
v_cmp_lt_i32 s[70:71], 31, v8
mA 32,56,32
rB 48,3,26624
rB 52,3,27648
mA 36,56,36
v_cmp_lt_i32 s[72:73], 30, v8
v_cmp_lt_i32 s[74:75], 29, v8
mA 44,60,36
dS 0,12,66,1024
mA 40,60,32
s_waitcnt lgkmcnt(4)
v_add_f32 v4, v4, v75
v_cndmask_b32 v113, v113, v13, s[70:71]
mA 48,64,32
rB 56,3,28672
rB 60,3,29696
mA 52,64,36
v_cndmask_b32 v114, v114, v13, s[72:73]
v_cndmask_b32 v115, v115, v13, s[74:75]
mA 60,68,36
v_add_f32 v5, v5, v79
v_cmp_lt_i32 s[70:71], 48, v9
mA 56,68,32
s_waitcnt lgkmcnt(4)
v_cmp_lt_i32 s[72:73], 47, v9
v_cmp_lt_i32 s[74:75], 46, v9
mA 64,40,32
rB 64,3,30720
rB 68,3,31744
mA 68,40,36
v_cndmask_b32 v116, v116, v13, s[70:71]
v_add_f32 v4, v4, v80
mA 76,44,36
dS 0,12,66,2048
mA 72,44,32
s_waitcnt lgkmcnt(4)
v_cndmask_b32 v117, v117, v13, s[72:73]
v_cndmask_b32 v118, v118, v13, s[74:75]
mA 80,48,32
v_cmp_lt_i32 s[70:71], 45, v9
v_cmp_lt_i32 s[72:73], 16, v8
mA 84,48,36
s_cmp_lt_u32 s59, s61
s_cselect_b32 s65, s59, 2147483648
v_add_f32 v5, v5, v84
mA 92,52,36
s_add_u32 s59, s59, 32768
v_cmp_lt_i32 s[74:75], 15, v8
v_cndmask_b32 v119, v119, v13, s[70:71]
mA 88,52,32
s_waitcnt lgkmcnt(2)
v_cndmask_b32 v120, v120, v13, s[72:73]
v_cndmask_b32 v121, v121, v13, s[74:75]
mA 96,56,32
s_add_u32 s57, s57, 1
v_add_f32 v4, v4, v81
v_cmp_lt_i32 s[70:71], 14, v8
mA 100,56,36
s_waitcnt lgkmcnt(0)
s_waitcnt vmcnt(15)
s_barrier
mA 108,60,36
rB 40,3,32768
rB 44,3,40960
mA 104,60,32
rB 48,3,33792
rB 52,3,41984
mA 112,64,32
s_cmp_ge_u32 s57, s33
v_cmp_lt_i32 s[72:73], 13, v8
v_cmp_lt_i32 s[74:75], 32, v9
mA 116,64,36
rB 56,3,34816
rB 60,3,43008
mA 124,68,36
dS 0,12,66,3072
mA 120,68,32
s_waitcnt lgkmcnt(4)
v_cndmask_b32 v122, v122, v13, s[70:71]
v_add_f32 v5, v5, v85
v_cndmask_b32 v123, v123, v13, s[72:73]
v_cndmask_b32 v124, v124, v13, s[74:75]
v_cmp_lt_i32 s[70:71], 31, v9
v_cmp_lt_i32 s[72:73], 30, v9
v_add_f32 v4, v4, v82
v_cmp_lt_i32 s[74:75], 29, v9
v_cndmask_b32 v125, v125, v13, s[70:71]
v_cndmask_b32 v126, v126, v13, s[72:73]
v_add_f32 v5, v5, v86
v_cndmask_b32 v127, v127, v13, s[74:75]
v_cmp_lt_i32 s[70:71], 0, v8
v_cmp_lt_i32 s[72:73], -1, v8
v_cmp_lt_i32 s[74:75], -2, v8
v_add_f32 v4, v4, v83
v_cndmask_b32 v128, v128, v13, s[70:71]
v_cndmask_b32 v129, v129, v13, s[72:73]
v_cndmask_b32 v130, v130, v13, s[74:75]
v_cmp_lt_i32 s[70:71], -3, v8
v_add_f32 v5, v5, v87
v_cmp_lt_i32 s[72:73], 64, v8
v_cmp_lt_i32 s[74:75], 63, v8
v_cndmask_b32 v131, v131, v13, s[70:71]
v_cndmask_b32 v132, v132, v13, s[72:73]
v_add_f32 v4, v4, v88
v_cndmask_b32 v133, v133, v13, s[74:75]
v_cmp_lt_i32 s[70:71], 62, v8
v_cmp_lt_i32 s[72:73], 61, v8
s_nop 0
v_cndmask_b32 v134, v134, v13, s[70:71]
v_add_f32 v5, v5, v92
v_cndmask_b32 v135, v135, v13, s[72:73]
v_add_f32 v4, v4, v89
v_max3_f32 v6, v104, v105, v106
v_max3_f32 v7, v107, v108, v109
v_add_f32 v5, v5, v93
v_max3_f32 v6, v6, v110, v111
v_max3_f32 v7, v7, v112, v113
v_add_f32 v4, v4, v90
v_max3_f32 v6, v6, v114, v115
v_add_f32 v5, v5, v94
v_max3_f32 v7, v7, v116, v117
v_max3_f32 v6, v6, v118, v119
v_add_f32 v4, v4, v91
v_max3_f32 v7, v7, v120, v121
v_max3_f32 v6, v6, v122, v123
v_add_f32 v5, v5, v95
v_max3_f32 v7, v7, v124, v125
v_add_f32 v4, v4, v96
v_max3_f32 v6, v6, v126, v127
v_max3_f32 v7, v7, v128, v129
v_add_f32 v5, v5, v100
v_max3_f32 v6, v6, v130, v131
v_max3_f32 v7, v7, v132, v133
v_add_f32 v4, v4, v97
v_max3_f32 v6, v6, v134, v135
v_add_f32 v5, v5, v101
v_max_f32 v6, v6, v7
v_cmp_lt_f32 vcc, 0x41000000, v6
v_add_f32 v4, v4, v98
v_add_f32 v5, v5, v102
v_add_f32 v4, v4, v99
v_add_f32 v5, v5, v103
s_cbranch_vccnz ATT_S1
s_branch ATT_D1
ATT_B1m:
mA 0,40,24
rB 64,2,6144
rB 68,2,7168
mA 4,40,28
s_add_u32 m0, s64, 98304
v_exp_f32 v124, v124
mA 12,44,28
dS 0,12,66,0
mA 8,44,24
s_waitcnt lgkmcnt(4)
v_exp_f32 v125, v125
mA 16,48,24
rB 40,2,8192
rB 44,2,9216
mA 20,48,28
v_exp_f32 v126, v126
mA 28,52,28
v_exp_f32 v127, v127
mA 24,52,24
s_waitcnt lgkmcnt(4)
v_exp_f32 v132, v132
mA 32,56,24
rB 48,2,10240
rB 52,2,11264
mA 36,56,28
v_exp_f32 v133, v133
mA 44,60,28
dS 0,12,66,1024
mA 40,60,24
s_waitcnt lgkmcnt(4)
v_exp_f32 v134, v134
mA 48,64,24
rB 56,2,12288
rB 60,2,13312
mA 52,64,28
v_exp_f32 v135, v135
mA 60,68,28
cP 36,124,125
cP 37,126,127
mA 56,68,24
s_waitcnt lgkmcnt(4)
cP 38,132,133
cP 39,134,135
mA 64,40,24
rB 64,2,14336
rB 68,2,15360
mA 68,40,28
v_subrev_u32 v9, s67, v12
v_add_f32 v4, v4, v104
mA 76,44,28
dS 0,12,66,2048
mA 72,44,24
s_waitcnt lgkmcnt(4)
v_add_u32 v8, 48, v9
s_sub_u32 s67, s67, 64
mA 80,48,24
rB 40,2,16384
rB 44,2,17408
mA 84,48,28
v_cmp_lt_i32 s[70:71], 48, v8
v_add_f32 v5, v5, v108
mA 92,52,28
v_cmp_lt_i32 s[72:73], 47, v8
v_cmp_lt_i32 s[74:75], 46, v8
mA 88,52,24
s_waitcnt lgkmcnt(4)
v_cndmask_b32 v72, v72, v13, s[70:71]
v_cndmask_b32 v73, v73, v13, s[72:73]
mA 96,56,24
rB 48,2,18432
rB 52,2,19456
mA 100,56,28
v_add_f32 v4, v4, v105
v_cndmask_b32 v74, v74, v13, s[74:75]
mA 108,60,28
dS 0,12,66,3072
mA 104,60,24
s_waitcnt lgkmcnt(4)
v_cmp_lt_i32 s[70:71], 45, v8
v_cmp_lt_i32 s[72:73], 64, v9
mA 112,64,24
rB 56,2,20480
rB 60,2,21504
mA 116,64,28
s_add_u32 m0, s64, 102400
v_cmp_lt_i32 s[74:75], 63, v9
v_add_f32 v5, v5, v109
mA 124,68,28
s_add_u32 s66, s66, 4096
v_cndmask_b32 v75, v75, v13, s[70:71]
v_cndmask_b32 v76, v76, v13, s[72:73]
mA 120,68,24
s_waitcnt lgkmcnt(4)
v_cndmask_b32 v77, v77, v13, s[74:75]
v_cmp_lt_i32 s[70:71], 62, v9
mA 0,40,32
rB 64,2,22528
rB 68,2,23552
mA 4,40,36
v_add_f32 v4, v4, v106
v_cmp_lt_i32 s[72:73], 61, v9
mA 12,44,36
dS 0,12,66,0
mA 8,44,32
s_waitcnt lgkmcnt(4)
v_cmp_lt_i32 s[74:75], 32, v8
v_cndmask_b32 v78, v78, v13, s[70:71]
mA 16,48,32
rB 40,2,24576
rB 44,2,25600
mA 20,48,36
v_cndmask_b32 v79, v79, v13, s[72:73]
v_add_f32 v5, v5, v110
mA 28,52,36
v_cndmask_b32 v80, v80, v13, s[74:75]
v_cmp_lt_i32 s[70:71], 31, v8
mA 24,52,32
s_waitcnt lgkmcnt(4)
v_cmp_lt_i32 s[72:73], 30, v8
v_cmp_lt_i32 s[74:75], 29, v8
mA 32,56,32
rB 48,2,26624
rB 52,2,27648
mA 36,56,36
v_add_f32 v4, v4, v107
v_cndmask_b32 v81, v81, v13, s[70:71]
mA 44,60,36
dS 0,12,66,1024
mA 40,60,32
s_waitcnt lgkmcnt(4)
v_cndmask_b32 v82, v82, v13, s[72:73]
v_cndmask_b32 v83, v83, v13, s[74:75]
mA 48,64,32
rB 56,2,28672
rB 60,2,29696
mA 52,64,36
v_add_f32 v5, v5, v111
v_cmp_lt_i32 s[70:71], 48, v9
mA 60,68,36
v_cmp_lt_i32 s[72:73], 47, v9
v_cmp_lt_i32 s[74:75], 46, v9
mA 56,68,32
s_waitcnt lgkmcnt(4)
v_cndmask_b32 v84, v84, v13, s[70:71]
v_add_f32 v4, v4, v112
mA 64,40,32
rB 64,2,30720
rB 68,2,31744
mA 68,40,36
v_cndmask_b32 v85, v85, v13, s[72:73]
v_cndmask_b32 v86, v86, v13, s[74:75]
mA 76,44,36
dS 0,12,66,2048
mA 72,44,32
s_waitcnt lgkmcnt(4)
v_cmp_lt_i32 s[70:71], 45, v9
v_cmp_lt_i32 s[72:73], 16, v8
mA 80,48,32
v_add_f32 v5, v5, v116
v_cmp_lt_i32 s[74:75], 15, v8
mA 84,48,36
s_cmp_lt_u32 s59, s61
s_cselect_b32 s65, s59, 2147483648
v_cndmask_b32 v87, v87, v13, s[70:71]
mA 92,52,36
s_add_u32 s59, s59, 32768
v_cndmask_b32 v88, v88, v13, s[72:73]
v_cndmask_b32 v89, v89, v13, s[74:75]
mA 88,52,32
s_waitcnt lgkmcnt(2)
v_add_f32 v4, v4, v113
v_cmp_lt_i32 s[70:71], 14, v8
mA 96,56,32
s_add_u32 s57, s57, 1
v_cmp_lt_i32 s[72:73], 13, v8
v_cmp_lt_i32 s[74:75], 32, v9
mA 100,56,36
s_waitcnt lgkmcnt(0)
s_waitcnt vmcnt(15)
s_barrier
mA 108,60,36
rB 40,2,32768
rB 44,2,40960
mA 104,60,32
rB 48,2,33792
rB 52,2,41984
mA 112,64,32
s_cmp_ge_u32 s57, s33
v_cndmask_b32 v90, v90, v13, s[70:71]
v_add_f32 v5, v5, v117
mA 116,64,36
rB 56,2,34816
rB 60,2,43008
mA 124,68,36
dS 0,12,66,3072
mA 120,68,32
s_waitcnt lgkmcnt(4)
v_cndmask_b32 v91, v91, v13, s[72:73]
v_cndmask_b32 v92, v92, v13, s[74:75]
v_cmp_lt_i32 s[70:71], 31, v9
v_cmp_lt_i32 s[72:73], 30, v9
v_add_f32 v4, v4, v114
v_cmp_lt_i32 s[74:75], 29, v9
v_cndmask_b32 v93, v93, v13, s[70:71]
v_cndmask_b32 v94, v94, v13, s[72:73]
v_add_f32 v5, v5, v118
v_cndmask_b32 v95, v95, v13, s[74:75]
v_cmp_lt_i32 s[70:71], 0, v8
v_cmp_lt_i32 s[72:73], -1, v8
v_cmp_lt_i32 s[74:75], -2, v8
v_add_f32 v4, v4, v115
v_cndmask_b32 v96, v96, v13, s[70:71]
v_cndmask_b32 v97, v97, v13, s[72:73]
v_cndmask_b32 v98, v98, v13, s[74:75]
v_cmp_lt_i32 s[70:71], -3, v8
v_add_f32 v5, v5, v119
v_cmp_lt_i32 s[72:73], 64, v8
v_cmp_lt_i32 s[74:75], 63, v8
v_cndmask_b32 v99, v99, v13, s[70:71]
v_cndmask_b32 v100, v100, v13, s[72:73]
v_add_f32 v4, v4, v120
v_cndmask_b32 v101, v101, v13, s[74:75]
v_cmp_lt_i32 s[70:71], 62, v8
v_cmp_lt_i32 s[72:73], 61, v8
s_nop 0
v_cndmask_b32 v102, v102, v13, s[70:71]
v_add_f32 v5, v5, v124
v_cndmask_b32 v103, v103, v13, s[72:73]
v_add_f32 v4, v4, v121
v_max3_f32 v6, v72, v73, v74
v_max3_f32 v7, v75, v76, v77
v_add_f32 v5, v5, v125
v_max3_f32 v6, v6, v78, v79
v_max3_f32 v7, v7, v80, v81
v_add_f32 v4, v4, v122
v_max3_f32 v6, v6, v82, v83
v_add_f32 v5, v5, v126
v_max3_f32 v7, v7, v84, v85
v_max3_f32 v6, v6, v86, v87
v_add_f32 v4, v4, v123
v_max3_f32 v7, v7, v88, v89
v_max3_f32 v6, v6, v90, v91
v_add_f32 v5, v5, v127
v_max3_f32 v7, v7, v92, v93
v_add_f32 v4, v4, v128
v_max3_f32 v6, v6, v94, v95
v_max3_f32 v7, v7, v96, v97
v_add_f32 v5, v5, v132
v_max3_f32 v6, v6, v98, v99
v_max3_f32 v7, v7, v100, v101
v_add_f32 v4, v4, v129
v_max3_f32 v6, v6, v102, v103
v_add_f32 v5, v5, v133
v_max_f32 v6, v6, v7
v_cmp_lt_f32 vcc, 0x41000000, v6
v_add_f32 v4, v4, v130
v_add_f32 v5, v5, v134
v_add_f32 v4, v4, v131
v_add_f32 v5, v5, v135
s_cbranch_vccnz ATT_S0
s_branch ATT_D0
ATT_S0:
s_nop 7
v_max3_f32 v200, v72, v73, v74
v_max3_f32 v201, v76, v77, v78
v_max3_f32 v200, v200, v75, v80
v_max3_f32 v201, v201, v79, v84
v_max3_f32 v200, v200, v81, v82
v_max3_f32 v201, v201, v85, v86
v_max3_f32 v200, v200, v83, v88
v_max3_f32 v201, v201, v87, v92
v_max3_f32 v200, v200, v89, v90
v_max3_f32 v201, v201, v93, v94
v_max3_f32 v200, v200, v91, v96
v_max3_f32 v201, v201, v95, v100
v_max3_f32 v200, v200, v97, v98
v_max3_f32 v201, v201, v101, v102
v_max_f32 v200, v200, v99
v_max_f32 v201, v201, v103
v_mov_b32 v202, v200
v_mov_b32 v203, v201
s_nop 0
v_permlane16_swap_b32 v200, v202
v_permlane16_swap_b32 v201, v203
v_max_f32 v200, v200, v202
v_max_f32 v201, v201, v203
v_mov_b32 v202, v200
v_mov_b32 v203, v201
s_nop 0
v_permlane32_swap_b32 v200, v202
v_permlane32_swap_b32 v201, v203
v_max_f32 v200, v200, v202
v_max_f32 v201, v201, v203
v_max_f32 v200, 0, v200
v_max_f32 v201, 0, v201
v_sub_f32 v16, v16, v200
v_sub_f32 v17, v17, v200
v_sub_f32 v18, v18, v200
v_sub_f32 v19, v19, v200
v_sub_f32 v20, v20, v201
v_sub_f32 v21, v21, v201
v_sub_f32 v22, v22, v201
v_sub_f32 v23, v23, v201
v_sub_f32 v72, v72, v200
v_sub_f32 v73, v73, v200
v_sub_f32 v74, v74, v200
v_sub_f32 v75, v75, v200
v_sub_f32 v76, v76, v201
v_sub_f32 v77, v77, v201
v_sub_f32 v78, v78, v201
v_sub_f32 v79, v79, v201
v_sub_f32 v80, v80, v200
v_sub_f32 v81, v81, v200
v_sub_f32 v82, v82, v200
v_sub_f32 v83, v83, v200
v_sub_f32 v84, v84, v201
v_sub_f32 v85, v85, v201
v_sub_f32 v86, v86, v201
v_sub_f32 v87, v87, v201
v_sub_f32 v88, v88, v200
v_sub_f32 v89, v89, v200
v_sub_f32 v90, v90, v200
v_sub_f32 v91, v91, v200
v_sub_f32 v92, v92, v201
v_sub_f32 v93, v93, v201
v_sub_f32 v94, v94, v201
v_sub_f32 v95, v95, v201
v_sub_f32 v96, v96, v200
v_sub_f32 v97, v97, v200
v_sub_f32 v98, v98, v200
v_sub_f32 v99, v99, v200
v_sub_f32 v100, v100, v201
v_sub_f32 v101, v101, v201
v_sub_f32 v102, v102, v201
v_sub_f32 v103, v103, v201
v_exp_f32 v202, -v200
v_exp_f32 v203, -v201
v_mul_f32 v4, v4, v202
v_mul_f32 v5, v5, v203
aR 204,0
aR 205,1
aR 206,2
aR 207,3
v_mul_f32 v204, v204, v202
v_mul_f32 v205, v205, v202
v_mul_f32 v206, v206, v202
v_mul_f32 v207, v207, v202
aW 0,204
aW 1,205
aW 2,206
aW 3,207
aR 208,4
aR 209,5
aR 210,6
aR 211,7
v_mul_f32 v208, v208, v203
v_mul_f32 v209, v209, v203
v_mul_f32 v210, v210, v203
v_mul_f32 v211, v211, v203
aW 4,208
aW 5,209
aW 6,210
aW 7,211
aR 204,8
aR 205,9
aR 206,10
aR 207,11
v_mul_f32 v204, v204, v202
v_mul_f32 v205, v205, v202
v_mul_f32 v206, v206, v202
v_mul_f32 v207, v207, v202
aW 8,204
aW 9,205
aW 10,206
aW 11,207
aR 208,12
aR 209,13
aR 210,14
aR 211,15
v_mul_f32 v208, v208, v203
v_mul_f32 v209, v209, v203
v_mul_f32 v210, v210, v203
v_mul_f32 v211, v211, v203
aW 12,208
aW 13,209
aW 14,210
aW 15,211
aR 204,16
aR 205,17
aR 206,18
aR 207,19
v_mul_f32 v204, v204, v202
v_mul_f32 v205, v205, v202
v_mul_f32 v206, v206, v202
v_mul_f32 v207, v207, v202
aW 16,204
aW 17,205
aW 18,206
aW 19,207
aR 208,20
aR 209,21
aR 210,22
aR 211,23
v_mul_f32 v208, v208, v203
v_mul_f32 v209, v209, v203
v_mul_f32 v210, v210, v203
v_mul_f32 v211, v211, v203
aW 20,208
aW 21,209
aW 22,210
aW 23,211
aR 204,24
aR 205,25
aR 206,26
aR 207,27
v_mul_f32 v204, v204, v202
v_mul_f32 v205, v205, v202
v_mul_f32 v206, v206, v202
v_mul_f32 v207, v207, v202
aW 24,204
aW 25,205
aW 26,206
aW 27,207
aR 208,28
aR 209,29
aR 210,30
aR 211,31
v_mul_f32 v208, v208, v203
v_mul_f32 v209, v209, v203
v_mul_f32 v210, v210, v203
v_mul_f32 v211, v211, v203
aW 28,208
aW 29,209
aW 30,210
aW 31,211
aR 204,32
aR 205,33
aR 206,34
aR 207,35
v_mul_f32 v204, v204, v202
v_mul_f32 v205, v205, v202
v_mul_f32 v206, v206, v202
v_mul_f32 v207, v207, v202
aW 32,204
aW 33,205
aW 34,206
aW 35,207
aR 208,36
aR 209,37
aR 210,38
aR 211,39
v_mul_f32 v208, v208, v203
v_mul_f32 v209, v209, v203
v_mul_f32 v210, v210, v203
v_mul_f32 v211, v211, v203
aW 36,208
aW 37,209
aW 38,210
aW 39,211
aR 204,40
aR 205,41
aR 206,42
aR 207,43
v_mul_f32 v204, v204, v202
v_mul_f32 v205, v205, v202
v_mul_f32 v206, v206, v202
v_mul_f32 v207, v207, v202
aW 40,204
aW 41,205
aW 42,206
aW 43,207
aR 208,44
aR 209,45
aR 210,46
aR 211,47
v_mul_f32 v208, v208, v203
v_mul_f32 v209, v209, v203
v_mul_f32 v210, v210, v203
v_mul_f32 v211, v211, v203
aW 44,208
aW 45,209
aW 46,210
aW 47,211
aR 204,48
aR 205,49
aR 206,50
aR 207,51
v_mul_f32 v204, v204, v202
v_mul_f32 v205, v205, v202
v_mul_f32 v206, v206, v202
v_mul_f32 v207, v207, v202
aW 48,204
aW 49,205
aW 50,206
aW 51,207
aR 208,52
aR 209,53
aR 210,54
aR 211,55
v_mul_f32 v208, v208, v203
v_mul_f32 v209, v209, v203
v_mul_f32 v210, v210, v203
v_mul_f32 v211, v211, v203
aW 52,208
aW 53,209
aW 54,210
aW 55,211
aR 204,56
aR 205,57
aR 206,58
aR 207,59
v_mul_f32 v204, v204, v202
v_mul_f32 v205, v205, v202
v_mul_f32 v206, v206, v202
v_mul_f32 v207, v207, v202
aW 56,204
aW 57,205
aW 58,206
aW 59,207
aR 208,60
aR 209,61
aR 210,62
aR 211,63
v_mul_f32 v208, v208, v203
v_mul_f32 v209, v209, v203
v_mul_f32 v210, v210, v203
v_mul_f32 v211, v211, v203
aW 60,208
aW 61,209
aW 62,210
aW 63,211
aR 204,64
aR 205,65
aR 206,66
aR 207,67
v_mul_f32 v204, v204, v202
v_mul_f32 v205, v205, v202
v_mul_f32 v206, v206, v202
v_mul_f32 v207, v207, v202
aW 64,204
aW 65,205
aW 66,206
aW 67,207
aR 208,68
aR 209,69
aR 210,70
aR 211,71
v_mul_f32 v208, v208, v203
v_mul_f32 v209, v209, v203
v_mul_f32 v210, v210, v203
v_mul_f32 v211, v211, v203
aW 68,208
aW 69,209
aW 70,210
aW 71,211
aR 204,72
aR 205,73
aR 206,74
aR 207,75
v_mul_f32 v204, v204, v202
v_mul_f32 v205, v205, v202
v_mul_f32 v206, v206, v202
v_mul_f32 v207, v207, v202
aW 72,204
aW 73,205
aW 74,206
aW 75,207
aR 208,76
aR 209,77
aR 210,78
aR 211,79
v_mul_f32 v208, v208, v203
v_mul_f32 v209, v209, v203
v_mul_f32 v210, v210, v203
v_mul_f32 v211, v211, v203
aW 76,208
aW 77,209
aW 78,210
aW 79,211
aR 204,80
aR 205,81
aR 206,82
aR 207,83
v_mul_f32 v204, v204, v202
v_mul_f32 v205, v205, v202
v_mul_f32 v206, v206, v202
v_mul_f32 v207, v207, v202
aW 80,204
aW 81,205
aW 82,206
aW 83,207
aR 208,84
aR 209,85
aR 210,86
aR 211,87
v_mul_f32 v208, v208, v203
v_mul_f32 v209, v209, v203
v_mul_f32 v210, v210, v203
v_mul_f32 v211, v211, v203
aW 84,208
aW 85,209
aW 86,210
aW 87,211
aR 204,88
aR 205,89
aR 206,90
aR 207,91
v_mul_f32 v204, v204, v202
v_mul_f32 v205, v205, v202
v_mul_f32 v206, v206, v202
v_mul_f32 v207, v207, v202
aW 88,204
aW 89,205
aW 90,206
aW 91,207
aR 208,92
aR 209,93
aR 210,94
aR 211,95
v_mul_f32 v208, v208, v203
v_mul_f32 v209, v209, v203
v_mul_f32 v210, v210, v203
v_mul_f32 v211, v211, v203
aW 92,208
aW 93,209
aW 94,210
aW 95,211
aR 204,96
aR 205,97
aR 206,98
aR 207,99
v_mul_f32 v204, v204, v202
v_mul_f32 v205, v205, v202
v_mul_f32 v206, v206, v202
v_mul_f32 v207, v207, v202
aW 96,204
aW 97,205
aW 98,206
aW 99,207
aR 208,100
aR 209,101
aR 210,102
aR 211,103
v_mul_f32 v208, v208, v203
v_mul_f32 v209, v209, v203
v_mul_f32 v210, v210, v203
v_mul_f32 v211, v211, v203
aW 100,208
aW 101,209
aW 102,210
aW 103,211
aR 204,104
aR 205,105
aR 206,106
aR 207,107
v_mul_f32 v204, v204, v202
v_mul_f32 v205, v205, v202
v_mul_f32 v206, v206, v202
v_mul_f32 v207, v207, v202
aW 104,204
aW 105,205
aW 106,206
aW 107,207
aR 208,108
aR 209,109
aR 210,110
aR 211,111
v_mul_f32 v208, v208, v203
v_mul_f32 v209, v209, v203
v_mul_f32 v210, v210, v203
v_mul_f32 v211, v211, v203
aW 108,208
aW 109,209
aW 110,210
aW 111,211
aR 204,112
aR 205,113
aR 206,114
aR 207,115
v_mul_f32 v204, v204, v202
v_mul_f32 v205, v205, v202
v_mul_f32 v206, v206, v202
v_mul_f32 v207, v207, v202
aW 112,204
aW 113,205
aW 114,206
aW 115,207
aR 208,116
aR 209,117
aR 210,118
aR 211,119
v_mul_f32 v208, v208, v203
v_mul_f32 v209, v209, v203
v_mul_f32 v210, v210, v203
v_mul_f32 v211, v211, v203
aW 116,208
aW 117,209
aW 118,210
aW 119,211
aR 204,120
aR 205,121
aR 206,122
aR 207,123
v_mul_f32 v204, v204, v202
v_mul_f32 v205, v205, v202
v_mul_f32 v206, v206, v202
v_mul_f32 v207, v207, v202
aW 120,204
aW 121,205
aW 122,206
aW 123,207
aR 208,124
aR 209,125
aR 210,126
aR 211,127
v_mul_f32 v208, v208, v203
v_mul_f32 v209, v209, v203
v_mul_f32 v210, v210, v203
v_mul_f32 v211, v211, v203
aW 124,208
aW 125,209
aW 126,210
aW 127,211
s_nop 1
s_cmp_ge_u32 s57, s33
s_branch ATT_D0
ATT_S1:
s_nop 7
v_max3_f32 v200, v104, v105, v106
v_max3_f32 v201, v108, v109, v110
v_max3_f32 v200, v200, v107, v112
v_max3_f32 v201, v201, v111, v116
v_max3_f32 v200, v200, v113, v114
v_max3_f32 v201, v201, v117, v118
v_max3_f32 v200, v200, v115, v120
v_max3_f32 v201, v201, v119, v124
v_max3_f32 v200, v200, v121, v122
v_max3_f32 v201, v201, v125, v126
v_max3_f32 v200, v200, v123, v128
v_max3_f32 v201, v201, v127, v132
v_max3_f32 v200, v200, v129, v130
v_max3_f32 v201, v201, v133, v134
v_max_f32 v200, v200, v131
v_max_f32 v201, v201, v135
v_mov_b32 v202, v200
v_mov_b32 v203, v201
s_nop 0
v_permlane16_swap_b32 v200, v202
v_permlane16_swap_b32 v201, v203
v_max_f32 v200, v200, v202
v_max_f32 v201, v201, v203
v_mov_b32 v202, v200
v_mov_b32 v203, v201
s_nop 0
v_permlane32_swap_b32 v200, v202
v_permlane32_swap_b32 v201, v203
v_max_f32 v200, v200, v202
v_max_f32 v201, v201, v203
v_max_f32 v200, 0, v200
v_max_f32 v201, 0, v201
v_sub_f32 v16, v16, v200
v_sub_f32 v17, v17, v200
v_sub_f32 v18, v18, v200
v_sub_f32 v19, v19, v200
v_sub_f32 v20, v20, v201
v_sub_f32 v21, v21, v201
v_sub_f32 v22, v22, v201
v_sub_f32 v23, v23, v201
v_sub_f32 v104, v104, v200
v_sub_f32 v105, v105, v200
v_sub_f32 v106, v106, v200
v_sub_f32 v107, v107, v200
v_sub_f32 v108, v108, v201
v_sub_f32 v109, v109, v201
v_sub_f32 v110, v110, v201
v_sub_f32 v111, v111, v201
v_sub_f32 v112, v112, v200
v_sub_f32 v113, v113, v200
v_sub_f32 v114, v114, v200
v_sub_f32 v115, v115, v200
v_sub_f32 v116, v116, v201
v_sub_f32 v117, v117, v201
v_sub_f32 v118, v118, v201
v_sub_f32 v119, v119, v201
v_sub_f32 v120, v120, v200
v_sub_f32 v121, v121, v200
v_sub_f32 v122, v122, v200
v_sub_f32 v123, v123, v200
v_sub_f32 v124, v124, v201
v_sub_f32 v125, v125, v201
v_sub_f32 v126, v126, v201
v_sub_f32 v127, v127, v201
v_sub_f32 v128, v128, v200
v_sub_f32 v129, v129, v200
v_sub_f32 v130, v130, v200
v_sub_f32 v131, v131, v200
v_sub_f32 v132, v132, v201
v_sub_f32 v133, v133, v201
v_sub_f32 v134, v134, v201
v_sub_f32 v135, v135, v201
v_exp_f32 v202, -v200
v_exp_f32 v203, -v201
v_mul_f32 v4, v4, v202
v_mul_f32 v5, v5, v203
aR 204,0
aR 205,1
aR 206,2
aR 207,3
v_mul_f32 v204, v204, v202
v_mul_f32 v205, v205, v202
v_mul_f32 v206, v206, v202
v_mul_f32 v207, v207, v202
aW 0,204
aW 1,205
aW 2,206
aW 3,207
aR 208,4
aR 209,5
aR 210,6
aR 211,7
v_mul_f32 v208, v208, v203
v_mul_f32 v209, v209, v203
v_mul_f32 v210, v210, v203
v_mul_f32 v211, v211, v203
aW 4,208
aW 5,209
aW 6,210
aW 7,211
aR 204,8
aR 205,9
aR 206,10
aR 207,11
v_mul_f32 v204, v204, v202
v_mul_f32 v205, v205, v202
v_mul_f32 v206, v206, v202
v_mul_f32 v207, v207, v202
aW 8,204
aW 9,205
aW 10,206
aW 11,207
aR 208,12
aR 209,13
aR 210,14
aR 211,15
v_mul_f32 v208, v208, v203
v_mul_f32 v209, v209, v203
v_mul_f32 v210, v210, v203
v_mul_f32 v211, v211, v203
aW 12,208
aW 13,209
aW 14,210
aW 15,211
aR 204,16
aR 205,17
aR 206,18
aR 207,19
v_mul_f32 v204, v204, v202
v_mul_f32 v205, v205, v202
v_mul_f32 v206, v206, v202
v_mul_f32 v207, v207, v202
aW 16,204
aW 17,205
aW 18,206
aW 19,207
aR 208,20
aR 209,21
aR 210,22
aR 211,23
v_mul_f32 v208, v208, v203
v_mul_f32 v209, v209, v203
v_mul_f32 v210, v210, v203
v_mul_f32 v211, v211, v203
aW 20,208
aW 21,209
aW 22,210
aW 23,211
aR 204,24
aR 205,25
aR 206,26
aR 207,27
v_mul_f32 v204, v204, v202
v_mul_f32 v205, v205, v202
v_mul_f32 v206, v206, v202
v_mul_f32 v207, v207, v202
aW 24,204
aW 25,205
aW 26,206
aW 27,207
aR 208,28
aR 209,29
aR 210,30
aR 211,31
v_mul_f32 v208, v208, v203
v_mul_f32 v209, v209, v203
v_mul_f32 v210, v210, v203
v_mul_f32 v211, v211, v203
aW 28,208
aW 29,209
aW 30,210
aW 31,211
aR 204,32
aR 205,33
aR 206,34
aR 207,35
v_mul_f32 v204, v204, v202
v_mul_f32 v205, v205, v202
v_mul_f32 v206, v206, v202
v_mul_f32 v207, v207, v202
aW 32,204
aW 33,205
aW 34,206
aW 35,207
aR 208,36
aR 209,37
aR 210,38
aR 211,39
v_mul_f32 v208, v208, v203
v_mul_f32 v209, v209, v203
v_mul_f32 v210, v210, v203
v_mul_f32 v211, v211, v203
aW 36,208
aW 37,209
aW 38,210
aW 39,211
aR 204,40
aR 205,41
aR 206,42
aR 207,43
v_mul_f32 v204, v204, v202
v_mul_f32 v205, v205, v202
v_mul_f32 v206, v206, v202
v_mul_f32 v207, v207, v202
aW 40,204
aW 41,205
aW 42,206
aW 43,207
aR 208,44
aR 209,45
aR 210,46
aR 211,47
v_mul_f32 v208, v208, v203
v_mul_f32 v209, v209, v203
v_mul_f32 v210, v210, v203
v_mul_f32 v211, v211, v203
aW 44,208
aW 45,209
aW 46,210
aW 47,211
aR 204,48
aR 205,49
aR 206,50
aR 207,51
v_mul_f32 v204, v204, v202
v_mul_f32 v205, v205, v202
v_mul_f32 v206, v206, v202
v_mul_f32 v207, v207, v202
aW 48,204
aW 49,205
aW 50,206
aW 51,207
aR 208,52
aR 209,53
aR 210,54
aR 211,55
v_mul_f32 v208, v208, v203
v_mul_f32 v209, v209, v203
v_mul_f32 v210, v210, v203
v_mul_f32 v211, v211, v203
aW 52,208
aW 53,209
aW 54,210
aW 55,211
aR 204,56
aR 205,57
aR 206,58
aR 207,59
v_mul_f32 v204, v204, v202
v_mul_f32 v205, v205, v202
v_mul_f32 v206, v206, v202
v_mul_f32 v207, v207, v202
aW 56,204
aW 57,205
aW 58,206
aW 59,207
aR 208,60
aR 209,61
aR 210,62
aR 211,63
v_mul_f32 v208, v208, v203
v_mul_f32 v209, v209, v203
v_mul_f32 v210, v210, v203
v_mul_f32 v211, v211, v203
aW 60,208
aW 61,209
aW 62,210
aW 63,211
aR 204,64
aR 205,65
aR 206,66
aR 207,67
v_mul_f32 v204, v204, v202
v_mul_f32 v205, v205, v202
v_mul_f32 v206, v206, v202
v_mul_f32 v207, v207, v202
aW 64,204
aW 65,205
aW 66,206
aW 67,207
aR 208,68
aR 209,69
aR 210,70
aR 211,71
v_mul_f32 v208, v208, v203
v_mul_f32 v209, v209, v203
v_mul_f32 v210, v210, v203
v_mul_f32 v211, v211, v203
aW 68,208
aW 69,209
aW 70,210
aW 71,211
aR 204,72
aR 205,73
aR 206,74
aR 207,75
v_mul_f32 v204, v204, v202
v_mul_f32 v205, v205, v202
v_mul_f32 v206, v206, v202
v_mul_f32 v207, v207, v202
aW 72,204
aW 73,205
aW 74,206
aW 75,207
aR 208,76
aR 209,77
aR 210,78
aR 211,79
v_mul_f32 v208, v208, v203
v_mul_f32 v209, v209, v203
v_mul_f32 v210, v210, v203
v_mul_f32 v211, v211, v203
aW 76,208
aW 77,209
aW 78,210
aW 79,211
aR 204,80
aR 205,81
aR 206,82
aR 207,83
v_mul_f32 v204, v204, v202
v_mul_f32 v205, v205, v202
v_mul_f32 v206, v206, v202
v_mul_f32 v207, v207, v202
aW 80,204
aW 81,205
aW 82,206
aW 83,207
aR 208,84
aR 209,85
aR 210,86
aR 211,87
v_mul_f32 v208, v208, v203
v_mul_f32 v209, v209, v203
v_mul_f32 v210, v210, v203
v_mul_f32 v211, v211, v203
aW 84,208
aW 85,209
aW 86,210
aW 87,211
aR 204,88
aR 205,89
aR 206,90
aR 207,91
v_mul_f32 v204, v204, v202
v_mul_f32 v205, v205, v202
v_mul_f32 v206, v206, v202
v_mul_f32 v207, v207, v202
aW 88,204
aW 89,205
aW 90,206
aW 91,207
aR 208,92
aR 209,93
aR 210,94
aR 211,95
v_mul_f32 v208, v208, v203
v_mul_f32 v209, v209, v203
v_mul_f32 v210, v210, v203
v_mul_f32 v211, v211, v203
aW 92,208
aW 93,209
aW 94,210
aW 95,211
aR 204,96
aR 205,97
aR 206,98
aR 207,99
v_mul_f32 v204, v204, v202
v_mul_f32 v205, v205, v202
v_mul_f32 v206, v206, v202
v_mul_f32 v207, v207, v202
aW 96,204
aW 97,205
aW 98,206
aW 99,207
aR 208,100
aR 209,101
aR 210,102
aR 211,103
v_mul_f32 v208, v208, v203
v_mul_f32 v209, v209, v203
v_mul_f32 v210, v210, v203
v_mul_f32 v211, v211, v203
aW 100,208
aW 101,209
aW 102,210
aW 103,211
aR 204,104
aR 205,105
aR 206,106
aR 207,107
v_mul_f32 v204, v204, v202
v_mul_f32 v205, v205, v202
v_mul_f32 v206, v206, v202
v_mul_f32 v207, v207, v202
aW 104,204
aW 105,205
aW 106,206
aW 107,207
aR 208,108
aR 209,109
aR 210,110
aR 211,111
v_mul_f32 v208, v208, v203
v_mul_f32 v209, v209, v203
v_mul_f32 v210, v210, v203
v_mul_f32 v211, v211, v203
aW 108,208
aW 109,209
aW 110,210
aW 111,211
aR 204,112
aR 205,113
aR 206,114
aR 207,115
v_mul_f32 v204, v204, v202
v_mul_f32 v205, v205, v202
v_mul_f32 v206, v206, v202
v_mul_f32 v207, v207, v202
aW 112,204
aW 113,205
aW 114,206
aW 115,207
aR 208,116
aR 209,117
aR 210,118
aR 211,119
v_mul_f32 v208, v208, v203
v_mul_f32 v209, v209, v203
v_mul_f32 v210, v210, v203
v_mul_f32 v211, v211, v203
aW 116,208
aW 117,209
aW 118,210
aW 119,211
aR 204,120
aR 205,121
aR 206,122
aR 207,123
v_mul_f32 v204, v204, v202
v_mul_f32 v205, v205, v202
v_mul_f32 v206, v206, v202
v_mul_f32 v207, v207, v202
aW 120,204
aW 121,205
aW 122,206
aW 123,207
aR 208,124
aR 209,125
aR 210,126
aR 211,127
v_mul_f32 v208, v208, v203
v_mul_f32 v209, v209, v203
v_mul_f32 v210, v210, v203
v_mul_f32 v211, v211, v203
aW 124,208
aW 125,209
aW 126,210
aW 127,211
s_nop 1
s_cmp_ge_u32 s57, s33
s_branch ATT_D1
ATT_hk:
v_lshl_add_u32 v200, s3, 6, v1
v_cmp_eq_u32 s[100:101], 0, v200
v_mov_b32 v200, 0x40000000
v_mov_b32 v201, 1
v_cndmask_b32 v200, v200, 0, s[100:101]
buffer_atomic_add v201, v200, s[12:15], s18 offen
buffer_atomic_add v201, v200, s[12:15], s19 offen
s_mov_b32 s18, 0x80000000
s_mov_b32 s19, 0x80000000
s_branch ATT_hk_ret
ATT_hkm:
v_lshl_add_u32 v200, s3, 6, v1
v_cmp_eq_u32 s[100:101], 0, v200
v_mov_b32 v200, 0x40000000
v_mov_b32 v201, 1
v_cndmask_b32 v200, v200, 0, s[100:101]
buffer_atomic_add v201, v200, s[12:15], s18 offen
buffer_atomic_add v201, v200, s[12:15], s19 offen
s_mov_b32 s18, 0x80000000
s_mov_b32 s19, 0x80000000
s_branch ATT_hkm_ret
ATT_F1:
s_waitcnt vmcnt(0)
s_barrier
rB 40,2,0
rB 44,2,1024
rB 48,2,2048
rB 52,2,3072
rB 56,2,4096
rB 60,2,5120
v_exp_f32 v104, v104
v_exp_f32 v105, v105
v_exp_f32 v106, v106
v_exp_f32 v107, v107
v_exp_f32 v112, v112
v_exp_f32 v113, v113
v_exp_f32 v114, v114
v_exp_f32 v115, v115
v_exp_f32 v108, v108
v_exp_f32 v109, v109
v_exp_f32 v110, v110
v_exp_f32 v111, v111
v_exp_f32 v116, v116
v_exp_f32 v117, v117
v_exp_f32 v118, v118
v_exp_f32 v119, v119
cP 24,104,105
cP 25,106,107
cP 26,112,113
cP 27,114,115
cP 28,108,109
cP 29,110,111
cP 30,116,117
cP 31,118,119
v_and_b32 v12, 15, v1
s_lshl_b32 s62, s3, 4
v_add_u32 v12, s62, v12
v_lshlrev_b32 v6, 2, v12
v_lshlrev_b32 v12, 3, v12
s_lshl_b32 s62, s51, 9
s_add_u32 s62, s62, 79953920
s_lshl_b32 s63, s56, 10
s_add_u32 s63, s63, 80740352
buffer_load_dword v14, v6, s[12:15], s62 offen offset:0 sc1
buffer_load_dword v15, v6, s[12:15], s62 offen offset:256 sc1
s_lshr_b32 s69, s50, 1
s_lshl_b32 s69, s69, 8
s_add_u32 s69, s69, 80216096
v_mov_b32 v240, 0
buffer_load_dword v240, v240, s[12:15], s69 offen sc1
s_lshl_b32 s69, s56, 16
s_lshl_b32 s68, s3, 10
s_add_u32 s69, s69, s68
s_add_u32 s69, s69, 83886080
s_cmp_eq_u32 s55, 2
s_cbranch_scc0 ATT_f1_nomerge
s_lshl_b32 s68, s56, 8
s_add_u32 s68, s68, 80216064
v_mov_b32 v212, 0
ATT_f1_poll:
buffer_load_dword v213, v212, s[12:15], s68 offen sc1
s_waitcnt vmcnt(0)
v_readfirstlane_b32 s57, v213
s_nop 0
s_cmp_lg_u32 s57, 0
s_cbranch_scc1 ATT_f1_pok
s_sleep 20
s_branch ATT_f1_poll
ATT_f1_pok:
buffer_load_dwordx2 v[212:213], v12, s[12:15], s63 offen offset:0 sc1
buffer_load_dwordx2 v[214:215], v12, s[12:15], s63 offen offset:512 sc1
s_mov_b32 s68, s69
buffer_load_dwordx4 v[136:139], v0, s[12:15], s68 offen offset:0 sc1
s_add_u32 s68, s68, 4096
buffer_load_dwordx4 v[168:171], v0, s[12:15], s68 offen offset:0 sc1
s_add_u32 s68, s68, 4096
buffer_load_dwordx4 v[140:143], v0, s[12:15], s68 offen offset:0 sc1
s_add_u32 s68, s68, 4096
buffer_load_dwordx4 v[172:175], v0, s[12:15], s68 offen offset:0 sc1
s_add_u32 s68, s68, 4096
buffer_load_dwordx4 v[144:147], v0, s[12:15], s68 offen offset:0 sc1
s_add_u32 s68, s68, 4096
buffer_load_dwordx4 v[176:179], v0, s[12:15], s68 offen offset:0 sc1
s_add_u32 s68, s68, 4096
buffer_load_dwordx4 v[148:151], v0, s[12:15], s68 offen offset:0 sc1
s_add_u32 s68, s68, 4096
buffer_load_dwordx4 v[180:183], v0, s[12:15], s68 offen offset:0 sc1
s_add_u32 s68, s68, 4096
buffer_load_dwordx4 v[152:155], v0, s[12:15], s68 offen offset:0 sc1
s_add_u32 s68, s68, 4096
buffer_load_dwordx4 v[184:187], v0, s[12:15], s68 offen offset:0 sc1
s_add_u32 s68, s68, 4096
buffer_load_dwordx4 v[156:159], v0, s[12:15], s68 offen offset:0 sc1
s_add_u32 s68, s68, 4096
buffer_load_dwordx4 v[188:191], v0, s[12:15], s68 offen offset:0 sc1
s_add_u32 s68, s68, 4096
buffer_load_dwordx4 v[160:163], v0, s[12:15], s68 offen offset:0 sc1
s_add_u32 s68, s68, 4096
buffer_load_dwordx4 v[192:195], v0, s[12:15], s68 offen offset:0 sc1
s_add_u32 s68, s68, 4096
buffer_load_dwordx4 v[164:167], v0, s[12:15], s68 offen offset:0 sc1
s_add_u32 s68, s68, 4096
buffer_load_dwordx4 v[196:199], v0, s[12:15], s68 offen offset:0 sc1
s_add_u32 s68, s68, 4096
ATT_f1_nomerge:
s_mul_i32 s68, s51, 156
s_lshl_b32 s62, s50, 3
s_add_u32 s68, s68, s62
s_lshl_b32 s68, s68, 13
s_lshl_b32 s62, s3, 10
s_add_u32 s68, s68, s62
s_add_u32 s68, s68, 50331648
s_waitcnt lgkmcnt(4)
mA 0,40,24
rB 64,2,6144
rB 68,2,7168
mA 4,40,28
v_exp_f32 v120, v120
mA 12,44,28
v_exp_f32 v121, v121
mA 8,44,24
s_waitcnt lgkmcnt(4)
v_exp_f32 v122, v122
mA 16,48,24
rB 40,2,8192
rB 44,2,9216
mA 20,48,28
v_exp_f32 v123, v123
mA 28,52,28
v_exp_f32 v128, v128
mA 24,52,24
s_waitcnt lgkmcnt(4)
v_exp_f32 v129, v129
mA 32,56,24
rB 48,2,10240
rB 52,2,11264
mA 36,56,28
v_exp_f32 v130, v130
mA 44,60,28
v_exp_f32 v131, v131
mA 40,60,24
s_waitcnt lgkmcnt(4)
cP 32,120,121
cP 33,122,123
mA 48,64,24
rB 56,2,12288
rB 60,2,13312
mA 52,64,28
cP 34,128,129
cP 35,130,131
mA 60,68,28
v_exp_f32 v124, v124
mA 56,68,24
s_waitcnt lgkmcnt(4)
v_exp_f32 v125, v125
mA 64,40,24
rB 64,2,14336
rB 68,2,15360
mA 68,40,28
v_exp_f32 v126, v126
mA 76,44,28
v_exp_f32 v127, v127
mA 72,44,24
s_waitcnt lgkmcnt(4)
v_exp_f32 v132, v132
mA 80,48,24
rB 40,2,16384
rB 44,2,17408
mA 84,48,28
v_exp_f32 v133, v133
mA 92,52,28
v_exp_f32 v134, v134
mA 88,52,24
s_waitcnt lgkmcnt(4)
v_exp_f32 v135, v135
mA 96,56,24
rB 48,2,18432
rB 52,2,19456
mA 100,56,28
cP 36,124,125
cP 37,126,127
mA 108,60,28
cP 38,132,133
cP 39,134,135
mA 104,60,24
s_waitcnt lgkmcnt(4)
v_add_f32 v4, v4, v104
v_add_f32 v5, v5, v108
mA 112,64,24
rB 56,2,20480
rB 60,2,21504
mA 116,64,28
v_add_f32 v4, v4, v105
v_add_f32 v5, v5, v109
mA 124,68,28
v_add_f32 v4, v4, v106
v_add_f32 v5, v5, v110
mA 120,68,24
s_waitcnt lgkmcnt(4)
v_add_f32 v4, v4, v107
v_add_f32 v5, v5, v111
mA 0,40,32
rB 64,2,22528
rB 68,2,23552
mA 4,40,36
v_add_f32 v4, v4, v112
v_add_f32 v5, v5, v116
mA 12,44,36
v_add_f32 v4, v4, v113
v_add_f32 v5, v5, v117
mA 8,44,32
s_waitcnt lgkmcnt(4)
v_add_f32 v4, v4, v114
v_add_f32 v5, v5, v118
mA 16,48,32
rB 40,2,24576
rB 44,2,25600
mA 20,48,36
v_add_f32 v4, v4, v115
v_add_f32 v5, v5, v119
mA 28,52,36
v_add_f32 v4, v4, v120
v_add_f32 v5, v5, v124
mA 24,52,32
s_waitcnt lgkmcnt(4)
v_add_f32 v4, v4, v121
v_add_f32 v5, v5, v125
mA 32,56,32
rB 48,2,26624
rB 52,2,27648
mA 36,56,36
v_add_f32 v4, v4, v122
v_add_f32 v5, v5, v126
mA 44,60,36
v_add_f32 v4, v4, v123
v_add_f32 v5, v5, v127
mA 40,60,32
s_waitcnt lgkmcnt(4)
v_add_f32 v4, v4, v128
v_add_f32 v5, v5, v132
mA 48,64,32
rB 56,2,28672
rB 60,2,29696
mA 52,64,36
v_add_f32 v4, v4, v129
v_add_f32 v5, v5, v133
mA 60,68,36
v_add_f32 v4, v4, v130
v_add_f32 v5, v5, v134
mA 56,68,32
s_waitcnt lgkmcnt(4)
v_add_f32 v4, v4, v131
v_add_f32 v5, v5, v135
mA 64,40,32
rB 64,2,30720
rB 68,2,31744
mA 68,40,36
v_mov_b32 v200, v4
v_mov_b32 v201, v5
mA 76,44,36
v_permlane16_swap_b32 v4, v200
v_permlane16_swap_b32 v5, v201
mA 72,44,32
s_waitcnt lgkmcnt(4)
v_add_f32 v4, v4, v200
v_add_f32 v5, v5, v201
mA 80,48,32
v_mov_b32 v200, v4
v_mov_b32 v201, v5
mA 84,48,36
v_permlane32_swap_b32 v4, v200
v_permlane32_swap_b32 v5, v201
mA 92,52,36
v_add_f32 v4, v4, v200
v_add_f32 v5, v5, v201
mA 88,52,32
s_waitcnt lgkmcnt(2)
mA 96,56,32
mA 100,56,36
mA 108,60,36
mA 104,60,32
s_waitcnt lgkmcnt(0)
mA 112,64,32
mA 116,64,36
mA 124,68,36
mA 120,68,32
ATT_E:
s_waitcnt vmcnt(0)
v_readfirstlane_b32 s17, v240
v_mov_b32 v216, 1.0
v_mov_b32 v218, 1.0
s_lshr_b32 s18, s50, 1
s_lshl_b32 s18, s18, 4
s_add_u32 s18, s18, s51
s_lshl_b32 s18, s18, 8
s_add_u32 s18, s18, 80216256
s_cmp_eq_u32 s55, 2
s_cbranch_scc0 ATT_e_nomerge2
v_min_f32 v224, v16, v212
v_min_f32 v225, v20, v214
v_sub_f32 v216, v224, v16
v_sub_f32 v220, v224, v212
v_sub_f32 v218, v225, v20
v_sub_f32 v222, v225, v214
v_exp_f32 v216, v216
v_exp_f32 v220, v220
v_exp_f32 v218, v218
v_exp_f32 v222, v222
v_mul_f32 v220, v220, v213
v_mul_f32 v222, v222, v215
v_fma_f32 v4, v4, v216, v220
v_fma_f32 v5, v5, v218, v222
ATT_e_nomerge2:
v_rcp_f32 v224, v4
v_rcp_f32 v225, v5
s_cmp_eq_u32 s55, 1
s_cbranch_scc0 ATT_e_notw
v_mov_b32 v14, 1.0
v_mov_b32 v15, 1.0
v_mov_b32 v228, v16
v_mov_b32 v229, v4
v_mov_b32 v230, v20
v_mov_b32 v231, v5
v_mov_b32 v226, 2147483648
v_cmp_gt_u32 vcc, 16, v1
s_nop 1
v_cndmask_b32 v12, v226, v12, vcc
buffer_store_dwordx2 v[228:229], v12, s[12:15], s63 offen offset:0 sc1
buffer_store_dwordx2 v[230:231], v12, s[12:15], s63 offen offset:512 sc1
s_mov_b32 s68, s69
s_lshl_b32 s18, s56, 8
s_add_u32 s18, s18, 80216064
ATT_e_notw:
v_mul_f32 v224, v224, v14
v_mul_f32 v225, v225, v15
v_mul_f32 v216, v216, v224
v_mul_f32 v220, v220, v224
v_mul_f32 v218, v218, v225
v_mul_f32 v222, v222, v225
s_cmp_eq_u32 s55, 2
s_cbranch_scc0 ATT_e_recv_n
aR 72,0
aR 73,1
aR 74,2
aR 75,3
aR 76,8
aR 77,9
aR 78,10
aR 79,11
v_lshlrev_b32 v80, 16, v136
v_and_b32 v81, 0xffff0000, v136
v_lshlrev_b32 v82, 16, v137
v_and_b32 v83, 0xffff0000, v137
v_lshlrev_b32 v84, 16, v138
v_and_b32 v85, 0xffff0000, v138
v_lshlrev_b32 v86, 16, v139
v_and_b32 v87, 0xffff0000, v139
v_pk_mul_f32 v[72:73], v[72:73], v[216:217] op_sel_hi:[1,0]
v_pk_mul_f32 v[74:75], v[74:75], v[216:217] op_sel_hi:[1,0]
v_pk_mul_f32 v[76:77], v[76:77], v[216:217] op_sel_hi:[1,0]
v_pk_mul_f32 v[78:79], v[78:79], v[216:217] op_sel_hi:[1,0]
v_pk_fma_f32 v[72:73], v[80:81], v[220:221], v[72:73] op_sel_hi:[1,0,1]
v_pk_fma_f32 v[74:75], v[82:83], v[220:221], v[74:75] op_sel_hi:[1,0,1]
v_pk_fma_f32 v[76:77], v[84:85], v[220:221], v[76:77] op_sel_hi:[1,0,1]
v_pk_fma_f32 v[78:79], v[86:87], v[220:221], v[78:79] op_sel_hi:[1,0,1]
cP 72,72,73
cP 73,74,75
cP 74,76,77
cP 75,78,79
buffer_store_dwordx4 v[72:75], v0, s[12:15], s68 offen offset:0 sc1
s_add_u32 s68, s68, 4096
aR 88,4
aR 89,5
aR 90,6
aR 91,7
aR 92,12
aR 93,13
aR 94,14
aR 95,15
v_lshlrev_b32 v96, 16, v168
v_and_b32 v97, 0xffff0000, v168
v_lshlrev_b32 v98, 16, v169
v_and_b32 v99, 0xffff0000, v169
v_lshlrev_b32 v100, 16, v170
v_and_b32 v101, 0xffff0000, v170
v_lshlrev_b32 v102, 16, v171
v_and_b32 v103, 0xffff0000, v171
v_pk_mul_f32 v[88:89], v[88:89], v[218:219] op_sel_hi:[1,0]
v_pk_mul_f32 v[90:91], v[90:91], v[218:219] op_sel_hi:[1,0]
v_pk_mul_f32 v[92:93], v[92:93], v[218:219] op_sel_hi:[1,0]
v_pk_mul_f32 v[94:95], v[94:95], v[218:219] op_sel_hi:[1,0]
v_pk_fma_f32 v[88:89], v[96:97], v[222:223], v[88:89] op_sel_hi:[1,0,1]
v_pk_fma_f32 v[90:91], v[98:99], v[222:223], v[90:91] op_sel_hi:[1,0,1]
v_pk_fma_f32 v[92:93], v[100:101], v[222:223], v[92:93] op_sel_hi:[1,0,1]
v_pk_fma_f32 v[94:95], v[102:103], v[222:223], v[94:95] op_sel_hi:[1,0,1]
cP 88,88,89
cP 89,90,91
cP 90,92,93
cP 91,94,95
buffer_store_dwordx4 v[88:91], v0, s[12:15], s68 offen offset:0 sc1
s_add_u32 s68, s68, 4096
aR 104,16
aR 105,17
aR 106,18
aR 107,19
aR 108,24
aR 109,25
aR 110,26
aR 111,27
v_lshlrev_b32 v112, 16, v140
v_and_b32 v113, 0xffff0000, v140
v_lshlrev_b32 v114, 16, v141
v_and_b32 v115, 0xffff0000, v141
v_lshlrev_b32 v116, 16, v142
v_and_b32 v117, 0xffff0000, v142
v_lshlrev_b32 v118, 16, v143
v_and_b32 v119, 0xffff0000, v143
v_pk_mul_f32 v[104:105], v[104:105], v[216:217] op_sel_hi:[1,0]
v_pk_mul_f32 v[106:107], v[106:107], v[216:217] op_sel_hi:[1,0]
v_pk_mul_f32 v[108:109], v[108:109], v[216:217] op_sel_hi:[1,0]
v_pk_mul_f32 v[110:111], v[110:111], v[216:217] op_sel_hi:[1,0]
v_pk_fma_f32 v[104:105], v[112:113], v[220:221], v[104:105] op_sel_hi:[1,0,1]
v_pk_fma_f32 v[106:107], v[114:115], v[220:221], v[106:107] op_sel_hi:[1,0,1]
v_pk_fma_f32 v[108:109], v[116:117], v[220:221], v[108:109] op_sel_hi:[1,0,1]
v_pk_fma_f32 v[110:111], v[118:119], v[220:221], v[110:111] op_sel_hi:[1,0,1]
cP 104,104,105
cP 105,106,107
cP 106,108,109
cP 107,110,111
buffer_store_dwordx4 v[104:107], v0, s[12:15], s68 offen offset:0 sc1
s_add_u32 s68, s68, 4096
aR 120,20
aR 121,21
aR 122,22
aR 123,23
aR 124,28
aR 125,29
aR 126,30
aR 127,31
v_lshlrev_b32 v128, 16, v172
v_and_b32 v129, 0xffff0000, v172
v_lshlrev_b32 v130, 16, v173
v_and_b32 v131, 0xffff0000, v173
v_lshlrev_b32 v132, 16, v174
v_and_b32 v133, 0xffff0000, v174
v_lshlrev_b32 v134, 16, v175
v_and_b32 v135, 0xffff0000, v175
v_pk_mul_f32 v[120:121], v[120:121], v[218:219] op_sel_hi:[1,0]
v_pk_mul_f32 v[122:123], v[122:123], v[218:219] op_sel_hi:[1,0]
v_pk_mul_f32 v[124:125], v[124:125], v[218:219] op_sel_hi:[1,0]
v_pk_mul_f32 v[126:127], v[126:127], v[218:219] op_sel_hi:[1,0]
v_pk_fma_f32 v[120:121], v[128:129], v[222:223], v[120:121] op_sel_hi:[1,0,1]
v_pk_fma_f32 v[122:123], v[130:131], v[222:223], v[122:123] op_sel_hi:[1,0,1]
v_pk_fma_f32 v[124:125], v[132:133], v[222:223], v[124:125] op_sel_hi:[1,0,1]
v_pk_fma_f32 v[126:127], v[134:135], v[222:223], v[126:127] op_sel_hi:[1,0,1]
cP 120,120,121
cP 121,122,123
cP 122,124,125
cP 123,126,127
buffer_store_dwordx4 v[120:123], v0, s[12:15], s68 offen offset:0 sc1
s_add_u32 s68, s68, 4096
aR 72,32
aR 73,33
aR 74,34
aR 75,35
aR 76,40
aR 77,41
aR 78,42
aR 79,43
v_lshlrev_b32 v80, 16, v144
v_and_b32 v81, 0xffff0000, v144
v_lshlrev_b32 v82, 16, v145
v_and_b32 v83, 0xffff0000, v145
v_lshlrev_b32 v84, 16, v146
v_and_b32 v85, 0xffff0000, v146
v_lshlrev_b32 v86, 16, v147
v_and_b32 v87, 0xffff0000, v147
v_pk_mul_f32 v[72:73], v[72:73], v[216:217] op_sel_hi:[1,0]
v_pk_mul_f32 v[74:75], v[74:75], v[216:217] op_sel_hi:[1,0]
v_pk_mul_f32 v[76:77], v[76:77], v[216:217] op_sel_hi:[1,0]
v_pk_mul_f32 v[78:79], v[78:79], v[216:217] op_sel_hi:[1,0]
v_pk_fma_f32 v[72:73], v[80:81], v[220:221], v[72:73] op_sel_hi:[1,0,1]
v_pk_fma_f32 v[74:75], v[82:83], v[220:221], v[74:75] op_sel_hi:[1,0,1]
v_pk_fma_f32 v[76:77], v[84:85], v[220:221], v[76:77] op_sel_hi:[1,0,1]
v_pk_fma_f32 v[78:79], v[86:87], v[220:221], v[78:79] op_sel_hi:[1,0,1]
cP 72,72,73
cP 73,74,75
cP 74,76,77
cP 75,78,79
buffer_store_dwordx4 v[72:75], v0, s[12:15], s68 offen offset:0 sc1
s_add_u32 s68, s68, 4096
aR 88,36
aR 89,37
aR 90,38
aR 91,39
aR 92,44
aR 93,45
aR 94,46
aR 95,47
v_lshlrev_b32 v96, 16, v176
v_and_b32 v97, 0xffff0000, v176
v_lshlrev_b32 v98, 16, v177
v_and_b32 v99, 0xffff0000, v177
v_lshlrev_b32 v100, 16, v178
v_and_b32 v101, 0xffff0000, v178
v_lshlrev_b32 v102, 16, v179
v_and_b32 v103, 0xffff0000, v179
v_pk_mul_f32 v[88:89], v[88:89], v[218:219] op_sel_hi:[1,0]
v_pk_mul_f32 v[90:91], v[90:91], v[218:219] op_sel_hi:[1,0]
v_pk_mul_f32 v[92:93], v[92:93], v[218:219] op_sel_hi:[1,0]
v_pk_mul_f32 v[94:95], v[94:95], v[218:219] op_sel_hi:[1,0]
v_pk_fma_f32 v[88:89], v[96:97], v[222:223], v[88:89] op_sel_hi:[1,0,1]
v_pk_fma_f32 v[90:91], v[98:99], v[222:223], v[90:91] op_sel_hi:[1,0,1]
v_pk_fma_f32 v[92:93], v[100:101], v[222:223], v[92:93] op_sel_hi:[1,0,1]
v_pk_fma_f32 v[94:95], v[102:103], v[222:223], v[94:95] op_sel_hi:[1,0,1]
cP 88,88,89
cP 89,90,91
cP 90,92,93
cP 91,94,95
buffer_store_dwordx4 v[88:91], v0, s[12:15], s68 offen offset:0 sc1
s_add_u32 s68, s68, 4096
aR 104,48
aR 105,49
aR 106,50
aR 107,51
aR 108,56
aR 109,57
aR 110,58
aR 111,59
v_lshlrev_b32 v112, 16, v148
v_and_b32 v113, 0xffff0000, v148
v_lshlrev_b32 v114, 16, v149
v_and_b32 v115, 0xffff0000, v149
v_lshlrev_b32 v116, 16, v150
v_and_b32 v117, 0xffff0000, v150
v_lshlrev_b32 v118, 16, v151
v_and_b32 v119, 0xffff0000, v151
v_pk_mul_f32 v[104:105], v[104:105], v[216:217] op_sel_hi:[1,0]
v_pk_mul_f32 v[106:107], v[106:107], v[216:217] op_sel_hi:[1,0]
v_pk_mul_f32 v[108:109], v[108:109], v[216:217] op_sel_hi:[1,0]
v_pk_mul_f32 v[110:111], v[110:111], v[216:217] op_sel_hi:[1,0]
v_pk_fma_f32 v[104:105], v[112:113], v[220:221], v[104:105] op_sel_hi:[1,0,1]
v_pk_fma_f32 v[106:107], v[114:115], v[220:221], v[106:107] op_sel_hi:[1,0,1]
v_pk_fma_f32 v[108:109], v[116:117], v[220:221], v[108:109] op_sel_hi:[1,0,1]
v_pk_fma_f32 v[110:111], v[118:119], v[220:221], v[110:111] op_sel_hi:[1,0,1]
cP 104,104,105
cP 105,106,107
cP 106,108,109
cP 107,110,111
buffer_store_dwordx4 v[104:107], v0, s[12:15], s68 offen offset:0 sc1
s_add_u32 s68, s68, 4096
aR 120,52
aR 121,53
aR 122,54
aR 123,55
aR 124,60
aR 125,61
aR 126,62
aR 127,63
v_lshlrev_b32 v128, 16, v180
v_and_b32 v129, 0xffff0000, v180
v_lshlrev_b32 v130, 16, v181
v_and_b32 v131, 0xffff0000, v181
v_lshlrev_b32 v132, 16, v182
v_and_b32 v133, 0xffff0000, v182
v_lshlrev_b32 v134, 16, v183
v_and_b32 v135, 0xffff0000, v183
v_pk_mul_f32 v[120:121], v[120:121], v[218:219] op_sel_hi:[1,0]
v_pk_mul_f32 v[122:123], v[122:123], v[218:219] op_sel_hi:[1,0]
v_pk_mul_f32 v[124:125], v[124:125], v[218:219] op_sel_hi:[1,0]
v_pk_mul_f32 v[126:127], v[126:127], v[218:219] op_sel_hi:[1,0]
v_pk_fma_f32 v[120:121], v[128:129], v[222:223], v[120:121] op_sel_hi:[1,0,1]
v_pk_fma_f32 v[122:123], v[130:131], v[222:223], v[122:123] op_sel_hi:[1,0,1]
v_pk_fma_f32 v[124:125], v[132:133], v[222:223], v[124:125] op_sel_hi:[1,0,1]
v_pk_fma_f32 v[126:127], v[134:135], v[222:223], v[126:127] op_sel_hi:[1,0,1]
cP 120,120,121
cP 121,122,123
cP 122,124,125
cP 123,126,127
buffer_store_dwordx4 v[120:123], v0, s[12:15], s68 offen offset:0 sc1
s_add_u32 s68, s68, 4096
aR 72,64
aR 73,65
aR 74,66
aR 75,67
aR 76,72
aR 77,73
aR 78,74
aR 79,75
v_lshlrev_b32 v80, 16, v152
v_and_b32 v81, 0xffff0000, v152
v_lshlrev_b32 v82, 16, v153
v_and_b32 v83, 0xffff0000, v153
v_lshlrev_b32 v84, 16, v154
v_and_b32 v85, 0xffff0000, v154
v_lshlrev_b32 v86, 16, v155
v_and_b32 v87, 0xffff0000, v155
v_pk_mul_f32 v[72:73], v[72:73], v[216:217] op_sel_hi:[1,0]
v_pk_mul_f32 v[74:75], v[74:75], v[216:217] op_sel_hi:[1,0]
v_pk_mul_f32 v[76:77], v[76:77], v[216:217] op_sel_hi:[1,0]
v_pk_mul_f32 v[78:79], v[78:79], v[216:217] op_sel_hi:[1,0]
v_pk_fma_f32 v[72:73], v[80:81], v[220:221], v[72:73] op_sel_hi:[1,0,1]
v_pk_fma_f32 v[74:75], v[82:83], v[220:221], v[74:75] op_sel_hi:[1,0,1]
v_pk_fma_f32 v[76:77], v[84:85], v[220:221], v[76:77] op_sel_hi:[1,0,1]
v_pk_fma_f32 v[78:79], v[86:87], v[220:221], v[78:79] op_sel_hi:[1,0,1]
cP 72,72,73
cP 73,74,75
cP 74,76,77
cP 75,78,79
buffer_store_dwordx4 v[72:75], v0, s[12:15], s68 offen offset:0 sc1
s_add_u32 s68, s68, 4096
aR 88,68
aR 89,69
aR 90,70
aR 91,71
aR 92,76
aR 93,77
aR 94,78
aR 95,79
v_lshlrev_b32 v96, 16, v184
v_and_b32 v97, 0xffff0000, v184
v_lshlrev_b32 v98, 16, v185
v_and_b32 v99, 0xffff0000, v185
v_lshlrev_b32 v100, 16, v186
v_and_b32 v101, 0xffff0000, v186
v_lshlrev_b32 v102, 16, v187
v_and_b32 v103, 0xffff0000, v187
v_pk_mul_f32 v[88:89], v[88:89], v[218:219] op_sel_hi:[1,0]
v_pk_mul_f32 v[90:91], v[90:91], v[218:219] op_sel_hi:[1,0]
v_pk_mul_f32 v[92:93], v[92:93], v[218:219] op_sel_hi:[1,0]
v_pk_mul_f32 v[94:95], v[94:95], v[218:219] op_sel_hi:[1,0]
v_pk_fma_f32 v[88:89], v[96:97], v[222:223], v[88:89] op_sel_hi:[1,0,1]
v_pk_fma_f32 v[90:91], v[98:99], v[222:223], v[90:91] op_sel_hi:[1,0,1]
v_pk_fma_f32 v[92:93], v[100:101], v[222:223], v[92:93] op_sel_hi:[1,0,1]
v_pk_fma_f32 v[94:95], v[102:103], v[222:223], v[94:95] op_sel_hi:[1,0,1]
cP 88,88,89
cP 89,90,91
cP 90,92,93
cP 91,94,95
buffer_store_dwordx4 v[88:91], v0, s[12:15], s68 offen offset:0 sc1
s_add_u32 s68, s68, 4096
aR 104,80
aR 105,81
aR 106,82
aR 107,83
aR 108,88
aR 109,89
aR 110,90
aR 111,91
v_lshlrev_b32 v112, 16, v156
v_and_b32 v113, 0xffff0000, v156
v_lshlrev_b32 v114, 16, v157
v_and_b32 v115, 0xffff0000, v157
v_lshlrev_b32 v116, 16, v158
v_and_b32 v117, 0xffff0000, v158
v_lshlrev_b32 v118, 16, v159
v_and_b32 v119, 0xffff0000, v159
v_pk_mul_f32 v[104:105], v[104:105], v[216:217] op_sel_hi:[1,0]
v_pk_mul_f32 v[106:107], v[106:107], v[216:217] op_sel_hi:[1,0]
v_pk_mul_f32 v[108:109], v[108:109], v[216:217] op_sel_hi:[1,0]
v_pk_mul_f32 v[110:111], v[110:111], v[216:217] op_sel_hi:[1,0]
v_pk_fma_f32 v[104:105], v[112:113], v[220:221], v[104:105] op_sel_hi:[1,0,1]
v_pk_fma_f32 v[106:107], v[114:115], v[220:221], v[106:107] op_sel_hi:[1,0,1]
v_pk_fma_f32 v[108:109], v[116:117], v[220:221], v[108:109] op_sel_hi:[1,0,1]
v_pk_fma_f32 v[110:111], v[118:119], v[220:221], v[110:111] op_sel_hi:[1,0,1]
cP 104,104,105
cP 105,106,107
cP 106,108,109
cP 107,110,111
buffer_store_dwordx4 v[104:107], v0, s[12:15], s68 offen offset:0 sc1
s_add_u32 s68, s68, 4096
aR 120,84
aR 121,85
aR 122,86
aR 123,87
aR 124,92
aR 125,93
aR 126,94
aR 127,95
v_lshlrev_b32 v128, 16, v188
v_and_b32 v129, 0xffff0000, v188
v_lshlrev_b32 v130, 16, v189
v_and_b32 v131, 0xffff0000, v189
v_lshlrev_b32 v132, 16, v190
v_and_b32 v133, 0xffff0000, v190
v_lshlrev_b32 v134, 16, v191
v_and_b32 v135, 0xffff0000, v191
v_pk_mul_f32 v[120:121], v[120:121], v[218:219] op_sel_hi:[1,0]
v_pk_mul_f32 v[122:123], v[122:123], v[218:219] op_sel_hi:[1,0]
v_pk_mul_f32 v[124:125], v[124:125], v[218:219] op_sel_hi:[1,0]
v_pk_mul_f32 v[126:127], v[126:127], v[218:219] op_sel_hi:[1,0]
v_pk_fma_f32 v[120:121], v[128:129], v[222:223], v[120:121] op_sel_hi:[1,0,1]
v_pk_fma_f32 v[122:123], v[130:131], v[222:223], v[122:123] op_sel_hi:[1,0,1]
v_pk_fma_f32 v[124:125], v[132:133], v[222:223], v[124:125] op_sel_hi:[1,0,1]
v_pk_fma_f32 v[126:127], v[134:135], v[222:223], v[126:127] op_sel_hi:[1,0,1]
cP 120,120,121
cP 121,122,123
cP 122,124,125
cP 123,126,127
buffer_store_dwordx4 v[120:123], v0, s[12:15], s68 offen offset:0 sc1
s_add_u32 s68, s68, 4096
aR 72,96
aR 73,97
aR 74,98
aR 75,99
aR 76,104
aR 77,105
aR 78,106
aR 79,107
v_lshlrev_b32 v80, 16, v160
v_and_b32 v81, 0xffff0000, v160
v_lshlrev_b32 v82, 16, v161
v_and_b32 v83, 0xffff0000, v161
v_lshlrev_b32 v84, 16, v162
v_and_b32 v85, 0xffff0000, v162
v_lshlrev_b32 v86, 16, v163
v_and_b32 v87, 0xffff0000, v163
v_pk_mul_f32 v[72:73], v[72:73], v[216:217] op_sel_hi:[1,0]
v_pk_mul_f32 v[74:75], v[74:75], v[216:217] op_sel_hi:[1,0]
v_pk_mul_f32 v[76:77], v[76:77], v[216:217] op_sel_hi:[1,0]
v_pk_mul_f32 v[78:79], v[78:79], v[216:217] op_sel_hi:[1,0]
v_pk_fma_f32 v[72:73], v[80:81], v[220:221], v[72:73] op_sel_hi:[1,0,1]
v_pk_fma_f32 v[74:75], v[82:83], v[220:221], v[74:75] op_sel_hi:[1,0,1]
v_pk_fma_f32 v[76:77], v[84:85], v[220:221], v[76:77] op_sel_hi:[1,0,1]
v_pk_fma_f32 v[78:79], v[86:87], v[220:221], v[78:79] op_sel_hi:[1,0,1]
cP 72,72,73
cP 73,74,75
cP 74,76,77
cP 75,78,79
buffer_store_dwordx4 v[72:75], v0, s[12:15], s68 offen offset:0 sc1
s_add_u32 s68, s68, 4096
aR 88,100
aR 89,101
aR 90,102
aR 91,103
aR 92,108
aR 93,109
aR 94,110
aR 95,111
v_lshlrev_b32 v96, 16, v192
v_and_b32 v97, 0xffff0000, v192
v_lshlrev_b32 v98, 16, v193
v_and_b32 v99, 0xffff0000, v193
v_lshlrev_b32 v100, 16, v194
v_and_b32 v101, 0xffff0000, v194
v_lshlrev_b32 v102, 16, v195
v_and_b32 v103, 0xffff0000, v195
v_pk_mul_f32 v[88:89], v[88:89], v[218:219] op_sel_hi:[1,0]
v_pk_mul_f32 v[90:91], v[90:91], v[218:219] op_sel_hi:[1,0]
v_pk_mul_f32 v[92:93], v[92:93], v[218:219] op_sel_hi:[1,0]
v_pk_mul_f32 v[94:95], v[94:95], v[218:219] op_sel_hi:[1,0]
v_pk_fma_f32 v[88:89], v[96:97], v[222:223], v[88:89] op_sel_hi:[1,0,1]
v_pk_fma_f32 v[90:91], v[98:99], v[222:223], v[90:91] op_sel_hi:[1,0,1]
v_pk_fma_f32 v[92:93], v[100:101], v[222:223], v[92:93] op_sel_hi:[1,0,1]
v_pk_fma_f32 v[94:95], v[102:103], v[222:223], v[94:95] op_sel_hi:[1,0,1]
cP 88,88,89
cP 89,90,91
cP 90,92,93
cP 91,94,95
buffer_store_dwordx4 v[88:91], v0, s[12:15], s68 offen offset:0 sc1
s_add_u32 s68, s68, 4096
aR 104,112
aR 105,113
aR 106,114
aR 107,115
aR 108,120
aR 109,121
aR 110,122
aR 111,123
v_lshlrev_b32 v112, 16, v164
v_and_b32 v113, 0xffff0000, v164
v_lshlrev_b32 v114, 16, v165
v_and_b32 v115, 0xffff0000, v165
v_lshlrev_b32 v116, 16, v166
v_and_b32 v117, 0xffff0000, v166
v_lshlrev_b32 v118, 16, v167
v_and_b32 v119, 0xffff0000, v167
v_pk_mul_f32 v[104:105], v[104:105], v[216:217] op_sel_hi:[1,0]
v_pk_mul_f32 v[106:107], v[106:107], v[216:217] op_sel_hi:[1,0]
v_pk_mul_f32 v[108:109], v[108:109], v[216:217] op_sel_hi:[1,0]
v_pk_mul_f32 v[110:111], v[110:111], v[216:217] op_sel_hi:[1,0]
v_pk_fma_f32 v[104:105], v[112:113], v[220:221], v[104:105] op_sel_hi:[1,0,1]
v_pk_fma_f32 v[106:107], v[114:115], v[220:221], v[106:107] op_sel_hi:[1,0,1]
v_pk_fma_f32 v[108:109], v[116:117], v[220:221], v[108:109] op_sel_hi:[1,0,1]
v_pk_fma_f32 v[110:111], v[118:119], v[220:221], v[110:111] op_sel_hi:[1,0,1]
cP 104,104,105
cP 105,106,107
cP 106,108,109
cP 107,110,111
buffer_store_dwordx4 v[104:107], v0, s[12:15], s68 offen offset:0 sc1
s_add_u32 s68, s68, 4096
aR 120,116
aR 121,117
aR 122,118
aR 123,119
aR 124,124
aR 125,125
aR 126,126
aR 127,127
v_lshlrev_b32 v128, 16, v196
v_and_b32 v129, 0xffff0000, v196
v_lshlrev_b32 v130, 16, v197
v_and_b32 v131, 0xffff0000, v197
v_lshlrev_b32 v132, 16, v198
v_and_b32 v133, 0xffff0000, v198
v_lshlrev_b32 v134, 16, v199
v_and_b32 v135, 0xffff0000, v199
v_pk_mul_f32 v[120:121], v[120:121], v[218:219] op_sel_hi:[1,0]
v_pk_mul_f32 v[122:123], v[122:123], v[218:219] op_sel_hi:[1,0]
v_pk_mul_f32 v[124:125], v[124:125], v[218:219] op_sel_hi:[1,0]
v_pk_mul_f32 v[126:127], v[126:127], v[218:219] op_sel_hi:[1,0]
v_pk_fma_f32 v[120:121], v[128:129], v[222:223], v[120:121] op_sel_hi:[1,0,1]
v_pk_fma_f32 v[122:123], v[130:131], v[222:223], v[122:123] op_sel_hi:[1,0,1]
v_pk_fma_f32 v[124:125], v[132:133], v[222:223], v[124:125] op_sel_hi:[1,0,1]
v_pk_fma_f32 v[126:127], v[134:135], v[222:223], v[126:127] op_sel_hi:[1,0,1]
cP 120,120,121
cP 121,122,123
cP 122,124,125
cP 123,126,127
buffer_store_dwordx4 v[120:123], v0, s[12:15], s68 offen offset:0 sc1
s_add_u32 s68, s68, 4096
s_branch ATT_e_done
ATT_e_recv_n:
aR 72,0
aR 73,1
aR 74,2
aR 75,3
aR 76,8
aR 77,9
aR 78,10
aR 79,11
v_pk_mul_f32 v[72:73], v[72:73], v[216:217] op_sel_hi:[1,0]
v_pk_mul_f32 v[74:75], v[74:75], v[216:217] op_sel_hi:[1,0]
v_pk_mul_f32 v[76:77], v[76:77], v[216:217] op_sel_hi:[1,0]
v_pk_mul_f32 v[78:79], v[78:79], v[216:217] op_sel_hi:[1,0]
cP 72,72,73
cP 73,74,75
cP 74,76,77
cP 75,78,79
buffer_store_dwordx4 v[72:75], v0, s[12:15], s68 offen offset:0 sc1
s_add_u32 s68, s68, 4096
aR 88,4
aR 89,5
aR 90,6
aR 91,7
aR 92,12
aR 93,13
aR 94,14
aR 95,15
v_pk_mul_f32 v[88:89], v[88:89], v[218:219] op_sel_hi:[1,0]
v_pk_mul_f32 v[90:91], v[90:91], v[218:219] op_sel_hi:[1,0]
v_pk_mul_f32 v[92:93], v[92:93], v[218:219] op_sel_hi:[1,0]
v_pk_mul_f32 v[94:95], v[94:95], v[218:219] op_sel_hi:[1,0]
cP 88,88,89
cP 89,90,91
cP 90,92,93
cP 91,94,95
buffer_store_dwordx4 v[88:91], v0, s[12:15], s68 offen offset:0 sc1
s_add_u32 s68, s68, 4096
aR 104,16
aR 105,17
aR 106,18
aR 107,19
aR 108,24
aR 109,25
aR 110,26
aR 111,27
v_pk_mul_f32 v[104:105], v[104:105], v[216:217] op_sel_hi:[1,0]
v_pk_mul_f32 v[106:107], v[106:107], v[216:217] op_sel_hi:[1,0]
v_pk_mul_f32 v[108:109], v[108:109], v[216:217] op_sel_hi:[1,0]
v_pk_mul_f32 v[110:111], v[110:111], v[216:217] op_sel_hi:[1,0]
cP 104,104,105
cP 105,106,107
cP 106,108,109
cP 107,110,111
buffer_store_dwordx4 v[104:107], v0, s[12:15], s68 offen offset:0 sc1
s_add_u32 s68, s68, 4096
aR 120,20
aR 121,21
aR 122,22
aR 123,23
aR 124,28
aR 125,29
aR 126,30
aR 127,31
v_pk_mul_f32 v[120:121], v[120:121], v[218:219] op_sel_hi:[1,0]
v_pk_mul_f32 v[122:123], v[122:123], v[218:219] op_sel_hi:[1,0]
v_pk_mul_f32 v[124:125], v[124:125], v[218:219] op_sel_hi:[1,0]
v_pk_mul_f32 v[126:127], v[126:127], v[218:219] op_sel_hi:[1,0]
cP 120,120,121
cP 121,122,123
cP 122,124,125
cP 123,126,127
buffer_store_dwordx4 v[120:123], v0, s[12:15], s68 offen offset:0 sc1
s_add_u32 s68, s68, 4096
aR 72,32
aR 73,33
aR 74,34
aR 75,35
aR 76,40
aR 77,41
aR 78,42
aR 79,43
v_pk_mul_f32 v[72:73], v[72:73], v[216:217] op_sel_hi:[1,0]
v_pk_mul_f32 v[74:75], v[74:75], v[216:217] op_sel_hi:[1,0]
v_pk_mul_f32 v[76:77], v[76:77], v[216:217] op_sel_hi:[1,0]
v_pk_mul_f32 v[78:79], v[78:79], v[216:217] op_sel_hi:[1,0]
cP 72,72,73
cP 73,74,75
cP 74,76,77
cP 75,78,79
buffer_store_dwordx4 v[72:75], v0, s[12:15], s68 offen offset:0 sc1
s_add_u32 s68, s68, 4096
aR 88,36
aR 89,37
aR 90,38
aR 91,39
aR 92,44
aR 93,45
aR 94,46
aR 95,47
v_pk_mul_f32 v[88:89], v[88:89], v[218:219] op_sel_hi:[1,0]
v_pk_mul_f32 v[90:91], v[90:91], v[218:219] op_sel_hi:[1,0]
v_pk_mul_f32 v[92:93], v[92:93], v[218:219] op_sel_hi:[1,0]
v_pk_mul_f32 v[94:95], v[94:95], v[218:219] op_sel_hi:[1,0]
cP 88,88,89
cP 89,90,91
cP 90,92,93
cP 91,94,95
buffer_store_dwordx4 v[88:91], v0, s[12:15], s68 offen offset:0 sc1
s_add_u32 s68, s68, 4096
aR 104,48
aR 105,49
aR 106,50
aR 107,51
aR 108,56
aR 109,57
aR 110,58
aR 111,59
v_pk_mul_f32 v[104:105], v[104:105], v[216:217] op_sel_hi:[1,0]
v_pk_mul_f32 v[106:107], v[106:107], v[216:217] op_sel_hi:[1,0]
v_pk_mul_f32 v[108:109], v[108:109], v[216:217] op_sel_hi:[1,0]
v_pk_mul_f32 v[110:111], v[110:111], v[216:217] op_sel_hi:[1,0]
cP 104,104,105
cP 105,106,107
cP 106,108,109
cP 107,110,111
buffer_store_dwordx4 v[104:107], v0, s[12:15], s68 offen offset:0 sc1
s_add_u32 s68, s68, 4096
aR 120,52
aR 121,53
aR 122,54
aR 123,55
aR 124,60
aR 125,61
aR 126,62
aR 127,63
v_pk_mul_f32 v[120:121], v[120:121], v[218:219] op_sel_hi:[1,0]
v_pk_mul_f32 v[122:123], v[122:123], v[218:219] op_sel_hi:[1,0]
v_pk_mul_f32 v[124:125], v[124:125], v[218:219] op_sel_hi:[1,0]
v_pk_mul_f32 v[126:127], v[126:127], v[218:219] op_sel_hi:[1,0]
cP 120,120,121
cP 121,122,123
cP 122,124,125
cP 123,126,127
buffer_store_dwordx4 v[120:123], v0, s[12:15], s68 offen offset:0 sc1
s_add_u32 s68, s68, 4096
aR 72,64
aR 73,65
aR 74,66
aR 75,67
aR 76,72
aR 77,73
aR 78,74
aR 79,75
v_pk_mul_f32 v[72:73], v[72:73], v[216:217] op_sel_hi:[1,0]
v_pk_mul_f32 v[74:75], v[74:75], v[216:217] op_sel_hi:[1,0]
v_pk_mul_f32 v[76:77], v[76:77], v[216:217] op_sel_hi:[1,0]
v_pk_mul_f32 v[78:79], v[78:79], v[216:217] op_sel_hi:[1,0]
cP 72,72,73
cP 73,74,75
cP 74,76,77
cP 75,78,79
buffer_store_dwordx4 v[72:75], v0, s[12:15], s68 offen offset:0 sc1
s_add_u32 s68, s68, 4096
aR 88,68
aR 89,69
aR 90,70
aR 91,71
aR 92,76
aR 93,77
aR 94,78
aR 95,79
v_pk_mul_f32 v[88:89], v[88:89], v[218:219] op_sel_hi:[1,0]
v_pk_mul_f32 v[90:91], v[90:91], v[218:219] op_sel_hi:[1,0]
v_pk_mul_f32 v[92:93], v[92:93], v[218:219] op_sel_hi:[1,0]
v_pk_mul_f32 v[94:95], v[94:95], v[218:219] op_sel_hi:[1,0]
cP 88,88,89
cP 89,90,91
cP 90,92,93
cP 91,94,95
buffer_store_dwordx4 v[88:91], v0, s[12:15], s68 offen offset:0 sc1
s_add_u32 s68, s68, 4096
aR 104,80
aR 105,81
aR 106,82
aR 107,83
aR 108,88
aR 109,89
aR 110,90
aR 111,91
v_pk_mul_f32 v[104:105], v[104:105], v[216:217] op_sel_hi:[1,0]
v_pk_mul_f32 v[106:107], v[106:107], v[216:217] op_sel_hi:[1,0]
v_pk_mul_f32 v[108:109], v[108:109], v[216:217] op_sel_hi:[1,0]
v_pk_mul_f32 v[110:111], v[110:111], v[216:217] op_sel_hi:[1,0]
cP 104,104,105
cP 105,106,107
cP 106,108,109
cP 107,110,111
buffer_store_dwordx4 v[104:107], v0, s[12:15], s68 offen offset:0 sc1
s_add_u32 s68, s68, 4096
aR 120,84
aR 121,85
aR 122,86
aR 123,87
aR 124,92
aR 125,93
aR 126,94
aR 127,95
v_pk_mul_f32 v[120:121], v[120:121], v[218:219] op_sel_hi:[1,0]
v_pk_mul_f32 v[122:123], v[122:123], v[218:219] op_sel_hi:[1,0]
v_pk_mul_f32 v[124:125], v[124:125], v[218:219] op_sel_hi:[1,0]
v_pk_mul_f32 v[126:127], v[126:127], v[218:219] op_sel_hi:[1,0]
cP 120,120,121
cP 121,122,123
cP 122,124,125
cP 123,126,127
buffer_store_dwordx4 v[120:123], v0, s[12:15], s68 offen offset:0 sc1
s_add_u32 s68, s68, 4096
aR 72,96
aR 73,97
aR 74,98
aR 75,99
aR 76,104
aR 77,105
aR 78,106
aR 79,107
v_pk_mul_f32 v[72:73], v[72:73], v[216:217] op_sel_hi:[1,0]
v_pk_mul_f32 v[74:75], v[74:75], v[216:217] op_sel_hi:[1,0]
v_pk_mul_f32 v[76:77], v[76:77], v[216:217] op_sel_hi:[1,0]
v_pk_mul_f32 v[78:79], v[78:79], v[216:217] op_sel_hi:[1,0]
cP 72,72,73
cP 73,74,75
cP 74,76,77
cP 75,78,79
buffer_store_dwordx4 v[72:75], v0, s[12:15], s68 offen offset:0 sc1
s_add_u32 s68, s68, 4096
aR 88,100
aR 89,101
aR 90,102
aR 91,103
aR 92,108
aR 93,109
aR 94,110
aR 95,111
v_pk_mul_f32 v[88:89], v[88:89], v[218:219] op_sel_hi:[1,0]
v_pk_mul_f32 v[90:91], v[90:91], v[218:219] op_sel_hi:[1,0]
v_pk_mul_f32 v[92:93], v[92:93], v[218:219] op_sel_hi:[1,0]
v_pk_mul_f32 v[94:95], v[94:95], v[218:219] op_sel_hi:[1,0]
cP 88,88,89
cP 89,90,91
cP 90,92,93
cP 91,94,95
buffer_store_dwordx4 v[88:91], v0, s[12:15], s68 offen offset:0 sc1
s_add_u32 s68, s68, 4096
aR 104,112
aR 105,113
aR 106,114
aR 107,115
aR 108,120
aR 109,121
aR 110,122
aR 111,123
v_pk_mul_f32 v[104:105], v[104:105], v[216:217] op_sel_hi:[1,0]
v_pk_mul_f32 v[106:107], v[106:107], v[216:217] op_sel_hi:[1,0]
v_pk_mul_f32 v[108:109], v[108:109], v[216:217] op_sel_hi:[1,0]
v_pk_mul_f32 v[110:111], v[110:111], v[216:217] op_sel_hi:[1,0]
cP 104,104,105
cP 105,106,107
cP 106,108,109
cP 107,110,111
buffer_store_dwordx4 v[104:107], v0, s[12:15], s68 offen offset:0 sc1
s_add_u32 s68, s68, 4096
aR 120,116
aR 121,117
aR 122,118
aR 123,119
aR 124,124
aR 125,125
aR 126,126
aR 127,127
v_pk_mul_f32 v[120:121], v[120:121], v[218:219] op_sel_hi:[1,0]
v_pk_mul_f32 v[122:123], v[122:123], v[218:219] op_sel_hi:[1,0]
v_pk_mul_f32 v[124:125], v[124:125], v[218:219] op_sel_hi:[1,0]
v_pk_mul_f32 v[126:127], v[126:127], v[218:219] op_sel_hi:[1,0]
cP 120,120,121
cP 121,122,123
cP 122,124,125
cP 123,126,127
buffer_store_dwordx4 v[120:123], v0, s[12:15], s68 offen offset:0 sc1
s_add_u32 s68, s68, 4096
ATT_e_done:
MG_jend:
s_barrier
MG_next:
s_load_dwordx4 s[76:79], s[46:47], 0
s_add_u32 s46, s46, 16
s_addc_u32 s47, s47, 0
s_waitcnt lgkmcnt(0)
s_and_b32 s50, s77, 255
s_bfe_u32 s51, s77, 0x80008
s_lshr_b32 s55, s77, 16
s_and_b32 s52, s78, 255
s_bfe_u32 s53, s78, 0x80008
s_lshr_b32 s54, s78, 16
s_mov_b32 s56, s79
MG_disp:
s_cmp_eq_u32 s76, 0
s_cbranch_scc1 MG_fin
s_bitcmp1_b32 s76, 1
s_cbranch_scc0 ATT_job
s_mov_b32 s4, s36
s_mov_b32 s5, s37
s_mov_b32 s6, 8388608
s_mov_b32 s7, 0x20000
s_mov_b32 s8, s38
s_mov_b32 s9, s39
s_mov_b32 s10, 4096
s_mov_b32 s11, 0x20000
s_and_b32 s56, s77, 255
s_lshr_b32 s57, s77, 8
s_lshr_b32 s58, s3, 1
s_and_b32 s59, s3, 1
s_lshl_b32 s55, s56, 20
s_lshl_b32 s51, s57, 13
s_add_u32 s51, s51, 75497472
s_lshl_b32 s64, s59, 7
s_mul_i32 s54, s3, 262144
s_add_u32 s55, s55, s54
s_mul_i32 s54, s3, 8192
v_lshrrev_b32 v15, 3, v1
v_mul_u32_u24 v15, 4096, v15
v_bfe_u32 v17, v1, 4, 2
v_and_b32 v16, 7, v1
v_xor_b32 v16, v16, v17
v_lshl_add_u32 v15, v16, 4, v15
v_add_u32 v5, 0, v15
v_xor_b32 v6, 64, v15
v_add_u32 v6, 31744, v6
v_add_u32 v7, 63488, v15
v_add_u32 v8, 63488, v6
v_add_u32 v9, 131072, v15
v_add_u32 v10, 131072, v6
v_add_u32 v11, 194560, v15
v_add_u32 v12, 194560, v6
s_mov_b32 s53, 0
s_lshl_b32 s60, s58, 2
s_mul_i32 s50, s3, 2048
s_add_u32 s51, s51, s50
v_lshlrev_b32 v2, 4, v1
s_lshl_b32 s101, s60, 10
s_add_u32 s101, s101, 98304
v_add_u32 v3, s101, v2
s_add_u32 s65, s55, 4096
s_add_u32 s66, s51, 3670016
s_mul_i32 s60, s57, 37
s_lshr_b32 s60, s60, 3
s_lshl_b32 s62, s60, 7
s_add_u32 s55, s55, s62
s_mul_i32 s62, s60, 114688
s_add_u32 s51, s51, s62
s_add_u32 s100, s54, s53
s_add_u32 m0, s100, 0
s_nop 0
dL 5,4,55,0
dL 6,4,55,1024
dL 7,4,55,2048
dL 8,4,55,3072
s_add_u32 s100, s54, s53
s_add_u32 m0, s100, 4096
s_nop 0
dL 9,4,55,0
dL 10,4,55,1024
dL 11,4,55,2048
dL 12,4,55,3072
s_add_u32 s55, s55, 128
s_cmp_ge_u32 s55, s65
s_cselect_b32 s101, 4096, 0
s_sub_u32 s55, s55, s101
s_add_u32 s53, s53, 32768
s_cmp_lt_u32 s53, 98304
s_cselect_b32 s53, s53, 0
s_add_u32 m0, s50, 98304
s_nop 0
dS 2,12,51,0
dS 2,12,51,1024
s_add_u32 s51, s51, 57344
s_cmp_ge_u32 s51, s66
s_cselect_b32 s101, 3670016, 0
s_sub_u32 s51, s51, s101
s_add_u32 m0, s50, 106496
s_nop 0
dS 2,12,51,0
dS 2,12,51,1024
s_add_u32 s51, s51, 57344
s_cmp_ge_u32 s51, s66
s_cselect_b32 s101, 3670016, 0
s_sub_u32 s51, s51, s101
s_add_u32 s100, s54, s53
s_add_u32 m0, s100, 0
s_nop 0
dL 5,4,55,0
dL 6,4,55,1024
dL 7,4,55,2048
dL 8,4,55,3072
s_add_u32 s100, s54, s53
s_add_u32 m0, s100, 4096
s_nop 0
dL 9,4,55,0
dL 10,4,55,1024
dL 11,4,55,2048
dL 12,4,55,3072
s_add_u32 s55, s55, 128
s_cmp_ge_u32 s55, s65
s_cselect_b32 s101, 4096, 0
s_sub_u32 s55, s55, s101
s_add_u32 s53, s53, 32768
s_cmp_lt_u32 s53, 98304
s_cselect_b32 s53, s53, 0
s_add_u32 m0, s50, 114688
s_nop 0
dS 2,12,51,0
dS 2,12,51,1024
s_add_u32 s51, s51, 57344
s_cmp_ge_u32 s51, s66
s_cselect_b32 s101, 3670016, 0
s_sub_u32 s51, s51, s101
s_add_u32 m0, s50, 122880
s_nop 0
dS 2,12,51,0
dS 2,12,51,1024
s_add_u32 s51, s51, 57344
s_cmp_ge_u32 s51, s66
s_cselect_b32 s101, 3670016, 0
s_sub_u32 s51, s51, s101
s_add_u32 s100, s54, s53
s_add_u32 m0, s100, 0
s_nop 0
dL 5,4,55,0
dL 6,4,55,1024
dL 7,4,55,2048
dL 8,4,55,3072
s_add_u32 s100, s54, s53
s_add_u32 m0, s100, 4096
s_nop 0
dL 9,4,55,0
dL 10,4,55,1024
dL 11,4,55,2048
dL 12,4,55,3072
s_add_u32 s55, s55, 128
s_cmp_ge_u32 s55, s65
s_cselect_b32 s101, 4096, 0
s_sub_u32 s55, s55, s101
s_add_u32 s53, s53, 32768
s_cmp_lt_u32 s53, 98304
s_cselect_b32 s53, s53, 0
s_add_u32 m0, s50, 131072
s_nop 0
dS 2,12,51,0
dS 2,12,51,1024
s_add_u32 s51, s51, 57344
s_cmp_ge_u32 s51, s66
s_cselect_b32 s101, 3670016, 0
s_sub_u32 s51, s51, s101
s_add_u32 m0, s50, 139264
s_nop 0
dS 2,12,51,0
dS 2,12,51,1024
s_add_u32 s51, s51, 57344
s_cmp_ge_u32 s51, s66
s_cselect_b32 s101, 3670016, 0
s_sub_u32 s51, s51, s101
s_add_u32 m0, s50, 147456
s_nop 0
dS 2,12,51,0
dS 2,12,51,1024
s_add_u32 s51, s51, 57344
s_cmp_ge_u32 s51, s66
s_cselect_b32 s101, 3670016, 0
s_sub_u32 s51, s51, s101
s_add_u32 m0, s50, 155648
s_nop 0
dS 2,12,51,0
dS 2,12,51,1024
s_add_u32 s51, s51, 57344
s_cmp_ge_u32 s51, s66
s_cselect_b32 s101, 3670016, 0
s_sub_u32 s51, s51, s101
v_and_b32 v15, 15, v1
v_lshrrev_b32 v16, 1, v15
v_lshrrev_b32 v17, 4, v1
v_xor_b32 v16, v16, v17
v_add_u32 v15, s64, v15
v_lshlrev_b32 v15, 7, v15
v_lshl_add_u32 v13, v16, 4, v15
v_mov_b32 v4, v13
s_mov_b32 s52, 0
v_xor_b32 v14, 64, v13
s_waitcnt vmcnt(28)
s_barrier
rB 32,3,0
rB 36,3,1024
rB 40,3,2048
rB 44,3,3072
rB 48,13,0
rB 52,13,2048
rB 56,13,4096
rB 60,13,6144
rB 64,13,8192
rB 68,13,10240
rB 72,13,12288
rB 76,13,14336
s_waitcnt lgkmcnt(0)
s_barrier
v_lshl_add_u32 v128, s3, 6, v1
v_cmp_eq_u32 vcc, 0, v128
v_mov_b32 v128, 0x40000000
v_mov_b32 v129, 1
v_cndmask_b32 v128, v128, 0, vcc
buffer_atomic_add v129, v128, s[12:15], s18 offen
buffer_atomic_add v129, v128, s[12:15], s19 offen
s_mov_b32 s18, 0x80000000
s_mov_b32 s19, 0x80000000
mAz 0,32,48
rB 80,3,8192
s_add_u32 m0, s50, 98304
mAz 32,36,48
rB 84,3,9216
mAz 36,36,52
rB 88,3,10240
mAz 4,32,52
rB 92,3,11264
mAz 8,32,56
mAz 40,36,56
rB 96,14,0
mAz 44,36,60
dS 2,12,51,0
mAz 12,32,60
rB 100,14,2048
rB 104,14,4096
mAz 16,32,64
mAz 48,36,64
rB 108,14,6144
mAz 52,36,68
rB 112,14,8192
mAz 20,32,68
rB 116,14,10240
mAz 24,32,72
dS 2,12,51,1024
mAz 56,36,72
rB 120,14,12288
mAz 60,36,76
rB 124,14,14336
mAz 28,32,76
s_add_u32 s52, s52, 32768
s_cmp_lt_u32 s52, 98304
s_cselect_b32 s52, s52, 0
mAz 92,40,76
v_add_u32 v13, s52, v4
mAz 124,44,76
mAz 120,44,72
s_add_u32 s51, s51, 57344
v_xor_b32 v14, 64, v13
mAz 88,40,72
mAz 84,40,68
mAz 116,44,68
mAz 112,44,64
mAz 80,40,64
mAz 76,40,60
s_cmp_ge_u32 s51, s66
s_cselect_b32 s101, 3670016, 0
s_sub_u32 s51, s51, s101
mAz 108,44,60
s_waitcnt lgkmcnt(0)
s_waitcnt vmcnt(20)
s_barrier
mAz 104,44,56
mAz 72,40,56
mAz 68,40,52
mAz 100,44,52
mAz 96,44,48
mAz 64,40,48
mA 0,80,96
rB 32,3,16384
mA 32,84,96
s_add_u32 s100, s54, s53
s_add_u32 m0, s100, 0
rB 36,3,17408
mA 36,84,100
dL 5,4,55,0
mA 4,80,100
rB 40,3,18432
mA 8,80,104
dL 6,4,55,1024
mA 40,84,104
rB 44,3,19456
mA 44,84,108
rB 48,13,0
mA 12,80,108
dL 7,4,55,2048
mA 16,80,112
rB 52,13,2048
mA 48,84,112
dL 8,4,55,3072
mA 52,84,116
rB 56,13,4096
mA 20,80,116
rB 60,13,6144
mA 24,80,120
s_add_u32 s100, s54, s53
s_add_u32 m0, s100, 4096
mA 56,84,120
rB 64,13,8192
mA 60,84,124
dL 9,4,55,0
mA 28,80,124
rB 68,13,10240
mA 92,88,124
rB 72,13,12288
mA 124,92,124
dL 10,4,55,1024
mA 120,92,120
rB 76,13,14336
mA 88,88,120
dL 11,4,55,2048
mA 84,88,116
mA 116,92,116
dL 12,4,55,3072
mA 112,92,112
mA 80,88,112
s_add_u32 s55, s55, 128
mA 76,88,108
mA 108,92,108
s_waitcnt lgkmcnt(0)
mA 104,92,104
s_cmp_ge_u32 s55, s65
s_cselect_b32 s101, 4096, 0
s_sub_u32 s55, s55, s101
mA 72,88,104
mA 68,88,100
s_add_u32 s53, s53, 32768
s_cmp_lt_u32 s53, 98304
s_cselect_b32 s53, s53, 0
mA 100,92,100
mA 96,92,96
mA 64,88,96
mA 0,32,48
rB 80,3,24576
s_add_u32 m0, s50, 106496
mA 32,36,48
rB 84,3,25600
mA 36,36,52
rB 88,3,26624
mA 4,32,52
rB 92,3,27648
mA 8,32,56
mA 40,36,56
rB 96,14,0
mA 44,36,60
dS 2,12,51,0
mA 12,32,60
rB 100,14,2048
rB 104,14,4096
mA 16,32,64
mA 48,36,64
rB 108,14,6144
mA 52,36,68
rB 112,14,8192
mA 20,32,68
rB 116,14,10240
mA 24,32,72
dS 2,12,51,1024
mA 56,36,72
rB 120,14,12288
mA 60,36,76
rB 124,14,14336
mA 28,32,76
s_add_u32 s52, s52, 32768
s_cmp_lt_u32 s52, 98304
s_cselect_b32 s52, s52, 0
mA 92,40,76
v_add_u32 v13, s52, v4
mA 124,44,76
mA 120,44,72
s_add_u32 s51, s51, 57344
v_xor_b32 v14, 64, v13
mA 88,40,72
mA 84,40,68
mA 116,44,68
mA 112,44,64
mA 80,40,64
mA 76,40,60
s_cmp_ge_u32 s51, s66
s_cselect_b32 s101, 3670016, 0
s_sub_u32 s51, s51, s101
mA 108,44,60
s_waitcnt lgkmcnt(0)
s_waitcnt vmcnt(18)
s_barrier
mA 104,44,56
mA 72,40,56
mA 68,40,52
mA 100,44,52
mA 96,44,48
mA 64,40,48
mA 0,80,96
rB 32,3,32768
mA 32,84,96
s_add_u32 s100, s54, s53
s_add_u32 m0, s100, 0
rB 36,3,33792
mA 36,84,100
dL 5,4,55,0
mA 4,80,100
rB 40,3,34816
mA 8,80,104
dL 6,4,55,1024
mA 40,84,104
rB 44,3,35840
mA 44,84,108
rB 48,13,0
mA 12,80,108
dL 7,4,55,2048
mA 16,80,112
rB 52,13,2048
mA 48,84,112
dL 8,4,55,3072
mA 52,84,116
rB 56,13,4096
mA 20,80,116
rB 60,13,6144
mA 24,80,120
s_add_u32 s100, s54, s53
s_add_u32 m0, s100, 4096
mA 56,84,120
rB 64,13,8192
mA 60,84,124
dL 9,4,55,0
mA 28,80,124
rB 68,13,10240
mA 92,88,124
rB 72,13,12288
mA 124,92,124
dL 10,4,55,1024
mA 120,92,120
rB 76,13,14336
mA 88,88,120
dL 11,4,55,2048
mA 84,88,116
mA 116,92,116
dL 12,4,55,3072
mA 112,92,112
mA 80,88,112
s_add_u32 s55, s55, 128
mA 76,88,108
mA 108,92,108
s_waitcnt lgkmcnt(0)
mA 104,92,104
s_cmp_ge_u32 s55, s65
s_cselect_b32 s101, 4096, 0
s_sub_u32 s55, s55, s101
mA 72,88,104
mA 68,88,100
s_add_u32 s53, s53, 32768
s_cmp_lt_u32 s53, 98304
s_cselect_b32 s53, s53, 0
mA 100,92,100
mA 96,92,96
mA 64,88,96
mA 0,32,48
rB 80,3,40960
s_add_u32 m0, s50, 114688
mA 32,36,48
rB 84,3,41984
mA 36,36,52
rB 88,3,43008
mA 4,32,52
dS 2,12,51,0
mA 8,32,56
rB 92,3,44032
mA 40,36,56
rB 96,14,0
mA 44,36,60
dS 2,12,51,1024
mA 12,32,60
rB 100,14,2048
rB 104,14,4096
mA 16,32,64
mA 48,36,64
s_add_u32 s51, s51, 57344
rB 108,14,6144
mA 52,36,68
rB 112,14,8192
mA 20,32,68
rB 116,14,10240
mA 24,32,72
s_cmp_ge_u32 s51, s66
s_cselect_b32 s101, 3670016, 0
s_sub_u32 s51, s51, s101
mA 56,36,72
rB 120,14,12288
mA 60,36,76
rB 124,14,14336
mA 28,32,76
s_add_u32 m0, s50, 122880
mA 92,40,76
s_add_u32 s52, s52, 32768
s_cmp_lt_u32 s52, 98304
s_cselect_b32 s52, s52, 0
mA 124,44,76
v_add_u32 v13, s52, v4
mA 120,44,72
dS 2,12,51,0
mA 88,40,72
v_xor_b32 v14, 64, v13
mA 84,40,68
mA 116,44,68
dS 2,12,51,1024
mA 112,44,64
mA 80,40,64
mA 76,40,60
s_add_u32 s51, s51, 57344
mA 108,44,60
s_waitcnt lgkmcnt(0)
s_waitcnt vmcnt(14)
s_barrier
mA 104,44,56
mA 72,40,56
s_cmp_ge_u32 s51, s66
s_cselect_b32 s101, 3670016, 0
s_sub_u32 s51, s51, s101
mA 68,40,52
mA 100,44,52
mA 96,44,48
mA 64,40,48
s_mov_b32 s61, 4
SP_loop:
mA 0,80,96
rB 32,3,49152
mA 32,84,96
s_add_u32 s100, s54, s53
s_add_u32 m0, s100, 0
rB 36,3,50176
mA 36,84,100
dL 5,4,55,0
mA 4,80,100
rB 40,3,51200
mA 8,80,104
dL 6,4,55,1024
mA 40,84,104
rB 44,3,52224
mA 44,84,108
rB 48,13,0
mA 12,80,108
dL 7,4,55,2048
mA 16,80,112
rB 52,13,2048
mA 48,84,112
dL 8,4,55,3072
mA 52,84,116
rB 56,13,4096
mA 20,80,116
rB 60,13,6144
mA 24,80,120
s_add_u32 s100, s54, s53
s_add_u32 m0, s100, 4096
mA 56,84,120
rB 64,13,8192
mA 60,84,124
dL 9,4,55,0
mA 28,80,124
rB 68,13,10240
mA 92,88,124
rB 72,13,12288
mA 124,92,124
dL 10,4,55,1024
mA 120,92,120
rB 76,13,14336
mA 88,88,120
dL 11,4,55,2048
mA 84,88,116
mA 116,92,116
dL 12,4,55,3072
mA 112,92,112
mA 80,88,112
s_add_u32 s55, s55, 128
mA 76,88,108
mA 108,92,108
s_waitcnt lgkmcnt(0)
mA 104,92,104
s_cmp_ge_u32 s55, s65
s_cselect_b32 s101, 4096, 0
s_sub_u32 s55, s55, s101
mA 72,88,104
mA 68,88,100
s_add_u32 s53, s53, 32768
s_cmp_lt_u32 s53, 98304
s_cselect_b32 s53, s53, 0
mA 100,92,100
mA 96,92,96
mA 64,88,96
mA 0,32,48
rB 80,3,57344
s_add_u32 m0, s50, 131072
mA 32,36,48
rB 84,3,58368
mA 36,36,52
rB 88,3,59392
mA 4,32,52
dS 2,12,51,0
mA 8,32,56
rB 92,3,60416
mA 40,36,56
rB 96,14,0
mA 44,36,60
dS 2,12,51,1024
mA 12,32,60
rB 100,14,2048
rB 104,14,4096
mA 16,32,64
mA 48,36,64
s_add_u32 s51, s51, 57344
rB 108,14,6144
mA 52,36,68
rB 112,14,8192
mA 20,32,68
rB 116,14,10240
mA 24,32,72
s_cmp_ge_u32 s51, s66
s_cselect_b32 s101, 3670016, 0
s_sub_u32 s51, s51, s101
mA 56,36,72
rB 120,14,12288
mA 60,36,76
rB 124,14,14336
mA 28,32,76
s_add_u32 m0, s50, 139264
mA 92,40,76
s_add_u32 s52, s52, 32768
s_cmp_lt_u32 s52, 98304
s_cselect_b32 s52, s52, 0
mA 124,44,76
v_add_u32 v13, s52, v4
mA 120,44,72
dS 2,12,51,0
mA 88,40,72
v_xor_b32 v14, 64, v13
mA 84,40,68
mA 116,44,68
dS 2,12,51,1024
mA 112,44,64
mA 80,40,64
mA 76,40,60
s_add_u32 s51, s51, 57344
mA 108,44,60
s_waitcnt lgkmcnt(0)
s_waitcnt vmcnt(16)
s_barrier
mA 104,44,56
mA 72,40,56
s_cmp_ge_u32 s51, s66
s_cselect_b32 s101, 3670016, 0
s_sub_u32 s51, s51, s101
mA 68,40,52
mA 100,44,52
mA 96,44,48
mA 64,40,48
mA 0,80,96
rB 32,3,0
mA 32,84,96
s_add_u32 s100, s54, s53
s_add_u32 m0, s100, 0
rB 36,3,1024
mA 36,84,100
dL 5,4,55,0
mA 4,80,100
rB 40,3,2048
mA 8,80,104
dL 6,4,55,1024
mA 40,84,104
rB 44,3,3072
mA 44,84,108
rB 48,13,0
mA 12,80,108
dL 7,4,55,2048
mA 16,80,112
rB 52,13,2048
mA 48,84,112
dL 8,4,55,3072
mA 52,84,116
rB 56,13,4096
mA 20,80,116
rB 60,13,6144
mA 24,80,120
s_add_u32 s100, s54, s53
s_add_u32 m0, s100, 4096
mA 56,84,120
rB 64,13,8192
mA 60,84,124
dL 9,4,55,0
mA 28,80,124
rB 68,13,10240
mA 92,88,124
rB 72,13,12288
mA 124,92,124
dL 10,4,55,1024
mA 120,92,120
rB 76,13,14336
mA 88,88,120
dL 11,4,55,2048
mA 84,88,116
mA 116,92,116
dL 12,4,55,3072
mA 112,92,112
mA 80,88,112
s_add_u32 s55, s55, 128
mA 76,88,108
mA 108,92,108
s_waitcnt lgkmcnt(0)
mA 104,92,104
s_cmp_ge_u32 s55, s65
s_cselect_b32 s101, 4096, 0
s_sub_u32 s55, s55, s101
mA 72,88,104
mA 68,88,100
s_add_u32 s53, s53, 32768
s_cmp_lt_u32 s53, 98304
s_cselect_b32 s53, s53, 0
mA 100,92,100
mA 96,92,96
mA 64,88,96
mA 0,32,48
rB 80,3,8192
s_add_u32 m0, s50, 147456
mA 32,36,48
rB 84,3,9216
mA 36,36,52
rB 88,3,10240
mA 4,32,52
dS 2,12,51,0
mA 8,32,56
rB 92,3,11264
mA 40,36,56
rB 96,14,0
mA 44,36,60
dS 2,12,51,1024
mA 12,32,60
rB 100,14,2048
rB 104,14,4096
mA 16,32,64
mA 48,36,64
s_add_u32 s51, s51, 57344
rB 108,14,6144
mA 52,36,68
rB 112,14,8192
mA 20,32,68
rB 116,14,10240
mA 24,32,72
s_cmp_ge_u32 s51, s66
s_cselect_b32 s101, 3670016, 0
s_sub_u32 s51, s51, s101
mA 56,36,72
rB 120,14,12288
mA 60,36,76
rB 124,14,14336
mA 28,32,76
s_add_u32 m0, s50, 155648
mA 92,40,76
s_add_u32 s52, s52, 32768
s_cmp_lt_u32 s52, 98304
s_cselect_b32 s52, s52, 0
mA 124,44,76
v_add_u32 v13, s52, v4
mA 120,44,72
dS 2,12,51,0
mA 88,40,72
v_xor_b32 v14, 64, v13
mA 84,40,68
mA 116,44,68
dS 2,12,51,1024
mA 112,44,64
mA 80,40,64
mA 76,40,60
s_add_u32 s51, s51, 57344
mA 108,44,60
s_waitcnt lgkmcnt(0)
s_waitcnt vmcnt(16)
s_barrier
mA 104,44,56
mA 72,40,56
s_cmp_ge_u32 s51, s66
s_cselect_b32 s101, 3670016, 0
s_sub_u32 s51, s51, s101
mA 68,40,52
mA 100,44,52
mA 96,44,48
mA 64,40,48
mA 0,80,96
rB 32,3,16384
mA 32,84,96
s_add_u32 s100, s54, s53
s_add_u32 m0, s100, 0
rB 36,3,17408
mA 36,84,100
dL 5,4,55,0
mA 4,80,100
rB 40,3,18432
mA 8,80,104
dL 6,4,55,1024
mA 40,84,104
rB 44,3,19456
mA 44,84,108
rB 48,13,0
mA 12,80,108
dL 7,4,55,2048
mA 16,80,112
rB 52,13,2048
mA 48,84,112
dL 8,4,55,3072
mA 52,84,116
rB 56,13,4096
mA 20,80,116
rB 60,13,6144
mA 24,80,120
s_add_u32 s100, s54, s53
s_add_u32 m0, s100, 4096
mA 56,84,120
rB 64,13,8192
mA 60,84,124
dL 9,4,55,0
mA 28,80,124
rB 68,13,10240
mA 92,88,124
rB 72,13,12288
mA 124,92,124
dL 10,4,55,1024
mA 120,92,120
rB 76,13,14336
mA 88,88,120
dL 11,4,55,2048
mA 84,88,116
mA 116,92,116
dL 12,4,55,3072
mA 112,92,112
mA 80,88,112
s_add_u32 s55, s55, 128
mA 76,88,108
mA 108,92,108
s_waitcnt lgkmcnt(0)
mA 104,92,104
s_cmp_ge_u32 s55, s65
s_cselect_b32 s101, 4096, 0
s_sub_u32 s55, s55, s101
mA 72,88,104
mA 68,88,100
s_add_u32 s53, s53, 32768
s_cmp_lt_u32 s53, 98304
s_cselect_b32 s53, s53, 0
mA 100,92,100
mA 96,92,96
mA 64,88,96
mA 0,32,48
rB 80,3,24576
s_add_u32 m0, s50, 98304
mA 32,36,48
rB 84,3,25600
mA 36,36,52
rB 88,3,26624
mA 4,32,52
dS 2,12,51,0
mA 8,32,56
rB 92,3,27648
mA 40,36,56
rB 96,14,0
mA 44,36,60
dS 2,12,51,1024
mA 12,32,60
rB 100,14,2048
rB 104,14,4096
mA 16,32,64
mA 48,36,64
s_add_u32 s51, s51, 57344
rB 108,14,6144
mA 52,36,68
rB 112,14,8192
mA 20,32,68
rB 116,14,10240
mA 24,32,72
s_cmp_ge_u32 s51, s66
s_cselect_b32 s101, 3670016, 0
s_sub_u32 s51, s51, s101
mA 56,36,72
rB 120,14,12288
mA 60,36,76
rB 124,14,14336
mA 28,32,76
s_add_u32 m0, s50, 106496
mA 92,40,76
s_add_u32 s52, s52, 32768
s_cmp_lt_u32 s52, 98304
s_cselect_b32 s52, s52, 0
mA 124,44,76
v_add_u32 v13, s52, v4
mA 120,44,72
dS 2,12,51,0
mA 88,40,72
v_xor_b32 v14, 64, v13
mA 84,40,68
mA 116,44,68
dS 2,12,51,1024
mA 112,44,64
mA 80,40,64
mA 76,40,60
s_add_u32 s51, s51, 57344
mA 108,44,60
s_waitcnt lgkmcnt(0)
s_waitcnt vmcnt(16)
s_barrier
mA 104,44,56
mA 72,40,56
s_cmp_ge_u32 s51, s66
s_cselect_b32 s101, 3670016, 0
s_sub_u32 s51, s51, s101
mA 68,40,52
mA 100,44,52
mA 96,44,48
mA 64,40,48
mA 0,80,96
rB 32,3,32768
mA 32,84,96
s_add_u32 s100, s54, s53
s_add_u32 m0, s100, 0
rB 36,3,33792
mA 36,84,100
dL 5,4,55,0
mA 4,80,100
rB 40,3,34816
mA 8,80,104
dL 6,4,55,1024
mA 40,84,104
rB 44,3,35840
mA 44,84,108
rB 48,13,0
mA 12,80,108
dL 7,4,55,2048
mA 16,80,112
rB 52,13,2048
mA 48,84,112
dL 8,4,55,3072
mA 52,84,116
rB 56,13,4096
mA 20,80,116
rB 60,13,6144
mA 24,80,120
s_add_u32 s100, s54, s53
s_add_u32 m0, s100, 4096
mA 56,84,120
rB 64,13,8192
mA 60,84,124
dL 9,4,55,0
mA 28,80,124
rB 68,13,10240
mA 92,88,124
rB 72,13,12288
mA 124,92,124
dL 10,4,55,1024
mA 120,92,120
rB 76,13,14336
mA 88,88,120
dL 11,4,55,2048
mA 84,88,116
mA 116,92,116
dL 12,4,55,3072
mA 112,92,112
mA 80,88,112
s_add_u32 s55, s55, 128
mA 76,88,108
mA 108,92,108
s_waitcnt lgkmcnt(0)
mA 104,92,104
s_cmp_ge_u32 s55, s65
s_cselect_b32 s101, 4096, 0
s_sub_u32 s55, s55, s101
mA 72,88,104
mA 68,88,100
s_add_u32 s53, s53, 32768
s_cmp_lt_u32 s53, 98304
s_cselect_b32 s53, s53, 0
mA 100,92,100
mA 96,92,96
mA 64,88,96
mA 0,32,48
rB 80,3,40960
s_add_u32 m0, s50, 114688
mA 32,36,48
rB 84,3,41984
mA 36,36,52
rB 88,3,43008
mA 4,32,52
dS 2,12,51,0
mA 8,32,56
rB 92,3,44032
mA 40,36,56
rB 96,14,0
mA 44,36,60
dS 2,12,51,1024
mA 12,32,60
rB 100,14,2048
rB 104,14,4096
mA 16,32,64
mA 48,36,64
s_add_u32 s51, s51, 57344
rB 108,14,6144
mA 52,36,68
rB 112,14,8192
mA 20,32,68
rB 116,14,10240
mA 24,32,72
s_cmp_ge_u32 s51, s66
s_cselect_b32 s101, 3670016, 0
s_sub_u32 s51, s51, s101
mA 56,36,72
rB 120,14,12288
mA 60,36,76
rB 124,14,14336
mA 28,32,76
s_add_u32 m0, s50, 122880
mA 92,40,76
s_add_u32 s52, s52, 32768
s_cmp_lt_u32 s52, 98304
s_cselect_b32 s52, s52, 0
mA 124,44,76
v_add_u32 v13, s52, v4
mA 120,44,72
dS 2,12,51,0
mA 88,40,72
v_xor_b32 v14, 64, v13
mA 84,40,68
mA 116,44,68
dS 2,12,51,1024
mA 112,44,64
mA 80,40,64
mA 76,40,60
s_add_u32 s51, s51, 57344
mA 108,44,60
s_waitcnt lgkmcnt(0)
s_waitcnt vmcnt(16)
s_barrier
mA 104,44,56
mA 72,40,56
s_cmp_ge_u32 s51, s66
s_cselect_b32 s101, 3670016, 0
s_sub_u32 s51, s51, s101
mA 68,40,52
mA 100,44,52
mA 96,44,48
mA 64,40,48
s_sub_u32 s61, s61, 1
s_cmp_lg_u32 s61, 0
s_cbranch_scc1 SP_loop
mA 0,80,96
rB 32,3,49152
mA 32,84,96
s_add_u32 s100, s54, s53
s_add_u32 m0, s100, 0
rB 36,3,50176
mA 36,84,100
dL 5,4,55,0
mA 4,80,100
rB 40,3,51200
mA 8,80,104
dL 6,4,55,1024
mA 40,84,104
rB 44,3,52224
mA 44,84,108
rB 48,13,0
mA 12,80,108
dL 7,4,55,2048
mA 16,80,112
rB 52,13,2048
mA 48,84,112
dL 8,4,55,3072
mA 52,84,116
rB 56,13,4096
mA 20,80,116
rB 60,13,6144
mA 24,80,120
s_add_u32 s100, s54, s53
s_add_u32 m0, s100, 4096
mA 56,84,120
rB 64,13,8192
mA 60,84,124
dL 9,4,55,0
mA 28,80,124
rB 68,13,10240
mA 92,88,124
rB 72,13,12288
mA 124,92,124
dL 10,4,55,1024
mA 120,92,120
rB 76,13,14336
mA 88,88,120
dL 11,4,55,2048
mA 84,88,116
mA 116,92,116
dL 12,4,55,3072
mA 112,92,112
mA 80,88,112
s_add_u32 s55, s55, 128
mA 76,88,108
mA 108,92,108
s_waitcnt lgkmcnt(0)
mA 104,92,104
s_cmp_ge_u32 s55, s65
s_cselect_b32 s101, 4096, 0
s_sub_u32 s55, s55, s101
mA 72,88,104
mA 68,88,100
s_add_u32 s53, s53, 32768
s_cmp_lt_u32 s53, 98304
s_cselect_b32 s53, s53, 0
mA 100,92,100
mA 96,92,96
mA 64,88,96
mA 0,32,48
rB 80,3,57344
s_add_u32 m0, s50, 131072
mA 32,36,48
rB 84,3,58368
mA 36,36,52
rB 88,3,59392
mA 4,32,52
dS 2,12,51,0
mA 8,32,56
rB 92,3,60416
mA 40,36,56
rB 96,14,0
mA 44,36,60
dS 2,12,51,1024
mA 12,32,60
rB 100,14,2048
rB 104,14,4096
mA 16,32,64
mA 48,36,64
s_add_u32 s51, s51, 57344
rB 108,14,6144
mA 52,36,68
rB 112,14,8192
mA 20,32,68
rB 116,14,10240
mA 24,32,72
s_cmp_ge_u32 s51, s66
s_cselect_b32 s101, 3670016, 0
s_sub_u32 s51, s51, s101
mA 56,36,72
rB 120,14,12288
mA 60,36,76
rB 124,14,14336
mA 28,32,76
s_add_u32 m0, s50, 139264
mA 92,40,76
s_add_u32 s52, s52, 32768
s_cmp_lt_u32 s52, 98304
s_cselect_b32 s52, s52, 0
mA 124,44,76
v_add_u32 v13, s52, v4
mA 120,44,72
dS 2,12,51,0
mA 88,40,72
v_xor_b32 v14, 64, v13
mA 84,40,68
mA 116,44,68
dS 2,12,51,1024
mA 112,44,64
mA 80,40,64
mA 76,40,60
s_add_u32 s51, s51, 57344
mA 108,44,60
s_waitcnt lgkmcnt(0)
s_waitcnt vmcnt(16)
s_barrier
mA 104,44,56
mA 72,40,56
s_cmp_ge_u32 s51, s66
s_cselect_b32 s101, 3670016, 0
s_sub_u32 s51, s51, s101
mA 68,40,52
mA 100,44,52
mA 96,44,48
mA 64,40,48
mA 0,80,96
rB 32,3,0
mA 32,84,96
s_add_u32 s100, s54, s53
s_add_u32 m0, s100, 0
rB 36,3,1024
mA 36,84,100
dL 5,4,55,0
mA 4,80,100
rB 40,3,2048
mA 8,80,104
dL 6,4,55,1024
mA 40,84,104
rB 44,3,3072
mA 44,84,108
rB 48,13,0
mA 12,80,108
dL 7,4,55,2048
mA 16,80,112
rB 52,13,2048
mA 48,84,112
dL 8,4,55,3072
mA 52,84,116
rB 56,13,4096
mA 20,80,116
rB 60,13,6144
mA 24,80,120
s_add_u32 s100, s54, s53
s_add_u32 m0, s100, 4096
mA 56,84,120
rB 64,13,8192
mA 60,84,124
dL 9,4,55,0
mA 28,80,124
rB 68,13,10240
mA 92,88,124
rB 72,13,12288
mA 124,92,124
dL 10,4,55,1024
mA 120,92,120
rB 76,13,14336
mA 88,88,120
dL 11,4,55,2048
mA 84,88,116
mA 116,92,116
dL 12,4,55,3072
mA 112,92,112
mA 80,88,112
s_add_u32 s55, s55, 128
mA 76,88,108
mA 108,92,108
s_waitcnt lgkmcnt(0)
mA 104,92,104
s_cmp_ge_u32 s55, s65
s_cselect_b32 s101, 4096, 0
s_sub_u32 s55, s55, s101
mA 72,88,104
mA 68,88,100
s_add_u32 s53, s53, 32768
s_cmp_lt_u32 s53, 98304
s_cselect_b32 s53, s53, 0
mA 100,92,100
mA 96,92,96
mA 64,88,96
mA 0,32,48
rB 80,3,8192
s_add_u32 m0, s50, 147456
mA 32,36,48
rB 84,3,9216
mA 36,36,52
rB 88,3,10240
mA 4,32,52
dS 2,12,51,0
mA 8,32,56
rB 92,3,11264
mA 40,36,56
rB 96,14,0
mA 44,36,60
dS 2,12,51,1024
mA 12,32,60
rB 100,14,2048
rB 104,14,4096
mA 16,32,64
mA 48,36,64
s_add_u32 s51, s51, 57344
rB 108,14,6144
mA 52,36,68
rB 112,14,8192
mA 20,32,68
rB 116,14,10240
mA 24,32,72
s_cmp_ge_u32 s51, s66
s_cselect_b32 s101, 3670016, 0
s_sub_u32 s51, s51, s101
mA 56,36,72
rB 120,14,12288
mA 60,36,76
rB 124,14,14336
mA 28,32,76
s_add_u32 m0, s50, 155648
mA 92,40,76
s_add_u32 s52, s52, 32768
s_cmp_lt_u32 s52, 98304
s_cselect_b32 s52, s52, 0
mA 124,44,76
v_add_u32 v13, s52, v4
mA 120,44,72
dS 2,12,51,0
mA 88,40,72
v_xor_b32 v14, 64, v13
mA 84,40,68
mA 116,44,68
dS 2,12,51,1024
mA 112,44,64
mA 80,40,64
mA 76,40,60
s_add_u32 s51, s51, 57344
mA 108,44,60
s_waitcnt lgkmcnt(0)
s_waitcnt vmcnt(16)
s_barrier
mA 104,44,56
mA 72,40,56
s_cmp_ge_u32 s51, s66
s_cselect_b32 s101, 3670016, 0
s_sub_u32 s51, s51, s101
mA 68,40,52
mA 100,44,52
mA 96,44,48
mA 64,40,48
mA 0,80,96
rB 32,3,16384
mA 32,84,96
s_add_u32 s100, s54, s53
s_add_u32 m0, s100, 0
rB 36,3,17408
mA 36,84,100
dL 5,4,55,0
mA 4,80,100
rB 40,3,18432
mA 8,80,104
dL 6,4,55,1024
mA 40,84,104
rB 44,3,19456
mA 44,84,108
rB 48,13,0
mA 12,80,108
dL 7,4,55,2048
mA 16,80,112
rB 52,13,2048
mA 48,84,112
dL 8,4,55,3072
mA 52,84,116
rB 56,13,4096
mA 20,80,116
rB 60,13,6144
mA 24,80,120
s_add_u32 s100, s54, s53
s_add_u32 m0, s100, 4096
mA 56,84,120
rB 64,13,8192
mA 60,84,124
dL 9,4,55,0
mA 28,80,124
rB 68,13,10240
mA 92,88,124
rB 72,13,12288
mA 124,92,124
dL 10,4,55,1024
mA 120,92,120
rB 76,13,14336
mA 88,88,120
dL 11,4,55,2048
mA 84,88,116
mA 116,92,116
dL 12,4,55,3072
mA 112,92,112
mA 80,88,112
s_add_u32 s55, s55, 128
mA 76,88,108
mA 108,92,108
s_waitcnt lgkmcnt(0)
mA 104,92,104
s_cmp_ge_u32 s55, s65
s_cselect_b32 s101, 4096, 0
s_sub_u32 s55, s55, s101
mA 72,88,104
mA 68,88,100
s_add_u32 s53, s53, 32768
s_cmp_lt_u32 s53, 98304
s_cselect_b32 s53, s53, 0
mA 100,92,100
mA 96,92,96
mA 64,88,96
mA 0,32,48
rB 80,3,24576
s_add_u32 m0, s50, 98304
mA 32,36,48
rB 84,3,25600
mA 36,36,52
rB 88,3,26624
mA 4,32,52
dS 2,12,51,0
mA 8,32,56
rB 92,3,27648
mA 40,36,56
rB 96,14,0
mA 44,36,60
dS 2,12,51,1024
mA 12,32,60
rB 100,14,2048
rB 104,14,4096
mA 16,32,64
mA 48,36,64
s_add_u32 s51, s51, 57344
rB 108,14,6144
mA 52,36,68
rB 112,14,8192
mA 20,32,68
rB 116,14,10240
mA 24,32,72
s_cmp_ge_u32 s51, s66
s_cselect_b32 s101, 3670016, 0
s_sub_u32 s51, s51, s101
mA 56,36,72
rB 120,14,12288
mA 60,36,76
rB 124,14,14336
mA 28,32,76
s_add_u32 m0, s50, 106496
mA 92,40,76
s_add_u32 s52, s52, 32768
s_cmp_lt_u32 s52, 98304
s_cselect_b32 s52, s52, 0
mA 124,44,76
v_add_u32 v13, s52, v4
mA 120,44,72
dS 2,12,51,0
mA 88,40,72
v_xor_b32 v14, 64, v13
mA 84,40,68
mA 116,44,68
dS 2,12,51,1024
mA 112,44,64
mA 80,40,64
mA 76,40,60
s_add_u32 s51, s51, 57344
mA 108,44,60
s_waitcnt lgkmcnt(0)
s_waitcnt vmcnt(16)
s_barrier
mA 104,44,56
mA 72,40,56
s_cmp_ge_u32 s51, s66
s_cselect_b32 s101, 3670016, 0
s_sub_u32 s51, s51, s101
mA 68,40,52
mA 100,44,52
mA 96,44,48
mA 64,40,48
mA 0,80,96
rB 32,3,32768
mA 32,84,96
s_add_u32 s100, s54, s53
s_add_u32 m0, s100, 0
rB 36,3,33792
mA 36,84,100
dL 5,4,55,0
mA 4,80,100
rB 40,3,34816
mA 8,80,104
dL 6,4,55,1024
mA 40,84,104
rB 44,3,35840
mA 44,84,108
rB 48,13,0
mA 12,80,108
dL 7,4,55,2048
mA 16,80,112
rB 52,13,2048
mA 48,84,112
dL 8,4,55,3072
mA 52,84,116
rB 56,13,4096
mA 20,80,116
rB 60,13,6144
mA 24,80,120
s_add_u32 s100, s54, s53
s_add_u32 m0, s100, 4096
mA 56,84,120
rB 64,13,8192
mA 60,84,124
dL 9,4,55,0
mA 28,80,124
rB 68,13,10240
mA 92,88,124
rB 72,13,12288
mA 124,92,124
dL 10,4,55,1024
mA 120,92,120
rB 76,13,14336
mA 88,88,120
dL 11,4,55,2048
mA 84,88,116
mA 116,92,116
dL 12,4,55,3072
mA 112,92,112
mA 80,88,112
s_add_u32 s55, s55, 128
mA 76,88,108
mA 108,92,108
s_waitcnt lgkmcnt(0)
mA 104,92,104
s_cmp_ge_u32 s55, s65
s_cselect_b32 s101, 4096, 0
s_sub_u32 s55, s55, s101
mA 72,88,104
mA 68,88,100
s_add_u32 s53, s53, 32768
s_cmp_lt_u32 s53, 98304
s_cselect_b32 s53, s53, 0
mA 100,92,100
mA 96,92,96
mA 64,88,96
mA 0,32,48
rB 80,3,40960
s_add_u32 m0, s50, 114688
mA 32,36,48
rB 84,3,41984
mA 36,36,52
v_and_b32 v128, 7, v1
mA 4,32,52
rB 88,3,43008
mA 8,32,56
dS 2,12,51,0
mA 40,36,56
rB 92,3,44032
v_lshlrev_b32 v128, 8, v128
mA 44,36,60
rB 96,14,0
mA 12,32,60
dS 2,12,51,1024
mA 16,32,64
rB 100,14,2048
s_mov_b32 s60, 80222272
mA 48,36,64
rB 104,14,4096
s_add_u32 s51, s51, 57344
mA 52,36,68
rB 108,14,6144
mA 20,32,68
buffer_load_dword v129, v128, s[12:15], s60 offen sc1
mA 24,32,72
rB 112,14,8192
rB 116,14,10240
mA 56,36,72
s_cmp_ge_u32 s51, s66
s_cselect_b32 s101, 3670016, 0
s_sub_u32 s51, s51, s101
mA 60,36,76
rB 120,14,12288
rB 124,14,14336
mA 28,32,76
s_add_u32 m0, s50, 122880
mA 92,40,76
s_add_u32 s52, s52, 32768
s_cmp_lt_u32 s52, 98304
s_cselect_b32 s52, s52, 0
mA 124,44,76
v_add_u32 v13, s52, v4
mA 120,44,72
dS 2,12,51,0
mA 88,40,72
v_xor_b32 v14, 64, v13
mA 84,40,68
mA 116,44,68
dS 2,12,51,1024
mA 112,44,64
mA 80,40,64
mA 76,40,60
s_add_u32 s51, s51, 57344
mA 108,44,60
s_waitcnt lgkmcnt(0)
s_waitcnt vmcnt(17)
s_barrier
mA 104,44,56
mA 72,40,56
s_cmp_ge_u32 s51, s66
s_cselect_b32 s101, 3670016, 0
s_sub_u32 s51, s51, s101
mA 68,40,52
mA 100,44,52
mA 96,44,48
mA 64,40,48
mA 0,80,96
rB 32,3,49152
mA 32,84,96
s_add_u32 s100, s54, s53
s_add_u32 m0, s100, 0
rB 36,3,50176
mA 36,84,100
dL 5,4,55,0
mA 4,80,100
rB 40,3,51200
mA 8,80,104
dL 6,4,55,1024
mA 40,84,104
rB 44,3,52224
mA 44,84,108
rB 48,13,0
mA 12,80,108
dL 7,4,55,2048
mA 16,80,112
rB 52,13,2048
mA 48,84,112
dL 8,4,55,3072
mA 52,84,116
rB 56,13,4096
mA 20,80,116
rB 60,13,6144
mA 24,80,120
s_add_u32 s100, s54, s53
s_add_u32 m0, s100, 4096
mA 56,84,120
rB 64,13,8192
mA 60,84,124
dL 9,4,55,0
mA 28,80,124
rB 68,13,10240
mA 92,88,124
rB 72,13,12288
mA 124,92,124
dL 10,4,55,1024
mA 120,92,120
rB 76,13,14336
mA 88,88,120
dL 11,4,55,2048
mA 84,88,116
mA 116,92,116
dL 12,4,55,3072
mA 112,92,112
mA 80,88,112
s_add_u32 s55, s55, 128
mA 76,88,108
mA 108,92,108
s_waitcnt lgkmcnt(0)
mA 104,92,104
s_cmp_ge_u32 s55, s65
s_cselect_b32 s101, 4096, 0
s_sub_u32 s55, s55, s101
mA 72,88,104
mA 68,88,100
s_add_u32 s53, s53, 32768
s_cmp_lt_u32 s53, 98304
s_cselect_b32 s53, s53, 0
mA 100,92,100
mA 96,92,96
mA 64,88,96
mA 0,32,48
rB 80,3,57344
s_add_u32 m0, s50, 131072
mA 32,36,48
rB 84,3,58368
mA 36,36,52
rB 88,3,59392
mA 4,32,52
dS 2,12,51,0
mA 8,32,56
rB 92,3,60416
mA 40,36,56
rB 96,14,0
mA 44,36,60
dS 2,12,51,1024
mA 12,32,60
rB 100,14,2048
rB 104,14,4096
mA 16,32,64
mA 48,36,64
s_add_u32 s51, s51, 57344
rB 108,14,6144
mA 52,36,68
rB 112,14,8192
mA 20,32,68
rB 116,14,10240
mA 24,32,72
s_cmp_ge_u32 s51, s66
s_cselect_b32 s101, 3670016, 0
s_sub_u32 s51, s51, s101
mA 56,36,72
rB 120,14,12288
mA 60,36,76
rB 124,14,14336
mA 28,32,76
s_add_u32 m0, s50, 139264
mA 92,40,76
s_add_u32 s52, s52, 32768
s_cmp_lt_u32 s52, 98304
s_cselect_b32 s52, s52, 0
mA 124,44,76
v_add_u32 v13, s52, v4
mA 120,44,72
dS 2,12,51,0
mA 88,40,72
v_xor_b32 v14, 64, v13
mA 84,40,68
mA 116,44,68
dS 2,12,51,1024
mA 112,44,64
mA 80,40,64
mA 76,40,60
s_add_u32 s51, s51, 57344
mA 108,44,60
s_waitcnt lgkmcnt(0)
s_waitcnt vmcnt(17)
s_barrier
mA 104,44,56
mA 72,40,56
s_cmp_ge_u32 s51, s66
s_cselect_b32 s101, 3670016, 0
s_sub_u32 s51, s51, s101
mA 68,40,52
mA 100,44,52
mA 96,44,48
mA 64,40,48
mA 0,80,96
rB 32,3,0
mA 32,84,96
s_add_u32 s100, s54, s53
s_add_u32 m0, s100, 0
rB 36,3,1024
mA 36,84,100
dL 5,4,55,0
mA 4,80,100
rB 40,3,2048
mA 8,80,104
dL 6,4,55,1024
mA 40,84,104
rB 44,3,3072
mA 44,84,108
rB 48,13,0
mA 12,80,108
dL 7,4,55,2048
mA 16,80,112
rB 52,13,2048
mA 48,84,112
dL 8,4,55,3072
mA 52,84,116
rB 56,13,4096
mA 20,80,116
rB 60,13,6144
mA 24,80,120
s_add_u32 s100, s54, s53
s_add_u32 m0, s100, 4096
mA 56,84,120
rB 64,13,8192
mA 60,84,124
dL 9,4,55,0
mA 28,80,124
rB 68,13,10240
mA 92,88,124
rB 72,13,12288
mA 124,92,124
dL 10,4,55,1024
mA 120,92,120
rB 76,13,14336
mA 88,88,120
dL 11,4,55,2048
mA 84,88,116
s_waitcnt vmcnt(21)
mA 116,92,116
dL 12,4,55,3072
mA 112,92,112
v_cmp_gt_u32 vcc, 16, v129
s_cbranch_vccnz SP_z1spin
SP_z1ret:
mA 80,88,112
s_add_u32 s55, s55, 128
mA 76,88,108
mA 108,92,108
s_waitcnt lgkmcnt(0)
mA 104,92,104
s_cmp_ge_u32 s55, s65
s_cselect_b32 s101, 4096, 0
s_sub_u32 s55, s55, s101
mA 72,88,104
mA 68,88,100
s_add_u32 s53, s53, 32768
s_cmp_lt_u32 s53, 98304
s_cselect_b32 s53, s53, 0
mA 100,92,100
mA 96,92,96
mA 64,88,96
mA 0,32,48
rB 80,3,8192
s_add_u32 m0, s50, 147456
mA 32,36,48
s_lshl_b32 s63, s56, 4
s_lshl_b32 s60, s59, 3
s_add_u32 s63, s63, s60
mA 36,36,52
s_lshl_b32 s62, s63, 5
rB 84,3,9216
v_and_b32 v19, 15, v1
mA 4,32,52
rB 88,3,10240
v_lshlrev_b32 v15, 1, v19
mA 8,32,56
dS 2,12,51,0
mA 40,36,56
rB 92,3,11264
v_lshlrev_b32 v19, 2, v19
mA 44,36,60
rB 96,14,0
v_lshlrev_b32 v18, 3, v1
mA 12,32,60
dS 2,12,51,1024
mA 16,32,64
rB 100,14,2048
mA 48,36,64
buffer_load_ushort a128, v15, s[8:11], s62 offen offset:0
mA 52,36,68
rB 104,14,4096
s_add_u32 s51, s51, 57344
mA 20,32,68
rB 108,14,6144
mA 24,32,72
buffer_load_ushort a129, v15, s[8:11], s62 offen offset:32
mA 56,36,72
rB 112,14,8192
rB 116,14,10240
mA 60,36,76
s_cmp_ge_u32 s51, s66
s_cselect_b32 s101, 3670016, 0
s_sub_u32 s51, s51, s101
mA 28,32,76
rB 120,14,12288
mA 92,40,76
buffer_load_ushort a130, v15, s[8:11], s62 offen offset:64
mA 124,44,76
rB 124,14,14336
s_add_u32 m0, s50, 155648
mA 120,44,72
s_add_u32 s52, s52, 32768
s_cmp_lt_u32 s52, 98304
s_cselect_b32 s52, s52, 0
mA 88,40,72
buffer_load_ushort a131, v15, s[8:11], s62 offen offset:96
mA 84,40,68
v_add_u32 v13, s52, v4
mA 116,44,68
dS 2,12,51,0
mA 112,44,64
v_xor_b32 v14, 64, v13
mA 80,40,64
buffer_load_ushort a132, v15, s[8:11], s62 offen offset:128
mA 76,40,60
dS 2,12,51,1024
mA 108,44,60
buffer_load_ushort a133, v15, s[8:11], s62 offen offset:160
mA 104,44,56
s_add_u32 s51, s51, 57344
buffer_load_ushort a134, v15, s[8:11], s62 offen offset:192
mA 72,40,56
s_waitcnt lgkmcnt(0)
s_waitcnt vmcnt(23)
s_barrier
mA 68,40,52
s_cmp_ge_u32 s51, s66
s_cselect_b32 s101, 3670016, 0
s_sub_u32 s51, s51, s101
mA 100,44,52
buffer_load_ushort a135, v15, s[8:11], s62 offen offset:224
mA 96,44,48
s_lshl_b32 s62, s62, 1
mA 64,40,48
s_add_u32 s62, s62, 79953920
buffer_load_dword v20, v19, s[12:15], s62 offen offset:0 sc1
mA 0,80,96
rB 32,3,16384
mA 32,84,96
s_add_u32 s100, s54, s53
s_add_u32 m0, s100, 0
rB 36,3,17408
mA 36,84,100
dL 5,4,55,0
mA 4,80,100
buffer_load_dword v21, v19, s[12:15], s62 offen offset:64 sc1
mA 8,80,104
rB 40,3,18432
mA 40,84,104
dL 6,4,55,1024
mA 44,84,108
rB 44,3,19456
mA 12,80,108
buffer_load_dword v22, v19, s[12:15], s62 offen offset:128 sc1
mA 16,80,112
rB 48,13,0
mA 48,84,112
dL 7,4,55,2048
mA 52,84,116
rB 52,13,2048
mA 20,80,116
buffer_load_dword v23, v19, s[12:15], s62 offen offset:192 sc1
mA 24,80,120
dL 8,4,55,3072
mA 56,84,120
rB 56,13,4096
mA 60,84,124
buffer_load_dword v24, v19, s[12:15], s62 offen offset:256 sc1
mA 28,80,124
rB 60,13,6144
mA 92,88,124
s_add_u32 s100, s54, s53
s_add_u32 m0, s100, 4096
rB 64,13,8192
mA 124,92,124
dL 9,4,55,0
mA 120,92,120
buffer_load_dword v25, v19, s[12:15], s62 offen offset:320 sc1
mA 88,88,120
rB 68,13,10240
rB 72,13,12288
mA 84,88,116
dL 10,4,55,1024
mA 116,92,116
buffer_load_dword v26, v19, s[12:15], s62 offen offset:384 sc1
mA 112,92,112
rB 76,13,14336
mA 80,88,112
dL 11,4,55,2048
mA 76,88,108
buffer_load_dword v27, v19, s[12:15], s62 offen offset:448 sc1
mA 108,92,108
dL 12,4,55,3072
mA 104,92,104
s_mul_i32 s62, s63, 56
s_add_u32 s55, s55, 128
s_lshl_b32 s60, s57, 3
mA 72,88,104
s_add_u32 s62, s62, s60
s_lshl_b32 s60, s58, 2
s_add_u32 s62, s62, s60
mA 68,88,100
s_lshl_b32 s62, s62, 9
s_add_u32 s62, s62, 71303168
s_waitcnt lgkmcnt(0)
mA 100,92,100
buffer_load_dwordx2 v[128:129], v18, s[12:15], s62 offen offset:0 sc1
mA 96,92,96
s_cmp_ge_u32 s55, s65
s_cselect_b32 s101, 4096, 0
s_sub_u32 s55, s55, s101
mA 64,88,96
s_add_u32 s53, s53, 32768
s_cmp_lt_u32 s53, 98304
s_cselect_b32 s53, s53, 0
buffer_load_dwordx2 v[130:131], v18, s[12:15], s62 offen offset:512 sc1
buffer_load_dwordx2 v[132:133], v18, s[12:15], s62 offen offset:1024 sc1
mA 0,32,48
rB 80,3,24576
s_add_u32 m0, s50, 98304
mA 32,36,48
rB 84,3,25600
mA 36,36,52
buffer_load_dwordx2 v[134:135], v18, s[12:15], s62 offen offset:1536 sc1
mA 4,32,52
rB 88,3,26624
mA 8,32,56
dS 2,12,51,0
mA 40,36,56
rB 92,3,27648
rB 96,14,0
mA 44,36,60
s_add_u32 s62, s62, 28672
buffer_load_dwordx2 v[136:137], v18, s[12:15], s62 offen offset:0 sc1
mA 12,32,60
dS 2,12,51,1024
mA 16,32,64
rB 100,14,2048
rB 104,14,4096
mA 48,36,64
buffer_load_dwordx2 v[138:139], v18, s[12:15], s62 offen offset:512 sc1
mA 52,36,68
s_add_u32 s51, s51, 57344
rB 108,14,6144
rB 112,14,8192
mA 20,32,68
buffer_load_dwordx2 v[140:141], v18, s[12:15], s62 offen offset:1024 sc1
mA 24,32,72
rB 116,14,10240
mA 56,36,72
s_cmp_ge_u32 s51, s66
s_cselect_b32 s101, 3670016, 0
s_sub_u32 s51, s51, s101
mA 60,36,76
rB 120,14,12288
rB 124,14,14336
mA 28,32,76
buffer_load_dwordx2 v[142:143], v18, s[12:15], s62 offen offset:1536 sc1
mA 92,40,76
s_add_u32 m0, s50, 106496
mA 124,44,76
s_add_u32 s52, s52, 32768
s_cmp_lt_u32 s52, 98304
s_cselect_b32 s52, s52, 0
mA 120,44,72
v_add_u32 v13, s52, v4
s_add_u32 s62, s62, 28672
mA 88,40,72
buffer_load_dwordx2 v[144:145], v18, s[12:15], s62 offen offset:0 sc1
mA 84,40,68
dS 2,12,51,0
mA 116,44,68
v_xor_b32 v14, 64, v13
mA 112,44,64
buffer_load_dwordx2 v[146:147], v18, s[12:15], s62 offen offset:512 sc1
mA 80,40,64
dS 2,12,51,1024
mA 76,40,60
buffer_load_dwordx2 v[148:149], v18, s[12:15], s62 offen offset:1024 sc1
mA 108,44,60
s_add_u32 s51, s51, 57344
s_waitcnt lgkmcnt(0)
s_waitcnt vmcnt(43)
mA 104,44,56
s_barrier
buffer_load_dwordx2 v[150:151], v18, s[12:15], s62 offen offset:1536 sc1
mA 72,40,56
s_cmp_ge_u32 s51, s66
s_cselect_b32 s101, 3670016, 0
s_sub_u32 s51, s51, s101
mA 68,40,52
mA 100,44,52
s_add_u32 s62, s62, 28672
buffer_load_dwordx2 v[152:153], v18, s[12:15], s62 offen offset:0 sc1
mA 96,44,48
mA 64,40,48
mA 0,80,96
rB 32,3,32768
mA 32,84,96
s_add_u32 s100, s54, s53
s_add_u32 m0, s100, 0
mA 36,84,100
buffer_load_dwordx2 v[154:155], v18, s[12:15], s62 offen offset:512 sc1
mA 4,80,100
rB 36,3,33792
mA 8,80,104
dL 5,4,55,0
mA 40,84,104
rB 40,3,34816
mA 44,84,108
buffer_load_dwordx2 v[156:157], v18, s[12:15], s62 offen offset:1024 sc1
mA 12,80,108
dL 6,4,55,1024
mA 16,80,112
rB 44,3,35840
rB 48,13,0
mA 48,84,112
buffer_load_dwordx2 v[158:159], v18, s[12:15], s62 offen offset:1536 sc1
mA 52,84,116
dL 7,4,55,2048
mA 20,80,116
rB 52,13,2048
mA 24,80,120
dL 8,4,55,3072
mA 56,84,120
s_add_u32 s62, s62, 28672
rB 56,13,4096
mA 60,84,124
buffer_load_dwordx2 v[160:161], v18, s[12:15], s62 offen offset:0 sc1
mA 28,80,124
rB 60,13,6144
mA 92,88,124
s_add_u32 s100, s54, s53
s_add_u32 m0, s100, 4096
mA 124,92,124
buffer_load_dwordx2 v[162:163], v18, s[12:15], s62 offen offset:512 sc1
mA 120,92,120
rB 64,13,8192
mA 88,88,120
dL 9,4,55,0
mA 84,88,116
rB 68,13,10240
mA 116,92,116
buffer_load_dwordx2 v[164:165], v18, s[12:15], s62 offen offset:1024 sc1
mA 112,92,112
rB 72,13,12288
mA 80,88,112
dL 10,4,55,1024
mA 76,88,108
rB 76,13,14336
mA 108,92,108
dL 11,4,55,2048
mA 104,92,104
buffer_load_dwordx2 v[166:167], v18, s[12:15], s62 offen offset:1536 sc1
mA 72,88,104
dL 12,4,55,3072
mA 68,88,100
s_add_u32 s62, s62, 28672
buffer_load_dwordx2 v[168:169], v18, s[12:15], s62 offen offset:0 sc1
mA 100,92,100
s_add_u32 s55, s55, 128
buffer_load_dwordx2 v[170:171], v18, s[12:15], s62 offen offset:512 sc1
mA 96,92,96
s_waitcnt lgkmcnt(0)
mA 64,88,96
s_cmp_ge_u32 s55, s65
s_cselect_b32 s101, 4096, 0
s_sub_u32 s55, s55, s101
buffer_load_dwordx2 v[172:173], v18, s[12:15], s62 offen offset:1024 sc1
s_add_u32 s53, s53, 32768
s_cmp_lt_u32 s53, 98304
s_cselect_b32 s53, s53, 0
buffer_load_dwordx2 v[174:175], v18, s[12:15], s62 offen offset:1536 sc1
mA 0,32,48
rB 80,3,40960
s_add_u32 m0, s50, 114688
mA 32,36,48
rB 84,3,41984
s_add_u32 s62, s62, 28672
mA 36,36,52
buffer_load_dwordx2 v[176:177], v18, s[12:15], s62 offen offset:0 sc1
mA 4,32,52
rB 88,3,43008
mA 8,32,56
dS 2,12,51,0
mA 40,36,56
rB 92,3,44032
mA 44,36,60
buffer_load_dwordx2 v[178:179], v18, s[12:15], s62 offen offset:512 sc1
mA 12,32,60
rB 96,14,0
mA 16,32,64
dS 2,12,51,1024
mA 48,36,64
rB 100,14,2048
rB 104,14,4096
mA 52,36,68
buffer_load_dwordx2 v[180:181], v18, s[12:15], s62 offen offset:1024 sc1
mA 20,32,68
s_add_u32 s51, s51, 57344
rB 108,14,6144
rB 112,14,8192
mA 24,32,72
buffer_load_dwordx2 v[182:183], v18, s[12:15], s62 offen offset:1536 sc1
mA 56,36,72
rB 116,14,10240
mA 60,36,76
s_cmp_ge_u32 s51, s66
s_cselect_b32 s101, 3670016, 0
s_sub_u32 s51, s51, s101
mA 28,32,76
rB 120,14,12288
s_add_u32 s62, s62, 28672
mA 92,40,76
rB 124,14,14336
mA 124,44,76
buffer_load_dwordx2 v[184:185], v18, s[12:15], s62 offen offset:0 sc1
mA 120,44,72
s_add_u32 m0, s50, 122880
mA 88,40,72
s_add_u32 s52, s52, 32768
s_cmp_lt_u32 s52, 98304
s_cselect_b32 s52, s52, 0
mA 84,40,68
v_add_u32 v13, s52, v4
mA 116,44,68
buffer_load_dwordx2 v[186:187], v18, s[12:15], s62 offen offset:512 sc1
mA 112,44,64
dS 2,12,51,0
mA 80,40,64
v_xor_b32 v14, 64, v13
mA 76,40,60
buffer_load_dwordx2 v[188:189], v18, s[12:15], s62 offen offset:1024 sc1
mA 108,44,60
dS 2,12,51,1024
mA 104,44,56
buffer_load_dwordx2 v[190:191], v18, s[12:15], s62 offen offset:1536 sc1
mA 72,40,56
s_add_u32 s51, s51, 57344
s_waitcnt lgkmcnt(0)
s_waitcnt vmcnt(48)
mA 68,40,52
s_barrier
s_add_u32 s62, s62, 28672
s_and_b32 s60, s2, 7
mA 100,44,52
s_lshl_b32 s60, s60, 8
s_add_u32 s60, s60, 80216096
mA 96,44,48
s_cmp_ge_u32 s51, s66
s_cselect_b32 s101, 3670016, 0
s_sub_u32 s51, s51, s101
mA 64,40,48
v_mov_b32 v16, 0
buffer_load_dword v16, v16, s[12:15], s60 offen sc1
mA 0,80,96
rB 32,3,49152
mA 32,84,96
s_add_u32 s100, s54, s53
s_add_u32 m0, s100, 0
rB 36,3,50176
mA 36,84,100
dL 5,4,55,0
mA 4,80,100
rB 40,3,51200
mA 8,80,104
dL 6,4,55,1024
mA 40,84,104
rB 44,3,52224
mA 44,84,108
rB 48,13,0
mA 12,80,108
dL 7,4,55,2048
mA 16,80,112
rB 52,13,2048
mA 48,84,112
dL 8,4,55,3072
mA 52,84,116
rB 56,13,4096
mA 20,80,116
rB 60,13,6144
mA 24,80,120
s_add_u32 s100, s54, s53
s_add_u32 m0, s100, 4096
mA 56,84,120
rB 64,13,8192
mA 60,84,124
dL 9,4,55,0
mA 28,80,124
rB 68,13,10240
mA 92,88,124
rB 72,13,12288
mA 124,92,124
dL 10,4,55,1024
mA 120,92,120
rB 76,13,14336
mA 88,88,120
dL 11,4,55,2048
mA 84,88,116
mA 116,92,116
dL 12,4,55,3072
mA 112,92,112
mA 80,88,112
s_add_u32 s55, s55, 128
mA 76,88,108
mA 108,92,108
s_waitcnt lgkmcnt(0)
mA 104,92,104
s_cmp_ge_u32 s55, s65
s_cselect_b32 s101, 4096, 0
s_sub_u32 s55, s55, s101
mA 72,88,104
mA 68,88,100
s_add_u32 s53, s53, 32768
s_cmp_lt_u32 s53, 98304
s_cselect_b32 s53, s53, 0
mA 100,92,100
mA 96,92,96
mA 64,88,96
mA 0,32,48
rB 80,3,57344
s_add_u32 m0, s50, 131072
mA 32,36,48
rB 84,3,58368
mA 36,36,52
rB 88,3,59392
mA 4,32,52
dS 2,12,51,0
mA 8,32,56
rB 92,3,60416
mA 40,36,56
rB 96,14,0
mA 44,36,60
dS 2,12,51,1024
mA 12,32,60
rB 100,14,2048
rB 104,14,4096
mA 16,32,64
mA 48,36,64
s_add_u32 s51, s51, 57344
rB 108,14,6144
mA 52,36,68
rB 112,14,8192
mA 20,32,68
rB 116,14,10240
mA 24,32,72
s_cmp_ge_u32 s51, s66
s_cselect_b32 s101, 3670016, 0
s_sub_u32 s51, s51, s101
mA 56,36,72
rB 120,14,12288
mA 60,36,76
rB 124,14,14336
mA 28,32,76
s_add_u32 m0, s50, 139264
mA 92,40,76
s_add_u32 s52, s52, 32768
s_cmp_lt_u32 s52, 98304
s_cselect_b32 s52, s52, 0
mA 124,44,76
v_add_u32 v13, s52, v4
mA 120,44,72
dS 2,12,51,0
mA 88,40,72
v_xor_b32 v14, 64, v13
mA 84,40,68
mA 116,44,68
dS 2,12,51,1024
mA 112,44,64
mA 80,40,64
mA 76,40,60
s_add_u32 s51, s51, 57344
mA 108,44,60
s_waitcnt lgkmcnt(0)
s_waitcnt vmcnt(29)
s_barrier
mA 104,44,56
mA 72,40,56
s_cmp_ge_u32 s51, s66
s_cselect_b32 s101, 3670016, 0
s_sub_u32 s51, s51, s101
mA 68,40,52
mA 100,44,52
mA 96,44,48
mA 64,40,48
mA 0,80,96
rB 32,3,0
mA 32,84,96
s_add_u32 s100, s54, s53
s_add_u32 m0, s100, 0
rB 36,3,1024
mA 36,84,100
dL 5,4,55,0
mA 4,80,100
rB 40,3,2048
mA 8,80,104
dL 6,4,55,1024
mA 40,84,104
rB 44,3,3072
mA 44,84,108
rB 48,13,0
mA 12,80,108
dL 7,4,55,2048
mA 16,80,112
rB 52,13,2048
mA 48,84,112
dL 8,4,55,3072
mA 52,84,116
rB 56,13,4096
mA 20,80,116
rB 60,13,6144
mA 24,80,120
s_add_u32 s100, s54, s53
s_add_u32 m0, s100, 4096
mA 56,84,120
rB 64,13,8192
mA 60,84,124
dL 9,4,55,0
mA 28,80,124
rB 68,13,10240
mA 92,88,124
rB 72,13,12288
mA 124,92,124
dL 10,4,55,1024
mA 120,92,120
rB 76,13,14336
mA 88,88,120
dL 11,4,55,2048
mA 84,88,116
mA 116,92,116
dL 12,4,55,3072
mA 112,92,112
mA 80,88,112
s_add_u32 s55, s55, 128
mA 76,88,108
mA 108,92,108
s_waitcnt lgkmcnt(0)
mA 104,92,104
s_cmp_ge_u32 s55, s65
s_cselect_b32 s101, 4096, 0
s_sub_u32 s55, s55, s101
mA 72,88,104
mA 68,88,100
s_add_u32 s53, s53, 32768
s_cmp_lt_u32 s53, 98304
s_cselect_b32 s53, s53, 0
mA 100,92,100
mA 96,92,96
mA 64,88,96
mA 0,32,48
rB 80,3,8192
s_add_u32 m0, s50, 147456
mA 32,36,48
s_waitcnt vmcnt(20)
v_readfirstlane_b32 s17, v16
s_mov_b32 s29, 0
mA 36,36,52
rB 84,3,9216
v_sub_f32 v20, 1.0, v20
mA 4,32,52
v_sub_f32 v21, 1.0, v21
mA 8,32,56
rB 88,3,10240
mA 40,36,56
dS 2,12,51,0
mA 44,36,60
v_sub_f32 v22, 1.0, v22
mA 12,32,60
rB 92,3,11264
v_sub_f32 v23, 1.0, v23
mA 16,32,64
rB 96,14,0
v_sub_f32 v24, 1.0, v24
mA 48,36,64
dS 2,12,51,1024
mA 52,36,68
v_sub_f32 v25, 1.0, v25
mA 20,32,68
rB 100,14,2048
v_sub_f32 v26, 1.0, v26
mA 24,32,72
rB 104,14,4096
v_sub_f32 v27, 1.0, v27
mA 56,36,72
v_and_b32 v255, 0xffff0000, v191
s_add_u32 s51, s51, 57344
mA 60,36,76
rB 108,14,6144
v_lshlrev_b32 v254, 16, v191
mA 28,32,76
rB 112,14,8192
v_and_b32 v253, 0xffff0000, v190
mA 92,40,76
rB 116,14,10240
v_lshlrev_b32 v252, 16, v190
mA 124,44,76
s_cmp_ge_u32 s51, s66
s_cselect_b32 s101, 3670016, 0
s_sub_u32 s51, s51, s101
mA 120,44,72
v_and_b32 v251, 0xffff0000, v189
mA 88,40,72
rB 120,14,12288
v_lshlrev_b32 v250, 16, v189
mA 84,40,68
rB 124,14,14336
v_and_b32 v249, 0xffff0000, v188
mA 116,44,68
s_add_u32 m0, s50, 155648
mA 112,44,64
s_add_u32 s52, s52, 32768
s_cmp_lt_u32 s52, 98304
s_cselect_b32 s52, s52, 0
mA 80,40,64
v_lshlrev_b32 v248, 16, v188
v_and_b32 v247, 0xffff0000, v187
mA 76,40,60
v_add_u32 v13, s52, v4
v_lshlrev_b32 v246, 16, v187
mA 108,44,60
dS 2,12,51,0
mA 104,44,56
v_xor_b32 v14, 64, v13
v_and_b32 v245, 0xffff0000, v186
mA 72,40,56
v_lshlrev_b32 v244, 16, v186
v_and_b32 v243, 0xffff0000, v185
mA 68,40,52
dS 2,12,51,1024
mA 100,44,52
v_lshlrev_b32 v242, 16, v185
v_and_b32 v241, 0xffff0000, v184
mA 96,44,48
v_lshlrev_b32 v240, 16, v184
v_mul_f32 v240, v240, v27
mA 64,40,48
s_add_u32 s51, s51, 57344
v_mul_f32 v241, v241, v27
s_waitcnt lgkmcnt(0)
s_waitcnt vmcnt(16)
s_barrier
v_mul_f32 v242, v242, v27
v_mul_f32 v243, v243, v27
s_cmp_ge_u32 s51, s66
s_cselect_b32 s101, 3670016, 0
s_sub_u32 s51, s51, s101
v_mul_f32 v244, v244, v27
v_mul_f32 v245, v245, v27
v_mul_f32 v246, v246, v27
v_mul_f32 v247, v247, v27
v_mul_f32 v248, v248, v27
mA 0,80,96
rB 32,3,16384
mA 32,84,96
s_add_u32 s100, s54, s53
s_add_u32 m0, s100, 0
v_mul_f32 v249, v249, v27
mA 36,84,100
rB 36,3,17408
v_mul_f32 v250, v250, v27
mA 4,80,100
v_mul_f32 v251, v251, v27
mA 8,80,104
rB 40,3,18432
v_mul_f32 v252, v252, v27
mA 40,84,104
v_mul_f32 v253, v253, v27
mA 44,84,108
rB 44,3,19456
v_mul_f32 v254, v254, v27
mA 12,80,108
dL 5,4,55,0
mA 16,80,112
rB 48,13,0
v_mul_f32 v255, v255, v27
mA 48,84,112
v_and_b32 v239, 0xffff0000, v183
mA 52,84,116
rB 52,13,2048
v_lshlrev_b32 v238, 16, v183
mA 20,80,116
v_and_b32 v237, 0xffff0000, v182
mA 24,80,120
rB 56,13,4096
v_lshlrev_b32 v236, 16, v182
mA 56,84,120
v_and_b32 v235, 0xffff0000, v181
mA 60,84,124
rB 60,13,6144
mA 28,80,124
dL 6,4,55,1024
mA 92,88,124
v_lshlrev_b32 v234, 16, v181
mA 124,92,124
rB 64,13,8192
v_and_b32 v233, 0xffff0000, v180
mA 120,92,120
v_lshlrev_b32 v232, 16, v180
mA 88,88,120
rB 68,13,10240
v_and_b32 v231, 0xffff0000, v179
mA 84,88,116
v_lshlrev_b32 v230, 16, v179
mA 116,92,116
rB 72,13,12288
v_and_b32 v229, 0xffff0000, v178
mA 112,92,112
v_lshlrev_b32 v228, 16, v178
mA 80,88,112
rB 76,13,14336
mA 76,88,108
dL 7,4,55,2048
mA 108,92,108
v_and_b32 v227, 0xffff0000, v177
v_lshlrev_b32 v226, 16, v177
mA 104,92,104
v_and_b32 v225, 0xffff0000, v176
v_lshlrev_b32 v224, 16, v176
mA 72,88,104
v_mul_f32 v224, v224, v26
v_mul_f32 v225, v225, v26
mA 68,88,100
dL 8,4,55,3072
mA 100,92,100
v_mul_f32 v226, v226, v26
v_mul_f32 v227, v227, v26
mA 96,92,96
s_waitcnt lgkmcnt(0)
v_mul_f32 v228, v228, v26
v_mul_f32 v229, v229, v26
mA 64,88,96
v_mul_f32 v230, v230, v26
v_mul_f32 v231, v231, v26
v_mul_f32 v232, v232, v26
v_mul_f32 v233, v233, v26
mA 0,32,48
rB 80,3,24576
mA 32,36,48
s_add_u32 s100, s54, s53
s_add_u32 m0, s100, 4096
v_mul_f32 v234, v234, v26
mA 36,36,52
v_mul_f32 v235, v235, v26
mA 4,32,52
rB 84,3,25600
v_mul_f32 v236, v236, v26
mA 8,32,56
rB 88,3,26624
v_mul_f32 v237, v237, v26
mA 40,36,56
dL 9,4,55,0
mA 44,36,60
rB 92,3,27648
v_mul_f32 v238, v238, v26
mA 12,32,60
v_mul_f32 v239, v239, v26
mA 16,32,64
rB 96,14,0
v_and_b32 v223, 0xffff0000, v175
mA 48,36,64
rB 100,14,2048
v_lshlrev_b32 v222, 16, v175
mA 52,36,68
dL 10,4,55,1024
mA 20,32,68
rB 104,14,4096
v_and_b32 v221, 0xffff0000, v174
mA 24,32,72
v_lshlrev_b32 v220, 16, v174
mA 56,36,72
rB 108,14,6144
v_and_b32 v219, 0xffff0000, v173
mA 60,36,76
rB 112,14,8192
v_lshlrev_b32 v218, 16, v173
mA 28,32,76
dL 11,4,55,2048
mA 92,40,76
v_and_b32 v217, 0xffff0000, v172
mA 124,44,76
rB 116,14,10240
v_lshlrev_b32 v216, 16, v172
mA 120,44,72
rB 120,14,12288
v_and_b32 v215, 0xffff0000, v171
mA 88,40,72
rB 124,14,14336
v_lshlrev_b32 v214, 16, v171
mA 84,40,68
dL 12,4,55,3072
mA 116,44,68
v_and_b32 v213, 0xffff0000, v170
mA 112,44,64
s_add_u32 s52, s52, 32768
s_cmp_lt_u32 s52, 98304
s_cselect_b32 s52, s52, 0
mA 80,40,64
v_lshlrev_b32 v212, 16, v170
v_add_u32 v13, s52, v4
mA 76,40,60
v_and_b32 v211, 0xffff0000, v169
v_xor_b32 v14, 64, v13
mA 108,44,60
v_lshlrev_b32 v210, 16, v169
s_add_u32 s55, s55, 128
mA 104,44,56
v_and_b32 v209, 0xffff0000, v168
v_lshlrev_b32 v208, 16, v168
mA 72,40,56
v_mul_f32 v208, v208, v25
v_mul_f32 v209, v209, v25
mA 68,40,52
s_cmp_ge_u32 s55, s65
s_cselect_b32 s101, 4096, 0
s_sub_u32 s55, s55, s101
mA 100,44,52
v_mul_f32 v210, v210, v25
v_mul_f32 v211, v211, v25
mA 96,44,48
v_mul_f32 v212, v212, v25
s_waitcnt lgkmcnt(0)
mA 64,40,48
s_waitcnt vmcnt(12)
s_barrier
v_mul_f32 v213, v213, v25
s_add_u32 s53, s53, 32768
s_cmp_lt_u32 s53, 98304
s_cselect_b32 s53, s53, 0
v_mul_f32 v214, v214, v25
v_mul_f32 v215, v215, v25
v_mul_f32 v216, v216, v25
v_mul_f32 v217, v217, v25
v_mul_f32 v218, v218, v25
v_mul_f32 v219, v219, v25
mA 0,80,96
rB 32,3,32768
v_mul_f32 v220, v220, v25
mA 32,84,96
v_mul_f32 v221, v221, v25
mA 36,84,100
rB 36,3,33792
v_mul_f32 v222, v222, v25
mA 4,80,100
rB 40,3,34816
v_mul_f32 v223, v223, v25
mA 8,80,104
v_and_b32 v207, 0xffff0000, v167
mA 40,84,104
rB 44,3,35840
v_lshlrev_b32 v206, 16, v167
mA 44,84,108
v_and_b32 v205, 0xffff0000, v166
mA 12,80,108
rB 48,13,0
v_lshlrev_b32 v204, 16, v166
mA 16,80,112
rB 52,13,2048
v_and_b32 v203, 0xffff0000, v165
mA 48,84,112
v_lshlrev_b32 v202, 16, v165
mA 52,84,116
rB 56,13,4096
v_and_b32 v201, 0xffff0000, v164
mA 20,80,116
v_lshlrev_b32 v200, 16, v164
mA 24,80,120
rB 60,13,6144
v_and_b32 v199, 0xffff0000, v163
mA 56,84,120
v_lshlrev_b32 v198, 16, v163
mA 60,84,124
rB 64,13,8192
v_and_b32 v197, 0xffff0000, v162
mA 28,80,124
rB 68,13,10240
v_lshlrev_b32 v196, 16, v162
mA 92,88,124
v_and_b32 v195, 0xffff0000, v161
mA 124,92,124
rB 72,13,12288
v_lshlrev_b32 v194, 16, v161
mA 120,92,120
v_and_b32 v193, 0xffff0000, v160
mA 88,88,120
rB 76,13,14336
v_lshlrev_b32 v192, 16, v160
mA 84,88,116
v_mul_f32 v192, v192, v24
v_mul_f32 v193, v193, v24
mA 116,92,116
v_mul_f32 v194, v194, v24
mA 112,92,112
v_mul_f32 v195, v195, v24
mA 80,88,112
v_mul_f32 v196, v196, v24
mA 76,88,108
v_mul_f32 v197, v197, v24
mA 108,92,108
v_mul_f32 v198, v198, v24
s_waitcnt lgkmcnt(0)
mA 104,92,104
v_mul_f32 v199, v199, v24
mA 72,88,104
v_mul_f32 v200, v200, v24
mA 68,88,100
v_mul_f32 v201, v201, v24
mA 100,92,100
v_mul_f32 v202, v202, v24
mA 96,92,96
v_mul_f32 v203, v203, v24
mA 64,88,96
v_mul_f32 v204, v204, v24
mA 0,32,48
rB 80,3,40960
v_mul_f32 v205, v205, v24
mA 32,36,48
v_mul_f32 v206, v206, v24
mA 36,36,52
rB 84,3,41984
v_mul_f32 v207, v207, v24
mA 4,32,52
rB 88,3,43008
v_and_b32 v191, 0xffff0000, v159
mA 8,32,56
v_lshlrev_b32 v190, 16, v159
mA 40,36,56
rB 92,3,44032
v_and_b32 v189, 0xffff0000, v158
mA 44,36,60
rB 96,14,0
v_lshlrev_b32 v188, 16, v158
mA 12,32,60
rB 100,14,2048
v_and_b32 v187, 0xffff0000, v157
mA 16,32,64
v_lshlrev_b32 v186, 16, v157
mA 48,36,64
rB 104,14,4096
v_and_b32 v185, 0xffff0000, v156
mA 52,36,68
rB 108,14,6144
v_lshlrev_b32 v184, 16, v156
mA 20,32,68
rB 112,14,8192
v_and_b32 v183, 0xffff0000, v155
mA 24,32,72
v_lshlrev_b32 v182, 16, v155
mA 56,36,72
rB 116,14,10240
v_and_b32 v181, 0xffff0000, v154
mA 60,36,76
rB 120,14,12288
v_lshlrev_b32 v180, 16, v154
mA 28,32,76
v_and_b32 v179, 0xffff0000, v153
mA 92,40,76
rB 124,14,14336
v_lshlrev_b32 v178, 16, v153
mA 124,44,76
s_add_u32 s52, s52, 32768
s_cmp_lt_u32 s52, 98304
s_cselect_b32 s52, s52, 0
mA 120,44,72
v_and_b32 v177, 0xffff0000, v152
v_add_u32 v13, s52, v4
mA 88,40,72
v_lshlrev_b32 v176, 16, v152
v_mul_f32 v176, v176, v23
mA 84,40,68
v_xor_b32 v14, 64, v13
v_mul_f32 v177, v177, v23
mA 116,44,68
v_mul_f32 v178, v178, v23
v_mul_f32 v179, v179, v23
mA 112,44,64
v_mul_f32 v180, v180, v23
v_mul_f32 v181, v181, v23
mA 80,40,64
v_mul_f32 v182, v182, v23
mA 76,40,60
v_mul_f32 v183, v183, v23
mA 108,44,60
s_waitcnt lgkmcnt(0)
s_waitcnt vmcnt(0)
s_barrier
mA 104,44,56
v_mul_f32 v184, v184, v23
v_mul_f32 v185, v185, v23
mA 72,40,56
v_mul_f32 v186, v186, v23
mA 68,40,52
v_mul_f32 v187, v187, v23
mA 100,44,52
v_mul_f32 v188, v188, v23
mA 96,44,48
v_mul_f32 v189, v189, v23
mA 64,40,48
v_mul_f32 v190, v190, v23
mA 0,80,96
rB 32,3,49152
v_mul_f32 v191, v191, v23
mA 32,84,96
v_and_b32 v175, 0xffff0000, v151
mA 36,84,100
rB 36,3,50176
v_lshlrev_b32 v174, 16, v151
mA 4,80,100
v_and_b32 v173, 0xffff0000, v150
mA 8,80,104
rB 40,3,51200
v_lshlrev_b32 v172, 16, v150
mA 40,84,104
rB 44,3,52224
v_and_b32 v171, 0xffff0000, v149
mA 44,84,108
v_lshlrev_b32 v170, 16, v149
mA 12,80,108
rB 48,13,0
v_and_b32 v169, 0xffff0000, v148
mA 16,80,112
v_lshlrev_b32 v168, 16, v148
mA 48,84,112
rB 52,13,2048
v_and_b32 v167, 0xffff0000, v147
mA 52,84,116
rB 56,13,4096
v_lshlrev_b32 v166, 16, v147
mA 20,80,116
v_and_b32 v165, 0xffff0000, v146
mA 24,80,120
rB 60,13,6144
v_lshlrev_b32 v164, 16, v146
mA 56,84,120
v_and_b32 v163, 0xffff0000, v145
mA 60,84,124
rB 64,13,8192
v_lshlrev_b32 v162, 16, v145
mA 28,80,124
v_and_b32 v161, 0xffff0000, v144
mA 92,88,124
rB 68,13,10240
v_lshlrev_b32 v160, 16, v144
mA 124,92,124
rB 72,13,12288
v_mul_f32 v160, v160, v22
mA 120,92,120
v_mul_f32 v161, v161, v22
mA 88,88,120
rB 76,13,14336
v_mul_f32 v162, v162, v22
mA 84,88,116
v_mul_f32 v163, v163, v22
v_mul_f32 v164, v164, v22
mA 116,92,116
v_mul_f32 v165, v165, v22
mA 112,92,112
v_mul_f32 v166, v166, v22
mA 80,88,112
v_mul_f32 v167, v167, v22
mA 76,88,108
v_mul_f32 v168, v168, v22
mA 108,92,108
v_mul_f32 v169, v169, v22
s_waitcnt lgkmcnt(0)
mA 104,92,104
v_mul_f32 v170, v170, v22
mA 72,88,104
v_mul_f32 v171, v171, v22
v_mul_f32 v172, v172, v22
mA 68,88,100
v_mul_f32 v173, v173, v22
mA 100,92,100
v_mul_f32 v174, v174, v22
mA 96,92,96
v_mul_f32 v175, v175, v22
mA 64,88,96
v_and_b32 v159, 0xffff0000, v143
mA 0,32,48
rB 80,3,57344
v_lshlrev_b32 v158, 16, v143
mA 32,36,48
rB 84,3,58368
v_and_b32 v157, 0xffff0000, v142
mA 36,36,52
rB 88,3,59392
v_lshlrev_b32 v156, 16, v142
mA 4,32,52
v_and_b32 v155, 0xffff0000, v141
mA 8,32,56
rB 92,3,60416
v_lshlrev_b32 v154, 16, v141
mA 40,36,56
rB 96,14,0
v_and_b32 v153, 0xffff0000, v140
mA 44,36,60
v_lshlrev_b32 v152, 16, v140
mA 12,32,60
rB 100,14,2048
v_and_b32 v151, 0xffff0000, v139
mA 16,32,64
rB 104,14,4096
v_lshlrev_b32 v150, 16, v139
mA 48,36,64
rB 108,14,6144
v_and_b32 v149, 0xffff0000, v138
mA 52,36,68
v_lshlrev_b32 v148, 16, v138
mA 20,32,68
rB 112,14,8192
v_and_b32 v147, 0xffff0000, v137
mA 24,32,72
rB 116,14,10240
v_lshlrev_b32 v146, 16, v137
mA 56,36,72
rB 120,14,12288
v_and_b32 v145, 0xffff0000, v136
mA 60,36,76
v_lshlrev_b32 v144, 16, v136
mA 28,32,76
rB 124,14,14336
v_mul_f32 v144, v144, v21
mA 92,40,76
s_add_u32 s52, s52, 32768
s_cmp_lt_u32 s52, 98304
s_cselect_b32 s52, s52, 0
mA 124,44,76
v_mul_f32 v145, v145, v21
v_mul_f32 v146, v146, v21
mA 120,44,72
v_add_u32 v13, s52, v4
v_mul_f32 v147, v147, v21
mA 88,40,72
v_xor_b32 v14, 64, v13
v_mul_f32 v148, v148, v21
mA 84,40,68
v_mul_f32 v149, v149, v21
v_mul_f32 v150, v150, v21
mA 116,44,68
v_mul_f32 v151, v151, v21
mA 112,44,64
v_mul_f32 v152, v152, v21
mA 80,40,64
v_mul_f32 v153, v153, v21
mA 76,40,60
v_mul_f32 v154, v154, v21
mA 108,44,60
v_mul_f32 v155, v155, v21
s_waitcnt lgkmcnt(0)
mA 104,44,56
v_mul_f32 v156, v156, v21
mA 72,40,56
v_mul_f32 v157, v157, v21
mA 68,40,52
v_mul_f32 v158, v158, v21
mA 100,44,52
v_mul_f32 v159, v159, v21
mA 96,44,48
v_and_b32 v143, 0xffff0000, v135
mA 64,40,48
v_lshlrev_b32 v142, 16, v135
mA 0,80,96
v_and_b32 v141, 0xffff0000, v134
mA 32,84,96
v_lshlrev_b32 v140, 16, v134
mA 36,84,100
v_and_b32 v139, 0xffff0000, v133
v_lshlrev_b32 v138, 16, v133
mA 4,80,100
v_and_b32 v137, 0xffff0000, v132
mA 8,80,104
v_lshlrev_b32 v136, 16, v132
mA 40,84,104
v_and_b32 v135, 0xffff0000, v131
mA 44,84,108
v_lshlrev_b32 v134, 16, v131
mA 12,80,108
v_and_b32 v133, 0xffff0000, v130
mA 16,80,112
v_lshlrev_b32 v132, 16, v130
mA 48,84,112
v_and_b32 v131, 0xffff0000, v129
mA 52,84,116
v_lshlrev_b32 v130, 16, v129
mA 20,80,116
v_and_b32 v129, 0xffff0000, v128
mA 24,80,120
v_lshlrev_b32 v128, 16, v128
mA 56,84,120
v_mul_f32 v128, v128, v20
mA 60,84,124
v_mul_f32 v129, v129, v20
mA 28,80,124
v_mul_f32 v130, v130, v20
mA 92,88,124
v_mul_f32 v131, v131, v20
mA 124,92,124
v_mul_f32 v132, v132, v20
mA 120,92,120
v_mul_f32 v133, v133, v20
mA 88,88,120
v_mul_f32 v134, v134, v20
mA 84,88,116
v_mul_f32 v135, v135, v20
mA 116,92,116
v_mul_f32 v136, v136, v20
mA 112,92,112
v_mul_f32 v137, v137, v20
v_mul_f32 v138, v138, v20
mA 80,88,112
v_mul_f32 v139, v139, v20
mA 76,88,108
v_mul_f32 v140, v140, v20
mA 108,92,108
v_mul_f32 v141, v141, v20
mA 104,92,104
v_mul_f32 v142, v142, v20
mA 72,88,104
v_mul_f32 v143, v143, v20
mA 68,88,100
s_lshl_b32 s62, s56, 1
s_add_u32 s62, s62, s59
mA 100,92,100
s_mul_i32 s62, s62, 156
s_lshl_b32 s60, s57, 2
s_add_u32 s62, s62, s60
mA 96,92,96
s_lshl_b32 s60, s58, 1
s_add_u32 s62, s62, s60
s_lshl_b32 s62, s62, 13
mA 64,88,96
s_add_u32 s62, s62, 51380224
s_add_u32 s63, s62, 8192
v_lshlrev_b32 v15, 4, v1
aR 20,128
aR 21,129
aR 22,130
aR 23,131
aR 24,132
aR 25,133
aR 26,134
aR 27,135
v_lshlrev_b32 v32, 16, v20
v_lshlrev_b32 v34, 16, v21
v_lshlrev_b32 v36, 16, v22
v_lshlrev_b32 v38, 16, v23
v_lshlrev_b32 v40, 16, v24
v_lshlrev_b32 v42, 16, v25
v_lshlrev_b32 v44, 16, v26
v_lshlrev_b32 v46, 16, v27
aR 48,0
aR 49,1
aR 50,2
aR 51,3
aR 52,32
aR 53,33
aR 54,34
aR 55,35
v_pk_add_f32 v[48:49], v[48:49], v[32:33] op_sel_hi:[1,0]
v_pk_add_f32 v[50:51], v[50:51], v[32:33] op_sel_hi:[1,0]
v_pk_add_f32 v[52:53], v[52:53], v[32:33] op_sel_hi:[1,0]
v_pk_add_f32 v[54:55], v[54:55], v[32:33] op_sel_hi:[1,0]
v_pk_mul_f32 v[48:49], v[48:49], v[128:129]
v_pk_mul_f32 v[50:51], v[50:51], v[130:131]
v_pk_mul_f32 v[52:53], v[52:53], v[132:133]
v_pk_mul_f32 v[54:55], v[54:55], v[134:135]
cP 48,48,49
cP 49,50,51
cP 50,52,53
cP 51,54,55
buffer_store_dwordx4 v[48:51], v15, s[12:15], s62 offen offset:0 sc1
aR 56,64
aR 57,65
aR 58,66
aR 59,67
aR 60,96
aR 61,97
aR 62,98
aR 63,99
v_pk_add_f32 v[56:57], v[56:57], v[32:33] op_sel_hi:[1,0]
v_pk_add_f32 v[58:59], v[58:59], v[32:33] op_sel_hi:[1,0]
v_pk_add_f32 v[60:61], v[60:61], v[32:33] op_sel_hi:[1,0]
v_pk_add_f32 v[62:63], v[62:63], v[32:33] op_sel_hi:[1,0]
v_pk_mul_f32 v[56:57], v[56:57], v[136:137]
v_pk_mul_f32 v[58:59], v[58:59], v[138:139]
v_pk_mul_f32 v[60:61], v[60:61], v[140:141]
v_pk_mul_f32 v[62:63], v[62:63], v[142:143]
cP 56,56,57
cP 57,58,59
cP 58,60,61
cP 59,62,63
buffer_store_dwordx4 v[56:59], v15, s[12:15], s63 offen offset:0 sc1
aR 64,4
aR 65,5
aR 66,6
aR 67,7
aR 68,36
aR 69,37
aR 70,38
aR 71,39
v_pk_add_f32 v[64:65], v[64:65], v[34:35] op_sel_hi:[1,0]
v_pk_add_f32 v[66:67], v[66:67], v[34:35] op_sel_hi:[1,0]
v_pk_add_f32 v[68:69], v[68:69], v[34:35] op_sel_hi:[1,0]
v_pk_add_f32 v[70:71], v[70:71], v[34:35] op_sel_hi:[1,0]
v_pk_mul_f32 v[64:65], v[64:65], v[144:145]
v_pk_mul_f32 v[66:67], v[66:67], v[146:147]
v_pk_mul_f32 v[68:69], v[68:69], v[148:149]
v_pk_mul_f32 v[70:71], v[70:71], v[150:151]
cP 64,64,65
cP 65,66,67
cP 66,68,69
cP 67,70,71
buffer_store_dwordx4 v[64:67], v15, s[12:15], s62 offen offset:1024 sc1
aR 72,68
aR 73,69
aR 74,70
aR 75,71
aR 76,100
aR 77,101
aR 78,102
aR 79,103
v_pk_add_f32 v[72:73], v[72:73], v[34:35] op_sel_hi:[1,0]
v_pk_add_f32 v[74:75], v[74:75], v[34:35] op_sel_hi:[1,0]
v_pk_add_f32 v[76:77], v[76:77], v[34:35] op_sel_hi:[1,0]
v_pk_add_f32 v[78:79], v[78:79], v[34:35] op_sel_hi:[1,0]
v_pk_mul_f32 v[72:73], v[72:73], v[152:153]
v_pk_mul_f32 v[74:75], v[74:75], v[154:155]
v_pk_mul_f32 v[76:77], v[76:77], v[156:157]
v_pk_mul_f32 v[78:79], v[78:79], v[158:159]
cP 72,72,73
cP 73,74,75
cP 74,76,77
cP 75,78,79
buffer_store_dwordx4 v[72:75], v15, s[12:15], s63 offen offset:1024 sc1
aR 48,8
aR 49,9
aR 50,10
aR 51,11
aR 52,40
aR 53,41
aR 54,42
aR 55,43
v_pk_add_f32 v[48:49], v[48:49], v[36:37] op_sel_hi:[1,0]
v_pk_add_f32 v[50:51], v[50:51], v[36:37] op_sel_hi:[1,0]
v_pk_add_f32 v[52:53], v[52:53], v[36:37] op_sel_hi:[1,0]
v_pk_add_f32 v[54:55], v[54:55], v[36:37] op_sel_hi:[1,0]
v_pk_mul_f32 v[48:49], v[48:49], v[160:161]
v_pk_mul_f32 v[50:51], v[50:51], v[162:163]
v_pk_mul_f32 v[52:53], v[52:53], v[164:165]
v_pk_mul_f32 v[54:55], v[54:55], v[166:167]
cP 48,48,49
cP 49,50,51
cP 50,52,53
cP 51,54,55
buffer_store_dwordx4 v[48:51], v15, s[12:15], s62 offen offset:2048 sc1
aR 56,72
aR 57,73
aR 58,74
aR 59,75
aR 60,104
aR 61,105
aR 62,106
aR 63,107
v_pk_add_f32 v[56:57], v[56:57], v[36:37] op_sel_hi:[1,0]
v_pk_add_f32 v[58:59], v[58:59], v[36:37] op_sel_hi:[1,0]
v_pk_add_f32 v[60:61], v[60:61], v[36:37] op_sel_hi:[1,0]
v_pk_add_f32 v[62:63], v[62:63], v[36:37] op_sel_hi:[1,0]
v_pk_mul_f32 v[56:57], v[56:57], v[168:169]
v_pk_mul_f32 v[58:59], v[58:59], v[170:171]
v_pk_mul_f32 v[60:61], v[60:61], v[172:173]
v_pk_mul_f32 v[62:63], v[62:63], v[174:175]
cP 56,56,57
cP 57,58,59
cP 58,60,61
cP 59,62,63
buffer_store_dwordx4 v[56:59], v15, s[12:15], s63 offen offset:2048 sc1
aR 64,12
aR 65,13
aR 66,14
aR 67,15
aR 68,44
aR 69,45
aR 70,46
aR 71,47
v_pk_add_f32 v[64:65], v[64:65], v[38:39] op_sel_hi:[1,0]
v_pk_add_f32 v[66:67], v[66:67], v[38:39] op_sel_hi:[1,0]
v_pk_add_f32 v[68:69], v[68:69], v[38:39] op_sel_hi:[1,0]
v_pk_add_f32 v[70:71], v[70:71], v[38:39] op_sel_hi:[1,0]
v_pk_mul_f32 v[64:65], v[64:65], v[176:177]
v_pk_mul_f32 v[66:67], v[66:67], v[178:179]
v_pk_mul_f32 v[68:69], v[68:69], v[180:181]
v_pk_mul_f32 v[70:71], v[70:71], v[182:183]
cP 64,64,65
cP 65,66,67
cP 66,68,69
cP 67,70,71
buffer_store_dwordx4 v[64:67], v15, s[12:15], s62 offen offset:3072 sc1
aR 72,76
aR 73,77
aR 74,78
aR 75,79
aR 76,108
aR 77,109
aR 78,110
aR 79,111
v_pk_add_f32 v[72:73], v[72:73], v[38:39] op_sel_hi:[1,0]
v_pk_add_f32 v[74:75], v[74:75], v[38:39] op_sel_hi:[1,0]
v_pk_add_f32 v[76:77], v[76:77], v[38:39] op_sel_hi:[1,0]
v_pk_add_f32 v[78:79], v[78:79], v[38:39] op_sel_hi:[1,0]
v_pk_mul_f32 v[72:73], v[72:73], v[184:185]
v_pk_mul_f32 v[74:75], v[74:75], v[186:187]
v_pk_mul_f32 v[76:77], v[76:77], v[188:189]
v_pk_mul_f32 v[78:79], v[78:79], v[190:191]
cP 72,72,73
cP 73,74,75
cP 74,76,77
cP 75,78,79
buffer_store_dwordx4 v[72:75], v15, s[12:15], s63 offen offset:3072 sc1
s_add_u32 s62, s62, 4096
s_add_u32 s63, s63, 4096
aR 48,16
aR 49,17
aR 50,18
aR 51,19
aR 52,48
aR 53,49
aR 54,50
aR 55,51
v_pk_add_f32 v[48:49], v[48:49], v[40:41] op_sel_hi:[1,0]
v_pk_add_f32 v[50:51], v[50:51], v[40:41] op_sel_hi:[1,0]
v_pk_add_f32 v[52:53], v[52:53], v[40:41] op_sel_hi:[1,0]
v_pk_add_f32 v[54:55], v[54:55], v[40:41] op_sel_hi:[1,0]
v_pk_mul_f32 v[48:49], v[48:49], v[192:193]
v_pk_mul_f32 v[50:51], v[50:51], v[194:195]
v_pk_mul_f32 v[52:53], v[52:53], v[196:197]
v_pk_mul_f32 v[54:55], v[54:55], v[198:199]
cP 48,48,49
cP 49,50,51
cP 50,52,53
cP 51,54,55
buffer_store_dwordx4 v[48:51], v15, s[12:15], s62 offen offset:0 sc1
aR 56,80
aR 57,81
aR 58,82
aR 59,83
aR 60,112
aR 61,113
aR 62,114
aR 63,115
v_pk_add_f32 v[56:57], v[56:57], v[40:41] op_sel_hi:[1,0]
v_pk_add_f32 v[58:59], v[58:59], v[40:41] op_sel_hi:[1,0]
v_pk_add_f32 v[60:61], v[60:61], v[40:41] op_sel_hi:[1,0]
v_pk_add_f32 v[62:63], v[62:63], v[40:41] op_sel_hi:[1,0]
v_pk_mul_f32 v[56:57], v[56:57], v[200:201]
v_pk_mul_f32 v[58:59], v[58:59], v[202:203]
v_pk_mul_f32 v[60:61], v[60:61], v[204:205]
v_pk_mul_f32 v[62:63], v[62:63], v[206:207]
cP 56,56,57
cP 57,58,59
cP 58,60,61
cP 59,62,63
buffer_store_dwordx4 v[56:59], v15, s[12:15], s63 offen offset:0 sc1
aR 64,20
aR 65,21
aR 66,22
aR 67,23
aR 68,52
aR 69,53
aR 70,54
aR 71,55
v_pk_add_f32 v[64:65], v[64:65], v[42:43] op_sel_hi:[1,0]
v_pk_add_f32 v[66:67], v[66:67], v[42:43] op_sel_hi:[1,0]
v_pk_add_f32 v[68:69], v[68:69], v[42:43] op_sel_hi:[1,0]
v_pk_add_f32 v[70:71], v[70:71], v[42:43] op_sel_hi:[1,0]
v_pk_mul_f32 v[64:65], v[64:65], v[208:209]
v_pk_mul_f32 v[66:67], v[66:67], v[210:211]
v_pk_mul_f32 v[68:69], v[68:69], v[212:213]
v_pk_mul_f32 v[70:71], v[70:71], v[214:215]
cP 64,64,65
cP 65,66,67
cP 66,68,69
cP 67,70,71
buffer_store_dwordx4 v[64:67], v15, s[12:15], s62 offen offset:1024 sc1
aR 72,84
aR 73,85
aR 74,86
aR 75,87
aR 76,116
aR 77,117
aR 78,118
aR 79,119
v_pk_add_f32 v[72:73], v[72:73], v[42:43] op_sel_hi:[1,0]
v_pk_add_f32 v[74:75], v[74:75], v[42:43] op_sel_hi:[1,0]
v_pk_add_f32 v[76:77], v[76:77], v[42:43] op_sel_hi:[1,0]
v_pk_add_f32 v[78:79], v[78:79], v[42:43] op_sel_hi:[1,0]
v_pk_mul_f32 v[72:73], v[72:73], v[216:217]
v_pk_mul_f32 v[74:75], v[74:75], v[218:219]
v_pk_mul_f32 v[76:77], v[76:77], v[220:221]
v_pk_mul_f32 v[78:79], v[78:79], v[222:223]
cP 72,72,73
cP 73,74,75
cP 74,76,77
cP 75,78,79
buffer_store_dwordx4 v[72:75], v15, s[12:15], s63 offen offset:1024 sc1
aR 48,24
aR 49,25
aR 50,26
aR 51,27
aR 52,56
aR 53,57
aR 54,58
aR 55,59
v_pk_add_f32 v[48:49], v[48:49], v[44:45] op_sel_hi:[1,0]
v_pk_add_f32 v[50:51], v[50:51], v[44:45] op_sel_hi:[1,0]
v_pk_add_f32 v[52:53], v[52:53], v[44:45] op_sel_hi:[1,0]
v_pk_add_f32 v[54:55], v[54:55], v[44:45] op_sel_hi:[1,0]
v_pk_mul_f32 v[48:49], v[48:49], v[224:225]
v_pk_mul_f32 v[50:51], v[50:51], v[226:227]
v_pk_mul_f32 v[52:53], v[52:53], v[228:229]
v_pk_mul_f32 v[54:55], v[54:55], v[230:231]
cP 48,48,49
cP 49,50,51
cP 50,52,53
cP 51,54,55
buffer_store_dwordx4 v[48:51], v15, s[12:15], s62 offen offset:2048 sc1
aR 56,88
aR 57,89
aR 58,90
aR 59,91
aR 60,120
aR 61,121
aR 62,122
aR 63,123
v_pk_add_f32 v[56:57], v[56:57], v[44:45] op_sel_hi:[1,0]
v_pk_add_f32 v[58:59], v[58:59], v[44:45] op_sel_hi:[1,0]
v_pk_add_f32 v[60:61], v[60:61], v[44:45] op_sel_hi:[1,0]
v_pk_add_f32 v[62:63], v[62:63], v[44:45] op_sel_hi:[1,0]
v_pk_mul_f32 v[56:57], v[56:57], v[232:233]
v_pk_mul_f32 v[58:59], v[58:59], v[234:235]
v_pk_mul_f32 v[60:61], v[60:61], v[236:237]
v_pk_mul_f32 v[62:63], v[62:63], v[238:239]
cP 56,56,57
cP 57,58,59
cP 58,60,61
cP 59,62,63
buffer_store_dwordx4 v[56:59], v15, s[12:15], s63 offen offset:2048 sc1
aR 64,28
aR 65,29
aR 66,30
aR 67,31
aR 68,60
aR 69,61
aR 70,62
aR 71,63
v_pk_add_f32 v[64:65], v[64:65], v[46:47] op_sel_hi:[1,0]
v_pk_add_f32 v[66:67], v[66:67], v[46:47] op_sel_hi:[1,0]
v_pk_add_f32 v[68:69], v[68:69], v[46:47] op_sel_hi:[1,0]
v_pk_add_f32 v[70:71], v[70:71], v[46:47] op_sel_hi:[1,0]
v_pk_mul_f32 v[64:65], v[64:65], v[240:241]
v_pk_mul_f32 v[66:67], v[66:67], v[242:243]
v_pk_mul_f32 v[68:69], v[68:69], v[244:245]
v_pk_mul_f32 v[70:71], v[70:71], v[246:247]
cP 64,64,65
cP 65,66,67
cP 66,68,69
cP 67,70,71
buffer_store_dwordx4 v[64:67], v15, s[12:15], s62 offen offset:3072 sc1
aR 72,92
aR 73,93
aR 74,94
aR 75,95
aR 76,124
aR 77,125
aR 78,126
aR 79,127
v_pk_add_f32 v[72:73], v[72:73], v[46:47] op_sel_hi:[1,0]
v_pk_add_f32 v[74:75], v[74:75], v[46:47] op_sel_hi:[1,0]
v_pk_add_f32 v[76:77], v[76:77], v[46:47] op_sel_hi:[1,0]
v_pk_add_f32 v[78:79], v[78:79], v[46:47] op_sel_hi:[1,0]
v_pk_mul_f32 v[72:73], v[72:73], v[248:249]
v_pk_mul_f32 v[74:75], v[74:75], v[250:251]
v_pk_mul_f32 v[76:77], v[76:77], v[252:253]
v_pk_mul_f32 v[78:79], v[78:79], v[254:255]
cP 72,72,73
cP 73,74,75
cP 74,76,77
cP 75,78,79
buffer_store_dwordx4 v[72:75], v15, s[12:15], s63 offen offset:3072 sc1
s_lshl_b32 s18, s56, 9
s_add_u32 s18, s18, 80216288
s_add_u32 s19, s18, 256
s_branch SP_done
SP_z1spin:
s_sleep 20
buffer_load_dword v129, v128, s[12:15], s60 offen sc1
s_waitcnt vmcnt(0)
v_cmp_gt_u32 vcc, 16, v129
s_cbranch_vccnz SP_z1spin
s_branch SP_z1ret
SP_done:
s_branch MG_jend
MG_fin:
s_mov_b32 s4, s30
s_mov_b32 s5, s31
s_mov_b32 s6, 3670016
s_mov_b32 s7, 0x20000
s_mov_b32 s8, s44
s_mov_b32 s9, s45
s_mov_b32 s10, 1835008
s_mov_b32 s11, 0x20000
s_and_b32 s50, s2, 7
s_lshr_b32 s51, s77, 1
s_and_b32 s52, s77, 1
s_mul_i32 s61, s50, 0
s_lshr_b32 s61, s61, 1
s_mul_i32 s62, s51, 156
s_add_u32 s60, s62, s61
s_add_u32 s60, s60, 128
s_lshl_b32 s53, s50, 4
s_add_u32 s62, s62, s53
s_lshl_b32 s53, s3, 11
s_add_u32 s53, s53, 50331648
s_lshl_b32 s62, s62, 13
s_add_u32 s62, s62, s53
s_lshl_b32 s60, s60, 13
s_add_u32 s60, s60, s53
s_mul_i32 s59, s52, 448
s_mul_i32 s64, s50, 458752
s_add_u32 s64, s64, s59
s_mul_i32 s53, s61, 28672
s_add_u32 s59, s59, s53
s_mul_i32 s53, s3, 7168
s_add_u32 s59, s59, s53
v_lshlrev_b32 v0, 4, v1
s_mov_b32 s53, 0
s_mul_i32 s63, s3, 7168
s_add_u32 s64, s64, s63
s_mul_i32 s63, s3, 4096
v_lshrrev_b32 v48, 5, v1
v_and_b32 v49, 31, v1
v_lshlrev_b32 v50, 1, v48
v_xor_b32 v49, v49, v50
v_lshlrev_b32 v49, 4, v49
v_mul_u32_u24 v48, 896, v48
v_add_u32 v2, v49, v48
v_xor_b32 v50, 0, v49
v_cmp_gt_u32 vcc, 448, v50
v_mov_b32 v50, 0x80000000
s_nop 0
v_cndmask_b32 v2, v50, v2, vcc
v_xor_b32 v3, 64, v49
v_add_u32 v3, v3, v48
v_add_u32 v3, 768, v3
v_xor_b32 v50, 64, v49
v_cmp_gt_u32 vcc, 448, v50
v_mov_b32 v50, 0x80000000
s_nop 0
v_cndmask_b32 v3, v50, v3, vcc
v_xor_b32 v4, 128, v49
v_add_u32 v4, v4, v48
v_add_u32 v4, 1536, v4
v_xor_b32 v50, 128, v49
v_cmp_gt_u32 vcc, 448, v50
v_mov_b32 v50, 0x80000000
s_nop 0
v_cndmask_b32 v4, v50, v4, vcc
v_xor_b32 v5, 192, v49
v_add_u32 v5, v5, v48
v_add_u32 v5, 2304, v5
v_xor_b32 v50, 192, v49
v_cmp_gt_u32 vcc, 448, v50
v_mov_b32 v50, 0x80000000
s_nop 0
v_cndmask_b32 v5, v50, v5, vcc
s_add_u32 m0, s63, 0
s_nop 0
dL 2,4,64,0
dL 3,4,64,1024
dL 4,4,64,2048
dL 5,4,64,3072
s_add_u32 s64, s64, 28672
s_add_u32 m0, s63, 16384
s_nop 0
dL 2,4,64,0
dL 3,4,64,1024
dL 4,4,64,2048
dL 5,4,64,3072
s_add_u32 s64, s64, 28672
s_add_u32 m0, s63, 32768
s_nop 0
dL 2,4,64,0
dL 3,4,64,1024
dL 4,4,64,2048
dL 5,4,64,3072
s_add_u32 s64, s64, 28672
v_lshrrev_b32 v48, 4, v1
v_bfe_u32 v49, v1, 2, 2
v_lshl_add_u32 v50, v48, 2, v49
v_and_b32 v48, 1, v48
v_lshl_add_u32 v48, v48, 2, v49
v_lshrrev_b32 v48, 0, v48
v_lshlrev_b32 v48, 5, v48
v_mul_u32_u24 v50, 512, v50
v_and_b32 v49, 3, v1
v_lshl_add_u32 v50, v49, 3, v50
v_add_u32 v50, 0, v50
s_lshl_b32 s101, s53, 5
v_xad_u32 v6, s101, v48, v50
s_add_u32 s101, s101, 32
v_add_u32 v20, 65536, v6
v_add_u32 v34, 131072, v6
v_xad_u32 v7, s101, v48, v50
s_add_u32 s101, s101, 32
v_add_u32 v21, 65536, v7
v_add_u32 v35, 131072, v7
v_xad_u32 v8, s101, v48, v50
s_add_u32 s101, s101, 32
v_add_u32 v22, 65536, v8
v_add_u32 v36, 131072, v8
v_xad_u32 v9, s101, v48, v50
s_add_u32 s101, s101, 32
v_add_u32 v23, 65536, v9
v_add_u32 v37, 131072, v9
v_xad_u32 v10, s101, v48, v50
s_add_u32 s101, s101, 32
v_add_u32 v24, 65536, v10
v_add_u32 v38, 131072, v10
v_xad_u32 v11, s101, v48, v50
s_add_u32 s101, s101, 32
v_add_u32 v25, 65536, v11
v_add_u32 v39, 131072, v11
v_xad_u32 v12, s101, v48, v50
s_add_u32 s101, s101, 32
v_add_u32 v26, 65536, v12
v_add_u32 v40, 131072, v12
v_xad_u32 v13, s101, v48, v50
s_add_u32 s101, s101, 32
v_add_u32 v27, 65536, v13
v_add_u32 v41, 131072, v13
v_xad_u32 v14, s101, v48, v50
s_add_u32 s101, s101, 32
v_add_u32 v28, 65536, v14
v_add_u32 v42, 131072, v14
v_xad_u32 v15, s101, v48, v50
s_add_u32 s101, s101, 32
v_add_u32 v29, 65536, v15
v_add_u32 v43, 131072, v15
v_xad_u32 v16, s101, v48, v50
s_add_u32 s101, s101, 32
v_add_u32 v30, 65536, v16
v_add_u32 v44, 131072, v16
v_xad_u32 v17, s101, v48, v50
s_add_u32 s101, s101, 32
v_add_u32 v31, 65536, v17
v_add_u32 v45, 131072, v17
v_xad_u32 v18, s101, v48, v50
s_add_u32 s101, s101, 32
v_add_u32 v32, 65536, v18
v_add_u32 v46, 131072, v18
v_xad_u32 v19, s101, v48, v50
s_add_u32 s101, s101, 32
v_add_u32 v33, 65536, v19
v_add_u32 v47, 131072, v19
s_mul_i32 s57, s77, 32
s_add_u32 s57, s57, s3
s_lshl_b32 s57, s57, 14
s_add_u32 s57, s57, 100663296
s_lshl_b32 s53, s50, 16
s_add_u32 s55, s57, s53
s_lshl_b32 s56, s77, 8
s_add_u32 s56, s56, 80216192
v_cmp_eq_u32 vcc, 0, v1
v_mov_b32 v52, 2147483648
v_mov_b32 v53, 1
v_cndmask_b32 v52, v52, 0, vcc
v_and_b32 v54, 15, v1
v_mul_u32_u24 v54, 896, v54
v_lshrrev_b32 v55, 4, v1
v_lshl_add_u32 v54, v55, 3, v54
v_mov_b32 v55, 0
s_lshl_b32 s58, s51, 7
s_lshl_b32 s53, s3, 5
s_add_u32 s58, s58, s53
s_mul_i32 s58, s58, 896
s_mul_i32 s53, s52, 448
s_add_u32 s58, s58, s53
s_lshl_b32 s53, s50, 4
s_add_u32 s53, s53, s51
s_lshl_b32 s53, s53, 8
s_lshl_b32 s54, s51, 8
s_add_u32 s54, s54, 32
v_mov_b32 v57, s54
v_mov_b32 v58, s53
v_cndmask_b32 v57, v57, v58, vcc
v_mov_b32 v58, 7
v_mov_b32 v59, 2
v_cndmask_b32 v58, v58, v59, vcc
s_mov_b32 s54, 80216256
s_waitcnt vmcnt(12)
s_barrier
v_lshl_add_u32 v64, s3, 6, v1
v_cmp_eq_u32 vcc, 0, v64
v_mov_b32 v64, 0x40000000
v_mov_b32 v65, 1
v_cndmask_b32 v64, v64, 0, vcc
buffer_atomic_add v65, v64, s[12:15], s18 offen
buffer_atomic_add v65, v64, s[12:15], s19 offen
s_mov_b32 s18, 0x80000000
s_mov_b32 s19, 0x80000000
buffer_load_dword v56, v57, s[12:15], s54 offen sc1
s_add_u32 m0, s63, 49152
s_nop 0
dL 2,4,64,0
dL 3,4,64,1024
dL 4,4,64,2048
dL 5,4,64,3072
s_add_u32 s64, s64, 28672
s_add_u32 m0, s63, 65536
s_nop 0
dL 2,4,64,0
dL 3,4,64,1024
dL 4,4,64,2048
dL 5,4,64,3072
s_add_u32 s64, s64, 28672
s_add_u32 m0, s63, 81920
s_nop 0
dL 2,4,64,0
dL 3,4,64,1024
dL 4,4,64,2048
dL 5,4,64,3072
s_add_u32 s64, s64, 28672
s_add_u32 m0, s63, 98304
s_nop 0
dL 2,4,64,0
dL 3,4,64,1024
dL 4,4,64,2048
dL 5,4,64,3072
s_add_u32 s64, s64, 28672
s_add_u32 m0, s63, 114688
s_nop 0
dL 2,4,64,0
dL 3,4,64,1024
dL 4,4,64,2048
dL 5,4,64,3072
s_add_u32 s64, s64, 28672
s_add_u32 m0, s63, 131072
s_nop 0
dL 2,4,64,0
dL 3,4,64,1024
dL 4,4,64,2048
dL 5,4,64,3072
s_add_u32 s64, s64, 28672
s_waitcnt vmcnt(24)
v_cmp_gt_u32 vcc, v58, v56
s_cbranch_vccz O8_go
O8_rdy:
buffer_load_dword v56, v57, s[12:15], s54 offen sc1
s_waitcnt vmcnt(0)
v_cmp_gt_u32 vcc, v58, v56
s_cbranch_vccz O8_go
s_sleep 10
s_branch O8_rdy
O8_go:
v_lshl_add_u32 v60, s3, 6, v1
v_cmp_eq_u32 vcc, 0, v60
v_mov_b32 v60, 2147483648
v_mov_b32 v61, 1
v_cndmask_b32 v60, v60, 16, vcc
buffer_atomic_add v61, v60, s[12:15], s56 offen sc0
buffer_load_dwordx4 v[192:195], v0, s[12:15], s62 offen offset:0 sc1
buffer_load_dwordx4 v[196:199], v0, s[12:15], s62 offen offset:1024 sc1
s_add_u32 s62, s62, 8192
buffer_load_dwordx4 v[200:203], v0, s[12:15], s62 offen offset:0 sc1
buffer_load_dwordx4 v[204:207], v0, s[12:15], s62 offen offset:1024 sc1
s_add_u32 s62, s62, 8192
buffer_load_dwordx4 v[208:211], v0, s[12:15], s62 offen offset:0 sc1
buffer_load_dwordx4 v[212:215], v0, s[12:15], s62 offen offset:1024 sc1
s_add_u32 s62, s62, 8192
buffer_load_dwordx4 v[216:219], v0, s[12:15], s62 offen offset:0 sc1
buffer_load_dwordx4 v[220:223], v0, s[12:15], s62 offen offset:1024 sc1
s_add_u32 s62, s62, 8192
buffer_load_dwordx4 v[224:227], v0, s[12:15], s62 offen offset:0 sc1
buffer_load_dwordx4 v[228:231], v0, s[12:15], s62 offen offset:1024 sc1
s_add_u32 s62, s62, 8192
buffer_load_dwordx4 v[232:235], v0, s[12:15], s62 offen offset:0 sc1
buffer_load_dwordx4 v[236:239], v0, s[12:15], s62 offen offset:1024 sc1
s_add_u32 s62, s62, 8192
buffer_load_dwordx4 v[240:243], v0, s[12:15], s62 offen offset:0 sc1
buffer_load_dwordx4 v[244:247], v0, s[12:15], s62 offen offset:1024 sc1
s_add_u32 s62, s62, 8192
buffer_load_dwordx4 v[248:251], v0, s[12:15], s62 offen offset:0 sc1
buffer_load_dwordx4 v[252:255], v0, s[12:15], s62 offen offset:1024 sc1
s_add_u32 s62, s62, 8192
s_barrier
rT 64,6,0
rT 66,6,8192
rT 68,7,0
rT 70,7,8192
rT 72,8,0
rT 74,8,8192
rT 76,9,0
rT 78,9,8192
rT 80,10,0
rT 82,10,8192
rT 84,11,0
rT 86,11,8192
rT 88,12,0
rT 90,12,8192
rT 92,13,0
rT 94,13,8192
rT 96,14,0
rT 98,14,8192
rT 100,15,0
rT 102,15,8192
rT 104,16,0
rT 106,16,8192
rT 108,17,0
rT 110,17,8192
rT 112,18,0
rT 114,18,8192
rT 116,19,0
rT 118,19,8192
s_waitcnt lgkmcnt(0)
s_waitcnt vmcnt(14)
s_barrier
mAz 0,64,192
rT 120,6,16384
s_add_u32 m0, s63, 0
mAz 4,68,192
rT 122,6,24576
rT 124,7,16384
mAz 60,68,196
rT 126,7,24576
mAz 56,64,196
rT 128,8,16384
rT 130,8,24576
mAz 64,72,196
dL 2,4,64,0
mAz 68,76,196
rT 132,9,16384
rT 134,9,24576
mAz 12,76,192
rT 136,10,16384
mAz 8,72,192
rT 138,10,24576
rT 140,11,16384
mAz 16,80,192
rT 142,11,24576
mAz 20,84,192
dL 3,4,64,1024
mAz 76,84,196
rT 144,12,16384
rT 146,12,24576
mAz 72,80,196
rT 148,13,16384
rT 150,13,24576
mAz 80,88,196
rT 152,14,16384
mAz 84,92,196
dL 4,4,64,2048
mAz 28,92,192
rT 154,14,24576
rT 156,15,16384
mAz 24,88,192
rT 158,15,24576
rT 160,16,16384
mAz 32,96,192
rT 162,16,24576
mAz 36,100,192
rT 164,17,16384
mAz 92,100,196
dL 5,4,64,3072
mAz 88,96,196
rT 166,17,24576
rT 168,18,16384
mAz 96,104,196
rT 170,18,24576
rT 172,19,16384
mAz 100,108,196
rT 174,19,24576
mAz 44,108,192
s_add_u32 s64, s64, 28672
mAz 40,104,192
mAz 48,112,192
mAz 52,116,192
s_waitcnt lgkmcnt(0)
mAz 108,116,196
mAz 104,112,196
s_waitcnt vmcnt(16)
mA 0,120,200
rT 64,6,32768
mA 4,124,200
buffer_load_dwordx4 v[192:195], v0, s[12:15], s62 offen offset:0 sc1
mA 60,124,204
rT 66,6,40960
rT 68,7,32768
mA 56,120,204
rT 70,7,40960
rT 72,8,32768
mA 64,128,204
v_readfirstlane_b32 s61, v61
mA 68,132,204
rT 74,8,40960
rT 76,9,32768
mA 12,132,200
v_mov_b32 v60, 0x271c0
mA 8,128,200
rT 78,9,40960
rT 80,10,32768
mA 16,136,200
v_mov_b32 v61, s61
mA 20,140,200
rT 82,10,40960
rT 84,11,32768
mA 76,140,204
s_cmp_eq_u32 s3, 0
s_cbranch_scc0 O8_nt
ds_write_b32 v60, v61
O8_nt:
mA 72,136,204
rT 86,11,40960
mA 80,144,204
buffer_load_dwordx4 v[196:199], v0, s[12:15], s62 offen offset:1024 sc1
mA 84,148,204
rT 88,12,32768
rT 90,12,40960
mA 28,148,200
rT 92,13,32768
rT 94,13,40960
mA 24,144,200
rT 96,14,32768
rT 98,14,40960
mA 32,152,200
rT 100,15,32768
rT 102,15,40960
mA 36,156,200
rT 104,16,32768
rT 106,16,40960
mA 92,156,204
rT 108,17,32768
s_add_u32 s62, s62, 8192
mA 88,152,204
rT 110,17,40960
rT 112,18,32768
mA 96,160,204
rT 114,18,40960
rT 116,19,32768
mA 100,164,204
rT 118,19,40960
mA 44,164,200
mA 40,160,200
mA 48,168,200
mA 52,172,200
s_waitcnt lgkmcnt(0)
s_barrier
mA 108,172,204
mA 104,168,204
s_waitcnt vmcnt(16)
mA 0,64,208
rT 120,6,49152
s_add_u32 m0, s63, 16384
mA 4,68,208
rT 122,6,57344
rT 124,7,49152
mA 60,68,212
ds_read_b32 v61, v60
rT 126,7,57344
mA 56,64,212
dL 2,4,64,0
mA 64,72,212
rT 128,8,49152
rT 130,8,57344
mA 68,76,212
rT 132,9,49152
rT 134,9,57344
mA 12,76,208
dL 3,4,64,1024
mA 8,72,208
rT 136,10,49152
rT 138,10,57344
mA 16,80,208
rT 140,11,49152
rT 142,11,57344
mA 20,84,208
dL 4,4,64,2048
mA 76,84,212
rT 144,12,49152
rT 146,12,57344
mA 72,80,212
rT 148,13,49152
rT 150,13,57344
mA 80,88,212
dL 5,4,64,3072
mA 84,92,212
rT 152,14,49152
rT 154,14,57344
mA 28,92,208
rT 156,15,49152
s_add_u32 s64, s64, 28672
mA 24,88,208
rT 158,15,57344
rT 160,16,49152
mA 32,96,208
rT 162,16,57344
mA 36,100,208
rT 164,17,49152
mA 92,100,212
buffer_load_dwordx4 v[200:203], v0, s[12:15], s62 offen offset:0 sc1
mA 88,96,212
rT 166,17,57344
rT 168,18,49152
mA 96,104,212
rT 170,18,57344
rT 172,19,49152
mA 100,108,212
buffer_load_dwordx4 v[204:207], v0, s[12:15], s62 offen offset:1024 sc1
mA 44,108,208
rT 174,19,57344
mA 40,104,208
s_add_u32 s62, s62, 8192
mA 48,112,208
mA 52,116,208
s_waitcnt lgkmcnt(0)
mA 108,116,212
mA 104,112,212
s_waitcnt vmcnt(20)
mA 0,120,216
rT 64,20,0
s_add_u32 m0, s63, 32768
mA 4,124,216
rT 66,20,8192
rT 68,21,0
mA 60,124,220
v_readfirstlane_b32 s61, v61
mA 56,120,220
rT 70,21,8192
mA 64,128,220
dL 2,4,64,0
mA 68,132,220
rT 72,22,0
s_lshl_b32 s72, s61, 2
mA 12,132,216
rT 74,22,8192
rT 76,23,0
mA 8,128,216
s_lshr_b32 s72, 214648, s72
rT 78,23,8192
mA 16,136,216
dL 3,4,64,1024
mA 20,140,216
rT 80,24,0
s_and_b32 s72, s72, 15
mA 76,140,220
rT 82,24,8192
rT 84,25,0
mA 72,136,220
s_add_u32 s72, s72, 16
rT 86,25,8192
mA 80,144,220
dL 4,4,64,2048
mA 84,148,220
rT 88,26,0
s_mov_b32 s74, 353306624
mA 28,148,216
rT 90,26,8192
rT 92,27,0
mA 24,144,216
s_mov_b32 s75, 471604249
rT 94,27,8192
mA 32,152,216
dL 5,4,64,3072
mA 36,156,216
rT 96,28,0
s_lshl_b32 s61, s61, 3
mA 92,156,220
rT 98,28,8192
rT 100,29,0
mA 88,152,220
s_lshr_b64 s[74:75], s[74:75], s61
s_add_u32 s64, s64, 28672
rT 102,29,8192
mA 96,160,220
rT 104,30,0
s_and_b32 s61, s74, 255
mA 100,164,220
rT 106,30,8192
rT 108,31,0
mA 44,164,216
s_lshl_b32 s73, s61, 13
buffer_load_dwordx4 v[208:211], v0, s[12:15], s62 offen offset:0 sc1
mA 40,160,216
rT 110,31,8192
rT 112,32,0
mA 48,168,216
s_add_u32 s60, s60, s73
rT 114,32,8192
rT 116,33,0
mA 52,172,216
buffer_load_dwordx4 v[212:215], v0, s[12:15], s62 offen offset:1024 sc1
mA 108,172,220
s_mul_i32 s73, s61, 28672
rT 118,33,8192
s_add_u32 s59, s59, s73
mA 104,168,220
s_waitcnt vmcnt(24)
s_add_u32 s62, s62, 8192
s_waitcnt lgkmcnt(0)
s_barrier
mA 0,64,224
rT 120,20,16384
s_add_u32 m0, s63, 49152
mA 4,68,224
rT 122,20,24576
rT 124,21,16384
mA 60,68,228
rT 126,21,24576
mA 56,64,228
dL 2,4,64,0
mA 64,72,228
rT 128,22,16384
rT 130,22,24576
mA 68,76,228
rT 132,23,16384
rT 134,23,24576
mA 12,76,224
dL 3,4,64,1024
mA 8,72,224
rT 136,24,16384
rT 138,24,24576
mA 16,80,224
rT 140,25,16384
rT 142,25,24576
mA 20,84,224
dL 4,4,64,2048
mA 76,84,228
rT 144,26,16384
rT 146,26,24576
mA 72,80,228
rT 148,27,16384
rT 150,27,24576
mA 80,88,228
dL 5,4,64,3072
mA 84,92,228
rT 152,28,16384
rT 154,28,24576
mA 28,92,224
rT 156,29,16384
s_add_u32 s64, s64, 28672
mA 24,88,224
rT 158,29,24576
rT 160,30,16384
mA 32,96,224
rT 162,30,24576
mA 36,100,224
rT 164,31,16384
mA 92,100,228
buffer_load_dwordx4 v[216:219], v0, s[12:15], s62 offen offset:0 sc1
mA 88,96,228
rT 166,31,24576
rT 168,32,16384
mA 96,104,228
rT 170,32,24576
rT 172,33,16384
mA 100,108,228
buffer_load_dwordx4 v[220:223], v0, s[12:15], s62 offen offset:1024 sc1
mA 44,108,224
rT 174,33,24576
mA 40,104,224
s_add_u32 s62, s62, 8192
mA 48,112,224
mA 52,116,224
s_waitcnt lgkmcnt(0)
mA 108,116,228
mA 104,112,228
s_waitcnt vmcnt(28)
mA 0,120,232
rT 64,20,32768
s_add_u32 m0, s63, 65536
mA 4,124,232
rT 66,20,40960
rT 68,21,32768
mA 60,124,236
rT 70,21,40960
mA 56,120,236
dL 2,4,64,0
mA 64,128,236
rT 72,22,32768
rT 74,22,40960
mA 68,132,236
rT 76,23,32768
rT 78,23,40960
mA 12,132,232
dL 3,4,64,1024
mA 8,128,232
rT 80,24,32768
rT 82,24,40960
mA 16,136,232
rT 84,25,32768
rT 86,25,40960
mA 20,140,232
dL 4,4,64,2048
mA 76,140,236
rT 88,26,32768
rT 90,26,40960
mA 72,136,236
rT 92,27,32768
rT 94,27,40960
mA 80,144,236
dL 5,4,64,3072
mA 84,148,236
rT 96,28,32768
rT 98,28,40960
mA 28,148,232
rT 100,29,32768
s_add_u32 s64, s64, 28672
mA 24,144,232
rT 102,29,40960
rT 104,30,32768
mA 32,152,232
rT 106,30,40960
mA 36,156,232
rT 108,31,32768
mA 92,156,236
buffer_load_dwordx4 v[224:227], v0, s[12:15], s62 offen offset:0 sc1
mA 88,152,236
rT 110,31,40960
rT 112,32,32768
mA 96,160,236
rT 114,32,40960
rT 116,33,32768
mA 100,164,236
buffer_load_dwordx4 v[228:231], v0, s[12:15], s62 offen offset:1024 sc1
mA 44,164,232
rT 118,33,40960
mA 40,160,232
s_add_u32 s62, s62, 8192
mA 48,168,232
mA 52,172,232
s_waitcnt lgkmcnt(0)
s_barrier
mA 108,172,236
mA 104,168,236
s_waitcnt vmcnt(32)
mA 0,64,240
rT 120,20,49152
s_add_u32 m0, s63, 81920
mA 4,68,240
rT 122,20,57344
rT 124,21,49152
mA 60,68,244
rT 126,21,57344
mA 56,64,244
dL 2,4,64,0
mA 64,72,244
rT 128,22,49152
rT 130,22,57344
mA 68,76,244
rT 132,23,49152
rT 134,23,57344
mA 12,76,240
dL 3,4,64,1024
mA 8,72,240
rT 136,24,49152
rT 138,24,57344
mA 16,80,240
rT 140,25,49152
rT 142,25,57344
mA 20,84,240
dL 4,4,64,2048
mA 76,84,244
rT 144,26,49152
rT 146,26,57344
mA 72,80,244
rT 148,27,49152
rT 150,27,57344
mA 80,88,244
dL 5,4,64,3072
mA 84,92,244
rT 152,28,49152
rT 154,28,57344
mA 28,92,240
rT 156,29,49152
s_add_u32 s64, s64, 28672
mA 24,88,240
rT 158,29,57344
rT 160,30,49152
mA 32,96,240
rT 162,30,57344
mA 36,100,240
rT 164,31,49152
mA 92,100,244
buffer_load_dwordx4 v[232:235], v0, s[12:15], s62 offen offset:0 sc1
mA 88,96,244
rT 166,31,57344
rT 168,32,49152
mA 96,104,244
rT 170,32,57344
rT 172,33,49152
mA 100,108,244
buffer_load_dwordx4 v[236:239], v0, s[12:15], s62 offen offset:1024 sc1
mA 44,108,240
rT 174,33,57344
mA 40,104,240
s_add_u32 s62, s62, 8192
mA 48,112,240
mA 52,116,240
s_waitcnt lgkmcnt(0)
mA 108,116,244
mA 104,112,244
s_waitcnt vmcnt(36)
mA 0,120,248
rT 64,34,0
s_add_u32 m0, s63, 98304
mA 4,124,248
rT 66,34,8192
rT 68,35,0
mA 60,124,252
rT 70,35,8192
mA 56,120,252
dL 2,4,64,0
mA 64,128,252
rT 72,36,0
rT 74,36,8192
mA 68,132,252
rT 76,37,0
rT 78,37,8192
mA 12,132,248
dL 3,4,64,1024
mA 8,128,248
rT 80,38,0
rT 82,38,8192
mA 16,136,248
rT 84,39,0
rT 86,39,8192
mA 20,140,248
dL 4,4,64,2048
mA 76,140,252
rT 88,40,0
rT 90,40,8192
mA 72,136,252
rT 92,41,0
rT 94,41,8192
mA 80,144,252
dL 5,4,64,3072
mA 84,148,252
rT 96,42,0
rT 98,42,8192
mA 28,148,248
rT 100,43,0
s_add_u32 s64, s64, 28672
mA 24,144,248
rT 102,43,8192
rT 104,44,0
mA 32,152,248
rT 106,44,8192
mA 36,156,248
rT 108,45,0
mA 92,156,252
buffer_load_dwordx4 v[240:243], v0, s[12:15], s62 offen offset:0 sc1
mA 88,152,252
rT 110,45,8192
rT 112,46,0
mA 96,160,252
rT 114,46,8192
rT 116,47,0
mA 100,164,252
buffer_load_dwordx4 v[244:247], v0, s[12:15], s62 offen offset:1024 sc1
mA 44,164,248
rT 118,47,8192
mA 40,160,248
s_add_u32 s62, s62, 8192
mA 48,168,248
mA 52,172,248
s_waitcnt lgkmcnt(0)
s_waitcnt vmcnt(32)
s_barrier
mA 108,172,252
mA 104,168,252
mA 0,64,192
rT 120,6,0
mA 4,68,192
s_mov_b32 s4, s40
s_mov_b32 s5, s41
s_mov_b32 s6, 802816
s_mov_b32 s64, s59
mA 60,68,196
rT 122,6,8192
rT 124,7,0
mA 56,64,196
rT 126,7,8192
mA 64,72,196
s_cmp_gt_u32 s72, 16
s_cselect_b32 s64, s64, 0x40000000
rT 128,8,0
mA 68,76,196
rT 130,8,8192
rT 132,9,0
mA 12,76,192
s_add_u32 m0, s63, 114688
rT 134,9,8192
rT 136,10,0
mA 8,72,192
rT 138,10,8192
mA 16,80,192
dL 2,4,64,0
mA 20,84,192
rT 140,11,0
rT 142,11,8192
mA 76,84,196
rT 144,12,0
mA 72,80,196
dL 3,4,64,1024
mA 80,88,196
rT 146,12,8192
rT 148,13,0
mA 84,92,196
rT 150,13,8192
mA 28,92,192
dL 4,4,64,2048
mA 24,88,192
rT 152,14,0
rT 154,14,8192
mA 32,96,192
rT 156,15,0
mA 36,100,192
dL 5,4,64,3072
mA 92,100,196
rT 158,15,8192
rT 160,16,0
mA 88,96,196
rT 162,16,8192
s_add_u32 s64, s64, 28672
mA 96,104,196
rT 164,17,0
rT 166,17,8192
mA 100,108,196
rT 168,18,0
mA 44,108,192
buffer_load_dwordx4 v[248:251], v0, s[12:15], s62 offen offset:0 sc1
mA 40,104,192
rT 170,18,8192
rT 172,19,0
mA 48,112,192
rT 174,19,8192
mA 52,116,192
buffer_load_dwordx4 v[252:255], v0, s[12:15], s62 offen offset:1024 sc1
mA 108,116,196
s_add_u32 s62, s62, 8192
s_waitcnt lgkmcnt(0)
mA 104,112,196
s_waitcnt vmcnt(36)
mA 0,120,200
rT 64,6,16384
mA 4,124,200
s_cmp_gt_u32 s72, 17
s_cselect_b32 s64, s64, 0x40000000
rT 66,6,24576
mA 60,124,204
rT 68,7,16384
s_add_u32 m0, s63, 131072
mA 56,120,204
rT 70,7,24576
rT 72,8,16384
mA 64,128,204
rT 74,8,24576
mA 68,132,204
dL 2,4,64,0
mA 12,132,200
rT 76,9,16384
rT 78,9,24576
mA 8,128,200
rT 80,10,16384
mA 16,136,200
dL 3,4,64,1024
mA 20,140,200
rT 82,10,24576
rT 84,11,16384
mA 76,140,204
rT 86,11,24576
mA 72,136,204
dL 4,4,64,2048
mA 80,144,204
rT 88,12,16384
rT 90,12,24576
mA 84,148,204
rT 92,13,16384
mA 28,148,200
dL 5,4,64,3072
mA 24,144,200
rT 94,13,24576
rT 96,14,16384
mA 32,152,200
s_add_u32 s64, s64, 28672
rT 98,14,24576
rT 100,15,16384
mA 36,156,200
rT 102,15,24576
s_mov_b32 s62, s60
mA 92,156,204
rT 104,16,16384
rT 106,16,24576
mA 88,152,204
rT 108,17,16384
mA 96,160,204
s_cmp_gt_u32 s72, 16
s_cselect_b32 s62, s62, 2147483648
rT 110,17,24576
mA 100,164,204
rT 112,18,16384
rT 114,18,24576
mA 44,164,200
buffer_load_dwordx4 v[192:195], v0, s[12:15], s62 offen offset:0 sc1
mA 40,160,200
rT 116,19,16384
rT 118,19,24576
mA 48,168,200
buffer_load_dwordx4 v[196:199], v0, s[12:15], s62 offen offset:1024 sc1
mA 52,172,200
s_add_u32 s62, s62, 8192
s_waitcnt lgkmcnt(0)
s_waitcnt vmcnt(32)
mA 108,172,204
s_barrier
mA 104,168,204
mA 0,64,208
rT 120,6,32768
mA 4,68,208
s_cmp_gt_u32 s72, 18
s_cselect_b32 s64, s64, 0x40000000
rT 122,6,40960
mA 60,68,212
rT 124,7,32768
rT 126,7,40960
mA 56,64,212
s_add_u32 m0, s63, 0
rT 128,8,32768
rT 130,8,40960
mA 64,72,212
rT 132,9,32768
mA 68,76,212
dL 2,4,64,0
mA 12,76,208
rT 134,9,40960
rT 136,10,32768
mA 8,72,208
rT 138,10,40960
mA 16,80,208
dL 3,4,64,1024
mA 20,84,208
rT 140,11,32768
rT 142,11,40960
mA 76,84,212
rT 144,12,32768
mA 72,80,212
dL 4,4,64,2048
mA 80,88,212
rT 146,12,40960
rT 148,13,32768
mA 84,92,212
rT 150,13,40960
mA 28,92,208
dL 5,4,64,3072
mA 24,88,208
rT 152,14,32768
rT 154,14,40960
mA 32,96,208
rT 156,15,32768
s_add_u32 s64, s64, 28672
mA 36,100,208
rT 158,15,40960
rT 160,16,32768
mA 92,100,212
rT 162,16,40960
mA 88,96,212
s_cmp_gt_u32 s72, 17
s_cselect_b32 s62, s62, 2147483648
rT 164,17,32768
mA 96,104,212
rT 166,17,40960
rT 168,18,32768
mA 100,108,212
buffer_load_dwordx4 v[200:203], v0, s[12:15], s62 offen offset:0 sc1
mA 44,108,208
rT 170,18,40960
rT 172,19,32768
mA 40,104,208
rT 174,19,40960
mA 48,112,208
buffer_load_dwordx4 v[204:207], v0, s[12:15], s62 offen offset:1024 sc1
mA 52,116,208
s_add_u32 s62, s62, 8192
s_waitcnt lgkmcnt(0)
mA 108,116,212
mA 104,112,212
s_waitcnt vmcnt(36)
mA 0,120,216
rT 64,6,49152
mA 4,124,216
s_cmp_gt_u32 s72, 19
s_cselect_b32 s64, s64, 0x40000000
rT 66,6,57344
mA 60,124,220
rT 68,7,49152
rT 70,7,57344
mA 56,120,220
s_add_u32 m0, s63, 16384
rT 72,8,49152
rT 74,8,57344
mA 64,128,220
rT 76,9,49152
mA 68,132,220
dL 2,4,64,0
mA 12,132,216
rT 78,9,57344
rT 80,10,49152
mA 8,128,216
rT 82,10,57344
mA 16,136,216
dL 3,4,64,1024
mA 20,140,216
rT 84,11,49152
rT 86,11,57344
mA 76,140,220
rT 88,12,49152
mA 72,136,220
dL 4,4,64,2048
mA 80,144,220
rT 90,12,57344
rT 92,13,49152
mA 84,148,220
rT 94,13,57344
mA 28,148,216
dL 5,4,64,3072
mA 24,144,216
rT 96,14,49152
rT 98,14,57344
mA 32,152,216
rT 100,15,49152
s_add_u32 s64, s64, 28672
mA 36,156,216
rT 102,15,57344
rT 104,16,49152
mA 92,156,220
rT 106,16,57344
mA 88,152,220
s_cmp_gt_u32 s72, 18
s_cselect_b32 s62, s62, 2147483648
rT 108,17,49152
mA 96,160,220
rT 110,17,57344
rT 112,18,49152
mA 100,164,220
buffer_load_dwordx4 v[208:211], v0, s[12:15], s62 offen offset:0 sc1
mA 44,164,216
rT 114,18,57344
rT 116,19,49152
mA 40,160,216
rT 118,19,57344
mA 48,168,216
buffer_load_dwordx4 v[212:215], v0, s[12:15], s62 offen offset:1024 sc1
mA 52,172,216
s_add_u32 s62, s62, 8192
s_waitcnt lgkmcnt(0)
s_waitcnt vmcnt(32)
mA 108,172,220
s_barrier
mA 104,168,220
mA 0,64,224
rT 120,20,0
mA 4,68,224
s_cmp_gt_u32 s72, 20
s_cselect_b32 s64, s64, 0x40000000
rT 122,20,8192
mA 60,68,228
rT 124,21,0
rT 126,21,8192
mA 56,64,228
s_add_u32 m0, s63, 32768
rT 128,22,0
rT 130,22,8192
mA 64,72,228
rT 132,23,0
mA 68,76,228
dL 2,4,64,0
mA 12,76,224
rT 134,23,8192
rT 136,24,0
mA 8,72,224
rT 138,24,8192
mA 16,80,224
dL 3,4,64,1024
mA 20,84,224
rT 140,25,0
rT 142,25,8192
mA 76,84,228
rT 144,26,0
mA 72,80,228
dL 4,4,64,2048
mA 80,88,228
rT 146,26,8192
rT 148,27,0
mA 84,92,228
rT 150,27,8192
mA 28,92,224
dL 5,4,64,3072
mA 24,88,224
rT 152,28,0
rT 154,28,8192
mA 32,96,224
rT 156,29,0
s_add_u32 s64, s64, 28672
mA 36,100,224
rT 158,29,8192
rT 160,30,0
mA 92,100,228
rT 162,30,8192
mA 88,96,228
s_cmp_gt_u32 s72, 19
s_cselect_b32 s62, s62, 2147483648
rT 164,31,0
mA 96,104,228
rT 166,31,8192
rT 168,32,0
mA 100,108,228
buffer_load_dwordx4 v[216:219], v0, s[12:15], s62 offen offset:0 sc1
mA 44,108,224
rT 170,32,8192
rT 172,33,0
mA 40,104,224
rT 174,33,8192
mA 48,112,224
buffer_load_dwordx4 v[220:223], v0, s[12:15], s62 offen offset:1024 sc1
mA 52,116,224
s_add_u32 s62, s62, 8192
s_waitcnt lgkmcnt(0)
mA 108,116,228
mA 104,112,228
s_waitcnt vmcnt(36)
mA 0,120,232
rT 64,20,16384
mA 4,124,232
s_cmp_gt_u32 s72, 21
s_cselect_b32 s64, s64, 0x40000000
rT 66,20,24576
mA 60,124,236
rT 68,21,16384
rT 70,21,24576
mA 56,120,236
s_add_u32 m0, s63, 49152
rT 72,22,16384
rT 74,22,24576
mA 64,128,236
rT 76,23,16384
mA 68,132,236
dL 2,4,64,0
mA 12,132,232
rT 78,23,24576
rT 80,24,16384
mA 8,128,232
rT 82,24,24576
mA 16,136,232
dL 3,4,64,1024
mA 20,140,232
rT 84,25,16384
rT 86,25,24576
mA 76,140,236
rT 88,26,16384
mA 72,136,236
dL 4,4,64,2048
mA 80,144,236
rT 90,26,24576
rT 92,27,16384
mA 84,148,236
rT 94,27,24576
mA 28,148,232
dL 5,4,64,3072
mA 24,144,232
rT 96,28,16384
rT 98,28,24576
mA 32,152,232
rT 100,29,16384
s_add_u32 s64, s64, 28672
mA 36,156,232
rT 102,29,24576
rT 104,30,16384
mA 92,156,236
rT 106,30,24576
mA 88,152,236
s_cmp_gt_u32 s72, 20
s_cselect_b32 s62, s62, 2147483648
rT 108,31,16384
mA 96,160,236
rT 110,31,24576
rT 112,32,16384
mA 100,164,236
buffer_load_dwordx4 v[224:227], v0, s[12:15], s62 offen offset:0 sc1
mA 44,164,232
rT 114,32,24576
rT 116,33,16384
mA 40,160,232
rT 118,33,24576
mA 48,168,232
buffer_load_dwordx4 v[228:231], v0, s[12:15], s62 offen offset:1024 sc1
mA 52,172,232
s_add_u32 s62, s62, 8192
s_waitcnt lgkmcnt(0)
s_waitcnt vmcnt(32)
mA 108,172,236
s_barrier
mA 104,168,236
mA 0,64,240
rT 120,20,32768
mA 4,68,240
s_cmp_gt_u32 s72, 22
s_cselect_b32 s64, s64, 0x40000000
rT 122,20,40960
mA 60,68,244
rT 124,21,32768
rT 126,21,40960
mA 56,64,244
s_add_u32 m0, s63, 65536
rT 128,22,32768
rT 130,22,40960
mA 64,72,244
rT 132,23,32768
mA 68,76,244
dL 2,4,64,0
mA 12,76,240
rT 134,23,40960
rT 136,24,32768
mA 8,72,240
rT 138,24,40960
mA 16,80,240
dL 3,4,64,1024
mA 20,84,240
rT 140,25,32768
rT 142,25,40960
mA 76,84,244
rT 144,26,32768
mA 72,80,244
dL 4,4,64,2048
mA 80,88,244
rT 146,26,40960
rT 148,27,32768
mA 84,92,244
rT 150,27,40960
mA 28,92,240
dL 5,4,64,3072
mA 24,88,240
rT 152,28,32768
rT 154,28,40960
mA 32,96,240
rT 156,29,32768
s_add_u32 s64, s64, 28672
mA 36,100,240
rT 158,29,40960
rT 160,30,32768
mA 92,100,244
rT 162,30,40960
mA 88,96,244
s_cmp_gt_u32 s72, 21
s_cselect_b32 s62, s62, 2147483648
rT 164,31,32768
mA 96,104,244
rT 166,31,40960
rT 168,32,32768
mA 100,108,244
buffer_load_dwordx4 v[232:235], v0, s[12:15], s62 offen offset:0 sc1
mA 44,108,240
rT 170,32,40960
rT 172,33,32768
mA 40,104,240
rT 174,33,40960
mA 48,112,240
buffer_load_dwordx4 v[236:239], v0, s[12:15], s62 offen offset:1024 sc1
mA 52,116,240
s_add_u32 s62, s62, 8192
s_waitcnt lgkmcnt(0)
mA 108,116,244
mA 104,112,244
s_waitcnt vmcnt(36)
mA 0,120,248
rT 64,20,49152
mA 4,124,248
s_cmp_gt_u32 s72, 23
s_cselect_b32 s64, s64, 0x40000000
rT 66,20,57344
mA 60,124,252
rT 68,21,49152
rT 70,21,57344
mA 56,120,252
s_add_u32 m0, s63, 81920
rT 72,22,49152
rT 74,22,57344
mA 64,128,252
rT 76,23,49152
mA 68,132,252
dL 2,4,64,0
mA 12,132,248
rT 78,23,57344
rT 80,24,49152
mA 8,128,248
rT 82,24,57344
mA 16,136,248
dL 3,4,64,1024
mA 20,140,248
rT 84,25,49152
rT 86,25,57344
mA 76,140,252
rT 88,26,49152
mA 72,136,252
dL 4,4,64,2048
mA 80,144,252
rT 90,26,57344
rT 92,27,49152
mA 84,148,252
rT 94,27,57344
mA 28,148,248
dL 5,4,64,3072
mA 24,144,248
rT 96,28,49152
rT 98,28,57344
mA 32,152,248
rT 100,29,49152
s_add_u32 s64, s64, 28672
mA 36,156,248
rT 102,29,57344
rT 104,30,49152
mA 92,156,252
rT 106,30,57344
mA 88,152,252
s_cmp_gt_u32 s72, 22
s_cselect_b32 s62, s62, 2147483648
rT 108,31,49152
mA 96,160,252
rT 110,31,57344
rT 112,32,49152
mA 100,164,252
buffer_load_dwordx4 v[240:243], v0, s[12:15], s62 offen offset:0 sc1
mA 44,164,248
rT 114,32,57344
rT 116,33,49152
mA 40,160,248
rT 118,33,57344
mA 48,168,248
buffer_load_dwordx4 v[244:247], v0, s[12:15], s62 offen offset:1024 sc1
mA 52,172,248
s_add_u32 s62, s62, 8192
s_waitcnt lgkmcnt(0)
s_waitcnt vmcnt(32)
mA 108,172,252
s_barrier
mA 104,168,252
s_cmp_eq_u32 s72, 16
s_cbranch_scc1 O8_post
mA 0,64,192
rT 120,34,0
mA 4,68,192
s_cmp_gt_u32 s72, 23
s_cselect_b32 s62, s62, 2147483648
rT 122,34,8192
mA 60,68,196
rT 124,35,0
rT 126,35,8192
mA 56,64,196
rT 128,36,0
rT 130,36,8192
mA 64,72,196
rT 132,37,0
mA 68,76,196
rT 134,37,8192
mA 12,76,192
rT 136,38,0
mA 8,72,192
buffer_load_dwordx4 v[248:251], v0, s[12:15], s62 offen offset:0 sc1
mA 16,80,192
rT 138,38,8192
rT 140,39,0
mA 20,84,192
rT 142,39,8192
rT 144,40,0
mA 76,84,196
rT 146,40,8192
mA 72,80,196
rT 148,41,0
rT 150,41,8192
mA 80,88,196
rT 152,42,0
mA 84,92,196
buffer_load_dwordx4 v[252:255], v0, s[12:15], s62 offen offset:1024 sc1
mA 28,92,192
rT 154,42,8192
rT 156,43,0
mA 24,88,192
rT 158,43,8192
rT 160,44,0
mA 32,96,192
rT 162,44,8192
mA 36,100,192
rT 164,45,0
mA 92,100,196
rT 166,45,8192
rT 168,46,0
mA 88,96,196
rT 170,46,8192
s_add_u32 s62, s62, 8192
mA 96,104,196
rT 172,47,0
mA 100,108,196
rT 174,47,8192
mA 44,108,192
mA 40,104,192
mA 48,112,192
mA 52,116,192
s_waitcnt lgkmcnt(0)
mA 108,116,196
mA 104,112,196
s_waitcnt vmcnt(32)
s_cmp_eq_u32 s72, 17
s_cbranch_scc1 O8_post
mA 0,120,200
rT 64,6,0
rT 66,6,8192
mA 4,124,200
rT 68,7,0
mA 60,124,204
rT 70,7,8192
mA 56,120,204
rT 72,8,0
rT 74,8,8192
mA 64,128,204
rT 76,9,0
mA 68,132,204
rT 78,9,8192
mA 12,132,200
rT 80,10,0
mA 8,128,200
rT 82,10,8192
rT 84,11,0
mA 16,136,200
rT 86,11,8192
mA 20,140,200
rT 88,12,0
mA 76,140,204
rT 90,12,8192
mA 72,136,204
rT 92,13,0
rT 94,13,8192
mA 80,144,204
rT 96,14,0
mA 84,148,204
rT 98,14,8192
mA 28,148,200
rT 100,15,0
rT 102,15,8192
mA 24,144,200
rT 104,16,0
mA 32,152,200
rT 106,16,8192
mA 36,156,200
rT 108,17,0
mA 92,156,204
rT 110,17,8192
rT 112,18,0
mA 88,152,204
rT 114,18,8192
mA 96,160,204
rT 116,19,0
mA 100,164,204
rT 118,19,8192
mA 44,164,200
mA 40,160,200
mA 48,168,200
mA 52,172,200
s_waitcnt lgkmcnt(0)
s_waitcnt vmcnt(22)
s_barrier
mA 108,172,204
mA 104,168,204
s_cmp_eq_u32 s72, 18
s_cbranch_scc1 O8_post
mA 0,64,208
rT 120,6,16384
rT 122,6,24576
mA 4,68,208
rT 124,7,16384
mA 60,68,212
rT 126,7,24576
mA 56,64,212
rT 128,8,16384
rT 130,8,24576
mA 64,72,212
rT 132,9,16384
mA 68,76,212
rT 134,9,24576
mA 12,76,208
rT 136,10,16384
mA 8,72,208
rT 138,10,24576
rT 140,11,16384
mA 16,80,208
rT 142,11,24576
mA 20,84,208
rT 144,12,16384
mA 76,84,212
rT 146,12,24576
mA 72,80,212
rT 148,13,16384
rT 150,13,24576
mA 80,88,212
rT 152,14,16384
mA 84,92,212
rT 154,14,24576
mA 28,92,208
rT 156,15,16384
rT 158,15,24576
mA 24,88,208
rT 160,16,16384
mA 32,96,208
rT 162,16,24576
mA 36,100,208
rT 164,17,16384
mA 92,100,212
rT 166,17,24576
rT 168,18,16384
mA 88,96,212
rT 170,18,24576
mA 96,104,212
rT 172,19,16384
mA 100,108,212
rT 174,19,24576
mA 44,108,208
mA 40,104,208
mA 48,112,208
mA 52,116,208
s_waitcnt lgkmcnt(0)
mA 108,116,212
mA 104,112,212
s_waitcnt vmcnt(20)
s_cmp_eq_u32 s72, 19
s_cbranch_scc1 O8_post
mA 0,120,216
rT 64,6,32768
rT 66,6,40960
mA 4,124,216
rT 68,7,32768
mA 60,124,220
rT 70,7,40960
mA 56,120,220
rT 72,8,32768
rT 74,8,40960
mA 64,128,220
rT 76,9,32768
mA 68,132,220
rT 78,9,40960
mA 12,132,216
rT 80,10,32768
mA 8,128,216
rT 82,10,40960
rT 84,11,32768
mA 16,136,216
rT 86,11,40960
mA 20,140,216
rT 88,12,32768
mA 76,140,220
rT 90,12,40960
mA 72,136,220
rT 92,13,32768
rT 94,13,40960
mA 80,144,220
rT 96,14,32768
mA 84,148,220
rT 98,14,40960
mA 28,148,216
rT 100,15,32768
rT 102,15,40960
mA 24,144,216
rT 104,16,32768
mA 32,152,216
rT 106,16,40960
mA 36,156,216
rT 108,17,32768
mA 92,156,220
rT 110,17,40960
rT 112,18,32768
mA 88,152,220
rT 114,18,40960
mA 96,160,220
rT 116,19,32768
mA 100,164,220
rT 118,19,40960
mA 44,164,216
mA 40,160,216
mA 48,168,216
mA 52,172,216
s_waitcnt lgkmcnt(0)
s_waitcnt vmcnt(10)
s_barrier
mA 108,172,220
mA 104,168,220
s_cmp_eq_u32 s72, 20
s_cbranch_scc1 O8_post
mA 0,64,224
rT 120,6,49152
rT 122,6,57344
mA 4,68,224
rT 124,7,49152
mA 60,68,228
rT 126,7,57344
mA 56,64,228
rT 128,8,49152
rT 130,8,57344
mA 64,72,228
rT 132,9,49152
mA 68,76,228
rT 134,9,57344
mA 12,76,224
rT 136,10,49152
mA 8,72,224
rT 138,10,57344
rT 140,11,49152
mA 16,80,224
rT 142,11,57344
mA 20,84,224
rT 144,12,49152
mA 76,84,228
rT 146,12,57344
mA 72,80,228
rT 148,13,49152
rT 150,13,57344
mA 80,88,228
rT 152,14,49152
mA 84,92,228
rT 154,14,57344
mA 28,92,224
rT 156,15,49152
rT 158,15,57344
mA 24,88,224
rT 160,16,49152
mA 32,96,224
rT 162,16,57344
mA 36,100,224
rT 164,17,49152
mA 92,100,228
rT 166,17,57344
rT 168,18,49152
mA 88,96,228
rT 170,18,57344
mA 96,104,228
rT 172,19,49152
mA 100,108,228
rT 174,19,57344
mA 44,108,224
mA 40,104,224
mA 48,112,224
mA 52,116,224
s_waitcnt lgkmcnt(0)
mA 108,116,228
mA 104,112,228
s_waitcnt vmcnt(8)
s_cmp_eq_u32 s72, 21
s_cbranch_scc1 O8_post
mA 0,120,232
rT 64,20,0
rT 66,20,8192
mA 4,124,232
rT 68,21,0
mA 60,124,236
rT 70,21,8192
mA 56,120,236
rT 72,22,0
rT 74,22,8192
mA 64,128,236
rT 76,23,0
mA 68,132,236
rT 78,23,8192
mA 12,132,232
rT 80,24,0
mA 8,128,232
rT 82,24,8192
rT 84,25,0
mA 16,136,232
rT 86,25,8192
mA 20,140,232
rT 88,26,0
mA 76,140,236
rT 90,26,8192
mA 72,136,236
rT 92,27,0
rT 94,27,8192
mA 80,144,236
rT 96,28,0
mA 84,148,236
rT 98,28,8192
mA 28,148,232
rT 100,29,0
rT 102,29,8192
mA 24,144,232
rT 104,30,0
mA 32,152,232
rT 106,30,8192
mA 36,156,232
rT 108,31,0
mA 92,156,236
rT 110,31,8192
rT 112,32,0
mA 88,152,236
rT 114,32,8192
mA 96,160,236
rT 116,33,0
mA 100,164,236
rT 118,33,8192
mA 44,164,232
mA 40,160,232
mA 48,168,232
mA 52,172,232
s_waitcnt lgkmcnt(0)
s_waitcnt vmcnt(4)
s_barrier
mA 108,172,236
mA 104,168,236
s_waitcnt vmcnt(2)
s_cmp_eq_u32 s72, 22
s_cbranch_scc1 O8_post
mA 0,64,240
rT 120,20,16384
rT 122,20,24576
mA 4,68,240
rT 124,21,16384
mA 60,68,244
rT 126,21,24576
mA 56,64,244
rT 128,22,16384
rT 130,22,24576
mA 64,72,244
rT 132,23,16384
mA 68,76,244
rT 134,23,24576
mA 12,76,240
rT 136,24,16384
mA 8,72,240
rT 138,24,24576
rT 140,25,16384
mA 16,80,240
rT 142,25,24576
mA 20,84,240
rT 144,26,16384
mA 76,84,244
rT 146,26,24576
mA 72,80,244
rT 148,27,16384
rT 150,27,24576
mA 80,88,244
rT 152,28,16384
mA 84,92,244
rT 154,28,24576
mA 28,92,240
rT 156,29,16384
rT 158,29,24576
mA 24,88,240
rT 160,30,16384
mA 32,96,240
rT 162,30,24576
mA 36,100,240
rT 164,31,16384
mA 92,100,244
rT 166,31,24576
rT 168,32,16384
mA 88,96,244
rT 170,32,24576
mA 96,104,244
rT 172,33,16384
mA 100,108,244
rT 174,33,24576
mA 44,108,240
mA 40,104,240
mA 48,112,240
mA 52,116,240
s_waitcnt lgkmcnt(0)
mA 108,116,244
mA 104,112,244
s_waitcnt vmcnt(0)
s_cmp_eq_u32 s72, 23
s_cbranch_scc1 O8_post
mA 0,120,248
mA 4,124,248
mA 60,124,252
mA 56,120,252
mA 64,128,252
mA 68,132,252
mA 12,132,248
mA 8,128,248
mA 16,136,248
mA 20,140,248
mA 76,140,252
mA 72,136,252
mA 80,144,252
mA 84,148,252
mA 28,148,248
mA 24,144,248
mA 32,152,248
mA 36,156,248
mA 92,156,252
mA 88,152,252
mA 96,160,252
mA 100,164,252
mA 44,164,248
mA 40,160,248
mA 48,168,248
mA 52,172,248
mA 108,172,252
mA 104,168,252
O8_post:
s_nop 4
s_cmp_eq_u32 s50, 1
s_cbranch_scc1 O8_p1
s_cmp_eq_u32 s50, 2
s_cbranch_scc1 O8_p2
s_cmp_eq_u32 s50, 3
s_cbranch_scc1 O8_p3
s_cmp_eq_u32 s50, 4
s_cbranch_scc1 O8_p4
s_cmp_eq_u32 s50, 5
s_cbranch_scc1 O8_p5
s_cmp_eq_u32 s50, 6
s_cbranch_scc1 O8_p6
s_cmp_eq_u32 s50, 7
s_cbranch_scc1 O8_p7
O8_p0:
aR 64,8
aR 65,9
aR 66,10
aR 67,11
aR 68,12
aR 69,13
aR 70,14
aR 71,15
cP 64,64,65
cP 65,66,67
cP 66,68,69
cP 67,70,71
buffer_store_dwordx4 v[64:67], v0, s[12:15], s55 offen offset:1024 sc1
aR 72,16
aR 73,17
aR 74,18
aR 75,19
aR 76,20
aR 77,21
aR 78,22
aR 79,23
cP 72,72,73
cP 73,74,75
cP 74,76,77
cP 75,78,79
buffer_store_dwordx4 v[72:75], v0, s[12:15], s55 offen offset:2048 sc1
aR 80,24
aR 81,25
aR 82,26
aR 83,27
aR 84,28
aR 85,29
aR 86,30
aR 87,31
cP 80,80,81
cP 81,82,83
cP 82,84,85
cP 83,86,87
buffer_store_dwordx4 v[80:83], v0, s[12:15], s55 offen offset:3072 sc1
s_add_u32 s55, s55, 4096
aR 88,32
aR 89,33
aR 90,34
aR 91,35
aR 92,36
aR 93,37
aR 94,38
aR 95,39
cP 88,88,89
cP 89,90,91
cP 90,92,93
cP 91,94,95
buffer_store_dwordx4 v[88:91], v0, s[12:15], s55 offen offset:0 sc1
aR 64,40
aR 65,41
aR 66,42
aR 67,43
aR 68,44
aR 69,45
aR 70,46
aR 71,47
cP 64,64,65
cP 65,66,67
cP 66,68,69
cP 67,70,71
buffer_store_dwordx4 v[64:67], v0, s[12:15], s55 offen offset:1024 sc1
aR 72,48
aR 73,49
aR 74,50
aR 75,51
aR 76,52
aR 77,53
aR 78,54
aR 79,55
cP 72,72,73
cP 73,74,75
cP 74,76,77
cP 75,78,79
buffer_store_dwordx4 v[72:75], v0, s[12:15], s55 offen offset:2048 sc1
aR 80,56
aR 81,57
aR 82,58
aR 83,59
aR 84,60
aR 85,61
aR 86,62
aR 87,63
cP 80,80,81
cP 81,82,83
cP 82,84,85
cP 83,86,87
buffer_store_dwordx4 v[80:83], v0, s[12:15], s55 offen offset:3072 sc1
s_add_u32 s55, s55, 4096
aR 88,72
aR 89,73
aR 90,74
aR 91,75
aR 92,76
aR 93,77
aR 94,78
aR 95,79
cP 88,88,89
cP 89,90,91
cP 90,92,93
cP 91,94,95
buffer_store_dwordx4 v[88:91], v0, s[12:15], s55 offen offset:1024 sc1
aR 64,80
aR 65,81
aR 66,82
aR 67,83
aR 68,84
aR 69,85
aR 70,86
aR 71,87
cP 64,64,65
cP 65,66,67
cP 66,68,69
cP 67,70,71
buffer_store_dwordx4 v[64:67], v0, s[12:15], s55 offen offset:2048 sc1
aR 72,88
aR 73,89
aR 74,90
aR 75,91
aR 76,92
aR 77,93
aR 78,94
aR 79,95
cP 72,72,73
cP 73,74,75
cP 74,76,77
cP 75,78,79
buffer_store_dwordx4 v[72:75], v0, s[12:15], s55 offen offset:3072 sc1
s_add_u32 s55, s55, 4096
aR 80,96
aR 81,97
aR 82,98
aR 83,99
aR 84,100
aR 85,101
aR 86,102
aR 87,103
cP 80,80,81
cP 81,82,83
cP 82,84,85
cP 83,86,87
buffer_store_dwordx4 v[80:83], v0, s[12:15], s55 offen offset:0 sc1
aR 88,104
aR 89,105
aR 90,106
aR 91,107
aR 92,108
aR 93,109
aR 94,110
aR 95,111
cP 88,88,89
cP 89,90,91
cP 90,92,93
cP 91,94,95
buffer_store_dwordx4 v[88:91], v0, s[12:15], s55 offen offset:1024 sc1
aR 96,0
aR 97,1
aR 98,2
aR 99,3
aR 100,4
aR 101,5
aR 102,6
aR 103,7
aR 104,64
aR 105,65
aR 106,66
aR 107,67
aR 108,68
aR 109,69
aR 110,70
aR 111,71
s_waitcnt vmcnt(0)
s_barrier
s_cmp_eq_u32 s3, 0
s_cbranch_scc0 O8_w0
buffer_atomic_add v53, v52, s[12:15], s56 offen
O8_poll0:
buffer_load_dword v56, v55, s[12:15], s56 offen sc1
s_waitcnt vmcnt(0)
v_readfirstlane_b32 s53, v56
s_nop 0
s_cmp_ge_u32 s53, 8
s_cbranch_scc1 O8_w0
s_sleep 4
s_branch O8_poll0
O8_w0:
s_barrier
s_add_u32 s55, s57, 65536
buffer_load_dwordx4 v[128:131], v0, s[12:15], s55 offen sc1
s_add_u32 s55, s57, 131072
buffer_load_dwordx4 v[132:135], v0, s[12:15], s55 offen sc1
s_add_u32 s55, s57, 196608
buffer_load_dwordx4 v[136:139], v0, s[12:15], s55 offen sc1
s_add_u32 s55, s57, 262144
buffer_load_dwordx4 v[140:143], v0, s[12:15], s55 offen sc1
s_add_u32 s55, s57, 327680
buffer_load_dwordx4 v[144:147], v0, s[12:15], s55 offen sc1
s_add_u32 s55, s57, 393216
buffer_load_dwordx4 v[148:151], v0, s[12:15], s55 offen sc1
s_add_u32 s55, s57, 458752
buffer_load_dwordx4 v[152:155], v0, s[12:15], s55 offen sc1
s_add_u32 s55, s57, 73728
buffer_load_dwordx4 v[168:171], v0, s[12:15], s55 offen sc1
s_add_u32 s55, s57, 139264
buffer_load_dwordx4 v[172:175], v0, s[12:15], s55 offen sc1
s_add_u32 s55, s57, 204800
buffer_load_dwordx4 v[176:179], v0, s[12:15], s55 offen sc1
s_add_u32 s55, s57, 270336
buffer_load_dwordx4 v[180:183], v0, s[12:15], s55 offen sc1
s_add_u32 s55, s57, 335872
buffer_load_dwordx4 v[184:187], v0, s[12:15], s55 offen sc1
s_add_u32 s55, s57, 401408
buffer_load_dwordx4 v[188:191], v0, s[12:15], s55 offen sc1
s_add_u32 s55, s57, 466944
buffer_load_dwordx4 v[192:195], v0, s[12:15], s55 offen sc1
s_waitcnt vmcnt(13)
v_lshlrev_b32 v64, 16, v128
v_and_b32 v65, 0xffff0000, v128
v_lshlrev_b32 v66, 16, v129
v_and_b32 v67, 0xffff0000, v129
v_lshlrev_b32 v68, 16, v130
v_and_b32 v69, 0xffff0000, v130
v_lshlrev_b32 v70, 16, v131
v_and_b32 v71, 0xffff0000, v131
v_pk_add_f32 v[96:97], v[96:97], v[64:65]
v_pk_add_f32 v[98:99], v[98:99], v[66:67]
v_pk_add_f32 v[100:101], v[100:101], v[68:69]
v_pk_add_f32 v[102:103], v[102:103], v[70:71]
s_waitcnt vmcnt(12)
v_lshlrev_b32 v72, 16, v132
v_and_b32 v73, 0xffff0000, v132
v_lshlrev_b32 v74, 16, v133
v_and_b32 v75, 0xffff0000, v133
v_lshlrev_b32 v76, 16, v134
v_and_b32 v77, 0xffff0000, v134
v_lshlrev_b32 v78, 16, v135
v_and_b32 v79, 0xffff0000, v135
v_pk_add_f32 v[96:97], v[96:97], v[72:73]
v_pk_add_f32 v[98:99], v[98:99], v[74:75]
v_pk_add_f32 v[100:101], v[100:101], v[76:77]
v_pk_add_f32 v[102:103], v[102:103], v[78:79]
s_waitcnt vmcnt(11)
v_lshlrev_b32 v64, 16, v136
v_and_b32 v65, 0xffff0000, v136
v_lshlrev_b32 v66, 16, v137
v_and_b32 v67, 0xffff0000, v137
v_lshlrev_b32 v68, 16, v138
v_and_b32 v69, 0xffff0000, v138
v_lshlrev_b32 v70, 16, v139
v_and_b32 v71, 0xffff0000, v139
v_pk_add_f32 v[96:97], v[96:97], v[64:65]
v_pk_add_f32 v[98:99], v[98:99], v[66:67]
v_pk_add_f32 v[100:101], v[100:101], v[68:69]
v_pk_add_f32 v[102:103], v[102:103], v[70:71]
s_waitcnt vmcnt(10)
v_lshlrev_b32 v72, 16, v140
v_and_b32 v73, 0xffff0000, v140
v_lshlrev_b32 v74, 16, v141
v_and_b32 v75, 0xffff0000, v141
v_lshlrev_b32 v76, 16, v142
v_and_b32 v77, 0xffff0000, v142
v_lshlrev_b32 v78, 16, v143
v_and_b32 v79, 0xffff0000, v143
v_pk_add_f32 v[96:97], v[96:97], v[72:73]
v_pk_add_f32 v[98:99], v[98:99], v[74:75]
v_pk_add_f32 v[100:101], v[100:101], v[76:77]
v_pk_add_f32 v[102:103], v[102:103], v[78:79]
s_waitcnt vmcnt(9)
v_lshlrev_b32 v64, 16, v144
v_and_b32 v65, 0xffff0000, v144
v_lshlrev_b32 v66, 16, v145
v_and_b32 v67, 0xffff0000, v145
v_lshlrev_b32 v68, 16, v146
v_and_b32 v69, 0xffff0000, v146
v_lshlrev_b32 v70, 16, v147
v_and_b32 v71, 0xffff0000, v147
v_pk_add_f32 v[96:97], v[96:97], v[64:65]
v_pk_add_f32 v[98:99], v[98:99], v[66:67]
v_pk_add_f32 v[100:101], v[100:101], v[68:69]
v_pk_add_f32 v[102:103], v[102:103], v[70:71]
s_waitcnt vmcnt(8)
v_lshlrev_b32 v72, 16, v148
v_and_b32 v73, 0xffff0000, v148
v_lshlrev_b32 v74, 16, v149
v_and_b32 v75, 0xffff0000, v149
v_lshlrev_b32 v76, 16, v150
v_and_b32 v77, 0xffff0000, v150
v_lshlrev_b32 v78, 16, v151
v_and_b32 v79, 0xffff0000, v151
v_pk_add_f32 v[96:97], v[96:97], v[72:73]
v_pk_add_f32 v[98:99], v[98:99], v[74:75]
v_pk_add_f32 v[100:101], v[100:101], v[76:77]
v_pk_add_f32 v[102:103], v[102:103], v[78:79]
s_waitcnt vmcnt(7)
v_lshlrev_b32 v64, 16, v152
v_and_b32 v65, 0xffff0000, v152
v_lshlrev_b32 v66, 16, v153
v_and_b32 v67, 0xffff0000, v153
v_lshlrev_b32 v68, 16, v154
v_and_b32 v69, 0xffff0000, v154
v_lshlrev_b32 v70, 16, v155
v_and_b32 v71, 0xffff0000, v155
v_pk_add_f32 v[96:97], v[96:97], v[64:65]
v_pk_add_f32 v[98:99], v[98:99], v[66:67]
v_pk_add_f32 v[100:101], v[100:101], v[68:69]
v_pk_add_f32 v[102:103], v[102:103], v[70:71]
cP 96,96,97
cP 97,98,99
cP 98,100,101
cP 99,102,103
s_add_u32 s53, s58, 0
buffer_store_dwordx2 v[96:97], v54, s[8:11], s53 offen
buffer_store_dwordx2 v[98:99], v54, s[8:11], s53 offen offset:32
s_waitcnt vmcnt(8)
v_lshlrev_b32 v64, 16, v168
v_and_b32 v65, 0xffff0000, v168
v_lshlrev_b32 v66, 16, v169
v_and_b32 v67, 0xffff0000, v169
v_lshlrev_b32 v68, 16, v170
v_and_b32 v69, 0xffff0000, v170
v_lshlrev_b32 v70, 16, v171
v_and_b32 v71, 0xffff0000, v171
v_pk_add_f32 v[104:105], v[104:105], v[64:65]
v_pk_add_f32 v[106:107], v[106:107], v[66:67]
v_pk_add_f32 v[108:109], v[108:109], v[68:69]
v_pk_add_f32 v[110:111], v[110:111], v[70:71]
s_waitcnt vmcnt(7)
v_lshlrev_b32 v72, 16, v172
v_and_b32 v73, 0xffff0000, v172
v_lshlrev_b32 v74, 16, v173
v_and_b32 v75, 0xffff0000, v173
v_lshlrev_b32 v76, 16, v174
v_and_b32 v77, 0xffff0000, v174
v_lshlrev_b32 v78, 16, v175
v_and_b32 v79, 0xffff0000, v175
v_pk_add_f32 v[104:105], v[104:105], v[72:73]
v_pk_add_f32 v[106:107], v[106:107], v[74:75]
v_pk_add_f32 v[108:109], v[108:109], v[76:77]
v_pk_add_f32 v[110:111], v[110:111], v[78:79]
s_waitcnt vmcnt(6)
v_lshlrev_b32 v64, 16, v176
v_and_b32 v65, 0xffff0000, v176
v_lshlrev_b32 v66, 16, v177
v_and_b32 v67, 0xffff0000, v177
v_lshlrev_b32 v68, 16, v178
v_and_b32 v69, 0xffff0000, v178
v_lshlrev_b32 v70, 16, v179
v_and_b32 v71, 0xffff0000, v179
v_pk_add_f32 v[104:105], v[104:105], v[64:65]
v_pk_add_f32 v[106:107], v[106:107], v[66:67]
v_pk_add_f32 v[108:109], v[108:109], v[68:69]
v_pk_add_f32 v[110:111], v[110:111], v[70:71]
s_waitcnt vmcnt(5)
v_lshlrev_b32 v72, 16, v180
v_and_b32 v73, 0xffff0000, v180
v_lshlrev_b32 v74, 16, v181
v_and_b32 v75, 0xffff0000, v181
v_lshlrev_b32 v76, 16, v182
v_and_b32 v77, 0xffff0000, v182
v_lshlrev_b32 v78, 16, v183
v_and_b32 v79, 0xffff0000, v183
v_pk_add_f32 v[104:105], v[104:105], v[72:73]
v_pk_add_f32 v[106:107], v[106:107], v[74:75]
v_pk_add_f32 v[108:109], v[108:109], v[76:77]
v_pk_add_f32 v[110:111], v[110:111], v[78:79]
s_waitcnt vmcnt(4)
v_lshlrev_b32 v64, 16, v184
v_and_b32 v65, 0xffff0000, v184
v_lshlrev_b32 v66, 16, v185
v_and_b32 v67, 0xffff0000, v185
v_lshlrev_b32 v68, 16, v186
v_and_b32 v69, 0xffff0000, v186
v_lshlrev_b32 v70, 16, v187
v_and_b32 v71, 0xffff0000, v187
v_pk_add_f32 v[104:105], v[104:105], v[64:65]
v_pk_add_f32 v[106:107], v[106:107], v[66:67]
v_pk_add_f32 v[108:109], v[108:109], v[68:69]
v_pk_add_f32 v[110:111], v[110:111], v[70:71]
s_waitcnt vmcnt(3)
v_lshlrev_b32 v72, 16, v188
v_and_b32 v73, 0xffff0000, v188
v_lshlrev_b32 v74, 16, v189
v_and_b32 v75, 0xffff0000, v189
v_lshlrev_b32 v76, 16, v190
v_and_b32 v77, 0xffff0000, v190
v_lshlrev_b32 v78, 16, v191
v_and_b32 v79, 0xffff0000, v191
v_pk_add_f32 v[104:105], v[104:105], v[72:73]
v_pk_add_f32 v[106:107], v[106:107], v[74:75]
v_pk_add_f32 v[108:109], v[108:109], v[76:77]
v_pk_add_f32 v[110:111], v[110:111], v[78:79]
s_waitcnt vmcnt(2)
v_lshlrev_b32 v64, 16, v192
v_and_b32 v65, 0xffff0000, v192
v_lshlrev_b32 v66, 16, v193
v_and_b32 v67, 0xffff0000, v193
v_lshlrev_b32 v68, 16, v194
v_and_b32 v69, 0xffff0000, v194
v_lshlrev_b32 v70, 16, v195
v_and_b32 v71, 0xffff0000, v195
v_pk_add_f32 v[104:105], v[104:105], v[64:65]
v_pk_add_f32 v[106:107], v[106:107], v[66:67]
v_pk_add_f32 v[108:109], v[108:109], v[68:69]
v_pk_add_f32 v[110:111], v[110:111], v[70:71]
cP 104,104,105
cP 105,106,107
cP 106,108,109
cP 107,110,111
s_add_u32 s53, s58, 14400
buffer_store_dwordx2 v[104:105], v54, s[8:11], s53 offen
buffer_store_dwordx2 v[106:107], v54, s[8:11], s53 offen offset:32
s_branch O8_fin
O8_p1:
aR 64,0
aR 65,1
aR 66,2
aR 67,3
aR 68,4
aR 69,5
aR 70,6
aR 71,7
cP 64,64,65
cP 65,66,67
cP 66,68,69
cP 67,70,71
buffer_store_dwordx4 v[64:67], v0, s[12:15], s55 offen offset:0 sc1
aR 72,16
aR 73,17
aR 74,18
aR 75,19
aR 76,20
aR 77,21
aR 78,22
aR 79,23
cP 72,72,73
cP 73,74,75
cP 74,76,77
cP 75,78,79
buffer_store_dwordx4 v[72:75], v0, s[12:15], s55 offen offset:2048 sc1
aR 80,24
aR 81,25
aR 82,26
aR 83,27
aR 84,28
aR 85,29
aR 86,30
aR 87,31
cP 80,80,81
cP 81,82,83
cP 82,84,85
cP 83,86,87
buffer_store_dwordx4 v[80:83], v0, s[12:15], s55 offen offset:3072 sc1
s_add_u32 s55, s55, 4096
aR 88,32
aR 89,33
aR 90,34
aR 91,35
aR 92,36
aR 93,37
aR 94,38
aR 95,39
cP 88,88,89
cP 89,90,91
cP 90,92,93
cP 91,94,95
buffer_store_dwordx4 v[88:91], v0, s[12:15], s55 offen offset:0 sc1
aR 64,40
aR 65,41
aR 66,42
aR 67,43
aR 68,44
aR 69,45
aR 70,46
aR 71,47
cP 64,64,65
cP 65,66,67
cP 66,68,69
cP 67,70,71
buffer_store_dwordx4 v[64:67], v0, s[12:15], s55 offen offset:1024 sc1
aR 72,48
aR 73,49
aR 74,50
aR 75,51
aR 76,52
aR 77,53
aR 78,54
aR 79,55
cP 72,72,73
cP 73,74,75
cP 74,76,77
cP 75,78,79
buffer_store_dwordx4 v[72:75], v0, s[12:15], s55 offen offset:2048 sc1
aR 80,56
aR 81,57
aR 82,58
aR 83,59
aR 84,60
aR 85,61
aR 86,62
aR 87,63
cP 80,80,81
cP 81,82,83
cP 82,84,85
cP 83,86,87
buffer_store_dwordx4 v[80:83], v0, s[12:15], s55 offen offset:3072 sc1
s_add_u32 s55, s55, 4096
aR 88,64
aR 89,65
aR 90,66
aR 91,67
aR 92,68
aR 93,69
aR 94,70
aR 95,71
cP 88,88,89
cP 89,90,91
cP 90,92,93
cP 91,94,95
buffer_store_dwordx4 v[88:91], v0, s[12:15], s55 offen offset:0 sc1
aR 64,80
aR 65,81
aR 66,82
aR 67,83
aR 68,84
aR 69,85
aR 70,86
aR 71,87
cP 64,64,65
cP 65,66,67
cP 66,68,69
cP 67,70,71
buffer_store_dwordx4 v[64:67], v0, s[12:15], s55 offen offset:2048 sc1
aR 72,88
aR 73,89
aR 74,90
aR 75,91
aR 76,92
aR 77,93
aR 78,94
aR 79,95
cP 72,72,73
cP 73,74,75
cP 74,76,77
cP 75,78,79
buffer_store_dwordx4 v[72:75], v0, s[12:15], s55 offen offset:3072 sc1
s_add_u32 s55, s55, 4096
aR 80,96
aR 81,97
aR 82,98
aR 83,99
aR 84,100
aR 85,101
aR 86,102
aR 87,103
cP 80,80,81
cP 81,82,83
cP 82,84,85
cP 83,86,87
buffer_store_dwordx4 v[80:83], v0, s[12:15], s55 offen offset:0 sc1
aR 88,104
aR 89,105
aR 90,106
aR 91,107
aR 92,108
aR 93,109
aR 94,110
aR 95,111
cP 88,88,89
cP 89,90,91
cP 90,92,93
cP 91,94,95
buffer_store_dwordx4 v[88:91], v0, s[12:15], s55 offen offset:1024 sc1
aR 96,8
aR 97,9
aR 98,10
aR 99,11
aR 100,12
aR 101,13
aR 102,14
aR 103,15
aR 104,72
aR 105,73
aR 106,74
aR 107,75
aR 108,76
aR 109,77
aR 110,78
aR 111,79
s_waitcnt vmcnt(0)
s_barrier
s_cmp_eq_u32 s3, 0
s_cbranch_scc0 O8_w1
buffer_atomic_add v53, v52, s[12:15], s56 offen
O8_poll1:
buffer_load_dword v56, v55, s[12:15], s56 offen sc1
s_waitcnt vmcnt(0)
v_readfirstlane_b32 s53, v56
s_nop 0
s_cmp_ge_u32 s53, 8
s_cbranch_scc1 O8_w1
s_sleep 4
s_branch O8_poll1
O8_w1:
s_barrier
s_add_u32 s55, s57, 1024
buffer_load_dwordx4 v[128:131], v0, s[12:15], s55 offen sc1
s_add_u32 s55, s57, 132096
buffer_load_dwordx4 v[132:135], v0, s[12:15], s55 offen sc1
s_add_u32 s55, s57, 197632
buffer_load_dwordx4 v[136:139], v0, s[12:15], s55 offen sc1
s_add_u32 s55, s57, 263168
buffer_load_dwordx4 v[140:143], v0, s[12:15], s55 offen sc1
s_add_u32 s55, s57, 328704
buffer_load_dwordx4 v[144:147], v0, s[12:15], s55 offen sc1
s_add_u32 s55, s57, 394240
buffer_load_dwordx4 v[148:151], v0, s[12:15], s55 offen sc1
s_add_u32 s55, s57, 459776
buffer_load_dwordx4 v[152:155], v0, s[12:15], s55 offen sc1
s_add_u32 s55, s57, 9216
buffer_load_dwordx4 v[168:171], v0, s[12:15], s55 offen sc1
s_add_u32 s55, s57, 140288
buffer_load_dwordx4 v[172:175], v0, s[12:15], s55 offen sc1
s_add_u32 s55, s57, 205824
buffer_load_dwordx4 v[176:179], v0, s[12:15], s55 offen sc1
s_add_u32 s55, s57, 271360
buffer_load_dwordx4 v[180:183], v0, s[12:15], s55 offen sc1
s_add_u32 s55, s57, 336896
buffer_load_dwordx4 v[184:187], v0, s[12:15], s55 offen sc1
s_add_u32 s55, s57, 402432
buffer_load_dwordx4 v[188:191], v0, s[12:15], s55 offen sc1
s_add_u32 s55, s57, 467968
buffer_load_dwordx4 v[192:195], v0, s[12:15], s55 offen sc1
s_waitcnt vmcnt(13)
v_lshlrev_b32 v64, 16, v128
v_and_b32 v65, 0xffff0000, v128
v_lshlrev_b32 v66, 16, v129
v_and_b32 v67, 0xffff0000, v129
v_lshlrev_b32 v68, 16, v130
v_and_b32 v69, 0xffff0000, v130
v_lshlrev_b32 v70, 16, v131
v_and_b32 v71, 0xffff0000, v131
v_pk_add_f32 v[96:97], v[96:97], v[64:65]
v_pk_add_f32 v[98:99], v[98:99], v[66:67]
v_pk_add_f32 v[100:101], v[100:101], v[68:69]
v_pk_add_f32 v[102:103], v[102:103], v[70:71]
s_waitcnt vmcnt(12)
v_lshlrev_b32 v72, 16, v132
v_and_b32 v73, 0xffff0000, v132
v_lshlrev_b32 v74, 16, v133
v_and_b32 v75, 0xffff0000, v133
v_lshlrev_b32 v76, 16, v134
v_and_b32 v77, 0xffff0000, v134
v_lshlrev_b32 v78, 16, v135
v_and_b32 v79, 0xffff0000, v135
v_pk_add_f32 v[96:97], v[96:97], v[72:73]
v_pk_add_f32 v[98:99], v[98:99], v[74:75]
v_pk_add_f32 v[100:101], v[100:101], v[76:77]
v_pk_add_f32 v[102:103], v[102:103], v[78:79]
s_waitcnt vmcnt(11)
v_lshlrev_b32 v64, 16, v136
v_and_b32 v65, 0xffff0000, v136
v_lshlrev_b32 v66, 16, v137
v_and_b32 v67, 0xffff0000, v137
v_lshlrev_b32 v68, 16, v138
v_and_b32 v69, 0xffff0000, v138
v_lshlrev_b32 v70, 16, v139
v_and_b32 v71, 0xffff0000, v139
v_pk_add_f32 v[96:97], v[96:97], v[64:65]
v_pk_add_f32 v[98:99], v[98:99], v[66:67]
v_pk_add_f32 v[100:101], v[100:101], v[68:69]
v_pk_add_f32 v[102:103], v[102:103], v[70:71]
s_waitcnt vmcnt(10)
v_lshlrev_b32 v72, 16, v140
v_and_b32 v73, 0xffff0000, v140
v_lshlrev_b32 v74, 16, v141
v_and_b32 v75, 0xffff0000, v141
v_lshlrev_b32 v76, 16, v142
v_and_b32 v77, 0xffff0000, v142
v_lshlrev_b32 v78, 16, v143
v_and_b32 v79, 0xffff0000, v143
v_pk_add_f32 v[96:97], v[96:97], v[72:73]
v_pk_add_f32 v[98:99], v[98:99], v[74:75]
v_pk_add_f32 v[100:101], v[100:101], v[76:77]
v_pk_add_f32 v[102:103], v[102:103], v[78:79]
s_waitcnt vmcnt(9)
v_lshlrev_b32 v64, 16, v144
v_and_b32 v65, 0xffff0000, v144
v_lshlrev_b32 v66, 16, v145
v_and_b32 v67, 0xffff0000, v145
v_lshlrev_b32 v68, 16, v146
v_and_b32 v69, 0xffff0000, v146
v_lshlrev_b32 v70, 16, v147
v_and_b32 v71, 0xffff0000, v147
v_pk_add_f32 v[96:97], v[96:97], v[64:65]
v_pk_add_f32 v[98:99], v[98:99], v[66:67]
v_pk_add_f32 v[100:101], v[100:101], v[68:69]
v_pk_add_f32 v[102:103], v[102:103], v[70:71]
s_waitcnt vmcnt(8)
v_lshlrev_b32 v72, 16, v148
v_and_b32 v73, 0xffff0000, v148
v_lshlrev_b32 v74, 16, v149
v_and_b32 v75, 0xffff0000, v149
v_lshlrev_b32 v76, 16, v150
v_and_b32 v77, 0xffff0000, v150
v_lshlrev_b32 v78, 16, v151
v_and_b32 v79, 0xffff0000, v151
v_pk_add_f32 v[96:97], v[96:97], v[72:73]
v_pk_add_f32 v[98:99], v[98:99], v[74:75]
v_pk_add_f32 v[100:101], v[100:101], v[76:77]
v_pk_add_f32 v[102:103], v[102:103], v[78:79]
s_waitcnt vmcnt(7)
v_lshlrev_b32 v64, 16, v152
v_and_b32 v65, 0xffff0000, v152
v_lshlrev_b32 v66, 16, v153
v_and_b32 v67, 0xffff0000, v153
v_lshlrev_b32 v68, 16, v154
v_and_b32 v69, 0xffff0000, v154
v_lshlrev_b32 v70, 16, v155
v_and_b32 v71, 0xffff0000, v155
v_pk_add_f32 v[96:97], v[96:97], v[64:65]
v_pk_add_f32 v[98:99], v[98:99], v[66:67]
v_pk_add_f32 v[100:101], v[100:101], v[68:69]
v_pk_add_f32 v[102:103], v[102:103], v[70:71]
cP 96,96,97
cP 97,98,99
cP 98,100,101
cP 99,102,103
s_add_u32 s53, s58, 64
buffer_store_dwordx2 v[96:97], v54, s[8:11], s53 offen
buffer_store_dwordx2 v[98:99], v54, s[8:11], s53 offen offset:32
s_waitcnt vmcnt(8)
v_lshlrev_b32 v64, 16, v168
v_and_b32 v65, 0xffff0000, v168
v_lshlrev_b32 v66, 16, v169
v_and_b32 v67, 0xffff0000, v169
v_lshlrev_b32 v68, 16, v170
v_and_b32 v69, 0xffff0000, v170
v_lshlrev_b32 v70, 16, v171
v_and_b32 v71, 0xffff0000, v171
v_pk_add_f32 v[104:105], v[104:105], v[64:65]
v_pk_add_f32 v[106:107], v[106:107], v[66:67]
v_pk_add_f32 v[108:109], v[108:109], v[68:69]
v_pk_add_f32 v[110:111], v[110:111], v[70:71]
s_waitcnt vmcnt(7)
v_lshlrev_b32 v72, 16, v172
v_and_b32 v73, 0xffff0000, v172
v_lshlrev_b32 v74, 16, v173
v_and_b32 v75, 0xffff0000, v173
v_lshlrev_b32 v76, 16, v174
v_and_b32 v77, 0xffff0000, v174
v_lshlrev_b32 v78, 16, v175
v_and_b32 v79, 0xffff0000, v175
v_pk_add_f32 v[104:105], v[104:105], v[72:73]
v_pk_add_f32 v[106:107], v[106:107], v[74:75]
v_pk_add_f32 v[108:109], v[108:109], v[76:77]
v_pk_add_f32 v[110:111], v[110:111], v[78:79]
s_waitcnt vmcnt(6)
v_lshlrev_b32 v64, 16, v176
v_and_b32 v65, 0xffff0000, v176
v_lshlrev_b32 v66, 16, v177
v_and_b32 v67, 0xffff0000, v177
v_lshlrev_b32 v68, 16, v178
v_and_b32 v69, 0xffff0000, v178
v_lshlrev_b32 v70, 16, v179
v_and_b32 v71, 0xffff0000, v179
v_pk_add_f32 v[104:105], v[104:105], v[64:65]
v_pk_add_f32 v[106:107], v[106:107], v[66:67]
v_pk_add_f32 v[108:109], v[108:109], v[68:69]
v_pk_add_f32 v[110:111], v[110:111], v[70:71]
s_waitcnt vmcnt(5)
v_lshlrev_b32 v72, 16, v180
v_and_b32 v73, 0xffff0000, v180
v_lshlrev_b32 v74, 16, v181
v_and_b32 v75, 0xffff0000, v181
v_lshlrev_b32 v76, 16, v182
v_and_b32 v77, 0xffff0000, v182
v_lshlrev_b32 v78, 16, v183
v_and_b32 v79, 0xffff0000, v183
v_pk_add_f32 v[104:105], v[104:105], v[72:73]
v_pk_add_f32 v[106:107], v[106:107], v[74:75]
v_pk_add_f32 v[108:109], v[108:109], v[76:77]
v_pk_add_f32 v[110:111], v[110:111], v[78:79]
s_waitcnt vmcnt(4)
v_lshlrev_b32 v64, 16, v184
v_and_b32 v65, 0xffff0000, v184
v_lshlrev_b32 v66, 16, v185
v_and_b32 v67, 0xffff0000, v185
v_lshlrev_b32 v68, 16, v186
v_and_b32 v69, 0xffff0000, v186
v_lshlrev_b32 v70, 16, v187
v_and_b32 v71, 0xffff0000, v187
v_pk_add_f32 v[104:105], v[104:105], v[64:65]
v_pk_add_f32 v[106:107], v[106:107], v[66:67]
v_pk_add_f32 v[108:109], v[108:109], v[68:69]
v_pk_add_f32 v[110:111], v[110:111], v[70:71]
s_waitcnt vmcnt(3)
v_lshlrev_b32 v72, 16, v188
v_and_b32 v73, 0xffff0000, v188
v_lshlrev_b32 v74, 16, v189
v_and_b32 v75, 0xffff0000, v189
v_lshlrev_b32 v76, 16, v190
v_and_b32 v77, 0xffff0000, v190
v_lshlrev_b32 v78, 16, v191
v_and_b32 v79, 0xffff0000, v191
v_pk_add_f32 v[104:105], v[104:105], v[72:73]
v_pk_add_f32 v[106:107], v[106:107], v[74:75]
v_pk_add_f32 v[108:109], v[108:109], v[76:77]
v_pk_add_f32 v[110:111], v[110:111], v[78:79]
s_waitcnt vmcnt(2)
v_lshlrev_b32 v64, 16, v192
v_and_b32 v65, 0xffff0000, v192
v_lshlrev_b32 v66, 16, v193
v_and_b32 v67, 0xffff0000, v193
v_lshlrev_b32 v68, 16, v194
v_and_b32 v69, 0xffff0000, v194
v_lshlrev_b32 v70, 16, v195
v_and_b32 v71, 0xffff0000, v195
v_pk_add_f32 v[104:105], v[104:105], v[64:65]
v_pk_add_f32 v[106:107], v[106:107], v[66:67]
v_pk_add_f32 v[108:109], v[108:109], v[68:69]
v_pk_add_f32 v[110:111], v[110:111], v[70:71]
cP 104,104,105
cP 105,106,107
cP 106,108,109
cP 107,110,111
s_add_u32 s53, s58, 14464
buffer_store_dwordx2 v[104:105], v54, s[8:11], s53 offen
buffer_store_dwordx2 v[106:107], v54, s[8:11], s53 offen offset:32
s_branch O8_fin
O8_p2:
aR 64,0
aR 65,1
aR 66,2
aR 67,3
aR 68,4
aR 69,5
aR 70,6
aR 71,7
cP 64,64,65
cP 65,66,67
cP 66,68,69
cP 67,70,71
buffer_store_dwordx4 v[64:67], v0, s[12:15], s55 offen offset:0 sc1
aR 72,8
aR 73,9
aR 74,10
aR 75,11
aR 76,12
aR 77,13
aR 78,14
aR 79,15
cP 72,72,73
cP 73,74,75
cP 74,76,77
cP 75,78,79
buffer_store_dwordx4 v[72:75], v0, s[12:15], s55 offen offset:1024 sc1
aR 80,24
aR 81,25
aR 82,26
aR 83,27
aR 84,28
aR 85,29
aR 86,30
aR 87,31
cP 80,80,81
cP 81,82,83
cP 82,84,85
cP 83,86,87
buffer_store_dwordx4 v[80:83], v0, s[12:15], s55 offen offset:3072 sc1
s_add_u32 s55, s55, 4096
aR 88,32
aR 89,33
aR 90,34
aR 91,35
aR 92,36
aR 93,37
aR 94,38
aR 95,39
cP 88,88,89
cP 89,90,91
cP 90,92,93
cP 91,94,95
buffer_store_dwordx4 v[88:91], v0, s[12:15], s55 offen offset:0 sc1
aR 64,40
aR 65,41
aR 66,42
aR 67,43
aR 68,44
aR 69,45
aR 70,46
aR 71,47
cP 64,64,65
cP 65,66,67
cP 66,68,69
cP 67,70,71
buffer_store_dwordx4 v[64:67], v0, s[12:15], s55 offen offset:1024 sc1
aR 72,48
aR 73,49
aR 74,50
aR 75,51
aR 76,52
aR 77,53
aR 78,54
aR 79,55
cP 72,72,73
cP 73,74,75
cP 74,76,77
cP 75,78,79
buffer_store_dwordx4 v[72:75], v0, s[12:15], s55 offen offset:2048 sc1
aR 80,56
aR 81,57
aR 82,58
aR 83,59
aR 84,60
aR 85,61
aR 86,62
aR 87,63
cP 80,80,81
cP 81,82,83
cP 82,84,85
cP 83,86,87
buffer_store_dwordx4 v[80:83], v0, s[12:15], s55 offen offset:3072 sc1
s_add_u32 s55, s55, 4096
aR 88,64
aR 89,65
aR 90,66
aR 91,67
aR 92,68
aR 93,69
aR 94,70
aR 95,71
cP 88,88,89
cP 89,90,91
cP 90,92,93
cP 91,94,95
buffer_store_dwordx4 v[88:91], v0, s[12:15], s55 offen offset:0 sc1
aR 64,72
aR 65,73
aR 66,74
aR 67,75
aR 68,76
aR 69,77
aR 70,78
aR 71,79
cP 64,64,65
cP 65,66,67
cP 66,68,69
cP 67,70,71
buffer_store_dwordx4 v[64:67], v0, s[12:15], s55 offen offset:1024 sc1
aR 72,88
aR 73,89
aR 74,90
aR 75,91
aR 76,92
aR 77,93
aR 78,94
aR 79,95
cP 72,72,73
cP 73,74,75
cP 74,76,77
cP 75,78,79
buffer_store_dwordx4 v[72:75], v0, s[12:15], s55 offen offset:3072 sc1
s_add_u32 s55, s55, 4096
aR 80,96
aR 81,97
aR 82,98
aR 83,99
aR 84,100
aR 85,101
aR 86,102
aR 87,103
cP 80,80,81
cP 81,82,83
cP 82,84,85
cP 83,86,87
buffer_store_dwordx4 v[80:83], v0, s[12:15], s55 offen offset:0 sc1
aR 88,104
aR 89,105
aR 90,106
aR 91,107
aR 92,108
aR 93,109
aR 94,110
aR 95,111
cP 88,88,89
cP 89,90,91
cP 90,92,93
cP 91,94,95
buffer_store_dwordx4 v[88:91], v0, s[12:15], s55 offen offset:1024 sc1
aR 96,16
aR 97,17
aR 98,18
aR 99,19
aR 100,20
aR 101,21
aR 102,22
aR 103,23
aR 104,80
aR 105,81
aR 106,82
aR 107,83
aR 108,84
aR 109,85
aR 110,86
aR 111,87
s_waitcnt vmcnt(0)
s_barrier
s_cmp_eq_u32 s3, 0
s_cbranch_scc0 O8_w2
buffer_atomic_add v53, v52, s[12:15], s56 offen
O8_poll2:
buffer_load_dword v56, v55, s[12:15], s56 offen sc1
s_waitcnt vmcnt(0)
v_readfirstlane_b32 s53, v56
s_nop 0
s_cmp_ge_u32 s53, 8
s_cbranch_scc1 O8_w2
s_sleep 4
s_branch O8_poll2
O8_w2:
s_barrier
s_add_u32 s55, s57, 2048
buffer_load_dwordx4 v[128:131], v0, s[12:15], s55 offen sc1
s_add_u32 s55, s57, 67584
buffer_load_dwordx4 v[132:135], v0, s[12:15], s55 offen sc1
s_add_u32 s55, s57, 198656
buffer_load_dwordx4 v[136:139], v0, s[12:15], s55 offen sc1
s_add_u32 s55, s57, 264192
buffer_load_dwordx4 v[140:143], v0, s[12:15], s55 offen sc1
s_add_u32 s55, s57, 329728
buffer_load_dwordx4 v[144:147], v0, s[12:15], s55 offen sc1
s_add_u32 s55, s57, 395264
buffer_load_dwordx4 v[148:151], v0, s[12:15], s55 offen sc1
s_add_u32 s55, s57, 460800
buffer_load_dwordx4 v[152:155], v0, s[12:15], s55 offen sc1
s_add_u32 s55, s57, 10240
buffer_load_dwordx4 v[168:171], v0, s[12:15], s55 offen sc1
s_add_u32 s55, s57, 75776
buffer_load_dwordx4 v[172:175], v0, s[12:15], s55 offen sc1
s_add_u32 s55, s57, 206848
buffer_load_dwordx4 v[176:179], v0, s[12:15], s55 offen sc1
s_add_u32 s55, s57, 272384
buffer_load_dwordx4 v[180:183], v0, s[12:15], s55 offen sc1
s_add_u32 s55, s57, 337920
buffer_load_dwordx4 v[184:187], v0, s[12:15], s55 offen sc1
s_add_u32 s55, s57, 403456
buffer_load_dwordx4 v[188:191], v0, s[12:15], s55 offen sc1
s_add_u32 s55, s57, 468992
buffer_load_dwordx4 v[192:195], v0, s[12:15], s55 offen sc1
s_waitcnt vmcnt(13)
v_lshlrev_b32 v64, 16, v128
v_and_b32 v65, 0xffff0000, v128
v_lshlrev_b32 v66, 16, v129
v_and_b32 v67, 0xffff0000, v129
v_lshlrev_b32 v68, 16, v130
v_and_b32 v69, 0xffff0000, v130
v_lshlrev_b32 v70, 16, v131
v_and_b32 v71, 0xffff0000, v131
v_pk_add_f32 v[96:97], v[96:97], v[64:65]
v_pk_add_f32 v[98:99], v[98:99], v[66:67]
v_pk_add_f32 v[100:101], v[100:101], v[68:69]
v_pk_add_f32 v[102:103], v[102:103], v[70:71]
s_waitcnt vmcnt(12)
v_lshlrev_b32 v72, 16, v132
v_and_b32 v73, 0xffff0000, v132
v_lshlrev_b32 v74, 16, v133
v_and_b32 v75, 0xffff0000, v133
v_lshlrev_b32 v76, 16, v134
v_and_b32 v77, 0xffff0000, v134
v_lshlrev_b32 v78, 16, v135
v_and_b32 v79, 0xffff0000, v135
v_pk_add_f32 v[96:97], v[96:97], v[72:73]
v_pk_add_f32 v[98:99], v[98:99], v[74:75]
v_pk_add_f32 v[100:101], v[100:101], v[76:77]
v_pk_add_f32 v[102:103], v[102:103], v[78:79]
s_waitcnt vmcnt(11)
v_lshlrev_b32 v64, 16, v136
v_and_b32 v65, 0xffff0000, v136
v_lshlrev_b32 v66, 16, v137
v_and_b32 v67, 0xffff0000, v137
v_lshlrev_b32 v68, 16, v138
v_and_b32 v69, 0xffff0000, v138
v_lshlrev_b32 v70, 16, v139
v_and_b32 v71, 0xffff0000, v139
v_pk_add_f32 v[96:97], v[96:97], v[64:65]
v_pk_add_f32 v[98:99], v[98:99], v[66:67]
v_pk_add_f32 v[100:101], v[100:101], v[68:69]
v_pk_add_f32 v[102:103], v[102:103], v[70:71]
s_waitcnt vmcnt(10)
v_lshlrev_b32 v72, 16, v140
v_and_b32 v73, 0xffff0000, v140
v_lshlrev_b32 v74, 16, v141
v_and_b32 v75, 0xffff0000, v141
v_lshlrev_b32 v76, 16, v142
v_and_b32 v77, 0xffff0000, v142
v_lshlrev_b32 v78, 16, v143
v_and_b32 v79, 0xffff0000, v143
v_pk_add_f32 v[96:97], v[96:97], v[72:73]
v_pk_add_f32 v[98:99], v[98:99], v[74:75]
v_pk_add_f32 v[100:101], v[100:101], v[76:77]
v_pk_add_f32 v[102:103], v[102:103], v[78:79]
s_waitcnt vmcnt(9)
v_lshlrev_b32 v64, 16, v144
v_and_b32 v65, 0xffff0000, v144
v_lshlrev_b32 v66, 16, v145
v_and_b32 v67, 0xffff0000, v145
v_lshlrev_b32 v68, 16, v146
v_and_b32 v69, 0xffff0000, v146
v_lshlrev_b32 v70, 16, v147
v_and_b32 v71, 0xffff0000, v147
v_pk_add_f32 v[96:97], v[96:97], v[64:65]
v_pk_add_f32 v[98:99], v[98:99], v[66:67]
v_pk_add_f32 v[100:101], v[100:101], v[68:69]
v_pk_add_f32 v[102:103], v[102:103], v[70:71]
s_waitcnt vmcnt(8)
v_lshlrev_b32 v72, 16, v148
v_and_b32 v73, 0xffff0000, v148
v_lshlrev_b32 v74, 16, v149
v_and_b32 v75, 0xffff0000, v149
v_lshlrev_b32 v76, 16, v150
v_and_b32 v77, 0xffff0000, v150
v_lshlrev_b32 v78, 16, v151
v_and_b32 v79, 0xffff0000, v151
v_pk_add_f32 v[96:97], v[96:97], v[72:73]
v_pk_add_f32 v[98:99], v[98:99], v[74:75]
v_pk_add_f32 v[100:101], v[100:101], v[76:77]
v_pk_add_f32 v[102:103], v[102:103], v[78:79]
s_waitcnt vmcnt(7)
v_lshlrev_b32 v64, 16, v152
v_and_b32 v65, 0xffff0000, v152
v_lshlrev_b32 v66, 16, v153
v_and_b32 v67, 0xffff0000, v153
v_lshlrev_b32 v68, 16, v154
v_and_b32 v69, 0xffff0000, v154
v_lshlrev_b32 v70, 16, v155
v_and_b32 v71, 0xffff0000, v155
v_pk_add_f32 v[96:97], v[96:97], v[64:65]
v_pk_add_f32 v[98:99], v[98:99], v[66:67]
v_pk_add_f32 v[100:101], v[100:101], v[68:69]
v_pk_add_f32 v[102:103], v[102:103], v[70:71]
cP 96,96,97
cP 97,98,99
cP 98,100,101
cP 99,102,103
s_add_u32 s53, s58, 128
buffer_store_dwordx2 v[96:97], v54, s[8:11], s53 offen
buffer_store_dwordx2 v[98:99], v54, s[8:11], s53 offen offset:32
s_waitcnt vmcnt(8)
v_lshlrev_b32 v64, 16, v168
v_and_b32 v65, 0xffff0000, v168
v_lshlrev_b32 v66, 16, v169
v_and_b32 v67, 0xffff0000, v169
v_lshlrev_b32 v68, 16, v170
v_and_b32 v69, 0xffff0000, v170
v_lshlrev_b32 v70, 16, v171
v_and_b32 v71, 0xffff0000, v171
v_pk_add_f32 v[104:105], v[104:105], v[64:65]
v_pk_add_f32 v[106:107], v[106:107], v[66:67]
v_pk_add_f32 v[108:109], v[108:109], v[68:69]
v_pk_add_f32 v[110:111], v[110:111], v[70:71]
s_waitcnt vmcnt(7)
v_lshlrev_b32 v72, 16, v172
v_and_b32 v73, 0xffff0000, v172
v_lshlrev_b32 v74, 16, v173
v_and_b32 v75, 0xffff0000, v173
v_lshlrev_b32 v76, 16, v174
v_and_b32 v77, 0xffff0000, v174
v_lshlrev_b32 v78, 16, v175
v_and_b32 v79, 0xffff0000, v175
v_pk_add_f32 v[104:105], v[104:105], v[72:73]
v_pk_add_f32 v[106:107], v[106:107], v[74:75]
v_pk_add_f32 v[108:109], v[108:109], v[76:77]
v_pk_add_f32 v[110:111], v[110:111], v[78:79]
s_waitcnt vmcnt(6)
v_lshlrev_b32 v64, 16, v176
v_and_b32 v65, 0xffff0000, v176
v_lshlrev_b32 v66, 16, v177
v_and_b32 v67, 0xffff0000, v177
v_lshlrev_b32 v68, 16, v178
v_and_b32 v69, 0xffff0000, v178
v_lshlrev_b32 v70, 16, v179
v_and_b32 v71, 0xffff0000, v179
v_pk_add_f32 v[104:105], v[104:105], v[64:65]
v_pk_add_f32 v[106:107], v[106:107], v[66:67]
v_pk_add_f32 v[108:109], v[108:109], v[68:69]
v_pk_add_f32 v[110:111], v[110:111], v[70:71]
s_waitcnt vmcnt(5)
v_lshlrev_b32 v72, 16, v180
v_and_b32 v73, 0xffff0000, v180
v_lshlrev_b32 v74, 16, v181
v_and_b32 v75, 0xffff0000, v181
v_lshlrev_b32 v76, 16, v182
v_and_b32 v77, 0xffff0000, v182
v_lshlrev_b32 v78, 16, v183
v_and_b32 v79, 0xffff0000, v183
v_pk_add_f32 v[104:105], v[104:105], v[72:73]
v_pk_add_f32 v[106:107], v[106:107], v[74:75]
v_pk_add_f32 v[108:109], v[108:109], v[76:77]
v_pk_add_f32 v[110:111], v[110:111], v[78:79]
s_waitcnt vmcnt(4)
v_lshlrev_b32 v64, 16, v184
v_and_b32 v65, 0xffff0000, v184
v_lshlrev_b32 v66, 16, v185
v_and_b32 v67, 0xffff0000, v185
v_lshlrev_b32 v68, 16, v186
v_and_b32 v69, 0xffff0000, v186
v_lshlrev_b32 v70, 16, v187
v_and_b32 v71, 0xffff0000, v187
v_pk_add_f32 v[104:105], v[104:105], v[64:65]
v_pk_add_f32 v[106:107], v[106:107], v[66:67]
v_pk_add_f32 v[108:109], v[108:109], v[68:69]
v_pk_add_f32 v[110:111], v[110:111], v[70:71]
s_waitcnt vmcnt(3)
v_lshlrev_b32 v72, 16, v188
v_and_b32 v73, 0xffff0000, v188
v_lshlrev_b32 v74, 16, v189
v_and_b32 v75, 0xffff0000, v189
v_lshlrev_b32 v76, 16, v190
v_and_b32 v77, 0xffff0000, v190
v_lshlrev_b32 v78, 16, v191
v_and_b32 v79, 0xffff0000, v191
v_pk_add_f32 v[104:105], v[104:105], v[72:73]
v_pk_add_f32 v[106:107], v[106:107], v[74:75]
v_pk_add_f32 v[108:109], v[108:109], v[76:77]
v_pk_add_f32 v[110:111], v[110:111], v[78:79]
s_waitcnt vmcnt(2)
v_lshlrev_b32 v64, 16, v192
v_and_b32 v65, 0xffff0000, v192
v_lshlrev_b32 v66, 16, v193
v_and_b32 v67, 0xffff0000, v193
v_lshlrev_b32 v68, 16, v194
v_and_b32 v69, 0xffff0000, v194
v_lshlrev_b32 v70, 16, v195
v_and_b32 v71, 0xffff0000, v195
v_pk_add_f32 v[104:105], v[104:105], v[64:65]
v_pk_add_f32 v[106:107], v[106:107], v[66:67]
v_pk_add_f32 v[108:109], v[108:109], v[68:69]
v_pk_add_f32 v[110:111], v[110:111], v[70:71]
cP 104,104,105
cP 105,106,107
cP 106,108,109
cP 107,110,111
s_add_u32 s53, s58, 14528
buffer_store_dwordx2 v[104:105], v54, s[8:11], s53 offen
buffer_store_dwordx2 v[106:107], v54, s[8:11], s53 offen offset:32
s_branch O8_fin
O8_p3:
aR 64,0
aR 65,1
aR 66,2
aR 67,3
aR 68,4
aR 69,5
aR 70,6
aR 71,7
cP 64,64,65
cP 65,66,67
cP 66,68,69
cP 67,70,71
buffer_store_dwordx4 v[64:67], v0, s[12:15], s55 offen offset:0 sc1
aR 72,8
aR 73,9
aR 74,10
aR 75,11
aR 76,12
aR 77,13
aR 78,14
aR 79,15
cP 72,72,73
cP 73,74,75
cP 74,76,77
cP 75,78,79
buffer_store_dwordx4 v[72:75], v0, s[12:15], s55 offen offset:1024 sc1
aR 80,16
aR 81,17
aR 82,18
aR 83,19
aR 84,20
aR 85,21
aR 86,22
aR 87,23
cP 80,80,81
cP 81,82,83
cP 82,84,85
cP 83,86,87
buffer_store_dwordx4 v[80:83], v0, s[12:15], s55 offen offset:2048 sc1
s_add_u32 s55, s55, 4096
aR 88,32
aR 89,33
aR 90,34
aR 91,35
aR 92,36
aR 93,37
aR 94,38
aR 95,39
cP 88,88,89
cP 89,90,91
cP 90,92,93
cP 91,94,95
buffer_store_dwordx4 v[88:91], v0, s[12:15], s55 offen offset:0 sc1
aR 64,40
aR 65,41
aR 66,42
aR 67,43
aR 68,44
aR 69,45
aR 70,46
aR 71,47
cP 64,64,65
cP 65,66,67
cP 66,68,69
cP 67,70,71
buffer_store_dwordx4 v[64:67], v0, s[12:15], s55 offen offset:1024 sc1
aR 72,48
aR 73,49
aR 74,50
aR 75,51
aR 76,52
aR 77,53
aR 78,54
aR 79,55
cP 72,72,73
cP 73,74,75
cP 74,76,77
cP 75,78,79
buffer_store_dwordx4 v[72:75], v0, s[12:15], s55 offen offset:2048 sc1
aR 80,56
aR 81,57
aR 82,58
aR 83,59
aR 84,60
aR 85,61
aR 86,62
aR 87,63
cP 80,80,81
cP 81,82,83
cP 82,84,85
cP 83,86,87
buffer_store_dwordx4 v[80:83], v0, s[12:15], s55 offen offset:3072 sc1
s_add_u32 s55, s55, 4096
aR 88,64
aR 89,65
aR 90,66
aR 91,67
aR 92,68
aR 93,69
aR 94,70
aR 95,71
cP 88,88,89
cP 89,90,91
cP 90,92,93
cP 91,94,95
buffer_store_dwordx4 v[88:91], v0, s[12:15], s55 offen offset:0 sc1
aR 64,72
aR 65,73
aR 66,74
aR 67,75
aR 68,76
aR 69,77
aR 70,78
aR 71,79
cP 64,64,65
cP 65,66,67
cP 66,68,69
cP 67,70,71
buffer_store_dwordx4 v[64:67], v0, s[12:15], s55 offen offset:1024 sc1
aR 72,80
aR 73,81
aR 74,82
aR 75,83
aR 76,84
aR 77,85
aR 78,86
aR 79,87
cP 72,72,73
cP 73,74,75
cP 74,76,77
cP 75,78,79
buffer_store_dwordx4 v[72:75], v0, s[12:15], s55 offen offset:2048 sc1
s_add_u32 s55, s55, 4096
aR 80,96
aR 81,97
aR 82,98
aR 83,99
aR 84,100
aR 85,101
aR 86,102
aR 87,103
cP 80,80,81
cP 81,82,83
cP 82,84,85
cP 83,86,87
buffer_store_dwordx4 v[80:83], v0, s[12:15], s55 offen offset:0 sc1
aR 88,104
aR 89,105
aR 90,106
aR 91,107
aR 92,108
aR 93,109
aR 94,110
aR 95,111
cP 88,88,89
cP 89,90,91
cP 90,92,93
cP 91,94,95
buffer_store_dwordx4 v[88:91], v0, s[12:15], s55 offen offset:1024 sc1
aR 96,24
aR 97,25
aR 98,26
aR 99,27
aR 100,28
aR 101,29
aR 102,30
aR 103,31
aR 104,88
aR 105,89
aR 106,90
aR 107,91
aR 108,92
aR 109,93
aR 110,94
aR 111,95
s_waitcnt vmcnt(0)
s_barrier
s_cmp_eq_u32 s3, 0
s_cbranch_scc0 O8_w3
buffer_atomic_add v53, v52, s[12:15], s56 offen
O8_poll3:
buffer_load_dword v56, v55, s[12:15], s56 offen sc1
s_waitcnt vmcnt(0)
v_readfirstlane_b32 s53, v56
s_nop 0
s_cmp_ge_u32 s53, 8
s_cbranch_scc1 O8_w3
s_sleep 4
s_branch O8_poll3
O8_w3:
s_barrier
s_add_u32 s55, s57, 3072
buffer_load_dwordx4 v[128:131], v0, s[12:15], s55 offen sc1
s_add_u32 s55, s57, 68608
buffer_load_dwordx4 v[132:135], v0, s[12:15], s55 offen sc1
s_add_u32 s55, s57, 134144
buffer_load_dwordx4 v[136:139], v0, s[12:15], s55 offen sc1
s_add_u32 s55, s57, 265216
buffer_load_dwordx4 v[140:143], v0, s[12:15], s55 offen sc1
s_add_u32 s55, s57, 330752
buffer_load_dwordx4 v[144:147], v0, s[12:15], s55 offen sc1
s_add_u32 s55, s57, 396288
buffer_load_dwordx4 v[148:151], v0, s[12:15], s55 offen sc1
s_add_u32 s55, s57, 461824
buffer_load_dwordx4 v[152:155], v0, s[12:15], s55 offen sc1
s_add_u32 s55, s57, 11264
buffer_load_dwordx4 v[168:171], v0, s[12:15], s55 offen sc1
s_add_u32 s55, s57, 76800
buffer_load_dwordx4 v[172:175], v0, s[12:15], s55 offen sc1
s_add_u32 s55, s57, 142336
buffer_load_dwordx4 v[176:179], v0, s[12:15], s55 offen sc1
s_add_u32 s55, s57, 273408
buffer_load_dwordx4 v[180:183], v0, s[12:15], s55 offen sc1
s_add_u32 s55, s57, 338944
buffer_load_dwordx4 v[184:187], v0, s[12:15], s55 offen sc1
s_add_u32 s55, s57, 404480
buffer_load_dwordx4 v[188:191], v0, s[12:15], s55 offen sc1
s_add_u32 s55, s57, 470016
buffer_load_dwordx4 v[192:195], v0, s[12:15], s55 offen sc1
s_waitcnt vmcnt(13)
v_lshlrev_b32 v64, 16, v128
v_and_b32 v65, 0xffff0000, v128
v_lshlrev_b32 v66, 16, v129
v_and_b32 v67, 0xffff0000, v129
v_lshlrev_b32 v68, 16, v130
v_and_b32 v69, 0xffff0000, v130
v_lshlrev_b32 v70, 16, v131
v_and_b32 v71, 0xffff0000, v131
v_pk_add_f32 v[96:97], v[96:97], v[64:65]
v_pk_add_f32 v[98:99], v[98:99], v[66:67]
v_pk_add_f32 v[100:101], v[100:101], v[68:69]
v_pk_add_f32 v[102:103], v[102:103], v[70:71]
s_waitcnt vmcnt(12)
v_lshlrev_b32 v72, 16, v132
v_and_b32 v73, 0xffff0000, v132
v_lshlrev_b32 v74, 16, v133
v_and_b32 v75, 0xffff0000, v133
v_lshlrev_b32 v76, 16, v134
v_and_b32 v77, 0xffff0000, v134
v_lshlrev_b32 v78, 16, v135
v_and_b32 v79, 0xffff0000, v135
v_pk_add_f32 v[96:97], v[96:97], v[72:73]
v_pk_add_f32 v[98:99], v[98:99], v[74:75]
v_pk_add_f32 v[100:101], v[100:101], v[76:77]
v_pk_add_f32 v[102:103], v[102:103], v[78:79]
s_waitcnt vmcnt(11)
v_lshlrev_b32 v64, 16, v136
v_and_b32 v65, 0xffff0000, v136
v_lshlrev_b32 v66, 16, v137
v_and_b32 v67, 0xffff0000, v137
v_lshlrev_b32 v68, 16, v138
v_and_b32 v69, 0xffff0000, v138
v_lshlrev_b32 v70, 16, v139
v_and_b32 v71, 0xffff0000, v139
v_pk_add_f32 v[96:97], v[96:97], v[64:65]
v_pk_add_f32 v[98:99], v[98:99], v[66:67]
v_pk_add_f32 v[100:101], v[100:101], v[68:69]
v_pk_add_f32 v[102:103], v[102:103], v[70:71]
s_waitcnt vmcnt(10)
v_lshlrev_b32 v72, 16, v140
v_and_b32 v73, 0xffff0000, v140
v_lshlrev_b32 v74, 16, v141
v_and_b32 v75, 0xffff0000, v141
v_lshlrev_b32 v76, 16, v142
v_and_b32 v77, 0xffff0000, v142
v_lshlrev_b32 v78, 16, v143
v_and_b32 v79, 0xffff0000, v143
v_pk_add_f32 v[96:97], v[96:97], v[72:73]
v_pk_add_f32 v[98:99], v[98:99], v[74:75]
v_pk_add_f32 v[100:101], v[100:101], v[76:77]
v_pk_add_f32 v[102:103], v[102:103], v[78:79]
s_waitcnt vmcnt(9)
v_lshlrev_b32 v64, 16, v144
v_and_b32 v65, 0xffff0000, v144
v_lshlrev_b32 v66, 16, v145
v_and_b32 v67, 0xffff0000, v145
v_lshlrev_b32 v68, 16, v146
v_and_b32 v69, 0xffff0000, v146
v_lshlrev_b32 v70, 16, v147
v_and_b32 v71, 0xffff0000, v147
v_pk_add_f32 v[96:97], v[96:97], v[64:65]
v_pk_add_f32 v[98:99], v[98:99], v[66:67]
v_pk_add_f32 v[100:101], v[100:101], v[68:69]
v_pk_add_f32 v[102:103], v[102:103], v[70:71]
s_waitcnt vmcnt(8)
v_lshlrev_b32 v72, 16, v148
v_and_b32 v73, 0xffff0000, v148
v_lshlrev_b32 v74, 16, v149
v_and_b32 v75, 0xffff0000, v149
v_lshlrev_b32 v76, 16, v150
v_and_b32 v77, 0xffff0000, v150
v_lshlrev_b32 v78, 16, v151
v_and_b32 v79, 0xffff0000, v151
v_pk_add_f32 v[96:97], v[96:97], v[72:73]
v_pk_add_f32 v[98:99], v[98:99], v[74:75]
v_pk_add_f32 v[100:101], v[100:101], v[76:77]
v_pk_add_f32 v[102:103], v[102:103], v[78:79]
s_waitcnt vmcnt(7)
v_lshlrev_b32 v64, 16, v152
v_and_b32 v65, 0xffff0000, v152
v_lshlrev_b32 v66, 16, v153
v_and_b32 v67, 0xffff0000, v153
v_lshlrev_b32 v68, 16, v154
v_and_b32 v69, 0xffff0000, v154
v_lshlrev_b32 v70, 16, v155
v_and_b32 v71, 0xffff0000, v155
v_pk_add_f32 v[96:97], v[96:97], v[64:65]
v_pk_add_f32 v[98:99], v[98:99], v[66:67]
v_pk_add_f32 v[100:101], v[100:101], v[68:69]
v_pk_add_f32 v[102:103], v[102:103], v[70:71]
cP 96,96,97
cP 97,98,99
cP 98,100,101
cP 99,102,103
s_add_u32 s53, s58, 192
buffer_store_dwordx2 v[96:97], v54, s[8:11], s53 offen
buffer_store_dwordx2 v[98:99], v54, s[8:11], s53 offen offset:32
s_waitcnt vmcnt(8)
v_lshlrev_b32 v64, 16, v168
v_and_b32 v65, 0xffff0000, v168
v_lshlrev_b32 v66, 16, v169
v_and_b32 v67, 0xffff0000, v169
v_lshlrev_b32 v68, 16, v170
v_and_b32 v69, 0xffff0000, v170
v_lshlrev_b32 v70, 16, v171
v_and_b32 v71, 0xffff0000, v171
v_pk_add_f32 v[104:105], v[104:105], v[64:65]
v_pk_add_f32 v[106:107], v[106:107], v[66:67]
v_pk_add_f32 v[108:109], v[108:109], v[68:69]
v_pk_add_f32 v[110:111], v[110:111], v[70:71]
s_waitcnt vmcnt(7)
v_lshlrev_b32 v72, 16, v172
v_and_b32 v73, 0xffff0000, v172
v_lshlrev_b32 v74, 16, v173
v_and_b32 v75, 0xffff0000, v173
v_lshlrev_b32 v76, 16, v174
v_and_b32 v77, 0xffff0000, v174
v_lshlrev_b32 v78, 16, v175
v_and_b32 v79, 0xffff0000, v175
v_pk_add_f32 v[104:105], v[104:105], v[72:73]
v_pk_add_f32 v[106:107], v[106:107], v[74:75]
v_pk_add_f32 v[108:109], v[108:109], v[76:77]
v_pk_add_f32 v[110:111], v[110:111], v[78:79]
s_waitcnt vmcnt(6)
v_lshlrev_b32 v64, 16, v176
v_and_b32 v65, 0xffff0000, v176
v_lshlrev_b32 v66, 16, v177
v_and_b32 v67, 0xffff0000, v177
v_lshlrev_b32 v68, 16, v178
v_and_b32 v69, 0xffff0000, v178
v_lshlrev_b32 v70, 16, v179
v_and_b32 v71, 0xffff0000, v179
v_pk_add_f32 v[104:105], v[104:105], v[64:65]
v_pk_add_f32 v[106:107], v[106:107], v[66:67]
v_pk_add_f32 v[108:109], v[108:109], v[68:69]
v_pk_add_f32 v[110:111], v[110:111], v[70:71]
s_waitcnt vmcnt(5)
v_lshlrev_b32 v72, 16, v180
v_and_b32 v73, 0xffff0000, v180
v_lshlrev_b32 v74, 16, v181
v_and_b32 v75, 0xffff0000, v181
v_lshlrev_b32 v76, 16, v182
v_and_b32 v77, 0xffff0000, v182
v_lshlrev_b32 v78, 16, v183
v_and_b32 v79, 0xffff0000, v183
v_pk_add_f32 v[104:105], v[104:105], v[72:73]
v_pk_add_f32 v[106:107], v[106:107], v[74:75]
v_pk_add_f32 v[108:109], v[108:109], v[76:77]
v_pk_add_f32 v[110:111], v[110:111], v[78:79]
s_waitcnt vmcnt(4)
v_lshlrev_b32 v64, 16, v184
v_and_b32 v65, 0xffff0000, v184
v_lshlrev_b32 v66, 16, v185
v_and_b32 v67, 0xffff0000, v185
v_lshlrev_b32 v68, 16, v186
v_and_b32 v69, 0xffff0000, v186
v_lshlrev_b32 v70, 16, v187
v_and_b32 v71, 0xffff0000, v187
v_pk_add_f32 v[104:105], v[104:105], v[64:65]
v_pk_add_f32 v[106:107], v[106:107], v[66:67]
v_pk_add_f32 v[108:109], v[108:109], v[68:69]
v_pk_add_f32 v[110:111], v[110:111], v[70:71]
s_waitcnt vmcnt(3)
v_lshlrev_b32 v72, 16, v188
v_and_b32 v73, 0xffff0000, v188
v_lshlrev_b32 v74, 16, v189
v_and_b32 v75, 0xffff0000, v189
v_lshlrev_b32 v76, 16, v190
v_and_b32 v77, 0xffff0000, v190
v_lshlrev_b32 v78, 16, v191
v_and_b32 v79, 0xffff0000, v191
v_pk_add_f32 v[104:105], v[104:105], v[72:73]
v_pk_add_f32 v[106:107], v[106:107], v[74:75]
v_pk_add_f32 v[108:109], v[108:109], v[76:77]
v_pk_add_f32 v[110:111], v[110:111], v[78:79]
s_waitcnt vmcnt(2)
v_lshlrev_b32 v64, 16, v192
v_and_b32 v65, 0xffff0000, v192
v_lshlrev_b32 v66, 16, v193
v_and_b32 v67, 0xffff0000, v193
v_lshlrev_b32 v68, 16, v194
v_and_b32 v69, 0xffff0000, v194
v_lshlrev_b32 v70, 16, v195
v_and_b32 v71, 0xffff0000, v195
v_pk_add_f32 v[104:105], v[104:105], v[64:65]
v_pk_add_f32 v[106:107], v[106:107], v[66:67]
v_pk_add_f32 v[108:109], v[108:109], v[68:69]
v_pk_add_f32 v[110:111], v[110:111], v[70:71]
cP 104,104,105
cP 105,106,107
cP 106,108,109
cP 107,110,111
s_add_u32 s53, s58, 14592
buffer_store_dwordx2 v[104:105], v54, s[8:11], s53 offen
buffer_store_dwordx2 v[106:107], v54, s[8:11], s53 offen offset:32
s_branch O8_fin
O8_p4:
aR 64,0
aR 65,1
aR 66,2
aR 67,3
aR 68,4
aR 69,5
aR 70,6
aR 71,7
cP 64,64,65
cP 65,66,67
cP 66,68,69
cP 67,70,71
buffer_store_dwordx4 v[64:67], v0, s[12:15], s55 offen offset:0 sc1
aR 72,8
aR 73,9
aR 74,10
aR 75,11
aR 76,12
aR 77,13
aR 78,14
aR 79,15
cP 72,72,73
cP 73,74,75
cP 74,76,77
cP 75,78,79
buffer_store_dwordx4 v[72:75], v0, s[12:15], s55 offen offset:1024 sc1
aR 80,16
aR 81,17
aR 82,18
aR 83,19
aR 84,20
aR 85,21
aR 86,22
aR 87,23
cP 80,80,81
cP 81,82,83
cP 82,84,85
cP 83,86,87
buffer_store_dwordx4 v[80:83], v0, s[12:15], s55 offen offset:2048 sc1
aR 88,24
aR 89,25
aR 90,26
aR 91,27
aR 92,28
aR 93,29
aR 94,30
aR 95,31
cP 88,88,89
cP 89,90,91
cP 90,92,93
cP 91,94,95
buffer_store_dwordx4 v[88:91], v0, s[12:15], s55 offen offset:3072 sc1
s_add_u32 s55, s55, 4096
aR 64,40
aR 65,41
aR 66,42
aR 67,43
aR 68,44
aR 69,45
aR 70,46
aR 71,47
cP 64,64,65
cP 65,66,67
cP 66,68,69
cP 67,70,71
buffer_store_dwordx4 v[64:67], v0, s[12:15], s55 offen offset:1024 sc1
aR 72,48
aR 73,49
aR 74,50
aR 75,51
aR 76,52
aR 77,53
aR 78,54
aR 79,55
cP 72,72,73
cP 73,74,75
cP 74,76,77
cP 75,78,79
buffer_store_dwordx4 v[72:75], v0, s[12:15], s55 offen offset:2048 sc1
aR 80,56
aR 81,57
aR 82,58
aR 83,59
aR 84,60
aR 85,61
aR 86,62
aR 87,63
cP 80,80,81
cP 81,82,83
cP 82,84,85
cP 83,86,87
buffer_store_dwordx4 v[80:83], v0, s[12:15], s55 offen offset:3072 sc1
s_add_u32 s55, s55, 4096
aR 88,64
aR 89,65
aR 90,66
aR 91,67
aR 92,68
aR 93,69
aR 94,70
aR 95,71
cP 88,88,89
cP 89,90,91
cP 90,92,93
cP 91,94,95
buffer_store_dwordx4 v[88:91], v0, s[12:15], s55 offen offset:0 sc1
aR 64,72
aR 65,73
aR 66,74
aR 67,75
aR 68,76
aR 69,77
aR 70,78
aR 71,79
cP 64,64,65
cP 65,66,67
cP 66,68,69
cP 67,70,71
buffer_store_dwordx4 v[64:67], v0, s[12:15], s55 offen offset:1024 sc1
aR 72,80
aR 73,81
aR 74,82
aR 75,83
aR 76,84
aR 77,85
aR 78,86
aR 79,87
cP 72,72,73
cP 73,74,75
cP 74,76,77
cP 75,78,79
buffer_store_dwordx4 v[72:75], v0, s[12:15], s55 offen offset:2048 sc1
aR 80,88
aR 81,89
aR 82,90
aR 83,91
aR 84,92
aR 85,93
aR 86,94
aR 87,95
cP 80,80,81
cP 81,82,83
cP 82,84,85
cP 83,86,87
buffer_store_dwordx4 v[80:83], v0, s[12:15], s55 offen offset:3072 sc1
s_add_u32 s55, s55, 4096
aR 88,104
aR 89,105
aR 90,106
aR 91,107
aR 92,108
aR 93,109
aR 94,110
aR 95,111
cP 88,88,89
cP 89,90,91
cP 90,92,93
cP 91,94,95
buffer_store_dwordx4 v[88:91], v0, s[12:15], s55 offen offset:1024 sc1
aR 96,32
aR 97,33
aR 98,34
aR 99,35
aR 100,36
aR 101,37
aR 102,38
aR 103,39
aR 104,96
aR 105,97
aR 106,98
aR 107,99
aR 108,100
aR 109,101
aR 110,102
aR 111,103
s_waitcnt vmcnt(0)
s_barrier
s_cmp_eq_u32 s3, 0
s_cbranch_scc0 O8_w4
buffer_atomic_add v53, v52, s[12:15], s56 offen
O8_poll4:
buffer_load_dword v56, v55, s[12:15], s56 offen sc1
s_waitcnt vmcnt(0)
v_readfirstlane_b32 s53, v56
s_nop 0
s_cmp_ge_u32 s53, 8
s_cbranch_scc1 O8_w4
s_sleep 4
s_branch O8_poll4
O8_w4:
s_barrier
s_add_u32 s55, s57, 4096
buffer_load_dwordx4 v[128:131], v0, s[12:15], s55 offen sc1
s_add_u32 s55, s57, 69632
buffer_load_dwordx4 v[132:135], v0, s[12:15], s55 offen sc1
s_add_u32 s55, s57, 135168
buffer_load_dwordx4 v[136:139], v0, s[12:15], s55 offen sc1
s_add_u32 s55, s57, 200704
buffer_load_dwordx4 v[140:143], v0, s[12:15], s55 offen sc1
s_add_u32 s55, s57, 331776
buffer_load_dwordx4 v[144:147], v0, s[12:15], s55 offen sc1
s_add_u32 s55, s57, 397312
buffer_load_dwordx4 v[148:151], v0, s[12:15], s55 offen sc1
s_add_u32 s55, s57, 462848
buffer_load_dwordx4 v[152:155], v0, s[12:15], s55 offen sc1
s_add_u32 s55, s57, 12288
buffer_load_dwordx4 v[168:171], v0, s[12:15], s55 offen sc1
s_add_u32 s55, s57, 77824
buffer_load_dwordx4 v[172:175], v0, s[12:15], s55 offen sc1
s_add_u32 s55, s57, 143360
buffer_load_dwordx4 v[176:179], v0, s[12:15], s55 offen sc1
s_add_u32 s55, s57, 208896
buffer_load_dwordx4 v[180:183], v0, s[12:15], s55 offen sc1
s_add_u32 s55, s57, 339968
buffer_load_dwordx4 v[184:187], v0, s[12:15], s55 offen sc1
s_add_u32 s55, s57, 405504
buffer_load_dwordx4 v[188:191], v0, s[12:15], s55 offen sc1
s_add_u32 s55, s57, 471040
buffer_load_dwordx4 v[192:195], v0, s[12:15], s55 offen sc1
s_waitcnt vmcnt(13)
v_lshlrev_b32 v64, 16, v128
v_and_b32 v65, 0xffff0000, v128
v_lshlrev_b32 v66, 16, v129
v_and_b32 v67, 0xffff0000, v129
v_lshlrev_b32 v68, 16, v130
v_and_b32 v69, 0xffff0000, v130
v_lshlrev_b32 v70, 16, v131
v_and_b32 v71, 0xffff0000, v131
v_pk_add_f32 v[96:97], v[96:97], v[64:65]
v_pk_add_f32 v[98:99], v[98:99], v[66:67]
v_pk_add_f32 v[100:101], v[100:101], v[68:69]
v_pk_add_f32 v[102:103], v[102:103], v[70:71]
s_waitcnt vmcnt(12)
v_lshlrev_b32 v72, 16, v132
v_and_b32 v73, 0xffff0000, v132
v_lshlrev_b32 v74, 16, v133
v_and_b32 v75, 0xffff0000, v133
v_lshlrev_b32 v76, 16, v134
v_and_b32 v77, 0xffff0000, v134
v_lshlrev_b32 v78, 16, v135
v_and_b32 v79, 0xffff0000, v135
v_pk_add_f32 v[96:97], v[96:97], v[72:73]
v_pk_add_f32 v[98:99], v[98:99], v[74:75]
v_pk_add_f32 v[100:101], v[100:101], v[76:77]
v_pk_add_f32 v[102:103], v[102:103], v[78:79]
s_waitcnt vmcnt(11)
v_lshlrev_b32 v64, 16, v136
v_and_b32 v65, 0xffff0000, v136
v_lshlrev_b32 v66, 16, v137
v_and_b32 v67, 0xffff0000, v137
v_lshlrev_b32 v68, 16, v138
v_and_b32 v69, 0xffff0000, v138
v_lshlrev_b32 v70, 16, v139
v_and_b32 v71, 0xffff0000, v139
v_pk_add_f32 v[96:97], v[96:97], v[64:65]
v_pk_add_f32 v[98:99], v[98:99], v[66:67]
v_pk_add_f32 v[100:101], v[100:101], v[68:69]
v_pk_add_f32 v[102:103], v[102:103], v[70:71]
s_waitcnt vmcnt(10)
v_lshlrev_b32 v72, 16, v140
v_and_b32 v73, 0xffff0000, v140
v_lshlrev_b32 v74, 16, v141
v_and_b32 v75, 0xffff0000, v141
v_lshlrev_b32 v76, 16, v142
v_and_b32 v77, 0xffff0000, v142
v_lshlrev_b32 v78, 16, v143
v_and_b32 v79, 0xffff0000, v143
v_pk_add_f32 v[96:97], v[96:97], v[72:73]
v_pk_add_f32 v[98:99], v[98:99], v[74:75]
v_pk_add_f32 v[100:101], v[100:101], v[76:77]
v_pk_add_f32 v[102:103], v[102:103], v[78:79]
s_waitcnt vmcnt(9)
v_lshlrev_b32 v64, 16, v144
v_and_b32 v65, 0xffff0000, v144
v_lshlrev_b32 v66, 16, v145
v_and_b32 v67, 0xffff0000, v145
v_lshlrev_b32 v68, 16, v146
v_and_b32 v69, 0xffff0000, v146
v_lshlrev_b32 v70, 16, v147
v_and_b32 v71, 0xffff0000, v147
v_pk_add_f32 v[96:97], v[96:97], v[64:65]
v_pk_add_f32 v[98:99], v[98:99], v[66:67]
v_pk_add_f32 v[100:101], v[100:101], v[68:69]
v_pk_add_f32 v[102:103], v[102:103], v[70:71]
s_waitcnt vmcnt(8)
v_lshlrev_b32 v72, 16, v148
v_and_b32 v73, 0xffff0000, v148
v_lshlrev_b32 v74, 16, v149
v_and_b32 v75, 0xffff0000, v149
v_lshlrev_b32 v76, 16, v150
v_and_b32 v77, 0xffff0000, v150
v_lshlrev_b32 v78, 16, v151
v_and_b32 v79, 0xffff0000, v151
v_pk_add_f32 v[96:97], v[96:97], v[72:73]
v_pk_add_f32 v[98:99], v[98:99], v[74:75]
v_pk_add_f32 v[100:101], v[100:101], v[76:77]
v_pk_add_f32 v[102:103], v[102:103], v[78:79]
s_waitcnt vmcnt(7)
v_lshlrev_b32 v64, 16, v152
v_and_b32 v65, 0xffff0000, v152
v_lshlrev_b32 v66, 16, v153
v_and_b32 v67, 0xffff0000, v153
v_lshlrev_b32 v68, 16, v154
v_and_b32 v69, 0xffff0000, v154
v_lshlrev_b32 v70, 16, v155
v_and_b32 v71, 0xffff0000, v155
v_pk_add_f32 v[96:97], v[96:97], v[64:65]
v_pk_add_f32 v[98:99], v[98:99], v[66:67]
v_pk_add_f32 v[100:101], v[100:101], v[68:69]
v_pk_add_f32 v[102:103], v[102:103], v[70:71]
cP 96,96,97
cP 97,98,99
cP 98,100,101
cP 99,102,103
s_add_u32 s53, s58, 256
buffer_store_dwordx2 v[96:97], v54, s[8:11], s53 offen
buffer_store_dwordx2 v[98:99], v54, s[8:11], s53 offen offset:32
s_waitcnt vmcnt(8)
v_lshlrev_b32 v64, 16, v168
v_and_b32 v65, 0xffff0000, v168
v_lshlrev_b32 v66, 16, v169
v_and_b32 v67, 0xffff0000, v169
v_lshlrev_b32 v68, 16, v170
v_and_b32 v69, 0xffff0000, v170
v_lshlrev_b32 v70, 16, v171
v_and_b32 v71, 0xffff0000, v171
v_pk_add_f32 v[104:105], v[104:105], v[64:65]
v_pk_add_f32 v[106:107], v[106:107], v[66:67]
v_pk_add_f32 v[108:109], v[108:109], v[68:69]
v_pk_add_f32 v[110:111], v[110:111], v[70:71]
s_waitcnt vmcnt(7)
v_lshlrev_b32 v72, 16, v172
v_and_b32 v73, 0xffff0000, v172
v_lshlrev_b32 v74, 16, v173
v_and_b32 v75, 0xffff0000, v173
v_lshlrev_b32 v76, 16, v174
v_and_b32 v77, 0xffff0000, v174
v_lshlrev_b32 v78, 16, v175
v_and_b32 v79, 0xffff0000, v175
v_pk_add_f32 v[104:105], v[104:105], v[72:73]
v_pk_add_f32 v[106:107], v[106:107], v[74:75]
v_pk_add_f32 v[108:109], v[108:109], v[76:77]
v_pk_add_f32 v[110:111], v[110:111], v[78:79]
s_waitcnt vmcnt(6)
v_lshlrev_b32 v64, 16, v176
v_and_b32 v65, 0xffff0000, v176
v_lshlrev_b32 v66, 16, v177
v_and_b32 v67, 0xffff0000, v177
v_lshlrev_b32 v68, 16, v178
v_and_b32 v69, 0xffff0000, v178
v_lshlrev_b32 v70, 16, v179
v_and_b32 v71, 0xffff0000, v179
v_pk_add_f32 v[104:105], v[104:105], v[64:65]
v_pk_add_f32 v[106:107], v[106:107], v[66:67]
v_pk_add_f32 v[108:109], v[108:109], v[68:69]
v_pk_add_f32 v[110:111], v[110:111], v[70:71]
s_waitcnt vmcnt(5)
v_lshlrev_b32 v72, 16, v180
v_and_b32 v73, 0xffff0000, v180
v_lshlrev_b32 v74, 16, v181
v_and_b32 v75, 0xffff0000, v181
v_lshlrev_b32 v76, 16, v182
v_and_b32 v77, 0xffff0000, v182
v_lshlrev_b32 v78, 16, v183
v_and_b32 v79, 0xffff0000, v183
v_pk_add_f32 v[104:105], v[104:105], v[72:73]
v_pk_add_f32 v[106:107], v[106:107], v[74:75]
v_pk_add_f32 v[108:109], v[108:109], v[76:77]
v_pk_add_f32 v[110:111], v[110:111], v[78:79]
s_waitcnt vmcnt(4)
v_lshlrev_b32 v64, 16, v184
v_and_b32 v65, 0xffff0000, v184
v_lshlrev_b32 v66, 16, v185
v_and_b32 v67, 0xffff0000, v185
v_lshlrev_b32 v68, 16, v186
v_and_b32 v69, 0xffff0000, v186
v_lshlrev_b32 v70, 16, v187
v_and_b32 v71, 0xffff0000, v187
v_pk_add_f32 v[104:105], v[104:105], v[64:65]
v_pk_add_f32 v[106:107], v[106:107], v[66:67]
v_pk_add_f32 v[108:109], v[108:109], v[68:69]
v_pk_add_f32 v[110:111], v[110:111], v[70:71]
s_waitcnt vmcnt(3)
v_lshlrev_b32 v72, 16, v188
v_and_b32 v73, 0xffff0000, v188
v_lshlrev_b32 v74, 16, v189
v_and_b32 v75, 0xffff0000, v189
v_lshlrev_b32 v76, 16, v190
v_and_b32 v77, 0xffff0000, v190
v_lshlrev_b32 v78, 16, v191
v_and_b32 v79, 0xffff0000, v191
v_pk_add_f32 v[104:105], v[104:105], v[72:73]
v_pk_add_f32 v[106:107], v[106:107], v[74:75]
v_pk_add_f32 v[108:109], v[108:109], v[76:77]
v_pk_add_f32 v[110:111], v[110:111], v[78:79]
s_waitcnt vmcnt(2)
v_lshlrev_b32 v64, 16, v192
v_and_b32 v65, 0xffff0000, v192
v_lshlrev_b32 v66, 16, v193
v_and_b32 v67, 0xffff0000, v193
v_lshlrev_b32 v68, 16, v194
v_and_b32 v69, 0xffff0000, v194
v_lshlrev_b32 v70, 16, v195
v_and_b32 v71, 0xffff0000, v195
v_pk_add_f32 v[104:105], v[104:105], v[64:65]
v_pk_add_f32 v[106:107], v[106:107], v[66:67]
v_pk_add_f32 v[108:109], v[108:109], v[68:69]
v_pk_add_f32 v[110:111], v[110:111], v[70:71]
cP 104,104,105
cP 105,106,107
cP 106,108,109
cP 107,110,111
s_add_u32 s53, s58, 14656
buffer_store_dwordx2 v[104:105], v54, s[8:11], s53 offen
buffer_store_dwordx2 v[106:107], v54, s[8:11], s53 offen offset:32
s_branch O8_fin
O8_p5:
aR 64,0
aR 65,1
aR 66,2
aR 67,3
aR 68,4
aR 69,5
aR 70,6
aR 71,7
cP 64,64,65
cP 65,66,67
cP 66,68,69
cP 67,70,71
buffer_store_dwordx4 v[64:67], v0, s[12:15], s55 offen offset:0 sc1
aR 72,8
aR 73,9
aR 74,10
aR 75,11
aR 76,12
aR 77,13
aR 78,14
aR 79,15
cP 72,72,73
cP 73,74,75
cP 74,76,77
cP 75,78,79
buffer_store_dwordx4 v[72:75], v0, s[12:15], s55 offen offset:1024 sc1
aR 80,16
aR 81,17
aR 82,18
aR 83,19
aR 84,20
aR 85,21
aR 86,22
aR 87,23
cP 80,80,81
cP 81,82,83
cP 82,84,85
cP 83,86,87
buffer_store_dwordx4 v[80:83], v0, s[12:15], s55 offen offset:2048 sc1
aR 88,24
aR 89,25
aR 90,26
aR 91,27
aR 92,28
aR 93,29
aR 94,30
aR 95,31
cP 88,88,89
cP 89,90,91
cP 90,92,93
cP 91,94,95
buffer_store_dwordx4 v[88:91], v0, s[12:15], s55 offen offset:3072 sc1
s_add_u32 s55, s55, 4096
aR 64,32
aR 65,33
aR 66,34
aR 67,35
aR 68,36
aR 69,37
aR 70,38
aR 71,39
cP 64,64,65
cP 65,66,67
cP 66,68,69
cP 67,70,71
buffer_store_dwordx4 v[64:67], v0, s[12:15], s55 offen offset:0 sc1
aR 72,48
aR 73,49
aR 74,50
aR 75,51
aR 76,52
aR 77,53
aR 78,54
aR 79,55
cP 72,72,73
cP 73,74,75
cP 74,76,77
cP 75,78,79
buffer_store_dwordx4 v[72:75], v0, s[12:15], s55 offen offset:2048 sc1
aR 80,56
aR 81,57
aR 82,58
aR 83,59
aR 84,60
aR 85,61
aR 86,62
aR 87,63
cP 80,80,81
cP 81,82,83
cP 82,84,85
cP 83,86,87
buffer_store_dwordx4 v[80:83], v0, s[12:15], s55 offen offset:3072 sc1
s_add_u32 s55, s55, 4096
aR 88,64
aR 89,65
aR 90,66
aR 91,67
aR 92,68
aR 93,69
aR 94,70
aR 95,71
cP 88,88,89
cP 89,90,91
cP 90,92,93
cP 91,94,95
buffer_store_dwordx4 v[88:91], v0, s[12:15], s55 offen offset:0 sc1
aR 64,72
aR 65,73
aR 66,74
aR 67,75
aR 68,76
aR 69,77
aR 70,78
aR 71,79
cP 64,64,65
cP 65,66,67
cP 66,68,69
cP 67,70,71
buffer_store_dwordx4 v[64:67], v0, s[12:15], s55 offen offset:1024 sc1
aR 72,80
aR 73,81
aR 74,82
aR 75,83
aR 76,84
aR 77,85
aR 78,86
aR 79,87
cP 72,72,73
cP 73,74,75
cP 74,76,77
cP 75,78,79
buffer_store_dwordx4 v[72:75], v0, s[12:15], s55 offen offset:2048 sc1
aR 80,88
aR 81,89
aR 82,90
aR 83,91
aR 84,92
aR 85,93
aR 86,94
aR 87,95
cP 80,80,81
cP 81,82,83
cP 82,84,85
cP 83,86,87
buffer_store_dwordx4 v[80:83], v0, s[12:15], s55 offen offset:3072 sc1
s_add_u32 s55, s55, 4096
aR 88,96
aR 89,97
aR 90,98
aR 91,99
aR 92,100
aR 93,101
aR 94,102
aR 95,103
cP 88,88,89
cP 89,90,91
cP 90,92,93
cP 91,94,95
buffer_store_dwordx4 v[88:91], v0, s[12:15], s55 offen offset:0 sc1
aR 96,40
aR 97,41
aR 98,42
aR 99,43
aR 100,44
aR 101,45
aR 102,46
aR 103,47
aR 104,104
aR 105,105
aR 106,106
aR 107,107
aR 108,108
aR 109,109
aR 110,110
aR 111,111
s_waitcnt vmcnt(0)
s_barrier
s_cmp_eq_u32 s3, 0
s_cbranch_scc0 O8_w5
buffer_atomic_add v53, v52, s[12:15], s56 offen
O8_poll5:
buffer_load_dword v56, v55, s[12:15], s56 offen sc1
s_waitcnt vmcnt(0)
v_readfirstlane_b32 s53, v56
s_nop 0
s_cmp_ge_u32 s53, 8
s_cbranch_scc1 O8_w5
s_sleep 4
s_branch O8_poll5
O8_w5:
s_barrier
s_add_u32 s55, s57, 5120
buffer_load_dwordx4 v[128:131], v0, s[12:15], s55 offen sc1
s_add_u32 s55, s57, 70656
buffer_load_dwordx4 v[132:135], v0, s[12:15], s55 offen sc1
s_add_u32 s55, s57, 136192
buffer_load_dwordx4 v[136:139], v0, s[12:15], s55 offen sc1
s_add_u32 s55, s57, 201728
buffer_load_dwordx4 v[140:143], v0, s[12:15], s55 offen sc1
s_add_u32 s55, s57, 267264
buffer_load_dwordx4 v[144:147], v0, s[12:15], s55 offen sc1
s_add_u32 s55, s57, 398336
buffer_load_dwordx4 v[148:151], v0, s[12:15], s55 offen sc1
s_add_u32 s55, s57, 463872
buffer_load_dwordx4 v[152:155], v0, s[12:15], s55 offen sc1
s_add_u32 s55, s57, 13312
buffer_load_dwordx4 v[168:171], v0, s[12:15], s55 offen sc1
s_add_u32 s55, s57, 78848
buffer_load_dwordx4 v[172:175], v0, s[12:15], s55 offen sc1
s_add_u32 s55, s57, 144384
buffer_load_dwordx4 v[176:179], v0, s[12:15], s55 offen sc1
s_add_u32 s55, s57, 209920
buffer_load_dwordx4 v[180:183], v0, s[12:15], s55 offen sc1
s_add_u32 s55, s57, 275456
buffer_load_dwordx4 v[184:187], v0, s[12:15], s55 offen sc1
s_add_u32 s55, s57, 406528
buffer_load_dwordx4 v[188:191], v0, s[12:15], s55 offen sc1
s_add_u32 s55, s57, 472064
buffer_load_dwordx4 v[192:195], v0, s[12:15], s55 offen sc1
s_waitcnt vmcnt(13)
v_lshlrev_b32 v64, 16, v128
v_and_b32 v65, 0xffff0000, v128
v_lshlrev_b32 v66, 16, v129
v_and_b32 v67, 0xffff0000, v129
v_lshlrev_b32 v68, 16, v130
v_and_b32 v69, 0xffff0000, v130
v_lshlrev_b32 v70, 16, v131
v_and_b32 v71, 0xffff0000, v131
v_pk_add_f32 v[96:97], v[96:97], v[64:65]
v_pk_add_f32 v[98:99], v[98:99], v[66:67]
v_pk_add_f32 v[100:101], v[100:101], v[68:69]
v_pk_add_f32 v[102:103], v[102:103], v[70:71]
s_waitcnt vmcnt(12)
v_lshlrev_b32 v72, 16, v132
v_and_b32 v73, 0xffff0000, v132
v_lshlrev_b32 v74, 16, v133
v_and_b32 v75, 0xffff0000, v133
v_lshlrev_b32 v76, 16, v134
v_and_b32 v77, 0xffff0000, v134
v_lshlrev_b32 v78, 16, v135
v_and_b32 v79, 0xffff0000, v135
v_pk_add_f32 v[96:97], v[96:97], v[72:73]
v_pk_add_f32 v[98:99], v[98:99], v[74:75]
v_pk_add_f32 v[100:101], v[100:101], v[76:77]
v_pk_add_f32 v[102:103], v[102:103], v[78:79]
s_waitcnt vmcnt(11)
v_lshlrev_b32 v64, 16, v136
v_and_b32 v65, 0xffff0000, v136
v_lshlrev_b32 v66, 16, v137
v_and_b32 v67, 0xffff0000, v137
v_lshlrev_b32 v68, 16, v138
v_and_b32 v69, 0xffff0000, v138
v_lshlrev_b32 v70, 16, v139
v_and_b32 v71, 0xffff0000, v139
v_pk_add_f32 v[96:97], v[96:97], v[64:65]
v_pk_add_f32 v[98:99], v[98:99], v[66:67]
v_pk_add_f32 v[100:101], v[100:101], v[68:69]
v_pk_add_f32 v[102:103], v[102:103], v[70:71]
s_waitcnt vmcnt(10)
v_lshlrev_b32 v72, 16, v140
v_and_b32 v73, 0xffff0000, v140
v_lshlrev_b32 v74, 16, v141
v_and_b32 v75, 0xffff0000, v141
v_lshlrev_b32 v76, 16, v142
v_and_b32 v77, 0xffff0000, v142
v_lshlrev_b32 v78, 16, v143
v_and_b32 v79, 0xffff0000, v143
v_pk_add_f32 v[96:97], v[96:97], v[72:73]
v_pk_add_f32 v[98:99], v[98:99], v[74:75]
v_pk_add_f32 v[100:101], v[100:101], v[76:77]
v_pk_add_f32 v[102:103], v[102:103], v[78:79]
s_waitcnt vmcnt(9)
v_lshlrev_b32 v64, 16, v144
v_and_b32 v65, 0xffff0000, v144
v_lshlrev_b32 v66, 16, v145
v_and_b32 v67, 0xffff0000, v145
v_lshlrev_b32 v68, 16, v146
v_and_b32 v69, 0xffff0000, v146
v_lshlrev_b32 v70, 16, v147
v_and_b32 v71, 0xffff0000, v147
v_pk_add_f32 v[96:97], v[96:97], v[64:65]
v_pk_add_f32 v[98:99], v[98:99], v[66:67]
v_pk_add_f32 v[100:101], v[100:101], v[68:69]
v_pk_add_f32 v[102:103], v[102:103], v[70:71]
s_waitcnt vmcnt(8)
v_lshlrev_b32 v72, 16, v148
v_and_b32 v73, 0xffff0000, v148
v_lshlrev_b32 v74, 16, v149
v_and_b32 v75, 0xffff0000, v149
v_lshlrev_b32 v76, 16, v150
v_and_b32 v77, 0xffff0000, v150
v_lshlrev_b32 v78, 16, v151
v_and_b32 v79, 0xffff0000, v151
v_pk_add_f32 v[96:97], v[96:97], v[72:73]
v_pk_add_f32 v[98:99], v[98:99], v[74:75]
v_pk_add_f32 v[100:101], v[100:101], v[76:77]
v_pk_add_f32 v[102:103], v[102:103], v[78:79]
s_waitcnt vmcnt(7)
v_lshlrev_b32 v64, 16, v152
v_and_b32 v65, 0xffff0000, v152
v_lshlrev_b32 v66, 16, v153
v_and_b32 v67, 0xffff0000, v153
v_lshlrev_b32 v68, 16, v154
v_and_b32 v69, 0xffff0000, v154
v_lshlrev_b32 v70, 16, v155
v_and_b32 v71, 0xffff0000, v155
v_pk_add_f32 v[96:97], v[96:97], v[64:65]
v_pk_add_f32 v[98:99], v[98:99], v[66:67]
v_pk_add_f32 v[100:101], v[100:101], v[68:69]
v_pk_add_f32 v[102:103], v[102:103], v[70:71]
cP 96,96,97
cP 97,98,99
cP 98,100,101
cP 99,102,103
s_add_u32 s53, s58, 320
buffer_store_dwordx2 v[96:97], v54, s[8:11], s53 offen
buffer_store_dwordx2 v[98:99], v54, s[8:11], s53 offen offset:32
s_waitcnt vmcnt(8)
v_lshlrev_b32 v64, 16, v168
v_and_b32 v65, 0xffff0000, v168
v_lshlrev_b32 v66, 16, v169
v_and_b32 v67, 0xffff0000, v169
v_lshlrev_b32 v68, 16, v170
v_and_b32 v69, 0xffff0000, v170
v_lshlrev_b32 v70, 16, v171
v_and_b32 v71, 0xffff0000, v171
v_pk_add_f32 v[104:105], v[104:105], v[64:65]
v_pk_add_f32 v[106:107], v[106:107], v[66:67]
v_pk_add_f32 v[108:109], v[108:109], v[68:69]
v_pk_add_f32 v[110:111], v[110:111], v[70:71]
s_waitcnt vmcnt(7)
v_lshlrev_b32 v72, 16, v172
v_and_b32 v73, 0xffff0000, v172
v_lshlrev_b32 v74, 16, v173
v_and_b32 v75, 0xffff0000, v173
v_lshlrev_b32 v76, 16, v174
v_and_b32 v77, 0xffff0000, v174
v_lshlrev_b32 v78, 16, v175
v_and_b32 v79, 0xffff0000, v175
v_pk_add_f32 v[104:105], v[104:105], v[72:73]
v_pk_add_f32 v[106:107], v[106:107], v[74:75]
v_pk_add_f32 v[108:109], v[108:109], v[76:77]
v_pk_add_f32 v[110:111], v[110:111], v[78:79]
s_waitcnt vmcnt(6)
v_lshlrev_b32 v64, 16, v176
v_and_b32 v65, 0xffff0000, v176
v_lshlrev_b32 v66, 16, v177
v_and_b32 v67, 0xffff0000, v177
v_lshlrev_b32 v68, 16, v178
v_and_b32 v69, 0xffff0000, v178
v_lshlrev_b32 v70, 16, v179
v_and_b32 v71, 0xffff0000, v179
v_pk_add_f32 v[104:105], v[104:105], v[64:65]
v_pk_add_f32 v[106:107], v[106:107], v[66:67]
v_pk_add_f32 v[108:109], v[108:109], v[68:69]
v_pk_add_f32 v[110:111], v[110:111], v[70:71]
s_waitcnt vmcnt(5)
v_lshlrev_b32 v72, 16, v180
v_and_b32 v73, 0xffff0000, v180
v_lshlrev_b32 v74, 16, v181
v_and_b32 v75, 0xffff0000, v181
v_lshlrev_b32 v76, 16, v182
v_and_b32 v77, 0xffff0000, v182
v_lshlrev_b32 v78, 16, v183
v_and_b32 v79, 0xffff0000, v183
v_pk_add_f32 v[104:105], v[104:105], v[72:73]
v_pk_add_f32 v[106:107], v[106:107], v[74:75]
v_pk_add_f32 v[108:109], v[108:109], v[76:77]
v_pk_add_f32 v[110:111], v[110:111], v[78:79]
s_waitcnt vmcnt(4)
v_lshlrev_b32 v64, 16, v184
v_and_b32 v65, 0xffff0000, v184
v_lshlrev_b32 v66, 16, v185
v_and_b32 v67, 0xffff0000, v185
v_lshlrev_b32 v68, 16, v186
v_and_b32 v69, 0xffff0000, v186
v_lshlrev_b32 v70, 16, v187
v_and_b32 v71, 0xffff0000, v187
v_pk_add_f32 v[104:105], v[104:105], v[64:65]
v_pk_add_f32 v[106:107], v[106:107], v[66:67]
v_pk_add_f32 v[108:109], v[108:109], v[68:69]
v_pk_add_f32 v[110:111], v[110:111], v[70:71]
s_waitcnt vmcnt(3)
v_lshlrev_b32 v72, 16, v188
v_and_b32 v73, 0xffff0000, v188
v_lshlrev_b32 v74, 16, v189
v_and_b32 v75, 0xffff0000, v189
v_lshlrev_b32 v76, 16, v190
v_and_b32 v77, 0xffff0000, v190
v_lshlrev_b32 v78, 16, v191
v_and_b32 v79, 0xffff0000, v191
v_pk_add_f32 v[104:105], v[104:105], v[72:73]
v_pk_add_f32 v[106:107], v[106:107], v[74:75]
v_pk_add_f32 v[108:109], v[108:109], v[76:77]
v_pk_add_f32 v[110:111], v[110:111], v[78:79]
s_waitcnt vmcnt(2)
v_lshlrev_b32 v64, 16, v192
v_and_b32 v65, 0xffff0000, v192
v_lshlrev_b32 v66, 16, v193
v_and_b32 v67, 0xffff0000, v193
v_lshlrev_b32 v68, 16, v194
v_and_b32 v69, 0xffff0000, v194
v_lshlrev_b32 v70, 16, v195
v_and_b32 v71, 0xffff0000, v195
v_pk_add_f32 v[104:105], v[104:105], v[64:65]
v_pk_add_f32 v[106:107], v[106:107], v[66:67]
v_pk_add_f32 v[108:109], v[108:109], v[68:69]
v_pk_add_f32 v[110:111], v[110:111], v[70:71]
cP 104,104,105
cP 105,106,107
cP 106,108,109
cP 107,110,111
s_add_u32 s53, s58, 14720
buffer_store_dwordx2 v[104:105], v54, s[8:11], s53 offen
buffer_store_dwordx2 v[106:107], v54, s[8:11], s53 offen offset:32
s_branch O8_fin
O8_p6:
aR 64,0
aR 65,1
aR 66,2
aR 67,3
aR 68,4
aR 69,5
aR 70,6
aR 71,7
cP 64,64,65
cP 65,66,67
cP 66,68,69
cP 67,70,71
buffer_store_dwordx4 v[64:67], v0, s[12:15], s55 offen offset:0 sc1
aR 72,8
aR 73,9
aR 74,10
aR 75,11
aR 76,12
aR 77,13
aR 78,14
aR 79,15
cP 72,72,73
cP 73,74,75
cP 74,76,77
cP 75,78,79
buffer_store_dwordx4 v[72:75], v0, s[12:15], s55 offen offset:1024 sc1
aR 80,16
aR 81,17
aR 82,18
aR 83,19
aR 84,20
aR 85,21
aR 86,22
aR 87,23
cP 80,80,81
cP 81,82,83
cP 82,84,85
cP 83,86,87
buffer_store_dwordx4 v[80:83], v0, s[12:15], s55 offen offset:2048 sc1
aR 88,24
aR 89,25
aR 90,26
aR 91,27
aR 92,28
aR 93,29
aR 94,30
aR 95,31
cP 88,88,89
cP 89,90,91
cP 90,92,93
cP 91,94,95
buffer_store_dwordx4 v[88:91], v0, s[12:15], s55 offen offset:3072 sc1
s_add_u32 s55, s55, 4096
aR 64,32
aR 65,33
aR 66,34
aR 67,35
aR 68,36
aR 69,37
aR 70,38
aR 71,39
cP 64,64,65
cP 65,66,67
cP 66,68,69
cP 67,70,71
buffer_store_dwordx4 v[64:67], v0, s[12:15], s55 offen offset:0 sc1
aR 72,40
aR 73,41
aR 74,42
aR 75,43
aR 76,44
aR 77,45
aR 78,46
aR 79,47
cP 72,72,73
cP 73,74,75
cP 74,76,77
cP 75,78,79
buffer_store_dwordx4 v[72:75], v0, s[12:15], s55 offen offset:1024 sc1
aR 80,56
aR 81,57
aR 82,58
aR 83,59
aR 84,60
aR 85,61
aR 86,62
aR 87,63
cP 80,80,81
cP 81,82,83
cP 82,84,85
cP 83,86,87
buffer_store_dwordx4 v[80:83], v0, s[12:15], s55 offen offset:3072 sc1
s_add_u32 s55, s55, 4096
aR 88,64
aR 89,65
aR 90,66
aR 91,67
aR 92,68
aR 93,69
aR 94,70
aR 95,71
cP 88,88,89
cP 89,90,91
cP 90,92,93
cP 91,94,95
buffer_store_dwordx4 v[88:91], v0, s[12:15], s55 offen offset:0 sc1
aR 64,72
aR 65,73
aR 66,74
aR 67,75
aR 68,76
aR 69,77
aR 70,78
aR 71,79
cP 64,64,65
cP 65,66,67
cP 66,68,69
cP 67,70,71
buffer_store_dwordx4 v[64:67], v0, s[12:15], s55 offen offset:1024 sc1
aR 72,80
aR 73,81
aR 74,82
aR 75,83
aR 76,84
aR 77,85
aR 78,86
aR 79,87
cP 72,72,73
cP 73,74,75
cP 74,76,77
cP 75,78,79
buffer_store_dwordx4 v[72:75], v0, s[12:15], s55 offen offset:2048 sc1
aR 80,88
aR 81,89
aR 82,90
aR 83,91
aR 84,92
aR 85,93
aR 86,94
aR 87,95
cP 80,80,81
cP 81,82,83
cP 82,84,85
cP 83,86,87
buffer_store_dwordx4 v[80:83], v0, s[12:15], s55 offen offset:3072 sc1
s_add_u32 s55, s55, 4096
aR 88,96
aR 89,97
aR 90,98
aR 91,99
aR 92,100
aR 93,101
aR 94,102
aR 95,103
cP 88,88,89
cP 89,90,91
cP 90,92,93
cP 91,94,95
buffer_store_dwordx4 v[88:91], v0, s[12:15], s55 offen offset:0 sc1
aR 64,104
aR 65,105
aR 66,106
aR 67,107
aR 68,108
aR 69,109
aR 70,110
aR 71,111
cP 64,64,65
cP 65,66,67
cP 66,68,69
cP 67,70,71
buffer_store_dwordx4 v[64:67], v0, s[12:15], s55 offen offset:1024 sc1
aR 96,48
aR 97,49
aR 98,50
aR 99,51
aR 100,52
aR 101,53
aR 102,54
aR 103,55
s_waitcnt vmcnt(0)
s_barrier
s_cmp_eq_u32 s3, 0
s_cbranch_scc0 O8_w6
buffer_atomic_add v53, v52, s[12:15], s56 offen
O8_poll6:
buffer_load_dword v56, v55, s[12:15], s56 offen sc1
s_waitcnt vmcnt(0)
v_readfirstlane_b32 s53, v56
s_nop 0
s_cmp_ge_u32 s53, 8
s_cbranch_scc1 O8_w6
s_sleep 4
s_branch O8_poll6
O8_w6:
s_barrier
s_add_u32 s55, s57, 6144
buffer_load_dwordx4 v[128:131], v0, s[12:15], s55 offen sc1
s_add_u32 s55, s57, 71680
buffer_load_dwordx4 v[132:135], v0, s[12:15], s55 offen sc1
s_add_u32 s55, s57, 137216
buffer_load_dwordx4 v[136:139], v0, s[12:15], s55 offen sc1
s_add_u32 s55, s57, 202752
buffer_load_dwordx4 v[140:143], v0, s[12:15], s55 offen sc1
s_add_u32 s55, s57, 268288
buffer_load_dwordx4 v[144:147], v0, s[12:15], s55 offen sc1
s_add_u32 s55, s57, 333824
buffer_load_dwordx4 v[148:151], v0, s[12:15], s55 offen sc1
s_add_u32 s55, s57, 464896
buffer_load_dwordx4 v[152:155], v0, s[12:15], s55 offen sc1
s_waitcnt vmcnt(6)
v_lshlrev_b32 v64, 16, v128
v_and_b32 v65, 0xffff0000, v128
v_lshlrev_b32 v66, 16, v129
v_and_b32 v67, 0xffff0000, v129
v_lshlrev_b32 v68, 16, v130
v_and_b32 v69, 0xffff0000, v130
v_lshlrev_b32 v70, 16, v131
v_and_b32 v71, 0xffff0000, v131
v_pk_add_f32 v[96:97], v[96:97], v[64:65]
v_pk_add_f32 v[98:99], v[98:99], v[66:67]
v_pk_add_f32 v[100:101], v[100:101], v[68:69]
v_pk_add_f32 v[102:103], v[102:103], v[70:71]
s_waitcnt vmcnt(5)
v_lshlrev_b32 v72, 16, v132
v_and_b32 v73, 0xffff0000, v132
v_lshlrev_b32 v74, 16, v133
v_and_b32 v75, 0xffff0000, v133
v_lshlrev_b32 v76, 16, v134
v_and_b32 v77, 0xffff0000, v134
v_lshlrev_b32 v78, 16, v135
v_and_b32 v79, 0xffff0000, v135
v_pk_add_f32 v[96:97], v[96:97], v[72:73]
v_pk_add_f32 v[98:99], v[98:99], v[74:75]
v_pk_add_f32 v[100:101], v[100:101], v[76:77]
v_pk_add_f32 v[102:103], v[102:103], v[78:79]
s_waitcnt vmcnt(4)
v_lshlrev_b32 v64, 16, v136
v_and_b32 v65, 0xffff0000, v136
v_lshlrev_b32 v66, 16, v137
v_and_b32 v67, 0xffff0000, v137
v_lshlrev_b32 v68, 16, v138
v_and_b32 v69, 0xffff0000, v138
v_lshlrev_b32 v70, 16, v139
v_and_b32 v71, 0xffff0000, v139
v_pk_add_f32 v[96:97], v[96:97], v[64:65]
v_pk_add_f32 v[98:99], v[98:99], v[66:67]
v_pk_add_f32 v[100:101], v[100:101], v[68:69]
v_pk_add_f32 v[102:103], v[102:103], v[70:71]
s_waitcnt vmcnt(3)
v_lshlrev_b32 v72, 16, v140
v_and_b32 v73, 0xffff0000, v140
v_lshlrev_b32 v74, 16, v141
v_and_b32 v75, 0xffff0000, v141
v_lshlrev_b32 v76, 16, v142
v_and_b32 v77, 0xffff0000, v142
v_lshlrev_b32 v78, 16, v143
v_and_b32 v79, 0xffff0000, v143
v_pk_add_f32 v[96:97], v[96:97], v[72:73]
v_pk_add_f32 v[98:99], v[98:99], v[74:75]
v_pk_add_f32 v[100:101], v[100:101], v[76:77]
v_pk_add_f32 v[102:103], v[102:103], v[78:79]
s_waitcnt vmcnt(2)
v_lshlrev_b32 v64, 16, v144
v_and_b32 v65, 0xffff0000, v144
v_lshlrev_b32 v66, 16, v145
v_and_b32 v67, 0xffff0000, v145
v_lshlrev_b32 v68, 16, v146
v_and_b32 v69, 0xffff0000, v146
v_lshlrev_b32 v70, 16, v147
v_and_b32 v71, 0xffff0000, v147
v_pk_add_f32 v[96:97], v[96:97], v[64:65]
v_pk_add_f32 v[98:99], v[98:99], v[66:67]
v_pk_add_f32 v[100:101], v[100:101], v[68:69]
v_pk_add_f32 v[102:103], v[102:103], v[70:71]
s_waitcnt vmcnt(1)
v_lshlrev_b32 v72, 16, v148
v_and_b32 v73, 0xffff0000, v148
v_lshlrev_b32 v74, 16, v149
v_and_b32 v75, 0xffff0000, v149
v_lshlrev_b32 v76, 16, v150
v_and_b32 v77, 0xffff0000, v150
v_lshlrev_b32 v78, 16, v151
v_and_b32 v79, 0xffff0000, v151
v_pk_add_f32 v[96:97], v[96:97], v[72:73]
v_pk_add_f32 v[98:99], v[98:99], v[74:75]
v_pk_add_f32 v[100:101], v[100:101], v[76:77]
v_pk_add_f32 v[102:103], v[102:103], v[78:79]
s_waitcnt vmcnt(0)
v_lshlrev_b32 v64, 16, v152
v_and_b32 v65, 0xffff0000, v152
v_lshlrev_b32 v66, 16, v153
v_and_b32 v67, 0xffff0000, v153
v_lshlrev_b32 v68, 16, v154
v_and_b32 v69, 0xffff0000, v154
v_lshlrev_b32 v70, 16, v155
v_and_b32 v71, 0xffff0000, v155
v_pk_add_f32 v[96:97], v[96:97], v[64:65]
v_pk_add_f32 v[98:99], v[98:99], v[66:67]
v_pk_add_f32 v[100:101], v[100:101], v[68:69]
v_pk_add_f32 v[102:103], v[102:103], v[70:71]
cP 96,96,97
cP 97,98,99
cP 98,100,101
cP 99,102,103
s_add_u32 s53, s58, 384
buffer_store_dwordx2 v[96:97], v54, s[8:11], s53 offen
buffer_store_dwordx2 v[98:99], v54, s[8:11], s53 offen offset:32
s_branch O8_fin
O8_p7:
aR 64,0
aR 65,1
aR 66,2
aR 67,3
aR 68,4
aR 69,5
aR 70,6
aR 71,7
cP 64,64,65
cP 65,66,67
cP 66,68,69
cP 67,70,71
buffer_store_dwordx4 v[64:67], v0, s[12:15], s55 offen offset:0 sc1
aR 72,8
aR 73,9
aR 74,10
aR 75,11
aR 76,12
aR 77,13
aR 78,14
aR 79,15
cP 72,72,73
cP 73,74,75
cP 74,76,77
cP 75,78,79
buffer_store_dwordx4 v[72:75], v0, s[12:15], s55 offen offset:1024 sc1
aR 80,16
aR 81,17
aR 82,18
aR 83,19
aR 84,20
aR 85,21
aR 86,22
aR 87,23
cP 80,80,81
cP 81,82,83
cP 82,84,85
cP 83,86,87
buffer_store_dwordx4 v[80:83], v0, s[12:15], s55 offen offset:2048 sc1
aR 88,24
aR 89,25
aR 90,26
aR 91,27
aR 92,28
aR 93,29
aR 94,30
aR 95,31
cP 88,88,89
cP 89,90,91
cP 90,92,93
cP 91,94,95
buffer_store_dwordx4 v[88:91], v0, s[12:15], s55 offen offset:3072 sc1
s_add_u32 s55, s55, 4096
aR 64,32
aR 65,33
aR 66,34
aR 67,35
aR 68,36
aR 69,37
aR 70,38
aR 71,39
cP 64,64,65
cP 65,66,67
cP 66,68,69
cP 67,70,71
buffer_store_dwordx4 v[64:67], v0, s[12:15], s55 offen offset:0 sc1
aR 72,40
aR 73,41
aR 74,42
aR 75,43
aR 76,44
aR 77,45
aR 78,46
aR 79,47
cP 72,72,73
cP 73,74,75
cP 74,76,77
cP 75,78,79
buffer_store_dwordx4 v[72:75], v0, s[12:15], s55 offen offset:1024 sc1
aR 80,48
aR 81,49
aR 82,50
aR 83,51
aR 84,52
aR 85,53
aR 86,54
aR 87,55
cP 80,80,81
cP 81,82,83
cP 82,84,85
cP 83,86,87
buffer_store_dwordx4 v[80:83], v0, s[12:15], s55 offen offset:2048 sc1
s_add_u32 s55, s55, 4096
aR 88,64
aR 89,65
aR 90,66
aR 91,67
aR 92,68
aR 93,69
aR 94,70
aR 95,71
cP 88,88,89
cP 89,90,91
cP 90,92,93
cP 91,94,95
buffer_store_dwordx4 v[88:91], v0, s[12:15], s55 offen offset:0 sc1
aR 64,72
aR 65,73
aR 66,74
aR 67,75
aR 68,76
aR 69,77
aR 70,78
aR 71,79
cP 64,64,65
cP 65,66,67
cP 66,68,69
cP 67,70,71
buffer_store_dwordx4 v[64:67], v0, s[12:15], s55 offen offset:1024 sc1
aR 72,80
aR 73,81
aR 74,82
aR 75,83
aR 76,84
aR 77,85
aR 78,86
aR 79,87
cP 72,72,73
cP 73,74,75
cP 74,76,77
cP 75,78,79
buffer_store_dwordx4 v[72:75], v0, s[12:15], s55 offen offset:2048 sc1
aR 80,88
aR 81,89
aR 82,90
aR 83,91
aR 84,92
aR 85,93
aR 86,94
aR 87,95
cP 80,80,81
cP 81,82,83
cP 82,84,85
cP 83,86,87
buffer_store_dwordx4 v[80:83], v0, s[12:15], s55 offen offset:3072 sc1
s_add_u32 s55, s55, 4096
aR 88,96
aR 89,97
aR 90,98
aR 91,99
aR 92,100
aR 93,101
aR 94,102
aR 95,103
cP 88,88,89
cP 89,90,91
cP 90,92,93
cP 91,94,95
buffer_store_dwordx4 v[88:91], v0, s[12:15], s55 offen offset:0 sc1
aR 64,104
aR 65,105
aR 66,106
aR 67,107
aR 68,108
aR 69,109
aR 70,110
aR 71,111
cP 64,64,65
cP 65,66,67
cP 66,68,69
cP 67,70,71
buffer_store_dwordx4 v[64:67], v0, s[12:15], s55 offen offset:1024 sc1
aR 96,56
aR 97,57
aR 98,58
aR 99,59
aR 100,60
aR 101,61
aR 102,62
aR 103,63
s_waitcnt vmcnt(0)
s_barrier
s_cmp_eq_u32 s3, 0
s_cbranch_scc0 O8_w7
buffer_atomic_add v53, v52, s[12:15], s56 offen
O8_poll7:
buffer_load_dword v56, v55, s[12:15], s56 offen sc1
s_waitcnt vmcnt(0)
v_readfirstlane_b32 s53, v56
s_nop 0
s_cmp_ge_u32 s53, 8
s_cbranch_scc1 O8_w7
s_sleep 4
s_branch O8_poll7
O8_w7:
s_barrier
s_add_u32 s55, s57, 7168
buffer_load_dwordx4 v[128:131], v0, s[12:15], s55 offen sc1
s_add_u32 s55, s57, 72704
buffer_load_dwordx4 v[132:135], v0, s[12:15], s55 offen sc1
s_add_u32 s55, s57, 138240
buffer_load_dwordx4 v[136:139], v0, s[12:15], s55 offen sc1
s_add_u32 s55, s57, 203776
buffer_load_dwordx4 v[140:143], v0, s[12:15], s55 offen sc1
s_add_u32 s55, s57, 269312
buffer_load_dwordx4 v[144:147], v0, s[12:15], s55 offen sc1
s_add_u32 s55, s57, 334848
buffer_load_dwordx4 v[148:151], v0, s[12:15], s55 offen sc1
s_add_u32 s55, s57, 400384
buffer_load_dwordx4 v[152:155], v0, s[12:15], s55 offen sc1
s_waitcnt vmcnt(6)
v_lshlrev_b32 v64, 16, v128
v_and_b32 v65, 0xffff0000, v128
v_lshlrev_b32 v66, 16, v129
v_and_b32 v67, 0xffff0000, v129
v_lshlrev_b32 v68, 16, v130
v_and_b32 v69, 0xffff0000, v130
v_lshlrev_b32 v70, 16, v131
v_and_b32 v71, 0xffff0000, v131
v_pk_add_f32 v[96:97], v[96:97], v[64:65]
v_pk_add_f32 v[98:99], v[98:99], v[66:67]
v_pk_add_f32 v[100:101], v[100:101], v[68:69]
v_pk_add_f32 v[102:103], v[102:103], v[70:71]
s_waitcnt vmcnt(5)
v_lshlrev_b32 v72, 16, v132
v_and_b32 v73, 0xffff0000, v132
v_lshlrev_b32 v74, 16, v133
v_and_b32 v75, 0xffff0000, v133
v_lshlrev_b32 v76, 16, v134
v_and_b32 v77, 0xffff0000, v134
v_lshlrev_b32 v78, 16, v135
v_and_b32 v79, 0xffff0000, v135
v_pk_add_f32 v[96:97], v[96:97], v[72:73]
v_pk_add_f32 v[98:99], v[98:99], v[74:75]
v_pk_add_f32 v[100:101], v[100:101], v[76:77]
v_pk_add_f32 v[102:103], v[102:103], v[78:79]
s_waitcnt vmcnt(4)
v_lshlrev_b32 v64, 16, v136
v_and_b32 v65, 0xffff0000, v136
v_lshlrev_b32 v66, 16, v137
v_and_b32 v67, 0xffff0000, v137
v_lshlrev_b32 v68, 16, v138
v_and_b32 v69, 0xffff0000, v138
v_lshlrev_b32 v70, 16, v139
v_and_b32 v71, 0xffff0000, v139
v_pk_add_f32 v[96:97], v[96:97], v[64:65]
v_pk_add_f32 v[98:99], v[98:99], v[66:67]
v_pk_add_f32 v[100:101], v[100:101], v[68:69]
v_pk_add_f32 v[102:103], v[102:103], v[70:71]
s_waitcnt vmcnt(3)
v_lshlrev_b32 v72, 16, v140
v_and_b32 v73, 0xffff0000, v140
v_lshlrev_b32 v74, 16, v141
v_and_b32 v75, 0xffff0000, v141
v_lshlrev_b32 v76, 16, v142
v_and_b32 v77, 0xffff0000, v142
v_lshlrev_b32 v78, 16, v143
v_and_b32 v79, 0xffff0000, v143
v_pk_add_f32 v[96:97], v[96:97], v[72:73]
v_pk_add_f32 v[98:99], v[98:99], v[74:75]
v_pk_add_f32 v[100:101], v[100:101], v[76:77]
v_pk_add_f32 v[102:103], v[102:103], v[78:79]
s_waitcnt vmcnt(2)
v_lshlrev_b32 v64, 16, v144
v_and_b32 v65, 0xffff0000, v144
v_lshlrev_b32 v66, 16, v145
v_and_b32 v67, 0xffff0000, v145
v_lshlrev_b32 v68, 16, v146
v_and_b32 v69, 0xffff0000, v146
v_lshlrev_b32 v70, 16, v147
v_and_b32 v71, 0xffff0000, v147
v_pk_add_f32 v[96:97], v[96:97], v[64:65]
v_pk_add_f32 v[98:99], v[98:99], v[66:67]
v_pk_add_f32 v[100:101], v[100:101], v[68:69]
v_pk_add_f32 v[102:103], v[102:103], v[70:71]
s_waitcnt vmcnt(1)
v_lshlrev_b32 v72, 16, v148
v_and_b32 v73, 0xffff0000, v148
v_lshlrev_b32 v74, 16, v149
v_and_b32 v75, 0xffff0000, v149
v_lshlrev_b32 v76, 16, v150
v_and_b32 v77, 0xffff0000, v150
v_lshlrev_b32 v78, 16, v151
v_and_b32 v79, 0xffff0000, v151
v_pk_add_f32 v[96:97], v[96:97], v[72:73]
v_pk_add_f32 v[98:99], v[98:99], v[74:75]
v_pk_add_f32 v[100:101], v[100:101], v[76:77]
v_pk_add_f32 v[102:103], v[102:103], v[78:79]
s_waitcnt vmcnt(0)
v_lshlrev_b32 v64, 16, v152
v_and_b32 v65, 0xffff0000, v152
v_lshlrev_b32 v66, 16, v153
v_and_b32 v67, 0xffff0000, v153
v_lshlrev_b32 v68, 16, v154
v_and_b32 v69, 0xffff0000, v154
v_lshlrev_b32 v70, 16, v155
v_and_b32 v71, 0xffff0000, v155
v_pk_add_f32 v[96:97], v[96:97], v[64:65]
v_pk_add_f32 v[98:99], v[98:99], v[66:67]
v_pk_add_f32 v[100:101], v[100:101], v[68:69]
v_pk_add_f32 v[102:103], v[102:103], v[70:71]
cP 96,96,97
cP 97,98,99
cP 98,100,101
cP 99,102,103
s_add_u32 s53, s58, 14336
buffer_store_dwordx2 v[96:97], v54, s[8:11], s53 offen
buffer_store_dwordx2 v[98:99], v54, s[8:11], s53 offen offset:32
s_branch O8_fin
O8_fin:
gated_mix__compressed_kv_cla__mixer_gmlp__prompt_kernel_end:
s_endpgm
gated_mix__compressed_kv_cla__mixer_gmlp__prompt_kernel_stop:
s_endpgm
.section .rodata,"a"
.p2align 6
.amdhsa_kernel gated_mix__compressed_kv_cla__mixer_gmlp__prompt_kernel
  .amdhsa_next_free_vgpr 512
  .amdhsa_next_free_sgpr 102
  .amdhsa_accum_offset 256
  .amdhsa_group_segment_fixed_size 0
  .amdhsa_kernarg_size 120
  .amdhsa_user_sgpr_count 2
  .amdhsa_user_sgpr_kernarg_segment_ptr 1
  .amdhsa_system_sgpr_workgroup_id_x 1
.end_amdhsa_kernel
.p2align 6
mega_jt:
.long 1537, 1536, 790016, 6, 1, 134400, 329493, 13, 0, 23, 0, 0, 0, 23, 0, 6
.long 1537, 1538, 790016, 38, 1, 134402, 329493, 45, 0, 23, 0, 0, 0, 23, 2, 6
.long 1537, 1540, 790016, 70, 1, 134404, 329493, 77, 0, 23, 0, 0, 0, 23, 4, 6
.long 1537, 1542, 790016, 102, 1, 134406, 329493, 109, 0, 23, 0, 0, 0, 23, 6, 6
.long 1537, 1544, 790016, 134, 1, 134408, 329493, 141, 0, 23, 0, 0, 0, 23, 8, 6
.long 1537, 1546, 790016, 166, 1, 134410, 329493, 173, 0, 23, 0, 0, 0, 23, 10, 6
.long 1537, 1548, 790016, 198, 1, 134412, 329493, 205, 0, 23, 0, 0, 0, 23, 12, 6
.long 1537, 1550, 790016, 230, 1, 134414, 329493, 237, 0, 23, 0, 0, 0, 23, 14, 6
.long 2, 256, 0, 0, 1, 256, 132096, 1, 0, 22, 0, 0, 0, 22, 1, 6
.long 2, 257, 0, 0, 1, 258, 132096, 33, 0, 22, 0, 0, 0, 22, 3, 6
.long 2, 258, 0, 0, 1, 260, 132096, 65, 0, 22, 0, 0, 0, 22, 5, 6
.long 2, 259, 0, 0, 1, 262, 132096, 97, 0, 22, 0, 0, 0, 22, 7, 6
.long 2, 260, 0, 0, 1, 264, 132096, 129, 0, 22, 0, 0, 0, 22, 9, 6
.long 2, 261, 0, 0, 1, 266, 132096, 161, 0, 22, 0, 0, 0, 22, 11, 6
.long 2, 262, 0, 0, 1, 268, 132096, 193, 0, 22, 0, 0, 0, 22, 13, 6
.long 2, 263, 0, 0, 1, 270, 132096, 225, 0, 22, 0, 0, 0, 22, 15, 6
.long 1537, 768, 395264, 3, 1, 1537, 790016, 22, 0, 5, 0, 0, 0, 5, 0, 3
.long 1537, 770, 395264, 35, 1, 1539, 790016, 54, 0, 5, 0, 0, 0, 5, 2, 3
.long 1537, 772, 395264, 67, 1, 1541, 790016, 86, 0, 5, 0, 0, 0, 5, 4, 3
.long 1537, 774, 395264, 99, 1, 1543, 790016, 118, 0, 5, 0, 0, 0, 5, 6, 3
.long 1537, 776, 395264, 131, 1, 1545, 790016, 150, 0, 5, 0, 0, 0, 5, 8, 3
.long 1537, 778, 395264, 163, 1, 1547, 790016, 182, 0, 5, 0, 0, 0, 5, 10, 3
.long 1537, 780, 395264, 195, 1, 1549, 790016, 214, 0, 5, 0, 0, 0, 5, 12, 3
.long 1537, 782, 395264, 227, 1, 1551, 790016, 246, 0, 5, 0, 0, 0, 5, 14, 3
.long 513, 68864, 1381632, 13, 0, 15, 0, 0, 0, 0, 0, 0, 0, 15, 0, 13
.long 513, 68866, 1381632, 45, 0, 15, 0, 0, 0, 0, 0, 0, 0, 15, 2, 13
.long 513, 68868, 1381632, 77, 0, 15, 0, 0, 0, 0, 0, 0, 0, 15, 4, 13
.long 513, 68870, 1381632, 109, 0, 15, 0, 0, 0, 0, 0, 0, 0, 15, 6, 13
.long 513, 68872, 1381632, 141, 0, 15, 0, 0, 0, 0, 0, 0, 0, 15, 8, 13
.long 513, 68874, 1381632, 173, 0, 15, 0, 0, 0, 0, 0, 0, 0, 15, 10, 13
.long 513, 68876, 1381632, 205, 0, 15, 0, 0, 0, 0, 0, 0, 0, 15, 12, 13
.long 513, 68878, 1381632, 237, 0, 15, 0, 0, 0, 0, 0, 0, 0, 15, 14, 13
.long 1537, 1280, 658432, 5, 1, 134656, 461077, 14, 0, 27, 0, 0, 0, 27, 0, 5
.long 1537, 1282, 658432, 37, 1, 134658, 461077, 46, 0, 27, 0, 0, 0, 27, 2, 5
.long 1537, 1284, 658432, 69, 1, 134660, 461077, 78, 0, 27, 0, 0, 0, 27, 4, 5
.long 1537, 1286, 658432, 101, 1, 134662, 461077, 110, 0, 27, 0, 0, 0, 27, 6, 5
.long 1537, 1288, 658432, 133, 1, 134664, 461077, 142, 0, 27, 0, 0, 0, 27, 8, 5
.long 1537, 1290, 658432, 165, 1, 134666, 461077, 174, 0, 27, 0, 0, 0, 27, 10, 5
.long 1537, 1292, 658432, 197, 1, 134668, 461077, 206, 0, 27, 0, 0, 0, 27, 12, 5
.long 1537, 1294, 658432, 229, 1, 134670, 461077, 238, 0, 27, 0, 0, 0, 27, 14, 5
.long 513, 69376, 1381632, 15, 0, 16, 0, 0, 0, 0, 0, 0, 0, 16, 0, 15
.long 513, 69378, 1381632, 47, 0, 16, 0, 0, 0, 0, 0, 0, 0, 16, 2, 15
.long 513, 69380, 1381632, 79, 0, 16, 0, 0, 0, 0, 0, 0, 0, 16, 4, 15
.long 513, 69382, 1381632, 111, 0, 16, 0, 0, 0, 0, 0, 0, 0, 16, 6, 15
.long 513, 69384, 1381632, 143, 0, 16, 0, 0, 0, 0, 0, 0, 0, 16, 8, 15
.long 513, 69386, 1381632, 175, 0, 16, 0, 0, 0, 0, 0, 0, 0, 16, 10, 15
.long 513, 69388, 1381632, 207, 0, 16, 0, 0, 0, 0, 0, 0, 0, 16, 12, 15
.long 513, 69390, 1381632, 239, 0, 16, 0, 0, 0, 0, 0, 0, 0, 16, 14, 15
.long 1537, 1281, 658432, 21, 1, 134401, 461075, 29, 0, 30, 0, 0, 0, 30, 1, 5
.long 1537, 1283, 658432, 53, 1, 134403, 461075, 61, 0, 30, 0, 0, 0, 30, 3, 5
.long 1537, 1285, 658432, 85, 1, 134405, 461075, 93, 0, 30, 0, 0, 0, 30, 5, 5
.long 1537, 1287, 658432, 117, 1, 134407, 461075, 125, 0, 30, 0, 0, 0, 30, 7, 5
.long 1537, 1289, 658432, 149, 1, 134409, 461075, 157, 0, 30, 0, 0, 0, 30, 9, 5
.long 1537, 1291, 658432, 181, 1, 134411, 461075, 189, 0, 30, 0, 0, 0, 30, 11, 5
.long 1537, 1293, 658432, 213, 1, 134413, 461075, 221, 0, 30, 0, 0, 0, 30, 13, 5
.long 1537, 1295, 658432, 245, 1, 134415, 461075, 253, 0, 30, 0, 0, 0, 30, 15, 5
.long 1537, 1025, 526848, 20, 1, 134913, 592661, 31, 0, 29, 0, 0, 0, 29, 1, 4
.long 1537, 1027, 526848, 52, 1, 134915, 592661, 63, 0, 29, 0, 0, 0, 29, 3, 4
.long 1537, 1029, 526848, 84, 1, 134917, 592661, 95, 0, 29, 0, 0, 0, 29, 5, 4
.long 1537, 1031, 526848, 116, 1, 134919, 592661, 127, 0, 29, 0, 0, 0, 29, 7, 4
.long 1537, 1033, 526848, 148, 1, 134921, 592661, 159, 0, 29, 0, 0, 0, 29, 9, 4
.long 1537, 1035, 526848, 180, 1, 134923, 592661, 191, 0, 29, 0, 0, 0, 29, 11, 4
.long 1537, 1037, 526848, 212, 1, 134925, 592661, 223, 0, 29, 0, 0, 0, 29, 13, 4
.long 1537, 1039, 526848, 244, 1, 134927, 592661, 255, 0, 29, 0, 0, 0, 29, 15, 4
.long 1537, 1024, 526848, 4, 1, 134912, 592661, 15, 0, 28, 0, 0, 0, 28, 0, 4
.long 1537, 1026, 526848, 36, 1, 134914, 592661, 47, 0, 28, 0, 0, 0, 28, 2, 4
.long 1537, 1028, 526848, 68, 1, 134916, 592661, 79, 0, 28, 0, 0, 0, 28, 4, 4
.long 1537, 1030, 526848, 100, 1, 134918, 592661, 111, 0, 28, 0, 0, 0, 28, 6, 4
.long 1537, 1032, 526848, 132, 1, 134920, 592661, 143, 0, 28, 0, 0, 0, 28, 8, 4
.long 1537, 1034, 526848, 164, 1, 134922, 592661, 175, 0, 28, 0, 0, 0, 28, 10, 4
.long 1537, 1036, 526848, 196, 1, 134924, 592661, 207, 0, 28, 0, 0, 0, 28, 12, 4
.long 1537, 1038, 526848, 228, 1, 134926, 592661, 239, 0, 28, 0, 0, 0, 28, 14, 4
.long 1537, 1792, 921600, 7, 1, 512, 263680, 2, 0, 25, 0, 0, 0, 25, 0, 7
.long 1537, 1794, 921600, 39, 1, 514, 263680, 34, 0, 25, 0, 0, 0, 25, 2, 7
.long 1537, 1796, 921600, 71, 1, 516, 263680, 66, 0, 25, 0, 0, 0, 25, 4, 7
.long 1537, 1798, 921600, 103, 1, 518, 263680, 98, 0, 25, 0, 0, 0, 25, 6, 7
.long 1537, 1800, 921600, 135, 1, 520, 263680, 130, 0, 25, 0, 0, 0, 25, 8, 7
.long 1537, 1802, 921600, 167, 1, 522, 263680, 162, 0, 25, 0, 0, 0, 25, 10, 7
.long 1537, 1804, 921600, 199, 1, 524, 263680, 194, 0, 25, 0, 0, 0, 25, 12, 7
.long 1537, 1806, 921600, 231, 1, 526, 263680, 226, 0, 25, 0, 0, 0, 25, 14, 7
.long 1537, 3072, 1579520, 12, 0, 13, 0, 0, 0, 0, 0, 0, 0, 13, 0, 12
.long 1537, 3074, 1579520, 44, 0, 13, 0, 0, 0, 0, 0, 0, 0, 13, 2, 12
.long 1537, 3076, 1579520, 76, 0, 13, 0, 0, 0, 0, 0, 0, 0, 13, 4, 12
.long 1537, 3078, 1579520, 108, 0, 13, 0, 0, 0, 0, 0, 0, 0, 13, 6, 12
.long 1537, 3080, 1579520, 140, 0, 13, 0, 0, 0, 0, 0, 0, 0, 13, 8, 12
.long 1537, 3082, 1579520, 172, 0, 13, 0, 0, 0, 0, 0, 0, 0, 13, 10, 12
.long 1537, 3084, 1579520, 204, 0, 13, 0, 0, 0, 0, 0, 0, 0, 13, 12, 12
.long 1537, 3086, 1579520, 236, 0, 13, 0, 0, 0, 0, 0, 0, 0, 13, 14, 12
.long 513, 69377, 1381632, 31, 0, 19, 0, 0, 0, 0, 0, 0, 0, 19, 1, 15
.long 513, 69379, 1381632, 63, 0, 19, 0, 0, 0, 0, 0, 0, 0, 19, 3, 15
.long 513, 69381, 1381632, 95, 0, 19, 0, 0, 0, 0, 0, 0, 0, 19, 5, 15
.long 513, 69383, 1381632, 127, 0, 19, 0, 0, 0, 0, 0, 0, 0, 19, 7, 15
.long 513, 69385, 1381632, 159, 0, 19, 0, 0, 0, 0, 0, 0, 0, 19, 9, 15
.long 513, 69387, 1381632, 191, 0, 19, 0, 0, 0, 0, 0, 0, 0, 19, 11, 15
.long 513, 69389, 1381632, 223, 0, 19, 0, 0, 0, 0, 0, 0, 0, 19, 13, 15
.long 513, 69391, 1381632, 255, 0, 19, 0, 0, 0, 0, 0, 0, 0, 19, 15, 15
.long 1537, 3073, 1579520, 28, 0, 12, 0, 0, 0, 0, 0, 0, 0, 12, 1, 12
.long 1537, 3075, 1579520, 60, 0, 12, 0, 0, 0, 0, 0, 0, 0, 12, 3, 12
.long 1537, 3077, 1579520, 92, 0, 12, 0, 0, 0, 0, 0, 0, 0, 12, 5, 12
.long 1537, 3079, 1579520, 124, 0, 12, 0, 0, 0, 0, 0, 0, 0, 12, 7, 12
.long 1537, 3081, 1579520, 156, 0, 12, 0, 0, 0, 0, 0, 0, 0, 12, 9, 12
.long 1537, 3083, 1579520, 188, 0, 12, 0, 0, 0, 0, 0, 0, 0, 12, 11, 12
.long 1537, 3085, 1579520, 220, 0, 12, 0, 0, 0, 0, 0, 0, 0, 12, 13, 12
.long 1537, 3087, 1579520, 252, 0, 12, 0, 0, 0, 0, 0, 0, 0, 12, 15, 12
.long 513, 69120, 1381632, 14, 0, 18, 0, 0, 0, 0, 0, 0, 0, 18, 0, 14
.long 513, 69122, 1381632, 46, 0, 18, 0, 0, 0, 0, 0, 0, 0, 18, 2, 14
.long 513, 69124, 1381632, 78, 0, 18, 0, 0, 0, 0, 0, 0, 0, 18, 4, 14
.long 513, 69126, 1381632, 110, 0, 18, 0, 0, 0, 0, 0, 0, 0, 18, 6, 14
.long 513, 69128, 1381632, 142, 0, 18, 0, 0, 0, 0, 0, 0, 0, 18, 8, 14
.long 513, 69130, 1381632, 174, 0, 18, 0, 0, 0, 0, 0, 0, 0, 18, 10, 14
.long 513, 69132, 1381632, 206, 0, 18, 0, 0, 0, 0, 0, 0, 0, 18, 12, 14
.long 513, 69134, 1381632, 238, 0, 18, 0, 0, 0, 0, 0, 0, 0, 18, 14, 14
.long 1537, 1793, 921600, 23, 1, 513, 263680, 18, 0, 24, 0, 0, 0, 24, 1, 7
.long 1537, 1795, 921600, 55, 1, 515, 263680, 50, 0, 24, 0, 0, 0, 24, 3, 7
.long 1537, 1797, 921600, 87, 1, 517, 263680, 82, 0, 24, 0, 0, 0, 24, 5, 7
.long 1537, 1799, 921600, 119, 1, 519, 263680, 114, 0, 24, 0, 0, 0, 24, 7, 7
.long 1537, 1801, 921600, 151, 1, 521, 263680, 146, 0, 24, 0, 0, 0, 24, 9, 7
.long 1537, 1803, 921600, 183, 1, 523, 263680, 178, 0, 24, 0, 0, 0, 24, 11, 7
.long 1537, 1805, 921600, 215, 1, 525, 263680, 210, 0, 24, 0, 0, 0, 24, 13, 7
.long 1537, 1807, 921600, 247, 1, 527, 263680, 242, 0, 24, 0, 0, 0, 24, 15, 7
.long 2, 1024, 0, 0, 1, 257, 132096, 17, 0, 26, 0, 0, 0, 26, 1, 2
.long 2, 1025, 0, 0, 1, 259, 132096, 49, 0, 26, 0, 0, 0, 26, 3, 2
.long 2, 1026, 0, 0, 1, 261, 132096, 81, 0, 26, 0, 0, 0, 26, 5, 2
.long 2, 1027, 0, 0, 1, 263, 132096, 113, 0, 26, 0, 0, 0, 26, 7, 2
.long 2, 1028, 0, 0, 1, 265, 132096, 145, 0, 26, 0, 0, 0, 26, 9, 2
.long 2, 1029, 0, 0, 1, 267, 132096, 177, 0, 26, 0, 0, 0, 26, 11, 2
.long 2, 1030, 0, 0, 1, 269, 132096, 209, 0, 26, 0, 0, 0, 26, 13, 2
.long 2, 1031, 0, 0, 1, 271, 132096, 241, 0, 26, 0, 0, 0, 26, 15, 2
.long 1537, 2304, 1184768, 9, 0, 21, 0, 0, 0, 0, 0, 0, 0, 21, 0, 9
.long 1537, 2306, 1184768, 41, 0, 21, 0, 0, 0, 0, 0, 0, 0, 21, 2, 9
.long 1537, 2308, 1184768, 73, 0, 21, 0, 0, 0, 0, 0, 0, 0, 21, 4, 9
.long 1537, 2310, 1184768, 105, 0, 21, 0, 0, 0, 0, 0, 0, 0, 21, 6, 9
.long 1537, 2312, 1184768, 137, 0, 21, 0, 0, 0, 0, 0, 0, 0, 21, 8, 9
.long 1537, 2314, 1184768, 169, 0, 21, 0, 0, 0, 0, 0, 0, 0, 21, 10, 9
.long 1537, 2316, 1184768, 201, 0, 21, 0, 0, 0, 0, 0, 0, 0, 21, 12, 9
.long 1537, 2318, 1184768, 233, 0, 21, 0, 0, 0, 0, 0, 0, 0, 21, 14, 9
.long 513, 68865, 1250048, 29, 0, 11, 0, 0, 0, 0, 0, 0, 0, 11, 1, 13
.long 513, 68867, 1250048, 61, 0, 11, 0, 0, 0, 0, 0, 0, 0, 11, 3, 13
.long 513, 68869, 1250048, 93, 0, 11, 0, 0, 0, 0, 0, 0, 0, 11, 5, 13
.long 513, 68871, 1250048, 125, 0, 11, 0, 0, 0, 0, 0, 0, 0, 11, 7, 13
.long 513, 68873, 1250048, 157, 0, 11, 0, 0, 0, 0, 0, 0, 0, 11, 9, 13
.long 513, 68875, 1250048, 189, 0, 11, 0, 0, 0, 0, 0, 0, 0, 11, 11, 13
.long 513, 68877, 1250048, 221, 0, 11, 0, 0, 0, 0, 0, 0, 0, 11, 13, 13
.long 513, 68879, 1250048, 253, 0, 11, 0, 0, 0, 0, 0, 0, 0, 11, 15, 13
.long 513, 69121, 1250048, 30, 0, 14, 0, 0, 0, 0, 0, 0, 0, 14, 1, 14
.long 513, 69123, 1250048, 62, 0, 14, 0, 0, 0, 0, 0, 0, 0, 14, 3, 14
.long 513, 69125, 1250048, 94, 0, 14, 0, 0, 0, 0, 0, 0, 0, 14, 5, 14
.long 513, 69127, 1250048, 126, 0, 14, 0, 0, 0, 0, 0, 0, 0, 14, 7, 14
.long 513, 69129, 1250048, 158, 0, 14, 0, 0, 0, 0, 0, 0, 0, 14, 9, 14
.long 513, 69131, 1250048, 190, 0, 14, 0, 0, 0, 0, 0, 0, 0, 14, 11, 14
.long 513, 69133, 1250048, 222, 0, 14, 0, 0, 0, 0, 0, 0, 0, 14, 13, 14
.long 513, 69135, 1250048, 254, 0, 14, 0, 0, 0, 0, 0, 0, 0, 14, 15, 14
.long 2, 1280, 0, 0, 1, 0, 512, 0, 0, 17, 0, 0, 0, 17, 1, 1
.long 2, 1281, 0, 0, 1, 2, 512, 32, 0, 17, 0, 0, 0, 17, 3, 1
.long 2, 1282, 0, 0, 1, 4, 512, 64, 0, 17, 0, 0, 0, 17, 5, 1
.long 2, 1283, 0, 0, 1, 6, 512, 96, 0, 17, 0, 0, 0, 17, 7, 1
.long 2, 1284, 0, 0, 1, 8, 512, 128, 0, 17, 0, 0, 0, 17, 9, 1
.long 2, 1285, 0, 0, 1, 10, 512, 160, 0, 17, 0, 0, 0, 17, 11, 1
.long 2, 1286, 0, 0, 1, 12, 512, 192, 0, 17, 0, 0, 0, 17, 13, 1
.long 2, 1287, 0, 0, 1, 14, 512, 224, 0, 17, 0, 0, 0, 17, 15, 1
.long 2, 1536, 0, 0, 0, 6, 0, 0, 0, 0, 0, 0, 0, 6, 1, 0
.long 2, 1537, 0, 0, 0, 6, 0, 0, 0, 0, 0, 0, 0, 6, 3, 0
.long 2, 1538, 0, 0, 0, 6, 0, 0, 0, 0, 0, 0, 0, 6, 5, 0
.long 2, 1539, 0, 0, 0, 6, 0, 0, 0, 0, 0, 0, 0, 6, 7, 0
.long 2, 1540, 0, 0, 0, 6, 0, 0, 0, 0, 0, 0, 0, 6, 9, 0
.long 2, 1541, 0, 0, 0, 6, 0, 0, 0, 0, 0, 0, 0, 6, 11, 0
.long 2, 1542, 0, 0, 0, 6, 0, 0, 0, 0, 0, 0, 0, 6, 13, 0
.long 2, 1543, 0, 0, 0, 6, 0, 0, 0, 0, 0, 0, 0, 6, 15, 0
.long 1537, 2816, 1447936, 11, 0, 31, 0, 0, 0, 0, 0, 0, 0, 31, 0, 11
.long 1537, 2818, 1447936, 43, 0, 31, 0, 0, 0, 0, 0, 0, 0, 31, 2, 11
.long 1537, 2820, 1447936, 75, 0, 31, 0, 0, 0, 0, 0, 0, 0, 31, 4, 11
.long 1537, 2822, 1447936, 107, 0, 31, 0, 0, 0, 0, 0, 0, 0, 31, 6, 11
.long 1537, 2824, 1447936, 139, 0, 31, 0, 0, 0, 0, 0, 0, 0, 31, 8, 11
.long 1537, 2826, 1447936, 171, 0, 31, 0, 0, 0, 0, 0, 0, 0, 31, 10, 11
.long 1537, 2828, 1447936, 203, 0, 31, 0, 0, 0, 0, 0, 0, 0, 31, 12, 11
.long 1537, 2830, 1447936, 235, 0, 31, 0, 0, 0, 0, 0, 0, 0, 31, 14, 11
.long 1537, 2817, 1447936, 27, 0, 4, 0, 0, 0, 0, 0, 0, 0, 4, 1, 11
.long 1537, 2819, 1447936, 59, 0, 4, 0, 0, 0, 0, 0, 0, 0, 4, 3, 11
.long 1537, 2821, 1447936, 91, 0, 4, 0, 0, 0, 0, 0, 0, 0, 4, 5, 11
.long 1537, 2823, 1447936, 123, 0, 4, 0, 0, 0, 0, 0, 0, 0, 4, 7, 11
.long 1537, 2825, 1447936, 155, 0, 4, 0, 0, 0, 0, 0, 0, 0, 4, 9, 11
.long 1537, 2827, 1447936, 187, 0, 4, 0, 0, 0, 0, 0, 0, 0, 4, 11, 11
.long 1537, 2829, 1447936, 219, 0, 4, 0, 0, 0, 0, 0, 0, 0, 4, 13, 11
.long 1537, 2831, 1447936, 251, 0, 4, 0, 0, 0, 0, 0, 0, 0, 4, 15, 11
.long 1537, 2048, 1053184, 8, 0, 9, 0, 0, 0, 0, 0, 0, 0, 9, 0, 8
.long 1537, 2050, 1053184, 40, 0, 9, 0, 0, 0, 0, 0, 0, 0, 9, 2, 8
.long 1537, 2052, 1053184, 72, 0, 9, 0, 0, 0, 0, 0, 0, 0, 9, 4, 8
.long 1537, 2054, 1053184, 104, 0, 9, 0, 0, 0, 0, 0, 0, 0, 9, 6, 8
.long 1537, 2056, 1053184, 136, 0, 9, 0, 0, 0, 0, 0, 0, 0, 9, 8, 8
.long 1537, 2058, 1053184, 168, 0, 9, 0, 0, 0, 0, 0, 0, 0, 9, 10, 8
.long 1537, 2060, 1053184, 200, 0, 9, 0, 0, 0, 0, 0, 0, 0, 9, 12, 8
.long 1537, 2062, 1053184, 232, 0, 9, 0, 0, 0, 0, 0, 0, 0, 9, 14, 8
.long 1537, 2305, 1184768, 25, 0, 20, 0, 0, 0, 0, 0, 0, 0, 20, 1, 9
.long 1537, 2307, 1184768, 57, 0, 20, 0, 0, 0, 0, 0, 0, 0, 20, 3, 9
.long 1537, 2309, 1184768, 89, 0, 20, 0, 0, 0, 0, 0, 0, 0, 20, 5, 9
.long 1537, 2311, 1184768, 121, 0, 20, 0, 0, 0, 0, 0, 0, 0, 20, 7, 9
.long 1537, 2313, 1184768, 153, 0, 20, 0, 0, 0, 0, 0, 0, 0, 20, 9, 9
.long 1537, 2315, 1184768, 185, 0, 20, 0, 0, 0, 0, 0, 0, 0, 20, 11, 9
.long 1537, 2317, 1184768, 217, 0, 20, 0, 0, 0, 0, 0, 0, 0, 20, 13, 9
.long 1537, 2319, 1184768, 249, 0, 20, 0, 0, 0, 0, 0, 0, 0, 20, 15, 9
.long 1537, 2561, 1316352, 26, 0, 1, 0, 0, 0, 0, 0, 0, 0, 1, 1, 10
.long 1537, 2563, 1316352, 58, 0, 1, 0, 0, 0, 0, 0, 0, 0, 1, 3, 10
.long 1537, 2565, 1316352, 90, 0, 1, 0, 0, 0, 0, 0, 0, 0, 1, 5, 10
.long 1537, 2567, 1316352, 122, 0, 1, 0, 0, 0, 0, 0, 0, 0, 1, 7, 10
.long 1537, 2569, 1316352, 154, 0, 1, 0, 0, 0, 0, 0, 0, 0, 1, 9, 10
.long 1537, 2571, 1316352, 186, 0, 1, 0, 0, 0, 0, 0, 0, 0, 1, 11, 10
.long 1537, 2573, 1316352, 218, 0, 1, 0, 0, 0, 0, 0, 0, 0, 1, 13, 10
.long 1537, 2575, 1316352, 250, 0, 1, 0, 0, 0, 0, 0, 0, 0, 1, 15, 10
.long 2, 512, 0, 0, 0, 7, 0, 0, 0, 0, 0, 0, 0, 7, 0, 2
.long 2, 513, 0, 0, 0, 7, 0, 0, 0, 0, 0, 0, 0, 7, 2, 2
.long 2, 514, 0, 0, 0, 7, 0, 0, 0, 0, 0, 0, 0, 7, 4, 2
.long 2, 515, 0, 0, 0, 7, 0, 0, 0, 0, 0, 0, 0, 7, 6, 2
.long 2, 516, 0, 0, 0, 7, 0, 0, 0, 0, 0, 0, 0, 7, 8, 2
.long 2, 517, 0, 0, 0, 7, 0, 0, 0, 0, 0, 0, 0, 7, 10, 2
.long 2, 518, 0, 0, 0, 7, 0, 0, 0, 0, 0, 0, 0, 7, 12, 2
.long 2, 519, 0, 0, 0, 7, 0, 0, 0, 0, 0, 0, 0, 7, 14, 2
.long 1537, 2049, 1053184, 24, 0, 10, 0, 0, 0, 0, 0, 0, 0, 10, 1, 8
.long 1537, 2051, 1053184, 56, 0, 10, 0, 0, 0, 0, 0, 0, 0, 10, 3, 8
.long 1537, 2053, 1053184, 88, 0, 10, 0, 0, 0, 0, 0, 0, 0, 10, 5, 8
.long 1537, 2055, 1053184, 120, 0, 10, 0, 0, 0, 0, 0, 0, 0, 10, 7, 8
.long 1537, 2057, 1053184, 152, 0, 10, 0, 0, 0, 0, 0, 0, 0, 10, 9, 8
.long 1537, 2059, 1053184, 184, 0, 10, 0, 0, 0, 0, 0, 0, 0, 10, 11, 8
.long 1537, 2061, 1053184, 216, 0, 10, 0, 0, 0, 0, 0, 0, 0, 10, 13, 8
.long 1537, 2063, 1053184, 248, 0, 10, 0, 0, 0, 0, 0, 0, 0, 10, 15, 8
.long 2, 0, 0, 0, 0, 8, 0, 0, 0, 0, 0, 0, 0, 8, 0, 1
.long 2, 1, 0, 0, 0, 8, 0, 0, 0, 0, 0, 0, 0, 8, 2, 1
.long 2, 2, 0, 0, 0, 8, 0, 0, 0, 0, 0, 0, 0, 8, 4, 1
.long 2, 3, 0, 0, 0, 8, 0, 0, 0, 0, 0, 0, 0, 8, 6, 1
.long 2, 4, 0, 0, 0, 8, 0, 0, 0, 0, 0, 0, 0, 8, 8, 1
.long 2, 5, 0, 0, 0, 8, 0, 0, 0, 0, 0, 0, 0, 8, 10, 1
.long 2, 6, 0, 0, 0, 8, 0, 0, 0, 0, 0, 0, 0, 8, 12, 1
.long 2, 7, 0, 0, 0, 8, 0, 0, 0, 0, 0, 0, 0, 8, 14, 1
.long 2, 768, 0, 0, 1, 1, 512, 16, 0, 2, 0, 0, 0, 2, 0, 0
.long 2, 769, 0, 0, 1, 3, 512, 48, 0, 2, 0, 0, 0, 2, 2, 0
.long 2, 770, 0, 0, 1, 5, 512, 80, 0, 2, 0, 0, 0, 2, 4, 0
.long 2, 771, 0, 0, 1, 7, 512, 112, 0, 2, 0, 0, 0, 2, 6, 0
.long 2, 772, 0, 0, 1, 9, 512, 144, 0, 2, 0, 0, 0, 2, 8, 0
.long 2, 773, 0, 0, 1, 11, 512, 176, 0, 2, 0, 0, 0, 2, 10, 0
.long 2, 774, 0, 0, 1, 13, 512, 208, 0, 2, 0, 0, 0, 2, 12, 0
.long 2, 775, 0, 0, 1, 15, 512, 240, 0, 2, 0, 0, 0, 2, 14, 0
.long 1537, 769, 395264, 19, 1, 134657, 592659, 30, 0, 3, 0, 0, 0, 3, 1, 3
.long 1537, 771, 395264, 51, 1, 134659, 592659, 62, 0, 3, 0, 0, 0, 3, 3, 3
.long 1537, 773, 395264, 83, 1, 134661, 592659, 94, 0, 3, 0, 0, 0, 3, 5, 3
.long 1537, 775, 395264, 115, 1, 134663, 592659, 126, 0, 3, 0, 0, 0, 3, 7, 3
.long 1537, 777, 395264, 147, 1, 134665, 592659, 158, 0, 3, 0, 0, 0, 3, 9, 3
.long 1537, 779, 395264, 179, 1, 134667, 592659, 190, 0, 3, 0, 0, 0, 3, 11, 3
.long 1537, 781, 395264, 211, 1, 134669, 592659, 222, 0, 3, 0, 0, 0, 3, 13, 3
.long 1537, 783, 395264, 243, 1, 134671, 592659, 254, 0, 3, 0, 0, 0, 3, 15, 3
.long 1537, 2560, 1316352, 10, 0, 0, 0, 0, 0, 0, 0, 0, 0, 0, 0, 10
.long 1537, 2562, 1316352, 42, 0, 0, 0, 0, 0, 0, 0, 0, 0, 0, 2, 10
.long 1537, 2564, 1316352, 74, 0, 0, 0, 0, 0, 0, 0, 0, 0, 0, 4, 10
.long 1537, 2566, 1316352, 106, 0, 0, 0, 0, 0, 0, 0, 0, 0, 0, 6, 10
.long 1537, 2568, 1316352, 138, 0, 0, 0, 0, 0, 0, 0, 0, 0, 0, 8, 10
.long 1537, 2570, 1316352, 170, 0, 0, 0, 0, 0, 0, 0, 0, 0, 0, 10, 10
.long 1537, 2572, 1316352, 202, 0, 0, 0, 0, 0, 0, 0, 0, 0, 0, 12, 10
.long 1537, 2574, 1316352, 234, 0, 0, 0, 0, 0, 0, 0, 0, 0, 0, 14, 10
```
